```python
import torch

def _softmax(x, axis=-1):
    return torch.softmax(x, dim=axis)
def _gelu(x):
    return torch.nn.functional.gelu(x, approximate="tanh")
def _silu(x):
    return torch.nn.functional.silu(x)
def _sigmoid(x):
    return torch.sigmoid(x)
def _layernorm(x, axis=-1, eps=1e-5):
    m = x.mean(dim=axis, keepdim=True)
    v = x.var(dim=axis, keepdim=True, unbiased=False)
    return (x - m) / torch.sqrt(v + eps)
def _scatter_add(tgt, idx, src, axis=0):
    return tgt.clone().index_add_(axis, idx, src)
def _segment_sum(src, seg, n):
    out = torch.zeros((n,) + src.shape[1:], dtype=src.dtype)
    return out.index_add_(0, seg, src)
def _pad(x, pw):
    flat = tuple(v for pair in reversed(pw) for v in pair)
    return torch.nn.functional.pad(x, flat)

kernel_name = 'parallel_sum__ssm_conv_s5__geglu_ffn__prompt'

def setup_inputs():

    _w = (lambda a: (lambda t: t.to(torch.bfloat16) if t.is_floating_point() else t)(torch.as_tensor(a)))
    def _A_setup():
        B, S, D = 1, 2048, 1024
        P = D
        Lambda_re = -0.5 * (lambda _x: torch.exp(torch.as_tensor(_x)))((lambda *s: torch.randn(*s, dtype=torch.bfloat16) * 0.8)(P))
        Lambda_im = (lambda *s: torch.randn(*s, dtype=torch.bfloat16) * 0.8)(P) * 1.0
        B_re = (lambda *s: torch.randn(*s, dtype=torch.bfloat16) * 1.6)(P, D) * (D ** -0.5)
        B_im = (lambda *s: torch.randn(*s, dtype=torch.bfloat16) * 1.6)(P, D) * (D ** -0.5)
        C_re = (lambda *s: torch.randn(*s, dtype=torch.bfloat16) * 1.6)(D, P) * (P ** -0.5)
        C_im = (lambda *s: torch.randn(*s, dtype=torch.bfloat16) * 1.6)(D, P) * (P ** -0.5)
        log_dt = (lambda *s: torch.randn(*s, dtype=torch.bfloat16) * 0.8)(P) * 0.3 - 2.0
        Dskip = (lambda *s: torch.randn(*s, dtype=torch.bfloat16) * 0.4)(D)
        return {
            "x": _w((lambda *s: torch.randn(*s, dtype=torch.bfloat16) * 0.05)(B, S, D)),
            "Lambda_re": _w(Lambda_re),
            "Lambda_im": _w(Lambda_im),
            "B_re": _w(B_re),
            "B_im": _w(B_im),
            "C_re": _w(C_re),
            "C_im": _w(C_im),
            "log_dt": _w(log_dt),
            "Dskip": _w(Dskip),
        }
    _A_in = _A_setup()

    def _B_setup():
        B, S, D, F = 1, 2048, 1024, 3584
        return {
            "x": _w((lambda *s: torch.randn(*s, dtype=torch.bfloat16) * 0.05)(B, S, D)),
            "w_gate": _w((lambda *s: torch.randn(*s, dtype=torch.bfloat16) * 0.05)(D, F)),
            "w_up": _w((lambda *s: torch.randn(*s, dtype=torch.bfloat16) * 0.05)(D, F)),
            "w_down": _w((lambda *s: torch.randn(*s, dtype=torch.bfloat16) * 0.05)(F, D)),
        }
    _B_in = _B_setup()

    return {
        "A_x": _A_in["x"],
        "A_Lambda_re": _A_in["Lambda_re"],
        "A_Lambda_im": _A_in["Lambda_im"],
        "A_B_re": _A_in["B_re"],
        "A_B_im": _A_in["B_im"],
        "A_C_re": _A_in["C_re"],
        "A_C_im": _A_in["C_im"],
        "A_log_dt": _A_in["log_dt"],
        "A_Dskip": _A_in["Dskip"],
        "B_x": _B_in["x"],
        "B_w_gate": _B_in["w_gate"],
        "B_w_up": _B_in["w_up"],
        "B_w_down": _B_in["w_down"],
    }

def reference(A_x, A_Lambda_re, A_Lambda_im, A_B_re, A_B_im, A_C_re, A_C_im, A_log_dt, A_Dskip, B_x, B_w_gate, B_w_up, B_w_down):
    def _A_ref(x, Lambda_re, Lambda_im, B_re, B_im, C_re, C_im, log_dt, Dskip):
        Bsz, L, H = x.shape
        Lam = Lambda_re + 1j * Lambda_im
        Bmat = B_re + 1j * B_im
        Cmat = C_re + 1j * C_im
        dt = torch.exp(log_dt)
        Lam_bar = torch.exp(dt * Lam)
        B_bar = ((Lam_bar - 1.0) / Lam)[:, None] * Bmat
        Bu = torch.einsum("bld,pd->blp", x + 0j, B_bar)
        h = torch.zeros_like(Bu[:, 0, :])
        hs = []
        for t in range(L):
            h = Lam_bar[None, :] * h + Bu[:, t, :]
            hs.append(h)
        hseq = torch.stack(hs, 1)
        y = 2.0 * torch.einsum("blp,dp->bld", hseq, Cmat).real + x * Dskip[None, None, :]
        return y

    def _B_ref(x, w_gate, w_up, w_down):
        return (_gelu(x @ w_gate) * (x @ w_up)) @ w_down

    x = A_x
    xn = _layernorm(x, axis=-1)
    return x + _A_ref(xn, A_Lambda_re, A_Lambda_im, A_B_re, A_B_im, A_C_re, A_C_im, A_log_dt, A_Dskip) + _B_ref(xn, B_w_gate, B_w_up, B_w_down)
```

```asm
; @launch grid=(256,1,1) block=(256,1,1) lds=163840
.amdgcn_target "amdgcn-amd-amdhsa--gfx950"
.text
.globl parallel_sum__ssm_conv_s5__geglu_ffn__prompt_kernel
.p2align 8
.type parallel_sum__ssm_conv_s5__geglu_ffn__prompt_kernel,@function
parallel_sum__ssm_conv_s5__geglu_ffn__prompt_kernel:
s_cmp_ge_u32 s2, 256
s_cbranch_scc1 L_end
s_load_dwordx16 s[64:79], s[0:1], 0
s_load_dwordx16 s[80:95], s[0:1], 64
s_getpc_b64 s[96:97]
L_pc:
s_add_u32 s96, s96, L_main-L_pc
s_addc_u32 s97, s97, 0
v_lshrrev_b32 v56, 6, v0
s_lshr_b32 s44, s2, 3
s_lshl_b32 s44, s44, 7
v_lshl_add_u32 v57, v56, 12, s44
v_bfe_u32 v58, v0, 4, 2
v_min_u32 v58, 2, v58
v_lshl_add_u32 v57, v58, 14, v57
global_load_dword v19, v57, s[96:97]
v_and_b32 v1, 63, v0
v_readfirstlane_b32 s3, v56
s_bfe_u32 s4, s2, 0x30003
s_lshr_b32 s44, s2, 6
s_and_b32 s5, s2, 7
s_lshl_b32 s5, s5, 2
s_add_u32 s5, s5, s44
s_lshl_b32 s6, s4, 2
s_add_u32 s6, s6, s3
v_and_b32 v61, 7, v1
v_lshrrev_b32 v62, 4, v1
v_xor_b32 v61, v61, v62
v_lshlrev_b32 v61, 4, v61
v_lshrrev_b32 v62, 3, v1
s_lshl_b32 s44, s6, 17
v_lshl_add_u32 v2, v62, 13, v61
v_add_u32 v2, s44, v2
v_xor_b32 v3, 64, v2
v_add_u32 v3, 65536, v3
s_lshr_b32 s62, s3, 1
s_and_b32 s63, s3, 1
s_lshl_b32 s44, s5, 1
s_add_u32 s44, s44, s62
s_lshl_b32 s44, s44, 15
v_lshl_add_u32 v4, v62, 11, v61
v_add_u32 v4, s44, v4
v_xor_b32 v5, 64, v4
v_add_u32 v5, 16384, v5
s_mul_i32 s45, s62, 229376
s_lshr_b32 s44, s5, 1
s_mul_i32 s44, s44, 448
s_add_u32 s45, s45, s44
s_and_b32 s47, s5, 1
s_lshl_b32 s46, s47, 4
s_sub_u32 s47, s47, 12
v_add_u32 v56, 0, v1
v_mul_u32_u24 v57, 4682, v56
v_lshrrev_b32 v57, 16, v57
v_mul_u32_u24 v58, 14, v57
v_sub_u32 v58, v56, v58
v_add_u32 v59, s46, v58
v_lshl_add_u32 v60, v58, 1, s47
v_cmp_gt_u32 vcc, 12, v58
v_lshrrev_b32 v56, 1, v57
v_xor_b32 v56, v56, v57
v_cndmask_b32 v59, v60, v59, vcc
v_and_b32 v56, 4, v56
v_mul_u32_u24 v56, 3, v56
v_xor_b32 v56, v56, v57
v_mul_u32_u24 v56, 7168, v56
v_lshl_add_u32 v56, v59, 4, v56
v_add_u32 v6, s45, v56
s_mul_i32 s44, s62, -28
s_lshl_b32 s101, s4, 3
s_add_u32 s44, s44, s101
s_mul_i32 s44, s44, 7168
v_add_u32 v18, s44, v6
s_lshl_b32 s49, s3, 13
s_lshl_b32 s51, s63, 12
s_lshl_b32 s44, s62, 11
s_add_u32 s51, s51, s44
s_add_u32 s51, s51, 122880
s_mov_b32 s10, 4194304
s_mov_b32 s11, 0x20000
s_mov_b32 s14, 7340032
s_mov_b32 s15, 0x20000
s_mov_b32 s18, 2097152
s_mov_b32 s19, 0x20000
s_lshr_b32 s60, s2, 6
s_lshl_b32 s60, s60, 11
s_cmp_eq_u32 s63, 1
s_waitcnt lgkmcnt(0)
s_cselect_b64 s[12:13], s[86:87], s[84:85]
s_cselect_b64 s[16:17], s[72:73], s[70:71]
s_mov_b64 s[8:9], s[64:65]
s_mov_b64 s[82:83], s[96:97]
s_mov_b32 s101, 0
buffer_load_dwordx4 v[24:27], v18, s[12:15], s101 offen
s_xor_b32 s98, s60, 0
s_add_u32 m0, s49, s98
s_nop 0
buffer_load_dwordx4 v2, s[8:11], s98 offen lds
s_add_u32 m0, m0, 1024
s_nop 0
buffer_load_dwordx4 v3, s[8:11], s98 offen lds
s_add_u32 m0, s51, 0
s_mov_b32 s100, 0
buffer_load_dwordx4 v4, s[16:19], s100 offen lds
s_add_u32 m0, s51, 1024
s_nop 0
buffer_load_dwordx4 v5, s[16:19], s100 offen lds
s_mov_b32 s101, 458752
buffer_load_dwordx4 v[28:31], v18, s[12:15], s101 offen
v_and_b32 v20, 15, v1
s_lshl_b32 s44, s5, 5
v_add_lshl_u32 v20, v20, s44, 1
s_lshr_b32 s44, s2, 5
s_lshl_b32 s44, s44, 8
s_and_b32 s61, s2, 6
s_lshl_b32 s61, s61, 5
s_add_u32 s44, s44, s61
v_and_b32 v21, 7, v1
v_lshl_add_u32 v21, v21, 3, s44
v_mov_b32 v48, 0
v_mov_b32 v49, 0
v_mov_b32 v50, 0
v_mov_b32 v51, 0
s_mul_i32 s50, s63, 14336
s_mul_i32 s44, s62, 7168
s_add_u32 s50, s50, s44
s_add_u32 s50, s50, 65536
v_mfma_f32_32x32x16_bf16 a[80:95], v[48:51], v[48:51], 0
v_add_u32 v56, 64, v1
v_mul_u32_u24 v57, 4682, v56
v_lshrrev_b32 v57, 16, v57
global_load_dwordx2 a[152:153], v21, s[80:81]
v_mul_u32_u24 v58, 14, v57
v_sub_u32 v58, v56, v58
v_add_u32 v59, s46, v58
v_mfma_f32_32x32x16_bf16 a[64:79], v[48:51], v[48:51], 0
v_lshl_add_u32 v60, v58, 1, s47
v_cmp_gt_u32 vcc, 12, v58
v_lshrrev_b32 v56, 1, v57
v_xor_b32 v56, v56, v57
v_cndmask_b32 v59, v60, v59, vcc
global_load_ushort a159, v20, s[78:79] offset:32
v_and_b32 v56, 4, v56
v_mfma_f32_32x32x16_bf16 a[48:63], v[48:51], v[48:51], 0
v_mul_u32_u24 v56, 3, v56
v_xor_b32 v56, v56, v57
v_mul_u32_u24 v56, 7168, v56
v_lshl_add_u32 v56, v59, 4, v56
v_add_u32 v7, s45, v56
v_mfma_f32_32x32x16_bf16 a[32:47], v[48:51], v[48:51], 0
v_add_u32 v56, 128, v1
v_mul_u32_u24 v57, 4682, v56
v_lshrrev_b32 v57, 16, v57
global_load_ushort a158, v20, s[78:79] offset:0
v_mul_u32_u24 v58, 14, v57
v_sub_u32 v58, v56, v58
v_add_u32 v59, s46, v58
v_mfma_f32_32x32x16_bf16 a[16:31], v[48:51], v[48:51], 0
v_lshl_add_u32 v60, v58, 1, s47
v_cmp_gt_u32 vcc, 12, v58
v_lshrrev_b32 v56, 1, v57
v_xor_b32 v56, v56, v57
v_cndmask_b32 v59, v60, v59, vcc
global_load_ushort a157, v20, s[68:69] offset:32
v_and_b32 v56, 4, v56
v_mfma_f32_32x32x16_bf16 a[0:15], v[48:51], v[48:51], 0
v_mul_u32_u24 v56, 3, v56
v_xor_b32 v56, v56, v57
v_mul_u32_u24 v56, 7168, v56
v_lshl_add_u32 v56, v59, 4, v56
v_add_u32 v8, s45, v56
v_mfma_f32_32x32x16_bf16 v[240:255], v[48:51], v[48:51], 0
v_add_u32 v56, 192, v1
v_mul_u32_u24 v57, 4682, v56
v_lshrrev_b32 v57, 16, v57
global_load_ushort a156, v20, s[68:69] offset:0
v_mul_u32_u24 v58, 14, v57
v_sub_u32 v58, v56, v58
v_add_u32 v59, s46, v58
v_mfma_f32_32x32x16_bf16 v[224:239], v[48:51], v[48:51], 0
v_lshl_add_u32 v60, v58, 1, s47
v_cmp_gt_u32 vcc, 12, v58
v_lshrrev_b32 v56, 1, v57
v_xor_b32 v56, v56, v57
v_cndmask_b32 v59, v60, v59, vcc
global_load_ushort a155, v20, s[66:67] offset:32
v_and_b32 v56, 4, v56
v_mfma_f32_32x32x16_bf16 v[208:223], v[48:51], v[48:51], 0
v_mul_u32_u24 v56, 3, v56
v_xor_b32 v56, v56, v57
v_mul_u32_u24 v56, 7168, v56
v_lshl_add_u32 v56, v59, 4, v56
v_add_u32 v9, s45, v56
v_mfma_f32_32x32x16_bf16 v[192:207], v[48:51], v[48:51], 0
v_add_u32 v56, 256, v1
v_mul_u32_u24 v57, 4682, v56
v_lshrrev_b32 v57, 16, v57
global_load_ushort a154, v20, s[66:67] offset:0
v_mul_u32_u24 v58, 14, v57
v_sub_u32 v58, v56, v58
v_add_u32 v59, s46, v58
v_mfma_f32_32x32x16_bf16 v[176:191], v[48:51], v[48:51], 0
v_lshl_add_u32 v60, v58, 1, s47
v_cmp_gt_u32 vcc, 12, v58
v_lshrrev_b32 v56, 1, v57
v_xor_b32 v56, v56, v57
v_cndmask_b32 v59, v60, v59, vcc
v_and_b32 v56, 4, v56
v_mfma_f32_32x32x16_bf16 v[160:175], v[48:51], v[48:51], 0
v_mul_u32_u24 v56, 3, v56
v_xor_b32 v56, v56, v57
v_mul_u32_u24 v56, 7168, v56
v_lshl_add_u32 v56, v59, 4, v56
v_add_u32 v10, s45, v56
v_mfma_f32_32x32x16_bf16 v[144:159], v[48:51], v[48:51], 0
v_add_u32 v56, 320, v1
v_mul_u32_u24 v57, 4682, v56
v_lshrrev_b32 v57, 16, v57
v_mul_u32_u24 v58, 14, v57
v_sub_u32 v58, v56, v58
v_add_u32 v59, s46, v58
v_mfma_f32_32x32x16_bf16 v[128:143], v[48:51], v[48:51], 0
v_lshl_add_u32 v60, v58, 1, s47
v_cmp_gt_u32 vcc, 12, v58
v_lshrrev_b32 v56, 1, v57
v_xor_b32 v56, v56, v57
v_cndmask_b32 v59, v60, v59, vcc
v_and_b32 v56, 4, v56
v_mfma_f32_32x32x16_bf16 v[112:127], v[48:51], v[48:51], 0
v_mul_u32_u24 v56, 3, v56
v_xor_b32 v56, v56, v57
v_mul_u32_u24 v56, 7168, v56
v_lshl_add_u32 v56, v59, 4, v56
v_add_u32 v11, s45, v56
v_mfma_f32_32x32x16_bf16 v[96:111], v[48:51], v[48:51], 0
v_add_u32 v56, 384, v1
v_mul_u32_u24 v57, 4682, v56
v_lshrrev_b32 v57, 16, v57
v_mul_u32_u24 v58, 14, v57
v_sub_u32 v58, v56, v58
v_add_u32 v59, s46, v58
v_mfma_f32_32x32x16_bf16 v[80:95], v[48:51], v[48:51], 0
v_lshl_add_u32 v60, v58, 1, s47
v_cmp_gt_u32 vcc, 12, v58
v_lshrrev_b32 v56, 1, v57
v_xor_b32 v56, v56, v57
v_cndmask_b32 v59, v60, v59, vcc
v_and_b32 v56, 4, v56
v_mfma_f32_32x32x16_bf16 v[64:79], v[48:51], v[48:51], 0
v_mul_u32_u24 v56, 3, v56
v_xor_b32 v56, v56, v57
v_mul_u32_u24 v56, 7168, v56
v_lshl_add_u32 v56, v59, 4, v56
v_add_u32 v12, s45, v56
s_xor_b32 s98, s60, 2048
s_add_u32 m0, s49, s98
s_nop 0
buffer_load_dwordx4 v2, s[8:11], s98 offen lds
s_add_u32 m0, m0, 1024
s_nop 0
buffer_load_dwordx4 v3, s[8:11], s98 offen lds
s_xor_b32 s98, s60, 4096
s_add_u32 m0, s49, s98
s_nop 0
buffer_load_dwordx4 v2, s[8:11], s98 offen lds
s_add_u32 m0, m0, 1024
s_nop 0
buffer_load_dwordx4 v3, s[8:11], s98 offen lds
s_xor_b32 s98, s60, 6144
s_add_u32 m0, s49, s98
s_nop 0
buffer_load_dwordx4 v2, s[8:11], s98 offen lds
s_add_u32 m0, m0, 1024
s_nop 0
buffer_load_dwordx4 v3, s[8:11], s98 offen lds
s_add_u32 m0, s50, 0
s_mov_b32 s99, 0
buffer_load_dwordx4 v6, s[12:15], s99 offen  lds
s_add_u32 m0, s50, 1024
s_nop 0
buffer_load_dwordx4 v7, s[12:15], s99 offen  lds
s_add_u32 m0, s50, 2048
s_nop 0
buffer_load_dwordx4 v8, s[12:15], s99 offen  lds
s_add_u32 m0, s50, 3072
s_nop 0
buffer_load_dwordx4 v9, s[12:15], s99 offen  lds
s_add_u32 m0, s50, 4096
s_nop 0
buffer_load_dwordx4 v10, s[12:15], s99 offen  lds
s_add_u32 m0, s50, 5120
s_nop 0
buffer_load_dwordx4 v11, s[12:15], s99 offen  lds
s_add_u32 m0, s50, 6144
s_nop 0
buffer_load_dwordx4 v12, s[12:15], s99 offen  lds
v_and_b32 v56, 15, v1
v_lshrrev_b32 v57, 1, v56
v_lshrrev_b32 v58, 4, v1
v_xor_b32 v57, v57, v58
v_lshlrev_b32 v57, 4, v57
v_lshl_add_u32 v56, v56, 7, v57
v_add_u32 v13, s49, v56
v_xor_b32 v14, 64, v13
v_add_u32 v15, 122880, v56
v_xor_b32 v16, 64, v15
v_lshrrev_b32 v56, 5, v1
v_lshlrev_b32 v56, 4, v56
v_bfe_u32 v57, v1, 2, 3
v_add_u32 v56, v56, v57
v_mul_u32_u24 v56, 224, v56
v_and_b32 v57, 3, v1
v_lshl_add_u32 v56, v57, 3, v56
v_add_u32 v17, 65536, v56
s_mov_b64 exec, 0
s_cmp_eq_u32 s3, 1
s_cbranch_scc1 L_pg1
s_cmp_eq_u32 s3, 2
s_cbranch_scc1 L_pg2
s_cmp_eq_u32 s3, 3
s_cbranch_scc1 L_pg3
s_branch L_pg0
L_ret0:
s_mov_b64 exec, -1
s_add_u32 m0, s49, 32768
s_mov_b32 s98, 128
buffer_load_dwordx4 v2, s[8:11], s98 offen lds
s_add_u32 m0, s49, 33792
s_nop 0
buffer_load_dwordx4 v3, s[8:11], s98 offen lds
s_add_u32 m0, s49, 34816
s_mov_b32 s98, 2176
buffer_load_dwordx4 v2, s[8:11], s98 offen lds
s_add_u32 m0, s49, 35840
s_nop 0
buffer_load_dwordx4 v3, s[8:11], s98 offen lds
s_add_u32 m0, s49, 36864
s_mov_b32 s98, 4224
buffer_load_dwordx4 v2, s[8:11], s98 offen lds
s_add_u32 m0, s49, 37888
s_nop 0
buffer_load_dwordx4 v3, s[8:11], s98 offen lds
s_add_u32 m0, s49, 38912
s_mov_b32 s98, 6272
buffer_load_dwordx4 v2, s[8:11], s98 offen lds
s_add_u32 m0, s49, 39936
s_nop 0
buffer_load_dwordx4 v3, s[8:11], s98 offen lds
s_branch L_main
.p2align 12
L_main:
L_pg0:
s_cbranch_execz L_pg4
s_waitcnt vmcnt(8)
s_barrier
ds_read_b128 a[96:99], v13 offset:0
ds_read_b128 a[100:103], v13 offset:2048
ds_read_b128 a[104:107], v13 offset:4096
ds_read_b128 a[108:111], v13 offset:6144
ds_read_b128 a[128:131], v15 offset:0
ds_read_b128 a[132:135], v15 offset:2048
ds_read_b128 a[136:139], v15 offset:4096
ds_read_b128 a[140:143], v15 offset:6144
ds_read_b64_tr_b16 a[144:145], v17 offset:0
ds_read_b64_tr_b16 a[146:147], v17 offset:1792
s_waitcnt lgkmcnt(4)
v_mfma_f32_16x16x32_bf16 a[32:35], a[96:99], a[128:131], a[32:35]
ds_read_b64_tr_b16 a[148:149], v17 offset:14336
v_mov_b32_e64 v40, 0
v_mfma_f32_16x16x32_bf16 a[36:39], a[100:103], a[128:131], a[36:39]
ds_read_b64_tr_b16 a[150:151], v17 offset:16128
v_mov_b32 v41, 0
v_mfma_f32_16x16x32_bf16 a[40:43], a[104:107], a[128:131], a[40:43]
v_mov_b32 v42, 0
v_mov_b32_e64 v43, 0
v_mfma_f32_16x16x32_bf16 a[44:47], a[108:111], a[128:131], a[44:47]
v_mov_b32 v44, 0
v_mfma_f32_16x16x32_bf16 a[60:63], a[108:111], a[132:135], a[60:63]
ds_read_b64_tr_b16 a[128:129], v17 offset:32
v_mov_b32 v45, 0
v_mfma_f32_16x16x32_bf16 a[56:59], a[104:107], a[132:135], a[56:59]
ds_read_b64_tr_b16 a[130:131], v17 offset:1824
v_mov_b32_e64 v46, 0
v_mfma_f32_16x16x32_bf16 a[52:55], a[100:103], a[132:135], a[52:55]
ds_read_b128 a[112:115], v14 offset:0
v_mov_b32 v47, 0
v_mfma_f32_16x16x32_bf16 a[48:51], a[96:99], a[132:135], a[48:51]
s_waitcnt lgkmcnt(7)
v_mfma_f32_16x16x32_bf16 a[64:67], a[96:99], a[136:139], a[64:67]
ds_read_b64_tr_b16 a[132:133], v17 offset:14368
v_lshlrev_b32_e64 v20, 16, v24
v_mfma_f32_16x16x32_bf16 a[68:71], a[100:103], a[136:139], a[68:71]
ds_read_b64_tr_b16 a[134:135], v17 offset:16160
v_and_b32 v21, 0xffff0000, v24
v_mfma_f32_16x16x32_bf16 a[72:75], a[104:107], a[136:139], a[72:75]
v_add_f32 v40, v40, v20
v_add_f32 v41, v41, v21
v_mfma_f32_16x16x32_bf16 a[76:79], a[108:111], a[136:139], a[76:79]
v_lshlrev_b32_e64 v20, 16, v25
v_mfma_f32_16x16x32_bf16 a[92:95], a[108:111], a[140:143], a[92:95]
ds_read_b64_tr_b16 a[136:137], v17 offset:64
v_and_b32 v21, 0xffff0000, v25
v_mfma_f32_16x16x32_bf16 a[88:91], a[104:107], a[140:143], a[88:91]
ds_read_b64_tr_b16 a[138:139], v17 offset:1856
v_add_f32 v42, v42, v20
v_mfma_f32_16x16x32_bf16 a[84:87], a[100:103], a[140:143], a[84:87]
v_add_f32 v43, v43, v21
v_mfma_f32_16x16x32_bf16 a[80:83], a[96:99], a[140:143], a[80:83]
v_lshlrev_b32 v20, 16, v26
s_waitcnt lgkmcnt(7)
v_mfma_f32_16x16x32_bf16 v[64:67], a[144:147], a[96:99], v[64:67]
ds_read_b64_tr_b16 a[140:141], v17 offset:14400
v_and_b32 v21, 0xffff0000, v26
v_mfma_f32_16x16x32_bf16 v[68:71], a[144:147], a[100:103], v[68:71]
ds_read_b64_tr_b16 a[142:143], v17 offset:16192
v_add_f32_e64 v44, v44, v20
v_mfma_f32_16x16x32_bf16 v[72:75], a[144:147], a[104:107], v[72:75]
v_add_f32 v45, v45, v21
v_mfma_f32_16x16x32_bf16 v[76:79], a[144:147], a[108:111], v[76:79]
v_lshlrev_b32 v20, 16, v27
v_and_b32 v21, 0xffff0000, v27
v_mfma_f32_16x16x32_bf16 v[92:95], a[148:151], a[108:111], v[92:95]
ds_read_b64_tr_b16 a[144:145], v17 offset:96
v_add_f32_e64 v46, v46, v20
v_mfma_f32_16x16x32_bf16 v[88:91], a[148:151], a[104:107], v[88:91]
ds_read_b64_tr_b16 a[146:147], v17 offset:1888
v_add_f32_e64 v47, v47, v21
v_mfma_f32_16x16x32_bf16 v[84:87], a[148:151], a[100:103], v[84:87]
ds_read_b128 a[116:119], v14 offset:2048
v_mfma_f32_16x16x32_bf16 v[80:83], a[148:151], a[96:99], v[80:83]
v_lshlrev_b32 v20, 16, v28
s_waitcnt lgkmcnt(7)
v_mfma_f32_16x16x32_bf16 v[96:99], a[128:131], a[96:99], v[96:99]
ds_read_b64_tr_b16 a[148:149], v17 offset:14432
v_and_b32 v21, 0xffff0000, v28
v_mfma_f32_16x16x32_bf16 v[100:103], a[128:131], a[100:103], v[100:103]
ds_read_b64_tr_b16 a[150:151], v17 offset:16224
v_add_f32_e64 v40, v40, v20
v_mfma_f32_16x16x32_bf16 v[104:107], a[128:131], a[104:107], v[104:107]
v_add_f32 v41, v41, v21
v_mfma_f32_16x16x32_bf16 v[108:111], a[128:131], a[108:111], v[108:111]
v_lshlrev_b32 v20, 16, v29
v_and_b32 v21, 0xffff0000, v29
v_mfma_f32_16x16x32_bf16 v[124:127], a[132:135], a[108:111], v[124:127]
ds_read_b64_tr_b16 a[128:129], v17 offset:128
v_add_f32_e64 v42, v42, v20
v_mfma_f32_16x16x32_bf16 v[120:123], a[132:135], a[104:107], v[120:123]
ds_read_b64_tr_b16 a[130:131], v17 offset:1920
v_add_f32 v43, v43, v21
v_mfma_f32_16x16x32_bf16 v[116:119], a[132:135], a[100:103], v[116:119]
v_lshlrev_b32 v20, 16, v30
v_mfma_f32_16x16x32_bf16 v[112:115], a[132:135], a[96:99], v[112:115]
v_and_b32 v21, 0xffff0000, v30
s_waitcnt lgkmcnt(7)
v_mfma_f32_16x16x32_bf16 v[128:131], a[136:139], a[96:99], v[128:131]
ds_read_b64_tr_b16 a[132:133], v17 offset:14464
s_add_u32 m0, s50, 28672
v_mfma_f32_16x16x32_bf16 v[132:135], a[136:139], a[100:103], v[132:135]
ds_read_b64_tr_b16 a[134:135], v17 offset:16256
s_mov_b32 s99, 458752
v_mfma_f32_16x16x32_bf16 v[136:139], a[136:139], a[104:107], v[136:139]
buffer_load_dwordx4 v6, s[12:15], s99 offen  lds
v_mfma_f32_16x16x32_bf16 v[140:143], a[136:139], a[108:111], v[140:143]
v_add_f32 v44, v44, v20
v_add_f32_e64 v45, v45, v21
v_mfma_f32_16x16x32_bf16 v[156:159], a[140:143], a[108:111], v[156:159]
ds_read_b64_tr_b16 a[136:137], v17 offset:160
v_mfma_f32_16x16x32_bf16 v[152:155], a[140:143], a[104:107], v[152:155]
ds_read_b64_tr_b16 a[138:139], v17 offset:1952
s_add_u32 m0, s50, 29696
v_mfma_f32_16x16x32_bf16 v[148:151], a[140:143], a[100:103], v[148:151]
ds_read_b128 a[120:123], v14 offset:4096
buffer_load_dwordx4 v7, s[12:15], s99 offen  lds
v_mfma_f32_16x16x32_bf16 v[144:147], a[140:143], a[96:99], v[144:147]
v_lshlrev_b32 v20, 16, v31
s_waitcnt lgkmcnt(7)
v_mfma_f32_16x16x32_bf16 v[160:163], a[144:147], a[96:99], v[160:163]
ds_read_b64_tr_b16 a[140:141], v17 offset:14496
v_and_b32 v21, 0xffff0000, v31
v_mfma_f32_16x16x32_bf16 v[164:167], a[144:147], a[100:103], v[164:167]
ds_read_b64_tr_b16 a[142:143], v17 offset:16288
s_add_u32 m0, s50, 30720
v_mfma_f32_16x16x32_bf16 v[168:171], a[144:147], a[104:107], v[168:171]
buffer_load_dwordx4 v8, s[12:15], s99 offen  lds
v_mfma_f32_16x16x32_bf16 v[172:175], a[144:147], a[108:111], v[172:175]
v_add_f32 v46, v46, v20
v_add_f32 v47, v47, v21
v_mfma_f32_16x16x32_bf16 v[188:191], a[148:151], a[108:111], v[188:191]
ds_read_b64_tr_b16 a[144:145], v17 offset:192
v_mfma_f32_16x16x32_bf16 v[184:187], a[148:151], a[104:107], v[184:187]
ds_read_b64_tr_b16 a[146:147], v17 offset:1984
s_add_u32 m0, s50, 31744
v_mfma_f32_16x16x32_bf16 v[180:183], a[148:151], a[100:103], v[180:183]
buffer_load_dwordx4 v9, s[12:15], s99 offen  lds
v_mfma_f32_16x16x32_bf16 v[176:179], a[148:151], a[96:99], v[176:179]
v_mov_b32 v32, 0
s_waitcnt lgkmcnt(7)
v_mfma_f32_16x16x32_bf16 v[192:195], a[128:131], a[96:99], v[192:195]
ds_read_b64_tr_b16 a[148:149], v17 offset:14528
v_mov_b32_e64 v33, 0
v_mfma_f32_16x16x32_bf16 v[196:199], a[128:131], a[100:103], v[196:199]
ds_read_b64_tr_b16 a[150:151], v17 offset:16320
s_add_u32 m0, s50, 32768
v_mfma_f32_16x16x32_bf16 v[200:203], a[128:131], a[104:107], v[200:203]
buffer_load_dwordx4 v10, s[12:15], s99 offen  lds
v_mfma_f32_16x16x32_bf16 v[204:207], a[128:131], a[108:111], v[204:207]
v_mov_b32 v34, 0
v_lshlrev_b32 v23, 4, v1
v_mfma_f32_16x16x32_bf16 v[220:223], a[132:135], a[108:111], v[220:223]
ds_read_b128 a[128:131], v16 offset:0
v_mfma_f32_16x16x32_bf16 v[216:219], a[132:135], a[104:107], v[216:219]
s_add_u32 m0, s50, 33792
v_lshrrev_b32_e64 v22, 5, v1
v_mul_u32_u24 v22, 1536, v22
v_mfma_f32_16x16x32_bf16 v[212:215], a[132:135], a[100:103], v[212:215]
ds_read_b128 a[124:127], v14 offset:6144
buffer_load_dwordx4 v11, s[12:15], s99 offen  lds
v_mfma_f32_16x16x32_bf16 v[208:211], a[132:135], a[96:99], v[208:211]
v_add_u32 v22, v22, v23
s_waitcnt lgkmcnt(6)
v_mfma_f32_16x16x32_bf16 v[224:227], a[136:139], a[96:99], v[224:227]
ds_read_b128 a[132:135], v16 offset:2048
s_lshl_b32 s60, s4, 5
v_mfma_f32_16x16x32_bf16 v[228:231], a[136:139], a[100:103], v[228:231]
s_add_u32 m0, s50, 34816
s_add_u32 s60, s60, s5
v_mfma_f32_16x16x32_bf16 v[232:235], a[136:139], a[104:107], v[232:235]
buffer_load_dwordx4 v12, s[12:15], s99 offen  lds
v_mfma_f32_16x16x32_bf16 v[236:239], a[136:139], a[108:111], v[236:239]
s_lshl_b32 s60, s60, 2
v_mfma_f32_16x16x32_bf16 v[252:255], a[140:143], a[108:111], v[252:255]
ds_read_b128 a[136:139], v16 offset:4096
s_add_u32 m0, s51, 8192
v_mfma_f32_16x16x32_bf16 v[248:251], a[140:143], a[104:107], v[248:251]
s_mov_b32 s100, 128
s_add_u32 s60, s60, s3
s_lshl_b32 s60, s60, 12
v_mfma_f32_16x16x32_bf16 v[244:247], a[140:143], a[100:103], v[244:247]
buffer_load_dwordx4 v4, s[16:19], s100 offen lds
v_mfma_f32_16x16x32_bf16 v[240:243], a[140:143], a[96:99], v[240:243]
s_waitcnt lgkmcnt(4)
v_mfma_f32_16x16x32_bf16 a[0:3], a[144:147], a[96:99], a[0:3]
ds_read_b128 a[140:143], v16 offset:6144
v_mfma_f32_16x16x32_bf16 a[4:7], a[144:147], a[100:103], a[4:7]
s_add_u32 m0, s51, 9216
v_mfma_f32_16x16x32_bf16 a[8:11], a[144:147], a[104:107], a[8:11]
buffer_load_dwordx4 v5, s[16:19], s100 offen lds
v_mfma_f32_16x16x32_bf16 a[12:15], a[144:147], a[108:111], a[12:15]
s_mov_b32 s101, 917504
v_mfma_f32_16x16x32_bf16 a[28:31], a[148:151], a[108:111], a[28:31]
ds_read_b64_tr_b16 a[144:145], v17 offset:7168
v_mfma_f32_16x16x32_bf16 a[24:27], a[148:151], a[104:107], a[24:27]
ds_read_b64_tr_b16 a[146:147], v17 offset:8960
v_mfma_f32_16x16x32_bf16 a[20:23], a[148:151], a[100:103], a[20:23]
buffer_load_dwordx4 v[48:51], v18, s[12:15], s101 offen
v_mfma_f32_16x16x32_bf16 a[16:19], a[148:151], a[96:99], a[16:19]
s_mov_b32 s101, 1376256
s_waitcnt lgkmcnt(4)
v_mfma_f32_16x16x32_bf16 a[32:35], a[112:115], a[128:131], a[32:35]
ds_read_b64_tr_b16 a[148:149], v17 offset:21504
v_mfma_f32_16x16x32_bf16 a[36:39], a[116:119], a[128:131], a[36:39]
ds_read_b64_tr_b16 a[150:151], v17 offset:23296
v_mfma_f32_16x16x32_bf16 a[40:43], a[120:123], a[128:131], a[40:43]
buffer_load_dwordx4 v[36:39], v18, s[12:15], s101 offen
v_mfma_f32_16x16x32_bf16 a[44:47], a[124:127], a[128:131], a[44:47]
v_mfma_f32_16x16x32_bf16 a[60:63], a[124:127], a[132:135], a[60:63]
ds_read_b64_tr_b16 a[128:129], v17 offset:7200
v_mfma_f32_16x16x32_bf16 a[56:59], a[120:123], a[132:135], a[56:59]
ds_read_b64_tr_b16 a[130:131], v17 offset:8992
v_mfma_f32_16x16x32_bf16 a[52:55], a[116:119], a[132:135], a[52:55]
buffer_load_dwordx4 v[24:27], v22, s[8:11], s60 offen offset:512
v_mfma_f32_16x16x32_bf16 a[48:51], a[112:115], a[132:135], a[48:51]
s_waitcnt lgkmcnt(6)
v_mfma_f32_16x16x32_bf16 a[64:67], a[112:115], a[136:139], a[64:67]
ds_read_b64_tr_b16 a[132:133], v17 offset:21536
v_mfma_f32_16x16x32_bf16 a[68:71], a[116:119], a[136:139], a[68:71]
ds_read_b64_tr_b16 a[134:135], v17 offset:23328
v_mfma_f32_16x16x32_bf16 a[72:75], a[120:123], a[136:139], a[72:75]
v_mfma_f32_16x16x32_bf16 a[76:79], a[124:127], a[136:139], a[76:79]
v_mfma_f32_16x16x32_bf16 a[92:95], a[124:127], a[140:143], a[92:95]
ds_read_b64_tr_b16 a[136:137], v17 offset:7232
s_add_u32 m0, s49, 0
v_mfma_f32_16x16x32_bf16 a[88:91], a[120:123], a[140:143], a[88:91]
ds_read_b64_tr_b16 a[138:139], v17 offset:9024
s_mov_b32 s98, 256
v_mfma_f32_16x16x32_bf16 a[84:87], a[116:119], a[140:143], a[84:87]
buffer_load_dwordx4 v2, s[8:11], s98 offen lds
v_mfma_f32_16x16x32_bf16 a[80:83], a[112:115], a[140:143], a[80:83]
s_waitcnt lgkmcnt(6)
v_mfma_f32_16x16x32_bf16 v[64:67], a[144:147], a[112:115], v[64:67]
ds_read_b64_tr_b16 a[140:141], v17 offset:21568
v_mfma_f32_16x16x32_bf16 v[68:71], a[144:147], a[116:119], v[68:71]
ds_read_b64_tr_b16 a[142:143], v17 offset:23360
s_add_u32 m0, s49, 1024
v_mfma_f32_16x16x32_bf16 v[72:75], a[144:147], a[120:123], v[72:75]
buffer_load_dwordx4 v3, s[8:11], s98 offen lds
v_mfma_f32_16x16x32_bf16 v[76:79], a[144:147], a[124:127], v[76:79]
v_mfma_f32_16x16x32_bf16 v[92:95], a[148:151], a[124:127], v[92:95]
ds_read_b64_tr_b16 a[144:145], v17 offset:7264
v_mfma_f32_16x16x32_bf16 v[88:91], a[148:151], a[120:123], v[88:91]
ds_read_b64_tr_b16 a[146:147], v17 offset:9056
v_mfma_f32_16x16x32_bf16 v[84:87], a[148:151], a[116:119], v[84:87]
v_mfma_f32_16x16x32_bf16 v[80:83], a[148:151], a[112:115], v[80:83]
s_waitcnt lgkmcnt(6)
v_mfma_f32_16x16x32_bf16 v[96:99], a[128:131], a[112:115], v[96:99]
ds_read_b64_tr_b16 a[148:149], v17 offset:21600
s_add_u32 m0, s49, 2048
v_mfma_f32_16x16x32_bf16 v[100:103], a[128:131], a[116:119], v[100:103]
ds_read_b64_tr_b16 a[150:151], v17 offset:23392
s_mov_b32 s98, 2304
v_mfma_f32_16x16x32_bf16 v[104:107], a[128:131], a[120:123], v[104:107]
buffer_load_dwordx4 v2, s[8:11], s98 offen lds
v_mfma_f32_16x16x32_bf16 v[108:111], a[128:131], a[124:127], v[108:111]
s_mov_b32 s20, s94
v_mfma_f32_16x16x32_bf16 v[124:127], a[132:135], a[124:127], v[124:127]
ds_read_b64_tr_b16 a[128:129], v17 offset:7296
v_mfma_f32_16x16x32_bf16 v[120:123], a[132:135], a[120:123], v[120:123]
ds_read_b64_tr_b16 a[130:131], v17 offset:9088
s_add_u32 m0, s49, 3072
v_mfma_f32_16x16x32_bf16 v[116:119], a[132:135], a[116:119], v[116:119]
buffer_load_dwordx4 v3, s[8:11], s98 offen lds
v_mfma_f32_16x16x32_bf16 v[112:115], a[132:135], a[112:115], v[112:115]
s_mov_b32 s21, s95
s_waitcnt lgkmcnt(6)
v_mfma_f32_16x16x32_bf16 v[128:131], a[136:139], a[112:115], v[128:131]
ds_read_b64_tr_b16 a[132:133], v17 offset:21632
v_mfma_f32_16x16x32_bf16 v[132:135], a[136:139], a[116:119], v[132:135]
ds_read_b64_tr_b16 a[134:135], v17 offset:23424
v_mfma_f32_16x16x32_bf16 v[136:139], a[136:139], a[120:123], v[136:139]
s_mov_b32 s22, 268435456
v_mfma_f32_16x16x32_bf16 v[140:143], a[136:139], a[124:127], v[140:143]
v_mfma_f32_16x16x32_bf16 v[156:159], a[140:143], a[124:127], v[156:159]
ds_read_b64_tr_b16 a[136:137], v17 offset:7328
s_add_u32 m0, s49, 4096
v_mfma_f32_16x16x32_bf16 v[152:155], a[140:143], a[120:123], v[152:155]
ds_read_b64_tr_b16 a[138:139], v17 offset:9120
s_mov_b32 s98, 4352
v_mfma_f32_16x16x32_bf16 v[148:151], a[140:143], a[116:119], v[148:151]
buffer_load_dwordx4 v2, s[8:11], s98 offen lds
v_mfma_f32_16x16x32_bf16 v[144:147], a[140:143], a[112:115], v[144:147]
s_mov_b32 s23, 0x20000
s_waitcnt lgkmcnt(6)
v_mfma_f32_16x16x32_bf16 v[160:163], a[144:147], a[112:115], v[160:163]
ds_read_b64_tr_b16 a[140:141], v17 offset:21664
v_mfma_f32_16x16x32_bf16 v[164:167], a[144:147], a[116:119], v[164:167]
ds_read_b64_tr_b16 a[142:143], v17 offset:23456
s_add_u32 m0, s49, 5120
v_mfma_f32_16x16x32_bf16 v[168:171], a[144:147], a[120:123], v[168:171]
buffer_load_dwordx4 v3, s[8:11], s98 offen lds
v_mfma_f32_16x16x32_bf16 v[172:175], a[144:147], a[124:127], v[172:175]
v_mfma_f32_16x16x32_bf16 v[188:191], a[148:151], a[124:127], v[188:191]
ds_read_b64_tr_b16 a[144:145], v17 offset:7360
s_lshl_b32 s55, s2, 2
v_mfma_f32_16x16x32_bf16 v[184:187], a[148:151], a[120:123], v[184:187]
ds_read_b64_tr_b16 a[146:147], v17 offset:9152
v_mfma_f32_16x16x32_bf16 v[180:183], a[148:151], a[116:119], v[180:183]
s_add_u32 s55, s55, s3
v_mfma_f32_16x16x32_bf16 v[176:179], a[148:151], a[112:115], v[176:179]
s_waitcnt lgkmcnt(6)
v_mfma_f32_16x16x32_bf16 v[192:195], a[128:131], a[112:115], v[192:195]
ds_read_b64_tr_b16 a[148:149], v17 offset:21696
s_add_u32 m0, s49, 6144
v_mfma_f32_16x16x32_bf16 v[196:199], a[128:131], a[116:119], v[196:199]
ds_read_b64_tr_b16 a[150:151], v17 offset:23488
s_mov_b32 s98, 6400
v_mfma_f32_16x16x32_bf16 v[200:203], a[128:131], a[120:123], v[200:203]
buffer_load_dwordx4 v2, s[8:11], s98 offen lds
v_mfma_f32_16x16x32_bf16 v[204:207], a[128:131], a[124:127], v[204:207]
v_mfma_f32_16x16x32_bf16 v[220:223], a[132:135], a[124:127], v[220:223]
s_waitcnt vmcnt(19)
ds_read_b128 a[96:99], v13 offset:32768
v_mfma_f32_16x16x32_bf16 v[216:219], a[132:135], a[120:123], v[216:219]
ds_read_b128 a[100:103], v13 offset:34816
s_lshl_b32 s45, s5, 3
v_mfma_f32_16x16x32_bf16 v[212:215], a[132:135], a[116:119], v[212:215]
v_mfma_f32_16x16x32_bf16 v[208:211], a[132:135], a[112:115], v[208:211]
s_add_u32 s45, s45, s4
s_waitcnt lgkmcnt(6)
v_mfma_f32_16x16x32_bf16 v[224:227], a[136:139], a[112:115], v[224:227]
ds_read_b128 a[104:107], v13 offset:36864
v_mfma_f32_16x16x32_bf16 v[228:231], a[136:139], a[116:119], v[228:231]
ds_read_b128 a[108:111], v13 offset:38912
s_add_u32 m0, s49, 7168
v_mfma_f32_16x16x32_bf16 v[232:235], a[136:139], a[120:123], v[232:235]
buffer_load_dwordx4 v3, s[8:11], s98 offen lds
v_mfma_f32_16x16x32_bf16 v[236:239], a[136:139], a[124:127], v[236:239]
s_waitcnt vmcnt(11) lgkmcnt(4)
s_barrier
v_mfma_f32_16x16x32_bf16 v[252:255], a[140:143], a[124:127], v[252:255]
ds_read_b128 a[128:131], v15 offset:8192
v_mfma_f32_16x16x32_bf16 v[248:251], a[140:143], a[120:123], v[248:251]
ds_read_b128 a[132:135], v15 offset:10240
v_mfma_f32_16x16x32_bf16 v[244:247], a[140:143], a[116:119], v[244:247]
ds_read_b128 a[136:139], v15 offset:12288
s_lshl_b32 s61, s45, 1
v_mfma_f32_16x16x32_bf16 v[240:243], a[140:143], a[112:115], v[240:243]
v_mfma_f32_16x16x32_bf16 a[0:3], a[144:147], a[112:115], a[0:3]
ds_read_b128 a[140:143], v15 offset:14336
v_mfma_f32_16x16x32_bf16 a[4:7], a[144:147], a[116:119], a[4:7]
s_lshr_b32 s46, s3, 1
v_mfma_f32_16x16x32_bf16 a[8:11], a[144:147], a[120:123], a[8:11]
v_mfma_f32_16x16x32_bf16 a[12:15], a[144:147], a[124:127], a[12:15]
s_add_u32 s61, s61, s46
v_mfma_f32_16x16x32_bf16 a[28:31], a[148:151], a[124:127], a[28:31]
ds_read_b64_tr_b16 a[144:145], v17 offset:28672
v_mfma_f32_16x16x32_bf16 a[24:27], a[148:151], a[120:123], a[24:27]
ds_read_b64_tr_b16 a[146:147], v17 offset:30464
s_lshl_b32 s61, s61, 12
v_mfma_f32_16x16x32_bf16 a[20:23], a[148:151], a[116:119], a[20:23]
v_mfma_f32_16x16x32_bf16 a[16:19], a[148:151], a[112:115], a[16:19]
s_waitcnt lgkmcnt(4)
v_mfma_f32_16x16x32_bf16 a[32:35], a[96:99], a[128:131], a[32:35]
ds_read_b64_tr_b16 a[148:149], v17 offset:43008
s_add_u32 m0, s50, 0
v_mfma_f32_16x16x32_bf16 a[36:39], a[100:103], a[128:131], a[36:39]
ds_read_b64_tr_b16 a[150:151], v17 offset:44800
s_mov_b32 s99, 917504
v_mfma_f32_16x16x32_bf16 a[40:43], a[104:107], a[128:131], a[40:43]
buffer_load_dwordx4 v6, s[12:15], s99 offen  lds
v_mfma_f32_16x16x32_bf16 a[44:47], a[108:111], a[128:131], a[44:47]
s_mov_b32 s28, s88
v_mfma_f32_16x16x32_bf16 a[60:63], a[108:111], a[132:135], a[60:63]
ds_read_b64_tr_b16 a[128:129], v17 offset:28704
s_mov_b32 s29, s89
v_mfma_f32_16x16x32_bf16 a[56:59], a[104:107], a[132:135], a[56:59]
ds_read_b64_tr_b16 a[130:131], v17 offset:30496
v_mfma_f32_16x16x32_bf16 a[52:55], a[100:103], a[132:135], a[52:55]
ds_read_b128 a[112:115], v14 offset:32768
v_mfma_f32_16x16x32_bf16 a[48:51], a[96:99], a[132:135], a[48:51]
s_mov_b32 s30, 7340032
s_waitcnt lgkmcnt(7)
v_mfma_f32_16x16x32_bf16 a[64:67], a[96:99], a[136:139], a[64:67]
ds_read_b64_tr_b16 a[132:133], v17 offset:43040
v_mfma_f32_16x16x32_bf16 a[68:71], a[100:103], a[136:139], a[68:71]
ds_read_b64_tr_b16 a[134:135], v17 offset:44832
s_add_u32 m0, s50, 1024
v_mfma_f32_16x16x32_bf16 a[72:75], a[104:107], a[136:139], a[72:75]
buffer_load_dwordx4 v7, s[12:15], s99 offen  lds
v_mfma_f32_16x16x32_bf16 a[76:79], a[108:111], a[136:139], a[76:79]
s_mov_b32 s31, 0x20000
v_mfma_f32_16x16x32_bf16 a[92:95], a[108:111], a[140:143], a[92:95]
ds_read_b64_tr_b16 a[136:137], v17 offset:28736
v_mfma_f32_16x16x32_bf16 a[88:91], a[104:107], a[140:143], a[88:91]
ds_read_b64_tr_b16 a[138:139], v17 offset:30528
s_mov_b32 s32, s74
v_mfma_f32_16x16x32_bf16 a[84:87], a[100:103], a[140:143], a[84:87]
s_mov_b32 s33, s75
v_mfma_f32_16x16x32_bf16 a[80:83], a[96:99], a[140:143], a[80:83]
s_waitcnt lgkmcnt(7)
v_mfma_f32_16x16x32_bf16 v[64:67], a[144:147], a[96:99], v[64:67]
ds_read_b64_tr_b16 a[140:141], v17 offset:43072
v_mfma_f32_16x16x32_bf16 v[68:71], a[144:147], a[100:103], v[68:71]
ds_read_b64_tr_b16 a[142:143], v17 offset:44864
s_add_u32 m0, s50, 2048
v_mfma_f32_16x16x32_bf16 v[72:75], a[144:147], a[104:107], v[72:75]
buffer_load_dwordx4 v8, s[12:15], s99 offen  lds
v_mfma_f32_16x16x32_bf16 v[76:79], a[144:147], a[108:111], v[76:79]
s_mov_b32 s34, 2097152
v_mfma_f32_16x16x32_bf16 v[92:95], a[148:151], a[108:111], v[92:95]
ds_read_b64_tr_b16 a[144:145], v17 offset:28768
s_mov_b32 s35, 0x20000
v_mfma_f32_16x16x32_bf16 v[88:91], a[148:151], a[104:107], v[88:91]
ds_read_b64_tr_b16 a[146:147], v17 offset:30560
v_mfma_f32_16x16x32_bf16 v[84:87], a[148:151], a[100:103], v[84:87]
ds_read_b128 a[116:119], v14 offset:34816
v_mfma_f32_16x16x32_bf16 v[80:83], a[148:151], a[96:99], v[80:83]
s_mov_b32 s36, s76
s_waitcnt lgkmcnt(7)
v_mfma_f32_16x16x32_bf16 v[96:99], a[128:131], a[96:99], v[96:99]
ds_read_b64_tr_b16 a[148:149], v17 offset:43104
v_mfma_f32_16x16x32_bf16 v[100:103], a[128:131], a[100:103], v[100:103]
ds_read_b64_tr_b16 a[150:151], v17 offset:44896
s_add_u32 m0, s50, 3072
v_mfma_f32_16x16x32_bf16 v[104:107], a[128:131], a[104:107], v[104:107]
buffer_load_dwordx4 v9, s[12:15], s99 offen  lds
v_mfma_f32_16x16x32_bf16 v[108:111], a[128:131], a[108:111], v[108:111]
s_mov_b32 s37, s77
v_mfma_f32_16x16x32_bf16 v[124:127], a[132:135], a[108:111], v[124:127]
ds_read_b64_tr_b16 a[128:129], v17 offset:28800
v_mfma_f32_16x16x32_bf16 v[120:123], a[132:135], a[104:107], v[120:123]
ds_read_b64_tr_b16 a[130:131], v17 offset:30592
s_mov_b32 s38, 2097152
v_mfma_f32_16x16x32_bf16 v[116:119], a[132:135], a[100:103], v[116:119]
s_mov_b32 s39, 0x20000
v_mfma_f32_16x16x32_bf16 v[112:115], a[132:135], a[96:99], v[112:115]
s_waitcnt lgkmcnt(7)
v_mfma_f32_16x16x32_bf16 v[128:131], a[136:139], a[96:99], v[128:131]
ds_read_b64_tr_b16 a[132:133], v17 offset:43136
v_mfma_f32_16x16x32_bf16 v[132:135], a[136:139], a[100:103], v[132:135]
ds_read_b64_tr_b16 a[134:135], v17 offset:44928
s_add_u32 m0, s50, 4096
v_mfma_f32_16x16x32_bf16 v[136:139], a[136:139], a[104:107], v[136:139]
buffer_load_dwordx4 v10, s[12:15], s99 offen  lds
v_mfma_f32_16x16x32_bf16 v[140:143], a[136:139], a[108:111], v[140:143]
s_mov_b32 s40, s92
v_mfma_f32_16x16x32_bf16 v[156:159], a[140:143], a[108:111], v[156:159]
ds_read_b64_tr_b16 a[136:137], v17 offset:28832
v_mfma_f32_16x16x32_bf16 v[152:155], a[140:143], a[104:107], v[152:155]
ds_read_b64_tr_b16 a[138:139], v17 offset:30624
s_mov_b32 s41, s93
v_mfma_f32_16x16x32_bf16 v[148:151], a[140:143], a[100:103], v[148:151]
ds_read_b128 a[120:123], v14 offset:36864
v_mfma_f32_16x16x32_bf16 v[144:147], a[140:143], a[96:99], v[144:147]
s_mov_b32 s42, 256
s_waitcnt lgkmcnt(7)
v_mfma_f32_16x16x32_bf16 v[160:163], a[144:147], a[96:99], v[160:163]
ds_read_b64_tr_b16 a[140:141], v17 offset:43168
v_mfma_f32_16x16x32_bf16 v[164:167], a[144:147], a[100:103], v[164:167]
ds_read_b64_tr_b16 a[142:143], v17 offset:44960
s_add_u32 m0, s50, 5120
v_mfma_f32_16x16x32_bf16 v[168:171], a[144:147], a[104:107], v[168:171]
buffer_load_dwordx4 v11, s[12:15], s99 offen  lds
v_mfma_f32_16x16x32_bf16 v[172:175], a[144:147], a[108:111], v[172:175]
s_mov_b32 s43, 0x20000
v_mfma_f32_16x16x32_bf16 v[188:191], a[148:151], a[108:111], v[188:191]
ds_read_b64_tr_b16 a[144:145], v17 offset:28864
v_mfma_f32_16x16x32_bf16 v[184:187], a[148:151], a[104:107], v[184:187]
ds_read_b64_tr_b16 a[146:147], v17 offset:30656
v_mov_b32 v60, 1
v_mfma_f32_16x16x32_bf16 v[180:183], a[148:151], a[100:103], v[180:183]
v_mfma_f32_16x16x32_bf16 v[176:179], a[148:151], a[96:99], v[176:179]
s_and_b32 s47, s4, 1
s_waitcnt lgkmcnt(7)
v_mfma_f32_16x16x32_bf16 v[192:195], a[128:131], a[96:99], v[192:195]
ds_read_b64_tr_b16 a[148:149], v17 offset:43200
v_mfma_f32_16x16x32_bf16 v[196:199], a[128:131], a[100:103], v[196:199]
ds_read_b64_tr_b16 a[150:151], v17 offset:44992
s_add_u32 m0, s50, 6144
v_mfma_f32_16x16x32_bf16 v[200:203], a[128:131], a[104:107], v[200:203]
buffer_load_dwordx4 v12, s[12:15], s99 offen  lds
v_mfma_f32_16x16x32_bf16 v[204:207], a[128:131], a[108:111], v[204:207]
s_lshl_b32 s47, s47, 7
v_mfma_f32_16x16x32_bf16 v[220:223], a[132:135], a[108:111], v[220:223]
ds_read_b128 a[128:131], v16 offset:8192
v_mfma_f32_16x16x32_bf16 v[216:219], a[132:135], a[104:107], v[216:219]
v_mov_b32 v61, s47
v_mfma_f32_16x16x32_bf16 v[212:215], a[132:135], a[100:103], v[212:215]
ds_read_b128 a[124:127], v14 offset:38912
s_and_b32 s47, s4, 2
v_mfma_f32_16x16x32_bf16 v[208:211], a[132:135], a[96:99], v[208:211]
s_waitcnt lgkmcnt(6)
v_mfma_f32_16x16x32_bf16 v[224:227], a[136:139], a[96:99], v[224:227]
ds_read_b128 a[132:135], v16 offset:10240
s_add_u32 m0, s51, 0
v_mfma_f32_16x16x32_bf16 v[228:231], a[136:139], a[100:103], v[228:231]
s_mov_b32 s100, 256
s_add_u32 s47, s47, 4
v_mfma_f32_16x16x32_bf16 v[232:235], a[136:139], a[104:107], v[232:235]
buffer_load_dwordx4 v4, s[16:19], s100 offen lds
v_mfma_f32_16x16x32_bf16 v[236:239], a[136:139], a[108:111], v[236:239]
v_mfma_f32_16x16x32_bf16 v[252:255], a[140:143], a[108:111], v[252:255]
ds_read_b128 a[136:139], v16 offset:12288
v_mfma_f32_16x16x32_bf16 v[248:251], a[140:143], a[104:107], v[248:251]
s_cmp_eq_u32 s3, 0
s_cselect_b32 s47, s47, 0
v_mfma_f32_16x16x32_bf16 v[244:247], a[140:143], a[100:103], v[244:247]
v_mfma_f32_16x16x32_bf16 v[240:243], a[140:143], a[96:99], v[240:243]
s_waitcnt lgkmcnt(4)
v_mfma_f32_16x16x32_bf16 a[0:3], a[144:147], a[96:99], a[0:3]
ds_read_b128 a[140:143], v16 offset:14336
v_mfma_f32_16x16x32_bf16 a[4:7], a[144:147], a[100:103], a[4:7]
s_add_u32 m0, s51, 1024
v_mfma_f32_16x16x32_bf16 a[8:11], a[144:147], a[104:107], a[8:11]
buffer_load_dwordx4 v5, s[16:19], s100 offen lds
v_mfma_f32_16x16x32_bf16 a[12:15], a[144:147], a[108:111], a[12:15]
s_mov_b32 s101, 1835008
v_mfma_f32_16x16x32_bf16 a[28:31], a[148:151], a[108:111], a[28:31]
ds_read_b64_tr_b16 a[144:145], v17 offset:35840
v_mfma_f32_16x16x32_bf16 a[24:27], a[148:151], a[104:107], a[24:27]
ds_read_b64_tr_b16 a[146:147], v17 offset:37632
v_mfma_f32_16x16x32_bf16 a[20:23], a[148:151], a[100:103], a[20:23]
buffer_load_dwordx4 v[52:55], v18, s[12:15], s101 offen
v_mfma_f32_16x16x32_bf16 a[16:19], a[148:151], a[96:99], a[16:19]
s_mov_b32 s101, 2293760
s_waitcnt lgkmcnt(4)
v_mfma_f32_16x16x32_bf16 a[32:35], a[112:115], a[128:131], a[32:35]
ds_read_b64_tr_b16 a[148:149], v17 offset:50176
v_mov_b32_e64 v62, -1
v_mfma_f32_16x16x32_bf16 a[36:39], a[116:119], a[128:131], a[36:39]
ds_read_b64_tr_b16 a[150:151], v17 offset:51968
v_lshlrev_b32_e64 v63, 2, v0
v_mfma_f32_16x16x32_bf16 a[40:43], a[120:123], a[128:131], a[40:43]
buffer_load_dwordx4 v[56:59], v18, s[12:15], s101 offen
v_mfma_f32_16x16x32_bf16 a[44:47], a[124:127], a[128:131], a[44:47]
v_lshlrev_b32_e64 v19, 2, v1
v_mfma_f32_16x16x32_bf16 a[60:63], a[124:127], a[132:135], a[60:63]
ds_read_b64_tr_b16 a[128:129], v17 offset:35872
s_lshl_b32 s45, s45, 10
v_mfma_f32_16x16x32_bf16 a[56:59], a[120:123], a[132:135], a[56:59]
ds_read_b64_tr_b16 a[130:131], v17 offset:37664
v_mfma_f32_16x16x32_bf16 a[52:55], a[116:119], a[132:135], a[52:55]
buffer_load_dwordx4 v[28:31], v22, s[16:19], s61 offen offset:512
v_mfma_f32_16x16x32_bf16 a[48:51], a[112:115], a[132:135], a[48:51]
s_add_u32 s45, s45, 26214400
s_waitcnt lgkmcnt(6)
v_mfma_f32_16x16x32_bf16 a[64:67], a[112:115], a[136:139], a[64:67]
ds_read_b64_tr_b16 a[132:133], v17 offset:50208
v_mfma_f32_16x16x32_bf16 a[68:71], a[116:119], a[136:139], a[68:71]
ds_read_b64_tr_b16 a[134:135], v17 offset:52000
v_mfma_f32_16x16x32_bf16 a[72:75], a[120:123], a[136:139], a[72:75]
buffer_store_dword v62, v63, s[20:23], s45 offen sc1
v_mfma_f32_16x16x32_bf16 a[76:79], a[124:127], a[136:139], a[76:79]
s_lshl_b32 s45, s5, 5
v_mfma_f32_16x16x32_bf16 a[92:95], a[124:127], a[140:143], a[92:95]
ds_read_b64_tr_b16 a[136:137], v17 offset:35904
s_add_u32 m0, s49, 32768
v_mfma_f32_16x16x32_bf16 a[88:91], a[120:123], a[140:143], a[88:91]
ds_read_b64_tr_b16 a[138:139], v17 offset:37696
s_mov_b32 s98, 384
v_mfma_f32_16x16x32_bf16 a[84:87], a[116:119], a[140:143], a[84:87]
buffer_load_dwordx4 v2, s[8:11], s98 offen lds
v_mfma_f32_16x16x32_bf16 a[80:83], a[112:115], a[140:143], a[80:83]
L_pg1:
s_cbranch_execz L_pg5
s_sub_u32 s45, s45, s6
s_waitcnt lgkmcnt(6)
v_mfma_f32_16x16x32_bf16 v[64:67], a[144:147], a[112:115], v[64:67]
ds_read_b64_tr_b16 a[140:141], v17 offset:50240
s_lshl_b32 s45, s45, 8
v_mfma_f32_16x16x32_bf16 v[68:71], a[144:147], a[116:119], v[68:71]
ds_read_b64_tr_b16 a[142:143], v17 offset:52032
s_add_u32 m0, s49, 33792
v_mfma_f32_16x16x32_bf16 v[72:75], a[144:147], a[120:123], v[72:75]
buffer_load_dwordx4 v3, s[8:11], s98 offen lds
v_mfma_f32_16x16x32_bf16 v[76:79], a[144:147], a[124:127], v[76:79]
s_add_u32 s45, s45, 27270912
v_mfma_f32_16x16x32_bf16 v[92:95], a[148:151], a[124:127], v[92:95]
ds_read_b64_tr_b16 a[144:145], v17 offset:35936
v_mfma_f32_16x16x32_bf16 v[88:91], a[148:151], a[120:123], v[88:91]
ds_read_b64_tr_b16 a[146:147], v17 offset:37728
v_mfma_f32_16x16x32_bf16 v[84:87], a[148:151], a[116:119], v[84:87]
buffer_store_dword v62, v19, s[20:23], s45 offen sc1
v_mfma_f32_16x16x32_bf16 v[80:83], a[148:151], a[112:115], v[80:83]
s_lshr_b32 s45, s60, 8
s_waitcnt lgkmcnt(6)
v_mfma_f32_16x16x32_bf16 v[96:99], a[128:131], a[112:115], v[96:99]
ds_read_b64_tr_b16 a[148:149], v17 offset:50272
s_add_u32 m0, s49, 34816
v_mfma_f32_16x16x32_bf16 v[100:103], a[128:131], a[116:119], v[100:103]
ds_read_b64_tr_b16 a[150:151], v17 offset:52064
s_mov_b32 s98, 2432
v_mfma_f32_16x16x32_bf16 v[104:107], a[128:131], a[120:123], v[104:107]
buffer_load_dwordx4 v2, s[8:11], s98 offen lds
v_mfma_f32_16x16x32_bf16 v[108:111], a[128:131], a[124:127], v[108:111]
s_add_u32 s45, s45, 25165824
v_mfma_f32_16x16x32_bf16 v[124:127], a[132:135], a[124:127], v[124:127]
ds_read_b64_tr_b16 a[128:129], v17 offset:35968
v_lshrrev_b32 v63, 2, v1
v_mfma_f32_16x16x32_bf16 v[120:123], a[132:135], a[120:123], v[120:123]
ds_read_b64_tr_b16 a[130:131], v17 offset:37760
s_add_u32 m0, s49, 35840
v_mfma_f32_16x16x32_bf16 v[116:119], a[132:135], a[116:119], v[116:119]
buffer_load_dwordx4 v3, s[8:11], s98 offen lds
v_mfma_f32_16x16x32_bf16 v[112:115], a[132:135], a[112:115], v[112:115]
s_waitcnt lgkmcnt(6)
v_mfma_f32_16x16x32_bf16 v[128:131], a[136:139], a[112:115], v[128:131]
ds_read_b64_tr_b16 a[132:133], v17 offset:50304
v_min_u32 v63, 1, v63
v_mfma_f32_16x16x32_bf16 v[132:135], a[136:139], a[116:119], v[132:135]
ds_read_b64_tr_b16 a[134:135], v17 offset:52096
v_lshl_add_u32 v63, v63, 30, v19
v_mfma_f32_16x16x32_bf16 v[136:139], a[136:139], a[120:123], v[136:139]
v_add_u32 v63, s45, v63
v_mfma_f32_16x16x32_bf16 v[140:143], a[136:139], a[124:127], v[140:143]
s_lshr_b32 s45, s61, 9
v_mfma_f32_16x16x32_bf16 v[156:159], a[140:143], a[124:127], v[156:159]
ds_read_b64_tr_b16 a[136:137], v17 offset:36000
s_add_u32 m0, s49, 36864
v_mfma_f32_16x16x32_bf16 v[152:155], a[140:143], a[120:123], v[152:155]
ds_read_b64_tr_b16 a[138:139], v17 offset:37792
s_mov_b32 s98, 4480
v_mfma_f32_16x16x32_bf16 v[148:151], a[140:143], a[116:119], v[148:151]
buffer_load_dwordx4 v2, s[8:11], s98 offen lds
v_mfma_f32_16x16x32_bf16 v[144:147], a[140:143], a[112:115], v[144:147]
s_and_b32 s46, s3, 1
s_waitcnt lgkmcnt(6)
v_mfma_f32_16x16x32_bf16 v[160:163], a[144:147], a[112:115], v[160:163]
ds_read_b64_tr_b16 a[140:141], v17 offset:50336
v_mfma_f32_16x16x32_bf16 v[164:167], a[144:147], a[116:119], v[164:167]
ds_read_b64_tr_b16 a[142:143], v17 offset:52128
s_add_u32 m0, s49, 37888
v_mfma_f32_16x16x32_bf16 v[168:171], a[144:147], a[120:123], v[168:171]
buffer_load_dwordx4 v3, s[8:11], s98 offen lds
v_mfma_f32_16x16x32_bf16 v[172:175], a[144:147], a[124:127], v[172:175]
s_lshl_b32 s46, s46, 12
v_mfma_f32_16x16x32_bf16 v[188:191], a[148:151], a[124:127], v[188:191]
ds_read_b64_tr_b16 a[144:145], v17 offset:36032
s_add_u32 s45, s45, s46
v_mfma_f32_16x16x32_bf16 v[184:187], a[148:151], a[120:123], v[184:187]
ds_read_b64_tr_b16 a[146:147], v17 offset:37824
s_add_u32 s45, s45, 25182208
v_mfma_f32_16x16x32_bf16 v[180:183], a[148:151], a[116:119], v[180:183]
v_writelane_b32 v63, s45, 4
v_mfma_f32_16x16x32_bf16 v[176:179], a[148:151], a[112:115], v[176:179]
s_waitcnt lgkmcnt(6)
v_mfma_f32_16x16x32_bf16 v[192:195], a[128:131], a[112:115], v[192:195]
ds_read_b64_tr_b16 a[148:149], v17 offset:50368
s_add_u32 m0, s49, 38912
v_mfma_f32_16x16x32_bf16 v[196:199], a[128:131], a[116:119], v[196:199]
ds_read_b64_tr_b16 a[150:151], v17 offset:52160
s_mov_b32 s98, 6528
v_mfma_f32_16x16x32_bf16 v[200:203], a[128:131], a[120:123], v[200:203]
buffer_load_dwordx4 v2, s[8:11], s98 offen lds
v_mfma_f32_16x16x32_bf16 v[204:207], a[128:131], a[124:127], v[204:207]
s_add_u32 s45, s45, 4
v_writelane_b32 v63, s45, 5
v_mfma_f32_16x16x32_bf16 v[220:223], a[132:135], a[124:127], v[220:223]
s_waitcnt vmcnt(21)
ds_read_b128 a[96:99], v13 offset:0
v_mfma_f32_16x16x32_bf16 v[216:219], a[132:135], a[120:123], v[216:219]
ds_read_b128 a[100:103], v13 offset:2048
v_mfma_f32_16x16x32_bf16 v[212:215], a[132:135], a[116:119], v[212:215]
s_lshl_b32 s45, s6, 6
s_add_u32 s45, s45, s5
v_mfma_f32_16x16x32_bf16 v[208:211], a[132:135], a[112:115], v[208:211]
s_waitcnt lgkmcnt(6)
v_mfma_f32_16x16x32_bf16 v[224:227], a[136:139], a[112:115], v[224:227]
ds_read_b128 a[104:107], v13 offset:4096
s_lshl_b32 s45, s45, 2
v_mfma_f32_16x16x32_bf16 v[228:231], a[136:139], a[116:119], v[228:231]
ds_read_b128 a[108:111], v13 offset:6144
s_add_u32 m0, s49, 39936
v_mfma_f32_16x16x32_bf16 v[232:235], a[136:139], a[120:123], v[232:235]
buffer_load_dwordx4 v3, s[8:11], s98 offen lds
v_mfma_f32_16x16x32_bf16 v[236:239], a[136:139], a[124:127], v[236:239]
s_waitcnt vmcnt(13) lgkmcnt(4)
s_barrier
v_mfma_f32_16x16x32_bf16 v[252:255], a[140:143], a[124:127], v[252:255]
ds_read_b128 a[128:131], v15 offset:0
v_mfma_f32_16x16x32_bf16 v[248:251], a[140:143], a[120:123], v[248:251]
ds_read_b128 a[132:135], v15 offset:2048
s_add_u32 s45, s45, 28311552
v_mfma_f32_16x16x32_bf16 v[244:247], a[140:143], a[116:119], v[244:247]
ds_read_b128 a[136:139], v15 offset:4096
v_writelane_b32 v63, s45, 6
v_mfma_f32_16x16x32_bf16 v[240:243], a[140:143], a[112:115], v[240:243]
v_mfma_f32_16x16x32_bf16 a[0:3], a[144:147], a[112:115], a[0:3]
ds_read_b128 a[140:143], v15 offset:6144
s_add_u32 s45, s45, 128
v_mfma_f32_16x16x32_bf16 a[4:7], a[144:147], a[116:119], a[4:7]
v_writelane_b32 v63, s45, 7
v_mfma_f32_16x16x32_bf16 a[8:11], a[144:147], a[120:123], a[8:11]
s_lshl_b32 s45, s55, 6
v_mfma_f32_16x16x32_bf16 a[12:15], a[144:147], a[124:127], a[12:15]
s_add_u32 s45, s45, 29360128
v_mfma_f32_16x16x32_bf16 a[28:31], a[148:151], a[124:127], a[28:31]
ds_read_b64_tr_b16 a[144:145], v17 offset:0
v_writelane_b32 v63, s45, 8
v_mfma_f32_16x16x32_bf16 a[24:27], a[148:151], a[120:123], a[24:27]
ds_read_b64_tr_b16 a[146:147], v17 offset:1792
v_mfma_f32_16x16x32_bf16 a[20:23], a[148:151], a[116:119], a[20:23]
buffer_store_dword v62, v63, s[20:23], 0 offen sc1
v_mfma_f32_16x16x32_bf16 a[16:19], a[148:151], a[112:115], a[16:19]
s_waitcnt lgkmcnt(4)
v_mfma_f32_16x16x32_bf16 a[32:35], a[96:99], a[128:131], a[32:35]
ds_read_b64_tr_b16 a[148:149], v17 offset:14336
s_add_u32 m0, s50, 28672
v_mfma_f32_16x16x32_bf16 a[36:39], a[100:103], a[128:131], a[36:39]
ds_read_b64_tr_b16 a[150:151], v17 offset:16128
s_mov_b32 s99, 1376256
v_mfma_f32_16x16x32_bf16 a[40:43], a[104:107], a[128:131], a[40:43]
buffer_load_dwordx4 v6, s[12:15], s99 offen  lds
v_mfma_f32_16x16x32_bf16 a[44:47], a[108:111], a[128:131], a[44:47]
v_lshlrev_b32 v20, 16, v48
v_and_b32 v21, 0xffff0000, v48
v_mfma_f32_16x16x32_bf16 a[60:63], a[108:111], a[132:135], a[60:63]
ds_read_b64_tr_b16 a[128:129], v17 offset:32
v_add_f32 v40, v40, v20
v_mfma_f32_16x16x32_bf16 a[56:59], a[104:107], a[132:135], a[56:59]
ds_read_b64_tr_b16 a[130:131], v17 offset:1824
v_add_f32 v41, v41, v21
v_mfma_f32_16x16x32_bf16 a[52:55], a[100:103], a[132:135], a[52:55]
ds_read_b128 a[112:115], v14 offset:0
v_lshlrev_b32_e64 v20, 16, v49
v_mfma_f32_16x16x32_bf16 a[48:51], a[96:99], a[132:135], a[48:51]
v_and_b32 v21, 0xffff0000, v49
s_waitcnt lgkmcnt(7)
v_mfma_f32_16x16x32_bf16 a[64:67], a[96:99], a[136:139], a[64:67]
ds_read_b64_tr_b16 a[132:133], v17 offset:14368
v_add_f32 v42, v42, v20
v_mfma_f32_16x16x32_bf16 a[68:71], a[100:103], a[136:139], a[68:71]
ds_read_b64_tr_b16 a[134:135], v17 offset:16160
s_add_u32 m0, s50, 29696
v_mfma_f32_16x16x32_bf16 a[72:75], a[104:107], a[136:139], a[72:75]
buffer_load_dwordx4 v7, s[12:15], s99 offen  lds
v_mfma_f32_16x16x32_bf16 a[76:79], a[108:111], a[136:139], a[76:79]
v_add_f32 v43, v43, v21
v_lshlrev_b32 v20, 16, v50
v_mfma_f32_16x16x32_bf16 a[92:95], a[108:111], a[140:143], a[92:95]
ds_read_b64_tr_b16 a[136:137], v17 offset:64
v_and_b32 v21, 0xffff0000, v50
v_mfma_f32_16x16x32_bf16 a[88:91], a[104:107], a[140:143], a[88:91]
ds_read_b64_tr_b16 a[138:139], v17 offset:1856
v_add_f32 v44, v44, v20
v_mfma_f32_16x16x32_bf16 a[84:87], a[100:103], a[140:143], a[84:87]
v_add_f32 v45, v45, v21
v_mfma_f32_16x16x32_bf16 a[80:83], a[96:99], a[140:143], a[80:83]
v_lshlrev_b32 v20, 16, v51
s_waitcnt lgkmcnt(7)
v_mfma_f32_16x16x32_bf16 v[64:67], a[144:147], a[96:99], v[64:67]
ds_read_b64_tr_b16 a[140:141], v17 offset:14400
v_and_b32 v21, 0xffff0000, v51
v_mfma_f32_16x16x32_bf16 v[68:71], a[144:147], a[100:103], v[68:71]
ds_read_b64_tr_b16 a[142:143], v17 offset:16192
s_add_u32 m0, s50, 30720
v_mfma_f32_16x16x32_bf16 v[72:75], a[144:147], a[104:107], v[72:75]
buffer_load_dwordx4 v8, s[12:15], s99 offen  lds
v_mfma_f32_16x16x32_bf16 v[76:79], a[144:147], a[108:111], v[76:79]
v_add_f32 v46, v46, v20
v_add_f32 v47, v47, v21
v_mfma_f32_16x16x32_bf16 v[92:95], a[148:151], a[108:111], v[92:95]
ds_read_b64_tr_b16 a[144:145], v17 offset:96
v_lshlrev_b32_e64 v20, 16, v36
v_mfma_f32_16x16x32_bf16 v[88:91], a[148:151], a[104:107], v[88:91]
ds_read_b64_tr_b16 a[146:147], v17 offset:1888
v_and_b32 v21, 0xffff0000, v36
v_mfma_f32_16x16x32_bf16 v[84:87], a[148:151], a[100:103], v[84:87]
ds_read_b128 a[116:119], v14 offset:2048
v_add_f32 v40, v40, v20
v_mfma_f32_16x16x32_bf16 v[80:83], a[148:151], a[96:99], v[80:83]
v_add_f32 v41, v41, v21
s_waitcnt lgkmcnt(7)
v_mfma_f32_16x16x32_bf16 v[96:99], a[128:131], a[96:99], v[96:99]
ds_read_b64_tr_b16 a[148:149], v17 offset:14432
v_lshlrev_b32 v20, 16, v37
v_mfma_f32_16x16x32_bf16 v[100:103], a[128:131], a[100:103], v[100:103]
ds_read_b64_tr_b16 a[150:151], v17 offset:16224
s_add_u32 m0, s50, 31744
v_mfma_f32_16x16x32_bf16 v[104:107], a[128:131], a[104:107], v[104:107]
buffer_load_dwordx4 v9, s[12:15], s99 offen  lds
v_mfma_f32_16x16x32_bf16 v[108:111], a[128:131], a[108:111], v[108:111]
v_and_b32 v21, 0xffff0000, v37
v_add_f32_e64 v42, v42, v20
v_mfma_f32_16x16x32_bf16 v[124:127], a[132:135], a[108:111], v[124:127]
ds_read_b64_tr_b16 a[128:129], v17 offset:128
v_mfma_f32_16x16x32_bf16 v[120:123], a[132:135], a[104:107], v[120:123]
ds_read_b64_tr_b16 a[130:131], v17 offset:1920
v_add_f32_e64 v43, v43, v21
v_mfma_f32_16x16x32_bf16 v[116:119], a[132:135], a[100:103], v[116:119]
v_lshlrev_b32 v20, 16, v38
v_and_b32 v21, 0xffff0000, v38
v_mfma_f32_16x16x32_bf16 v[112:115], a[132:135], a[96:99], v[112:115]
v_add_f32 v44, v44, v20
s_waitcnt lgkmcnt(7)
v_mfma_f32_16x16x32_bf16 v[128:131], a[136:139], a[96:99], v[128:131]
ds_read_b64_tr_b16 a[132:133], v17 offset:14464
v_add_f32 v45, v45, v21
v_mfma_f32_16x16x32_bf16 v[132:135], a[136:139], a[100:103], v[132:135]
ds_read_b64_tr_b16 a[134:135], v17 offset:16256
s_add_u32 m0, s50, 32768
v_mfma_f32_16x16x32_bf16 v[136:139], a[136:139], a[104:107], v[136:139]
buffer_load_dwordx4 v10, s[12:15], s99 offen  lds
v_mfma_f32_16x16x32_bf16 v[140:143], a[136:139], a[108:111], v[140:143]
v_lshlrev_b32_e64 v20, 16, v39
v_and_b32 v21, 0xffff0000, v39
v_mfma_f32_16x16x32_bf16 v[156:159], a[140:143], a[108:111], v[156:159]
ds_read_b64_tr_b16 a[136:137], v17 offset:160
v_add_f32 v46, v46, v20
v_mfma_f32_16x16x32_bf16 v[152:155], a[140:143], a[104:107], v[152:155]
ds_read_b64_tr_b16 a[138:139], v17 offset:1952
v_add_f32 v47, v47, v21
v_mfma_f32_16x16x32_bf16 v[148:151], a[140:143], a[100:103], v[148:151]
ds_read_b128 a[120:123], v14 offset:4096
v_lshlrev_b32_e64 v20, 16, v24
v_mfma_f32_16x16x32_bf16 v[144:147], a[140:143], a[96:99], v[144:147]
v_and_b32 v21, 0xffff0000, v24
s_waitcnt lgkmcnt(7)
v_mfma_f32_16x16x32_bf16 v[160:163], a[144:147], a[96:99], v[160:163]
ds_read_b64_tr_b16 a[140:141], v17 offset:14496
v_mfma_f32_16x16x32_bf16 v[164:167], a[144:147], a[100:103], v[164:167]
ds_read_b64_tr_b16 a[142:143], v17 offset:16288
s_add_u32 m0, s50, 33792
v_mfma_f32_16x16x32_bf16 v[168:171], a[144:147], a[104:107], v[168:171]
buffer_load_dwordx4 v11, s[12:15], s99 offen  lds
v_mfma_f32_16x16x32_bf16 v[172:175], a[144:147], a[108:111], v[172:175]
v_add_f32 v32, v32, v20
v_fmac_f32_e64 v33, v20, v20
v_mfma_f32_16x16x32_bf16 v[188:191], a[148:151], a[108:111], v[188:191]
ds_read_b64_tr_b16 a[144:145], v17 offset:192
v_add_f32 v32, v32, v21
v_mfma_f32_16x16x32_bf16 v[184:187], a[148:151], a[104:107], v[184:187]
ds_read_b64_tr_b16 a[146:147], v17 offset:1984
v_fmac_f32 v33, v21, v21
v_mfma_f32_16x16x32_bf16 v[180:183], a[148:151], a[100:103], v[180:183]
v_lshlrev_b32 v20, 16, v25
v_and_b32 v21, 0xffff0000, v25
v_mfma_f32_16x16x32_bf16 v[176:179], a[148:151], a[96:99], v[176:179]
v_add_f32 v32, v32, v20
s_waitcnt lgkmcnt(7)
v_mfma_f32_16x16x32_bf16 v[192:195], a[128:131], a[96:99], v[192:195]
ds_read_b64_tr_b16 a[148:149], v17 offset:14528
v_fmac_f32 v33, v20, v20
v_mfma_f32_16x16x32_bf16 v[196:199], a[128:131], a[100:103], v[196:199]
ds_read_b64_tr_b16 a[150:151], v17 offset:16320
s_add_u32 m0, s50, 34816
v_mfma_f32_16x16x32_bf16 v[200:203], a[128:131], a[104:107], v[200:203]
buffer_load_dwordx4 v12, s[12:15], s99 offen  lds
v_mfma_f32_16x16x32_bf16 v[204:207], a[128:131], a[108:111], v[204:207]
v_add_f32 v32, v32, v21
v_fmac_f32 v33, v21, v21
v_mfma_f32_16x16x32_bf16 v[220:223], a[132:135], a[108:111], v[220:223]
ds_read_b128 a[128:131], v16 offset:0
v_lshlrev_b32_e64 v20, 16, v26
v_mfma_f32_16x16x32_bf16 v[216:219], a[132:135], a[104:107], v[216:219]
v_and_b32 v21, 0xffff0000, v26
v_mfma_f32_16x16x32_bf16 v[212:215], a[132:135], a[100:103], v[212:215]
ds_read_b128 a[124:127], v14 offset:6144
v_add_f32 v32, v32, v20
v_mfma_f32_16x16x32_bf16 v[208:211], a[132:135], a[96:99], v[208:211]
v_fmac_f32_e64 v33, v20, v20
s_waitcnt lgkmcnt(6)
v_mfma_f32_16x16x32_bf16 v[224:227], a[136:139], a[96:99], v[224:227]
ds_read_b128 a[132:135], v16 offset:2048
s_add_u32 m0, s51, 8192
v_mfma_f32_16x16x32_bf16 v[228:231], a[136:139], a[100:103], v[228:231]
s_mov_b32 s100, 384
v_add_f32 v32, v32, v21
v_fmac_f32 v33, v21, v21
v_mfma_f32_16x16x32_bf16 v[232:235], a[136:139], a[104:107], v[232:235]
buffer_load_dwordx4 v4, s[16:19], s100 offen lds
v_mfma_f32_16x16x32_bf16 v[236:239], a[136:139], a[108:111], v[236:239]
v_lshlrev_b32_e64 v20, 16, v27
v_mfma_f32_16x16x32_bf16 v[252:255], a[140:143], a[108:111], v[252:255]
ds_read_b128 a[136:139], v16 offset:4096
v_and_b32 v21, 0xffff0000, v27
v_mfma_f32_16x16x32_bf16 v[248:251], a[140:143], a[104:107], v[248:251]
v_add_f32 v32, v32, v20
v_fmac_f32 v33, v20, v20
v_mfma_f32_16x16x32_bf16 v[244:247], a[140:143], a[100:103], v[244:247]
v_add_f32 v32, v32, v21
v_fmac_f32_e64 v33, v21, v21
v_mfma_f32_16x16x32_bf16 v[240:243], a[140:143], a[96:99], v[240:243]
s_waitcnt lgkmcnt(4)
v_mfma_f32_16x16x32_bf16 a[0:3], a[144:147], a[96:99], a[0:3]
ds_read_b128 a[140:143], v16 offset:6144
v_mfma_f32_16x16x32_bf16 a[4:7], a[144:147], a[100:103], a[4:7]
s_add_u32 m0, s51, 9216
v_mfma_f32_16x16x32_bf16 a[8:11], a[144:147], a[104:107], a[8:11]
buffer_load_dwordx4 v5, s[16:19], s100 offen lds
v_mfma_f32_16x16x32_bf16 a[12:15], a[144:147], a[108:111], a[12:15]
s_mov_b32 s101, 2752512
v_mfma_f32_16x16x32_bf16 a[28:31], a[148:151], a[108:111], a[28:31]
ds_read_b64_tr_b16 a[144:145], v17 offset:7168
v_mfma_f32_16x16x32_bf16 a[24:27], a[148:151], a[104:107], a[24:27]
ds_read_b64_tr_b16 a[146:147], v17 offset:8960
v_mfma_f32_16x16x32_bf16 a[20:23], a[148:151], a[100:103], a[20:23]
buffer_load_dwordx4 v[48:51], v18, s[12:15], s101 offen
v_mfma_f32_16x16x32_bf16 a[16:19], a[148:151], a[96:99], a[16:19]
s_waitcnt lgkmcnt(4)
v_mfma_f32_16x16x32_bf16 a[32:35], a[112:115], a[128:131], a[32:35]
ds_read_b64_tr_b16 a[148:149], v17 offset:21504
v_mfma_f32_16x16x32_bf16 a[36:39], a[116:119], a[128:131], a[36:39]
ds_read_b64_tr_b16 a[150:151], v17 offset:23296
v_mfma_f32_16x16x32_bf16 a[40:43], a[120:123], a[128:131], a[40:43]
buffer_load_dwordx4 v[24:27], v22, s[8:11], s60 offen offset:1024
v_mfma_f32_16x16x32_bf16 a[44:47], a[124:127], a[128:131], a[44:47]
v_mfma_f32_16x16x32_bf16 a[60:63], a[124:127], a[132:135], a[60:63]
ds_read_b64_tr_b16 a[128:129], v17 offset:7200
v_mfma_f32_16x16x32_bf16 a[56:59], a[120:123], a[132:135], a[56:59]
ds_read_b64_tr_b16 a[130:131], v17 offset:8992
v_mfma_f32_16x16x32_bf16 a[52:55], a[116:119], a[132:135], a[52:55]
v_mfma_f32_16x16x32_bf16 a[48:51], a[112:115], a[132:135], a[48:51]
s_waitcnt lgkmcnt(6)
v_mfma_f32_16x16x32_bf16 a[64:67], a[112:115], a[136:139], a[64:67]
ds_read_b64_tr_b16 a[132:133], v17 offset:21536
v_mfma_f32_16x16x32_bf16 a[68:71], a[116:119], a[136:139], a[68:71]
ds_read_b64_tr_b16 a[134:135], v17 offset:23328
v_mfma_f32_16x16x32_bf16 a[72:75], a[120:123], a[136:139], a[72:75]
v_mfma_f32_16x16x32_bf16 a[76:79], a[124:127], a[136:139], a[76:79]
v_mfma_f32_16x16x32_bf16 a[92:95], a[124:127], a[140:143], a[92:95]
ds_read_b64_tr_b16 a[136:137], v17 offset:7232
s_add_u32 m0, s49, 0
v_mfma_f32_16x16x32_bf16 a[88:91], a[120:123], a[140:143], a[88:91]
ds_read_b64_tr_b16 a[138:139], v17 offset:9024
s_mov_b32 s98, 512
v_mfma_f32_16x16x32_bf16 a[84:87], a[116:119], a[140:143], a[84:87]
buffer_load_dwordx4 v2, s[8:11], s98 offen lds
v_mfma_f32_16x16x32_bf16 a[80:83], a[112:115], a[140:143], a[80:83]
s_waitcnt lgkmcnt(6)
v_mfma_f32_16x16x32_bf16 v[64:67], a[144:147], a[112:115], v[64:67]
ds_read_b64_tr_b16 a[140:141], v17 offset:21568
v_mfma_f32_16x16x32_bf16 v[68:71], a[144:147], a[116:119], v[68:71]
ds_read_b64_tr_b16 a[142:143], v17 offset:23360
s_add_u32 m0, s49, 1024
v_mfma_f32_16x16x32_bf16 v[72:75], a[144:147], a[120:123], v[72:75]
buffer_load_dwordx4 v3, s[8:11], s98 offen lds
v_mfma_f32_16x16x32_bf16 v[76:79], a[144:147], a[124:127], v[76:79]
v_mfma_f32_16x16x32_bf16 v[92:95], a[148:151], a[124:127], v[92:95]
ds_read_b64_tr_b16 a[144:145], v17 offset:7264
v_mfma_f32_16x16x32_bf16 v[88:91], a[148:151], a[120:123], v[88:91]
ds_read_b64_tr_b16 a[146:147], v17 offset:9056
v_mfma_f32_16x16x32_bf16 v[84:87], a[148:151], a[116:119], v[84:87]
v_mfma_f32_16x16x32_bf16 v[80:83], a[148:151], a[112:115], v[80:83]
s_waitcnt lgkmcnt(6)
v_mfma_f32_16x16x32_bf16 v[96:99], a[128:131], a[112:115], v[96:99]
ds_read_b64_tr_b16 a[148:149], v17 offset:21600
s_add_u32 m0, s49, 2048
v_mfma_f32_16x16x32_bf16 v[100:103], a[128:131], a[116:119], v[100:103]
ds_read_b64_tr_b16 a[150:151], v17 offset:23392
s_mov_b32 s98, 2560
v_mfma_f32_16x16x32_bf16 v[104:107], a[128:131], a[120:123], v[104:107]
buffer_load_dwordx4 v2, s[8:11], s98 offen lds
v_mfma_f32_16x16x32_bf16 v[108:111], a[128:131], a[124:127], v[108:111]
v_mfma_f32_16x16x32_bf16 v[124:127], a[132:135], a[124:127], v[124:127]
ds_read_b64_tr_b16 a[128:129], v17 offset:7296
v_mfma_f32_16x16x32_bf16 v[120:123], a[132:135], a[120:123], v[120:123]
ds_read_b64_tr_b16 a[130:131], v17 offset:9088
s_add_u32 m0, s49, 3072
v_mfma_f32_16x16x32_bf16 v[116:119], a[132:135], a[116:119], v[116:119]
buffer_load_dwordx4 v3, s[8:11], s98 offen lds
v_mfma_f32_16x16x32_bf16 v[112:115], a[132:135], a[112:115], v[112:115]
s_waitcnt lgkmcnt(6)
v_mfma_f32_16x16x32_bf16 v[128:131], a[136:139], a[112:115], v[128:131]
ds_read_b64_tr_b16 a[132:133], v17 offset:21632
v_mfma_f32_16x16x32_bf16 v[132:135], a[136:139], a[116:119], v[132:135]
ds_read_b64_tr_b16 a[134:135], v17 offset:23424
v_mfma_f32_16x16x32_bf16 v[136:139], a[136:139], a[120:123], v[136:139]
v_mfma_f32_16x16x32_bf16 v[140:143], a[136:139], a[124:127], v[140:143]
v_mfma_f32_16x16x32_bf16 v[156:159], a[140:143], a[124:127], v[156:159]
ds_read_b64_tr_b16 a[136:137], v17 offset:7328
s_add_u32 m0, s49, 4096
v_mfma_f32_16x16x32_bf16 v[152:155], a[140:143], a[120:123], v[152:155]
ds_read_b64_tr_b16 a[138:139], v17 offset:9120
s_mov_b32 s98, 4608
v_mfma_f32_16x16x32_bf16 v[148:151], a[140:143], a[116:119], v[148:151]
buffer_load_dwordx4 v2, s[8:11], s98 offen lds
v_mfma_f32_16x16x32_bf16 v[144:147], a[140:143], a[112:115], v[144:147]
s_waitcnt lgkmcnt(6)
v_mfma_f32_16x16x32_bf16 v[160:163], a[144:147], a[112:115], v[160:163]
ds_read_b64_tr_b16 a[140:141], v17 offset:21664
v_mfma_f32_16x16x32_bf16 v[164:167], a[144:147], a[116:119], v[164:167]
ds_read_b64_tr_b16 a[142:143], v17 offset:23456
s_add_u32 m0, s49, 5120
v_mfma_f32_16x16x32_bf16 v[168:171], a[144:147], a[120:123], v[168:171]
buffer_load_dwordx4 v3, s[8:11], s98 offen lds
v_mfma_f32_16x16x32_bf16 v[172:175], a[144:147], a[124:127], v[172:175]
v_mfma_f32_16x16x32_bf16 v[188:191], a[148:151], a[124:127], v[188:191]
ds_read_b64_tr_b16 a[144:145], v17 offset:7360
v_mfma_f32_16x16x32_bf16 v[184:187], a[148:151], a[120:123], v[184:187]
ds_read_b64_tr_b16 a[146:147], v17 offset:9152
v_mfma_f32_16x16x32_bf16 v[180:183], a[148:151], a[116:119], v[180:183]
v_mfma_f32_16x16x32_bf16 v[176:179], a[148:151], a[112:115], v[176:179]
s_waitcnt lgkmcnt(6)
v_mfma_f32_16x16x32_bf16 v[192:195], a[128:131], a[112:115], v[192:195]
ds_read_b64_tr_b16 a[148:149], v17 offset:21696
s_add_u32 m0, s49, 6144
v_mfma_f32_16x16x32_bf16 v[196:199], a[128:131], a[116:119], v[196:199]
ds_read_b64_tr_b16 a[150:151], v17 offset:23488
s_mov_b32 s98, 6656
v_mfma_f32_16x16x32_bf16 v[200:203], a[128:131], a[120:123], v[200:203]
buffer_load_dwordx4 v2, s[8:11], s98 offen lds
v_mfma_f32_16x16x32_bf16 v[204:207], a[128:131], a[124:127], v[204:207]
v_mfma_f32_16x16x32_bf16 v[220:223], a[132:135], a[124:127], v[220:223]
s_waitcnt vmcnt(19)
ds_read_b128 a[96:99], v13 offset:32768
v_mfma_f32_16x16x32_bf16 v[216:219], a[132:135], a[120:123], v[216:219]
ds_read_b128 a[100:103], v13 offset:34816
v_mfma_f32_16x16x32_bf16 v[212:215], a[132:135], a[116:119], v[212:215]
v_mfma_f32_16x16x32_bf16 v[208:211], a[132:135], a[112:115], v[208:211]
s_waitcnt lgkmcnt(6)
v_mfma_f32_16x16x32_bf16 v[224:227], a[136:139], a[112:115], v[224:227]
ds_read_b128 a[104:107], v13 offset:36864
v_mfma_f32_16x16x32_bf16 v[228:231], a[136:139], a[116:119], v[228:231]
ds_read_b128 a[108:111], v13 offset:38912
s_add_u32 m0, s49, 7168
v_mfma_f32_16x16x32_bf16 v[232:235], a[136:139], a[120:123], v[232:235]
buffer_load_dwordx4 v3, s[8:11], s98 offen lds
v_mfma_f32_16x16x32_bf16 v[236:239], a[136:139], a[124:127], v[236:239]
s_waitcnt vmcnt(10) lgkmcnt(4)
s_barrier
v_mfma_f32_16x16x32_bf16 v[252:255], a[140:143], a[124:127], v[252:255]
ds_read_b128 a[128:131], v15 offset:8192
v_mfma_f32_16x16x32_bf16 v[248:251], a[140:143], a[120:123], v[248:251]
ds_read_b128 a[132:135], v15 offset:10240
v_mfma_f32_16x16x32_bf16 v[244:247], a[140:143], a[116:119], v[244:247]
ds_read_b128 a[136:139], v15 offset:12288
v_mfma_f32_16x16x32_bf16 v[240:243], a[140:143], a[112:115], v[240:243]
v_mfma_f32_16x16x32_bf16 a[0:3], a[144:147], a[112:115], a[0:3]
ds_read_b128 a[140:143], v15 offset:14336
v_mfma_f32_16x16x32_bf16 a[4:7], a[144:147], a[116:119], a[4:7]
v_mfma_f32_16x16x32_bf16 a[8:11], a[144:147], a[120:123], a[8:11]
v_mfma_f32_16x16x32_bf16 a[12:15], a[144:147], a[124:127], a[12:15]
v_mfma_f32_16x16x32_bf16 a[28:31], a[148:151], a[124:127], a[28:31]
ds_read_b64_tr_b16 a[144:145], v17 offset:28672
v_mfma_f32_16x16x32_bf16 a[24:27], a[148:151], a[120:123], a[24:27]
ds_read_b64_tr_b16 a[146:147], v17 offset:30464
v_mfma_f32_16x16x32_bf16 a[20:23], a[148:151], a[116:119], a[20:23]
v_mfma_f32_16x16x32_bf16 a[16:19], a[148:151], a[112:115], a[16:19]
s_waitcnt lgkmcnt(4)
v_mfma_f32_16x16x32_bf16 a[32:35], a[96:99], a[128:131], a[32:35]
ds_read_b64_tr_b16 a[148:149], v17 offset:43008
s_add_u32 m0, s50, 0
v_mfma_f32_16x16x32_bf16 a[36:39], a[100:103], a[128:131], a[36:39]
ds_read_b64_tr_b16 a[150:151], v17 offset:44800
s_mov_b32 s99, 1835008
v_mfma_f32_16x16x32_bf16 a[40:43], a[104:107], a[128:131], a[40:43]
buffer_load_dwordx4 v6, s[12:15], s99 offen  lds
v_mfma_f32_16x16x32_bf16 a[44:47], a[108:111], a[128:131], a[44:47]
v_lshlrev_b32_e64 v20, 16, v52
v_and_b32 v21, 0xffff0000, v52
v_mfma_f32_16x16x32_bf16 a[60:63], a[108:111], a[132:135], a[60:63]
ds_read_b64_tr_b16 a[128:129], v17 offset:28704
v_add_f32 v40, v40, v20
v_mfma_f32_16x16x32_bf16 a[56:59], a[104:107], a[132:135], a[56:59]
ds_read_b64_tr_b16 a[130:131], v17 offset:30496
v_add_f32 v41, v41, v21
v_mfma_f32_16x16x32_bf16 a[52:55], a[100:103], a[132:135], a[52:55]
ds_read_b128 a[112:115], v14 offset:32768
v_mfma_f32_16x16x32_bf16 a[48:51], a[96:99], a[132:135], a[48:51]
v_lshlrev_b32 v20, 16, v53
s_waitcnt lgkmcnt(7)
v_mfma_f32_16x16x32_bf16 a[64:67], a[96:99], a[136:139], a[64:67]
ds_read_b64_tr_b16 a[132:133], v17 offset:43040
v_and_b32 v21, 0xffff0000, v53
v_mfma_f32_16x16x32_bf16 a[68:71], a[100:103], a[136:139], a[68:71]
ds_read_b64_tr_b16 a[134:135], v17 offset:44832
s_add_u32 m0, s50, 1024
v_mfma_f32_16x16x32_bf16 a[72:75], a[104:107], a[136:139], a[72:75]
buffer_load_dwordx4 v7, s[12:15], s99 offen  lds
v_mfma_f32_16x16x32_bf16 a[76:79], a[108:111], a[136:139], a[76:79]
v_add_f32 v42, v42, v20
v_add_f32 v43, v43, v21
v_mfma_f32_16x16x32_bf16 a[92:95], a[108:111], a[140:143], a[92:95]
ds_read_b64_tr_b16 a[136:137], v17 offset:28736
v_mfma_f32_16x16x32_bf16 a[88:91], a[104:107], a[140:143], a[88:91]
ds_read_b64_tr_b16 a[138:139], v17 offset:30528
v_lshlrev_b32_e64 v20, 16, v54
v_mfma_f32_16x16x32_bf16 a[84:87], a[100:103], a[140:143], a[84:87]
v_and_b32 v21, 0xffff0000, v54
v_add_f32 v44, v44, v20
v_mfma_f32_16x16x32_bf16 a[80:83], a[96:99], a[140:143], a[80:83]
v_add_f32_e64 v45, v45, v21
s_waitcnt lgkmcnt(7)
v_mfma_f32_16x16x32_bf16 v[64:67], a[144:147], a[96:99], v[64:67]
ds_read_b64_tr_b16 a[140:141], v17 offset:43072
v_mfma_f32_16x16x32_bf16 v[68:71], a[144:147], a[100:103], v[68:71]
ds_read_b64_tr_b16 a[142:143], v17 offset:44864
s_add_u32 m0, s50, 2048
v_mfma_f32_16x16x32_bf16 v[72:75], a[144:147], a[104:107], v[72:75]
buffer_load_dwordx4 v8, s[12:15], s99 offen  lds
v_mfma_f32_16x16x32_bf16 v[76:79], a[144:147], a[108:111], v[76:79]
v_lshlrev_b32 v20, 16, v55
v_and_b32 v21, 0xffff0000, v55
v_mfma_f32_16x16x32_bf16 v[92:95], a[148:151], a[108:111], v[92:95]
ds_read_b64_tr_b16 a[144:145], v17 offset:28768
v_add_f32 v46, v46, v20
v_mfma_f32_16x16x32_bf16 v[88:91], a[148:151], a[104:107], v[88:91]
ds_read_b64_tr_b16 a[146:147], v17 offset:30560
v_mfma_f32_16x16x32_bf16 v[84:87], a[148:151], a[100:103], v[84:87]
ds_read_b128 a[116:119], v14 offset:34816
v_add_f32 v47, v47, v21
v_mfma_f32_16x16x32_bf16 v[80:83], a[148:151], a[96:99], v[80:83]
v_lshlrev_b32_e64 v20, 16, v56
s_waitcnt lgkmcnt(7)
v_mfma_f32_16x16x32_bf16 v[96:99], a[128:131], a[96:99], v[96:99]
ds_read_b64_tr_b16 a[148:149], v17 offset:43104
v_and_b32 v21, 0xffff0000, v56
v_mfma_f32_16x16x32_bf16 v[100:103], a[128:131], a[100:103], v[100:103]
ds_read_b64_tr_b16 a[150:151], v17 offset:44896
s_add_u32 m0, s50, 3072
v_mfma_f32_16x16x32_bf16 v[104:107], a[128:131], a[104:107], v[104:107]
buffer_load_dwordx4 v9, s[12:15], s99 offen  lds
v_mfma_f32_16x16x32_bf16 v[108:111], a[128:131], a[108:111], v[108:111]
v_add_f32 v40, v40, v20
v_mfma_f32_16x16x32_bf16 v[124:127], a[132:135], a[108:111], v[124:127]
ds_read_b64_tr_b16 a[128:129], v17 offset:28800
v_add_f32 v41, v41, v21
v_mfma_f32_16x16x32_bf16 v[120:123], a[132:135], a[104:107], v[120:123]
ds_read_b64_tr_b16 a[130:131], v17 offset:30592
v_lshlrev_b32 v20, 16, v57
v_mfma_f32_16x16x32_bf16 v[116:119], a[132:135], a[100:103], v[116:119]
v_and_b32 v21, 0xffff0000, v57
v_add_f32 v42, v42, v20
L_pg2:
s_cbranch_execz L_pg6
v_mfma_f32_16x16x32_bf16 v[112:115], a[132:135], a[96:99], v[112:115]
s_waitcnt lgkmcnt(7)
v_mfma_f32_16x16x32_bf16 v[128:131], a[136:139], a[96:99], v[128:131]
ds_read_b64_tr_b16 a[132:133], v17 offset:43136
v_add_f32_e64 v43, v43, v21
v_mfma_f32_16x16x32_bf16 v[132:135], a[136:139], a[100:103], v[132:135]
ds_read_b64_tr_b16 a[134:135], v17 offset:44928
s_add_u32 m0, s50, 4096
v_mfma_f32_16x16x32_bf16 v[136:139], a[136:139], a[104:107], v[136:139]
buffer_load_dwordx4 v10, s[12:15], s99 offen  lds
v_mfma_f32_16x16x32_bf16 v[140:143], a[136:139], a[108:111], v[140:143]
v_lshlrev_b32_e64 v20, 16, v58
v_and_b32 v21, 0xffff0000, v58
v_mfma_f32_16x16x32_bf16 v[156:159], a[140:143], a[108:111], v[156:159]
ds_read_b64_tr_b16 a[136:137], v17 offset:28832
v_mfma_f32_16x16x32_bf16 v[152:155], a[140:143], a[104:107], v[152:155]
ds_read_b64_tr_b16 a[138:139], v17 offset:30624
v_add_f32 v44, v44, v20
v_mfma_f32_16x16x32_bf16 v[148:151], a[140:143], a[100:103], v[148:151]
ds_read_b128 a[120:123], v14 offset:36864
v_add_f32 v45, v45, v21
v_mfma_f32_16x16x32_bf16 v[144:147], a[140:143], a[96:99], v[144:147]
v_lshlrev_b32 v20, 16, v59
s_waitcnt lgkmcnt(7)
v_mfma_f32_16x16x32_bf16 v[160:163], a[144:147], a[96:99], v[160:163]
ds_read_b64_tr_b16 a[140:141], v17 offset:43168
v_and_b32 v21, 0xffff0000, v59
v_mfma_f32_16x16x32_bf16 v[164:167], a[144:147], a[100:103], v[164:167]
ds_read_b64_tr_b16 a[142:143], v17 offset:44960
s_add_u32 m0, s50, 5120
v_mfma_f32_16x16x32_bf16 v[168:171], a[144:147], a[104:107], v[168:171]
buffer_load_dwordx4 v11, s[12:15], s99 offen  lds
v_mfma_f32_16x16x32_bf16 v[172:175], a[144:147], a[108:111], v[172:175]
v_add_f32_e64 v46, v46, v20
v_mfma_f32_16x16x32_bf16 v[188:191], a[148:151], a[108:111], v[188:191]
ds_read_b64_tr_b16 a[144:145], v17 offset:28864
v_add_f32_e64 v47, v47, v21
v_mfma_f32_16x16x32_bf16 v[184:187], a[148:151], a[104:107], v[184:187]
ds_read_b64_tr_b16 a[146:147], v17 offset:30656
v_lshlrev_b32_e64 v20, 16, v28
v_mfma_f32_16x16x32_bf16 v[180:183], a[148:151], a[100:103], v[180:183]
v_and_b32 v21, 0xffff0000, v28
v_mfma_f32_16x16x32_bf16 v[176:179], a[148:151], a[96:99], v[176:179]
v_add_f32 v34, v34, v20
s_waitcnt lgkmcnt(7)
v_mfma_f32_16x16x32_bf16 v[192:195], a[128:131], a[96:99], v[192:195]
ds_read_b64_tr_b16 a[148:149], v17 offset:43200
v_add_f32_e64 v34, v34, v21
v_mfma_f32_16x16x32_bf16 v[196:199], a[128:131], a[100:103], v[196:199]
ds_read_b64_tr_b16 a[150:151], v17 offset:44992
s_add_u32 m0, s50, 6144
v_mfma_f32_16x16x32_bf16 v[200:203], a[128:131], a[104:107], v[200:203]
buffer_load_dwordx4 v12, s[12:15], s99 offen  lds
v_mfma_f32_16x16x32_bf16 v[204:207], a[128:131], a[108:111], v[204:207]
v_lshlrev_b32_e64 v20, 16, v29
v_mfma_f32_16x16x32_bf16 v[220:223], a[132:135], a[108:111], v[220:223]
ds_read_b128 a[128:131], v16 offset:8192
v_and_b32 v21, 0xffff0000, v29
v_mfma_f32_16x16x32_bf16 v[216:219], a[132:135], a[104:107], v[216:219]
v_add_f32 v34, v34, v20
v_add_f32 v34, v34, v21
v_mfma_f32_16x16x32_bf16 v[212:215], a[132:135], a[100:103], v[212:215]
ds_read_b128 a[124:127], v14 offset:38912
v_lshlrev_b32_e64 v20, 16, v30
v_mfma_f32_16x16x32_bf16 v[208:211], a[132:135], a[96:99], v[208:211]
s_waitcnt lgkmcnt(6)
v_mfma_f32_16x16x32_bf16 v[224:227], a[136:139], a[96:99], v[224:227]
ds_read_b128 a[132:135], v16 offset:10240
s_add_u32 m0, s51, 0
v_mfma_f32_16x16x32_bf16 v[228:231], a[136:139], a[100:103], v[228:231]
s_mov_b32 s100, 512
v_and_b32 v21, 0xffff0000, v30
v_add_f32_e64 v34, v34, v20
v_mfma_f32_16x16x32_bf16 v[232:235], a[136:139], a[104:107], v[232:235]
buffer_load_dwordx4 v4, s[16:19], s100 offen lds
v_mfma_f32_16x16x32_bf16 v[236:239], a[136:139], a[108:111], v[236:239]
v_add_f32_e64 v34, v34, v21
v_mfma_f32_16x16x32_bf16 v[252:255], a[140:143], a[108:111], v[252:255]
ds_read_b128 a[136:139], v16 offset:12288
v_lshlrev_b32_e64 v20, 16, v31
v_mfma_f32_16x16x32_bf16 v[248:251], a[140:143], a[104:107], v[248:251]
v_and_b32 v21, 0xffff0000, v31
v_mfma_f32_16x16x32_bf16 v[244:247], a[140:143], a[100:103], v[244:247]
v_add_f32 v34, v34, v20
v_add_f32 v34, v34, v21
v_mfma_f32_16x16x32_bf16 v[240:243], a[140:143], a[96:99], v[240:243]
s_waitcnt lgkmcnt(4)
v_mfma_f32_16x16x32_bf16 a[0:3], a[144:147], a[96:99], a[0:3]
ds_read_b128 a[140:143], v16 offset:14336
v_mfma_f32_16x16x32_bf16 a[4:7], a[144:147], a[100:103], a[4:7]
s_add_u32 m0, s51, 1024
v_mfma_f32_16x16x32_bf16 a[8:11], a[144:147], a[104:107], a[8:11]
buffer_load_dwordx4 v5, s[16:19], s100 offen lds
v_mfma_f32_16x16x32_bf16 a[12:15], a[144:147], a[108:111], a[12:15]
s_mov_b32 s101, 3211264
v_mfma_f32_16x16x32_bf16 a[28:31], a[148:151], a[108:111], a[28:31]
ds_read_b64_tr_b16 a[144:145], v17 offset:35840
v_mfma_f32_16x16x32_bf16 a[24:27], a[148:151], a[104:107], a[24:27]
ds_read_b64_tr_b16 a[146:147], v17 offset:37632
v_mfma_f32_16x16x32_bf16 a[20:23], a[148:151], a[100:103], a[20:23]
buffer_load_dwordx4 v[52:55], v18, s[12:15], s101 offen
v_mfma_f32_16x16x32_bf16 a[16:19], a[148:151], a[96:99], a[16:19]
s_waitcnt lgkmcnt(4)
v_mfma_f32_16x16x32_bf16 a[32:35], a[112:115], a[128:131], a[32:35]
ds_read_b64_tr_b16 a[148:149], v17 offset:50176
v_mfma_f32_16x16x32_bf16 a[36:39], a[116:119], a[128:131], a[36:39]
ds_read_b64_tr_b16 a[150:151], v17 offset:51968
v_mfma_f32_16x16x32_bf16 a[40:43], a[120:123], a[128:131], a[40:43]
buffer_load_dwordx4 v[28:31], v22, s[16:19], s61 offen offset:1024
v_mfma_f32_16x16x32_bf16 a[44:47], a[124:127], a[128:131], a[44:47]
s_lshl_b32 s63, s55, 10
s_add_u32 s63, s63, 0
v_mfma_f32_16x16x32_bf16 a[60:63], a[124:127], a[132:135], a[60:63]
ds_read_b64_tr_b16 a[128:129], v17 offset:35872
v_mfma_f32_16x16x32_bf16 a[56:59], a[120:123], a[132:135], a[56:59]
ds_read_b64_tr_b16 a[130:131], v17 offset:37664
v_mfma_f32_16x16x32_bf16 a[52:55], a[116:119], a[132:135], a[52:55]
buffer_load_dwordx4 v[36:39], v23, s[28:31], s63 offen
v_mfma_f32_16x16x32_bf16 a[48:51], a[112:115], a[132:135], a[48:51]
s_lshr_b32 s48, s2, 3
s_lshl_b32 s48, s48, 2
s_waitcnt lgkmcnt(6)
v_mfma_f32_16x16x32_bf16 a[64:67], a[112:115], a[136:139], a[64:67]
ds_read_b64_tr_b16 a[132:133], v17 offset:50208
s_add_u32 s48, s48, s3
v_mfma_f32_16x16x32_bf16 a[68:71], a[116:119], a[136:139], a[68:71]
ds_read_b64_tr_b16 a[134:135], v17 offset:52000
s_lshl_b32 s48, s48, 7
v_mfma_f32_16x16x32_bf16 a[72:75], a[120:123], a[136:139], a[72:75]
s_add_u32 s48, s48, 16384
s_min_u32 s48, s48, L_codeend-L_main-4
v_mov_b32 v19, s48
v_mfma_f32_16x16x32_bf16 a[76:79], a[124:127], a[136:139], a[76:79]
global_load_dword v39, v19, s[82:83]
v_mfma_f32_16x16x32_bf16 a[92:95], a[124:127], a[140:143], a[92:95]
ds_read_b64_tr_b16 a[136:137], v17 offset:35904
s_add_u32 m0, s49, 32768
v_mfma_f32_16x16x32_bf16 a[88:91], a[120:123], a[140:143], a[88:91]
ds_read_b64_tr_b16 a[138:139], v17 offset:37696
s_mov_b32 s98, 640
v_mfma_f32_16x16x32_bf16 a[84:87], a[116:119], a[140:143], a[84:87]
buffer_load_dwordx4 v2, s[8:11], s98 offen lds
v_mfma_f32_16x16x32_bf16 a[80:83], a[112:115], a[140:143], a[80:83]
s_waitcnt lgkmcnt(6)
v_mfma_f32_16x16x32_bf16 v[64:67], a[144:147], a[112:115], v[64:67]
ds_read_b64_tr_b16 a[140:141], v17 offset:50240
v_mfma_f32_16x16x32_bf16 v[68:71], a[144:147], a[116:119], v[68:71]
ds_read_b64_tr_b16 a[142:143], v17 offset:52032
s_add_u32 m0, s49, 33792
v_mfma_f32_16x16x32_bf16 v[72:75], a[144:147], a[120:123], v[72:75]
buffer_load_dwordx4 v3, s[8:11], s98 offen lds
v_mfma_f32_16x16x32_bf16 v[76:79], a[144:147], a[124:127], v[76:79]
v_mfma_f32_16x16x32_bf16 v[92:95], a[148:151], a[124:127], v[92:95]
ds_read_b64_tr_b16 a[144:145], v17 offset:35936
v_mfma_f32_16x16x32_bf16 v[88:91], a[148:151], a[120:123], v[88:91]
ds_read_b64_tr_b16 a[146:147], v17 offset:37728
v_mfma_f32_16x16x32_bf16 v[84:87], a[148:151], a[116:119], v[84:87]
v_mfma_f32_16x16x32_bf16 v[80:83], a[148:151], a[112:115], v[80:83]
s_waitcnt lgkmcnt(6)
v_mfma_f32_16x16x32_bf16 v[96:99], a[128:131], a[112:115], v[96:99]
ds_read_b64_tr_b16 a[148:149], v17 offset:50272
s_add_u32 m0, s49, 34816
v_mfma_f32_16x16x32_bf16 v[100:103], a[128:131], a[116:119], v[100:103]
ds_read_b64_tr_b16 a[150:151], v17 offset:52064
s_mov_b32 s98, 2688
v_mfma_f32_16x16x32_bf16 v[104:107], a[128:131], a[120:123], v[104:107]
buffer_load_dwordx4 v2, s[8:11], s98 offen lds
v_mfma_f32_16x16x32_bf16 v[108:111], a[128:131], a[124:127], v[108:111]
v_mfma_f32_16x16x32_bf16 v[124:127], a[132:135], a[124:127], v[124:127]
ds_read_b64_tr_b16 a[128:129], v17 offset:35968
v_mfma_f32_16x16x32_bf16 v[120:123], a[132:135], a[120:123], v[120:123]
ds_read_b64_tr_b16 a[130:131], v17 offset:37760
s_add_u32 m0, s49, 35840
v_mfma_f32_16x16x32_bf16 v[116:119], a[132:135], a[116:119], v[116:119]
buffer_load_dwordx4 v3, s[8:11], s98 offen lds
v_mfma_f32_16x16x32_bf16 v[112:115], a[132:135], a[112:115], v[112:115]
s_waitcnt lgkmcnt(6)
v_mfma_f32_16x16x32_bf16 v[128:131], a[136:139], a[112:115], v[128:131]
ds_read_b64_tr_b16 a[132:133], v17 offset:50304
v_mfma_f32_16x16x32_bf16 v[132:135], a[136:139], a[116:119], v[132:135]
ds_read_b64_tr_b16 a[134:135], v17 offset:52096
v_mfma_f32_16x16x32_bf16 v[136:139], a[136:139], a[120:123], v[136:139]
v_mfma_f32_16x16x32_bf16 v[140:143], a[136:139], a[124:127], v[140:143]
v_mfma_f32_16x16x32_bf16 v[156:159], a[140:143], a[124:127], v[156:159]
ds_read_b64_tr_b16 a[136:137], v17 offset:36000
s_add_u32 m0, s49, 36864
v_mfma_f32_16x16x32_bf16 v[152:155], a[140:143], a[120:123], v[152:155]
ds_read_b64_tr_b16 a[138:139], v17 offset:37792
s_mov_b32 s98, 4736
v_mfma_f32_16x16x32_bf16 v[148:151], a[140:143], a[116:119], v[148:151]
buffer_load_dwordx4 v2, s[8:11], s98 offen lds
v_mfma_f32_16x16x32_bf16 v[144:147], a[140:143], a[112:115], v[144:147]
s_waitcnt lgkmcnt(6)
v_mfma_f32_16x16x32_bf16 v[160:163], a[144:147], a[112:115], v[160:163]
ds_read_b64_tr_b16 a[140:141], v17 offset:50336
v_mfma_f32_16x16x32_bf16 v[164:167], a[144:147], a[116:119], v[164:167]
ds_read_b64_tr_b16 a[142:143], v17 offset:52128
s_add_u32 m0, s49, 37888
v_mfma_f32_16x16x32_bf16 v[168:171], a[144:147], a[120:123], v[168:171]
buffer_load_dwordx4 v3, s[8:11], s98 offen lds
v_mfma_f32_16x16x32_bf16 v[172:175], a[144:147], a[124:127], v[172:175]
v_mfma_f32_16x16x32_bf16 v[188:191], a[148:151], a[124:127], v[188:191]
ds_read_b64_tr_b16 a[144:145], v17 offset:36032
v_mfma_f32_16x16x32_bf16 v[184:187], a[148:151], a[120:123], v[184:187]
ds_read_b64_tr_b16 a[146:147], v17 offset:37824
v_mfma_f32_16x16x32_bf16 v[180:183], a[148:151], a[116:119], v[180:183]
v_mfma_f32_16x16x32_bf16 v[176:179], a[148:151], a[112:115], v[176:179]
s_waitcnt lgkmcnt(6)
v_mfma_f32_16x16x32_bf16 v[192:195], a[128:131], a[112:115], v[192:195]
ds_read_b64_tr_b16 a[148:149], v17 offset:50368
s_add_u32 m0, s49, 38912
v_mfma_f32_16x16x32_bf16 v[196:199], a[128:131], a[116:119], v[196:199]
ds_read_b64_tr_b16 a[150:151], v17 offset:52160
s_mov_b32 s98, 6784
v_mfma_f32_16x16x32_bf16 v[200:203], a[128:131], a[120:123], v[200:203]
buffer_load_dwordx4 v2, s[8:11], s98 offen lds
v_mfma_f32_16x16x32_bf16 v[204:207], a[128:131], a[124:127], v[204:207]
v_mfma_f32_16x16x32_bf16 v[220:223], a[132:135], a[124:127], v[220:223]
s_waitcnt vmcnt(20)
ds_read_b128 a[96:99], v13 offset:0
v_mfma_f32_16x16x32_bf16 v[216:219], a[132:135], a[120:123], v[216:219]
ds_read_b128 a[100:103], v13 offset:2048
v_mfma_f32_16x16x32_bf16 v[212:215], a[132:135], a[116:119], v[212:215]
v_mfma_f32_16x16x32_bf16 v[208:211], a[132:135], a[112:115], v[208:211]
s_waitcnt lgkmcnt(6)
v_mfma_f32_16x16x32_bf16 v[224:227], a[136:139], a[112:115], v[224:227]
ds_read_b128 a[104:107], v13 offset:4096
v_mfma_f32_16x16x32_bf16 v[228:231], a[136:139], a[116:119], v[228:231]
ds_read_b128 a[108:111], v13 offset:6144
s_add_u32 m0, s49, 39936
v_mfma_f32_16x16x32_bf16 v[232:235], a[136:139], a[120:123], v[232:235]
buffer_load_dwordx4 v3, s[8:11], s98 offen lds
v_mfma_f32_16x16x32_bf16 v[236:239], a[136:139], a[124:127], v[236:239]
s_waitcnt vmcnt(12) lgkmcnt(4)
s_barrier
v_mfma_f32_16x16x32_bf16 v[252:255], a[140:143], a[124:127], v[252:255]
ds_read_b128 a[128:131], v15 offset:0
v_mfma_f32_16x16x32_bf16 v[248:251], a[140:143], a[120:123], v[248:251]
ds_read_b128 a[132:135], v15 offset:2048
v_mfma_f32_16x16x32_bf16 v[244:247], a[140:143], a[116:119], v[244:247]
ds_read_b128 a[136:139], v15 offset:4096
v_mfma_f32_16x16x32_bf16 v[240:243], a[140:143], a[112:115], v[240:243]
v_mfma_f32_16x16x32_bf16 a[0:3], a[144:147], a[112:115], a[0:3]
ds_read_b128 a[140:143], v15 offset:6144
v_mfma_f32_16x16x32_bf16 a[4:7], a[144:147], a[116:119], a[4:7]
v_mfma_f32_16x16x32_bf16 a[8:11], a[144:147], a[120:123], a[8:11]
v_mfma_f32_16x16x32_bf16 a[12:15], a[144:147], a[124:127], a[12:15]
v_mfma_f32_16x16x32_bf16 a[28:31], a[148:151], a[124:127], a[28:31]
ds_read_b64_tr_b16 a[144:145], v17 offset:0
v_mfma_f32_16x16x32_bf16 a[24:27], a[148:151], a[120:123], a[24:27]
ds_read_b64_tr_b16 a[146:147], v17 offset:1792
v_mfma_f32_16x16x32_bf16 a[20:23], a[148:151], a[116:119], a[20:23]
v_mfma_f32_16x16x32_bf16 a[16:19], a[148:151], a[112:115], a[16:19]
s_waitcnt lgkmcnt(4)
v_mfma_f32_16x16x32_bf16 a[32:35], a[96:99], a[128:131], a[32:35]
ds_read_b64_tr_b16 a[148:149], v17 offset:14336
s_add_u32 m0, s50, 28672
v_mfma_f32_16x16x32_bf16 a[36:39], a[100:103], a[128:131], a[36:39]
ds_read_b64_tr_b16 a[150:151], v17 offset:16128
s_mov_b32 s99, 2293760
v_mfma_f32_16x16x32_bf16 a[40:43], a[104:107], a[128:131], a[40:43]
buffer_load_dwordx4 v6, s[12:15], s99 offen  lds
v_mfma_f32_16x16x32_bf16 a[44:47], a[108:111], a[128:131], a[44:47]
v_lshlrev_b32_e64 v20, 16, v48
v_and_b32 v21, 0xffff0000, v48
v_mfma_f32_16x16x32_bf16 a[60:63], a[108:111], a[132:135], a[60:63]
ds_read_b64_tr_b16 a[128:129], v17 offset:32
v_mfma_f32_16x16x32_bf16 a[56:59], a[104:107], a[132:135], a[56:59]
ds_read_b64_tr_b16 a[130:131], v17 offset:1824
v_add_f32 v40, v40, v20
v_mfma_f32_16x16x32_bf16 a[52:55], a[100:103], a[132:135], a[52:55]
ds_read_b128 a[112:115], v14 offset:0
v_add_f32 v41, v41, v21
v_mfma_f32_16x16x32_bf16 a[48:51], a[96:99], a[132:135], a[48:51]
s_waitcnt lgkmcnt(7)
v_mfma_f32_16x16x32_bf16 a[64:67], a[96:99], a[136:139], a[64:67]
ds_read_b64_tr_b16 a[132:133], v17 offset:14368
v_lshlrev_b32 v20, 16, v49
v_mfma_f32_16x16x32_bf16 a[68:71], a[100:103], a[136:139], a[68:71]
ds_read_b64_tr_b16 a[134:135], v17 offset:16160
s_add_u32 m0, s50, 29696
v_mfma_f32_16x16x32_bf16 a[72:75], a[104:107], a[136:139], a[72:75]
buffer_load_dwordx4 v7, s[12:15], s99 offen  lds
v_mfma_f32_16x16x32_bf16 a[76:79], a[108:111], a[136:139], a[76:79]
v_and_b32 v21, 0xffff0000, v49
v_mfma_f32_16x16x32_bf16 a[92:95], a[108:111], a[140:143], a[92:95]
ds_read_b64_tr_b16 a[136:137], v17 offset:64
v_add_f32 v42, v42, v20
v_mfma_f32_16x16x32_bf16 a[88:91], a[104:107], a[140:143], a[88:91]
ds_read_b64_tr_b16 a[138:139], v17 offset:1856
v_add_f32 v43, v43, v21
v_mfma_f32_16x16x32_bf16 a[84:87], a[100:103], a[140:143], a[84:87]
v_lshlrev_b32 v20, 16, v50
v_mfma_f32_16x16x32_bf16 a[80:83], a[96:99], a[140:143], a[80:83]
v_and_b32 v21, 0xffff0000, v50
s_waitcnt lgkmcnt(7)
v_mfma_f32_16x16x32_bf16 v[64:67], a[144:147], a[96:99], v[64:67]
ds_read_b64_tr_b16 a[140:141], v17 offset:14400
v_mfma_f32_16x16x32_bf16 v[68:71], a[144:147], a[100:103], v[68:71]
ds_read_b64_tr_b16 a[142:143], v17 offset:16192
s_add_u32 m0, s50, 30720
v_mfma_f32_16x16x32_bf16 v[72:75], a[144:147], a[104:107], v[72:75]
buffer_load_dwordx4 v8, s[12:15], s99 offen  lds
v_mfma_f32_16x16x32_bf16 v[76:79], a[144:147], a[108:111], v[76:79]
v_add_f32 v44, v44, v20
v_add_f32 v45, v45, v21
v_mfma_f32_16x16x32_bf16 v[92:95], a[148:151], a[108:111], v[92:95]
ds_read_b64_tr_b16 a[144:145], v17 offset:96
v_mfma_f32_16x16x32_bf16 v[88:91], a[148:151], a[104:107], v[88:91]
ds_read_b64_tr_b16 a[146:147], v17 offset:1888
v_lshlrev_b32_e64 v20, 16, v51
v_mfma_f32_16x16x32_bf16 v[84:87], a[148:151], a[100:103], v[84:87]
ds_read_b128 a[116:119], v14 offset:2048
v_and_b32 v21, 0xffff0000, v51
v_mfma_f32_16x16x32_bf16 v[80:83], a[148:151], a[96:99], v[80:83]
s_waitcnt lgkmcnt(7)
v_mfma_f32_16x16x32_bf16 v[96:99], a[128:131], a[96:99], v[96:99]
ds_read_b64_tr_b16 a[148:149], v17 offset:14432
v_add_f32 v46, v46, v20
v_mfma_f32_16x16x32_bf16 v[100:103], a[128:131], a[100:103], v[100:103]
ds_read_b64_tr_b16 a[150:151], v17 offset:16224
s_add_u32 m0, s50, 31744
v_mfma_f32_16x16x32_bf16 v[104:107], a[128:131], a[104:107], v[104:107]
buffer_load_dwordx4 v9, s[12:15], s99 offen  lds
v_mfma_f32_16x16x32_bf16 v[108:111], a[128:131], a[108:111], v[108:111]
v_add_f32_e64 v47, v47, v21
v_mfma_f32_16x16x32_bf16 v[124:127], a[132:135], a[108:111], v[124:127]
ds_read_b64_tr_b16 a[128:129], v17 offset:128
v_lshlrev_b32_e64 v20, 16, v24
v_mfma_f32_16x16x32_bf16 v[120:123], a[132:135], a[104:107], v[120:123]
ds_read_b64_tr_b16 a[130:131], v17 offset:1920
v_and_b32 v21, 0xffff0000, v24
v_mfma_f32_16x16x32_bf16 v[116:119], a[132:135], a[100:103], v[116:119]
v_add_f32_e64 v32, v32, v20
v_mfma_f32_16x16x32_bf16 v[112:115], a[132:135], a[96:99], v[112:115]
v_fmac_f32 v33, v20, v20
s_waitcnt lgkmcnt(7)
v_mfma_f32_16x16x32_bf16 v[128:131], a[136:139], a[96:99], v[128:131]
ds_read_b64_tr_b16 a[132:133], v17 offset:14464
v_mfma_f32_16x16x32_bf16 v[132:135], a[136:139], a[100:103], v[132:135]
ds_read_b64_tr_b16 a[134:135], v17 offset:16256
s_add_u32 m0, s50, 32768
v_mfma_f32_16x16x32_bf16 v[136:139], a[136:139], a[104:107], v[136:139]
buffer_load_dwordx4 v10, s[12:15], s99 offen  lds
v_mfma_f32_16x16x32_bf16 v[140:143], a[136:139], a[108:111], v[140:143]
v_add_f32_e64 v32, v32, v21
v_mfma_f32_16x16x32_bf16 v[156:159], a[140:143], a[108:111], v[156:159]
ds_read_b64_tr_b16 a[136:137], v17 offset:160
v_fmac_f32 v33, v21, v21
v_mfma_f32_16x16x32_bf16 v[152:155], a[140:143], a[104:107], v[152:155]
ds_read_b64_tr_b16 a[138:139], v17 offset:1952
v_lshlrev_b32 v20, 16, v25
v_mfma_f32_16x16x32_bf16 v[148:151], a[140:143], a[100:103], v[148:151]
ds_read_b128 a[120:123], v14 offset:4096
v_mfma_f32_16x16x32_bf16 v[144:147], a[140:143], a[96:99], v[144:147]
v_and_b32 v21, 0xffff0000, v25
s_waitcnt lgkmcnt(7)
v_mfma_f32_16x16x32_bf16 v[160:163], a[144:147], a[96:99], v[160:163]
ds_read_b64_tr_b16 a[140:141], v17 offset:14496
v_add_f32 v32, v32, v20
v_mfma_f32_16x16x32_bf16 v[164:167], a[144:147], a[100:103], v[164:167]
ds_read_b64_tr_b16 a[142:143], v17 offset:16288
s_add_u32 m0, s50, 33792
v_mfma_f32_16x16x32_bf16 v[168:171], a[144:147], a[104:107], v[168:171]
buffer_load_dwordx4 v11, s[12:15], s99 offen  lds
v_mfma_f32_16x16x32_bf16 v[172:175], a[144:147], a[108:111], v[172:175]
v_fmac_f32 v33, v20, v20
v_mfma_f32_16x16x32_bf16 v[188:191], a[148:151], a[108:111], v[188:191]
ds_read_b64_tr_b16 a[144:145], v17 offset:192
v_add_f32 v32, v32, v21
v_mfma_f32_16x16x32_bf16 v[184:187], a[148:151], a[104:107], v[184:187]
ds_read_b64_tr_b16 a[146:147], v17 offset:1984
v_mfma_f32_16x16x32_bf16 v[180:183], a[148:151], a[100:103], v[180:183]
v_fmac_f32 v33, v21, v21
v_lshlrev_b32 v20, 16, v26
v_mfma_f32_16x16x32_bf16 v[176:179], a[148:151], a[96:99], v[176:179]
s_waitcnt lgkmcnt(7)
v_mfma_f32_16x16x32_bf16 v[192:195], a[128:131], a[96:99], v[192:195]
ds_read_b64_tr_b16 a[148:149], v17 offset:14528
v_and_b32 v21, 0xffff0000, v26
v_mfma_f32_16x16x32_bf16 v[196:199], a[128:131], a[100:103], v[196:199]
ds_read_b64_tr_b16 a[150:151], v17 offset:16320
s_add_u32 m0, s50, 34816
v_mfma_f32_16x16x32_bf16 v[200:203], a[128:131], a[104:107], v[200:203]
buffer_load_dwordx4 v12, s[12:15], s99 offen  lds
v_mfma_f32_16x16x32_bf16 v[204:207], a[128:131], a[108:111], v[204:207]
v_add_f32 v32, v32, v20
v_mfma_f32_16x16x32_bf16 v[220:223], a[132:135], a[108:111], v[220:223]
ds_read_b128 a[128:131], v16 offset:0
v_fmac_f32 v33, v20, v20
v_mfma_f32_16x16x32_bf16 v[216:219], a[132:135], a[104:107], v[216:219]
v_add_f32 v32, v32, v21
v_mfma_f32_16x16x32_bf16 v[212:215], a[132:135], a[100:103], v[212:215]
ds_read_b128 a[124:127], v14 offset:6144
v_fmac_f32 v33, v21, v21
v_mfma_f32_16x16x32_bf16 v[208:211], a[132:135], a[96:99], v[208:211]
v_lshlrev_b32_e64 v20, 16, v27
s_waitcnt lgkmcnt(6)
v_mfma_f32_16x16x32_bf16 v[224:227], a[136:139], a[96:99], v[224:227]
ds_read_b128 a[132:135], v16 offset:2048
s_add_u32 m0, s51, 8192
v_mfma_f32_16x16x32_bf16 v[228:231], a[136:139], a[100:103], v[228:231]
s_mov_b32 s100, 640
v_and_b32 v21, 0xffff0000, v27
v_mfma_f32_16x16x32_bf16 v[232:235], a[136:139], a[104:107], v[232:235]
buffer_load_dwordx4 v4, s[16:19], s100 offen lds
v_mfma_f32_16x16x32_bf16 v[236:239], a[136:139], a[108:111], v[236:239]
v_add_f32_e64 v32, v32, v20
v_mfma_f32_16x16x32_bf16 v[252:255], a[140:143], a[108:111], v[252:255]
ds_read_b128 a[136:139], v16 offset:4096
v_mfma_f32_16x16x32_bf16 v[248:251], a[140:143], a[104:107], v[248:251]
v_fmac_f32 v33, v20, v20
v_add_f32 v32, v32, v21
v_mfma_f32_16x16x32_bf16 v[244:247], a[140:143], a[100:103], v[244:247]
v_fmac_f32_e64 v33, v21, v21
v_mfma_f32_16x16x32_bf16 v[240:243], a[140:143], a[96:99], v[240:243]
s_waitcnt lgkmcnt(4)
v_mfma_f32_16x16x32_bf16 a[0:3], a[144:147], a[96:99], a[0:3]
ds_read_b128 a[140:143], v16 offset:6144
v_mfma_f32_16x16x32_bf16 a[4:7], a[144:147], a[100:103], a[4:7]
s_add_u32 m0, s51, 9216
v_mfma_f32_16x16x32_bf16 a[8:11], a[144:147], a[104:107], a[8:11]
buffer_load_dwordx4 v5, s[16:19], s100 offen lds
v_mfma_f32_16x16x32_bf16 a[12:15], a[144:147], a[108:111], a[12:15]
s_mov_b32 s101, 3670016
v_mfma_f32_16x16x32_bf16 a[28:31], a[148:151], a[108:111], a[28:31]
ds_read_b64_tr_b16 a[144:145], v17 offset:7168
v_mfma_f32_16x16x32_bf16 a[24:27], a[148:151], a[104:107], a[24:27]
ds_read_b64_tr_b16 a[146:147], v17 offset:8960
v_mfma_f32_16x16x32_bf16 a[20:23], a[148:151], a[100:103], a[20:23]
buffer_load_dwordx4 v[48:51], v18, s[12:15], s101 offen
v_mfma_f32_16x16x32_bf16 a[16:19], a[148:151], a[96:99], a[16:19]
s_waitcnt lgkmcnt(4)
v_mfma_f32_16x16x32_bf16 a[32:35], a[112:115], a[128:131], a[32:35]
ds_read_b64_tr_b16 a[148:149], v17 offset:21504
v_mfma_f32_16x16x32_bf16 a[36:39], a[116:119], a[128:131], a[36:39]
ds_read_b64_tr_b16 a[150:151], v17 offset:23296
v_mfma_f32_16x16x32_bf16 a[40:43], a[120:123], a[128:131], a[40:43]
buffer_load_dwordx4 v[24:27], v22, s[8:11], s60 offen offset:1536
v_mfma_f32_16x16x32_bf16 a[44:47], a[124:127], a[128:131], a[44:47]
s_lshl_b32 s63, s55, 10
s_add_u32 s63, s63, 1048576
v_mfma_f32_16x16x32_bf16 a[60:63], a[124:127], a[132:135], a[60:63]
ds_read_b64_tr_b16 a[128:129], v17 offset:7200
v_mfma_f32_16x16x32_bf16 a[56:59], a[120:123], a[132:135], a[56:59]
ds_read_b64_tr_b16 a[130:131], v17 offset:8992
v_mfma_f32_16x16x32_bf16 a[52:55], a[116:119], a[132:135], a[52:55]
buffer_load_dwordx4 v[36:39], v23, s[28:31], s63 offen
v_mfma_f32_16x16x32_bf16 a[48:51], a[112:115], a[132:135], a[48:51]
s_cmp_eq_u32 s47, 4
s_cselect_b32 s46, 0, 0x1000
s_waitcnt lgkmcnt(6)
v_mfma_f32_16x16x32_bf16 a[64:67], a[112:115], a[136:139], a[64:67]
ds_read_b64_tr_b16 a[132:133], v17 offset:21536
v_mfma_f32_16x16x32_bf16 a[68:71], a[116:119], a[136:139], a[68:71]
ds_read_b64_tr_b16 a[134:135], v17 offset:23328
v_mfma_f32_16x16x32_bf16 a[72:75], a[120:123], a[136:139], a[72:75]
s_mov_b64 exec, 1
buffer_atomic_add v60, v61, s[40:43], s46 offen sc1
s_mov_b64 exec, -1
v_mfma_f32_16x16x32_bf16 a[76:79], a[124:127], a[136:139], a[76:79]
v_mfma_f32_16x16x32_bf16 a[92:95], a[124:127], a[140:143], a[92:95]
ds_read_b64_tr_b16 a[136:137], v17 offset:7232
s_add_u32 m0, s49, 0
v_mfma_f32_16x16x32_bf16 a[88:91], a[120:123], a[140:143], a[88:91]
ds_read_b64_tr_b16 a[138:139], v17 offset:9024
s_mov_b32 s98, 768
v_mfma_f32_16x16x32_bf16 a[84:87], a[116:119], a[140:143], a[84:87]
buffer_load_dwordx4 v2, s[8:11], s98 offen lds
v_mfma_f32_16x16x32_bf16 a[80:83], a[112:115], a[140:143], a[80:83]
s_waitcnt lgkmcnt(6)
v_mfma_f32_16x16x32_bf16 v[64:67], a[144:147], a[112:115], v[64:67]
ds_read_b64_tr_b16 a[140:141], v17 offset:21568
v_mfma_f32_16x16x32_bf16 v[68:71], a[144:147], a[116:119], v[68:71]
ds_read_b64_tr_b16 a[142:143], v17 offset:23360
s_add_u32 m0, s49, 1024
v_mfma_f32_16x16x32_bf16 v[72:75], a[144:147], a[120:123], v[72:75]
buffer_load_dwordx4 v3, s[8:11], s98 offen lds
v_mfma_f32_16x16x32_bf16 v[76:79], a[144:147], a[124:127], v[76:79]
v_mfma_f32_16x16x32_bf16 v[92:95], a[148:151], a[124:127], v[92:95]
ds_read_b64_tr_b16 a[144:145], v17 offset:7264
v_mfma_f32_16x16x32_bf16 v[88:91], a[148:151], a[120:123], v[88:91]
ds_read_b64_tr_b16 a[146:147], v17 offset:9056
v_mfma_f32_16x16x32_bf16 v[84:87], a[148:151], a[116:119], v[84:87]
v_mfma_f32_16x16x32_bf16 v[80:83], a[148:151], a[112:115], v[80:83]
s_waitcnt lgkmcnt(6)
v_mfma_f32_16x16x32_bf16 v[96:99], a[128:131], a[112:115], v[96:99]
ds_read_b64_tr_b16 a[148:149], v17 offset:21600
s_add_u32 m0, s49, 2048
v_mfma_f32_16x16x32_bf16 v[100:103], a[128:131], a[116:119], v[100:103]
ds_read_b64_tr_b16 a[150:151], v17 offset:23392
s_mov_b32 s98, 2816
v_mfma_f32_16x16x32_bf16 v[104:107], a[128:131], a[120:123], v[104:107]
buffer_load_dwordx4 v2, s[8:11], s98 offen lds
v_mfma_f32_16x16x32_bf16 v[108:111], a[128:131], a[124:127], v[108:111]
v_mfma_f32_16x16x32_bf16 v[124:127], a[132:135], a[124:127], v[124:127]
ds_read_b64_tr_b16 a[128:129], v17 offset:7296
v_mfma_f32_16x16x32_bf16 v[120:123], a[132:135], a[120:123], v[120:123]
ds_read_b64_tr_b16 a[130:131], v17 offset:9088
s_add_u32 m0, s49, 3072
v_mfma_f32_16x16x32_bf16 v[116:119], a[132:135], a[116:119], v[116:119]
buffer_load_dwordx4 v3, s[8:11], s98 offen lds
v_mfma_f32_16x16x32_bf16 v[112:115], a[132:135], a[112:115], v[112:115]
s_waitcnt lgkmcnt(6)
v_mfma_f32_16x16x32_bf16 v[128:131], a[136:139], a[112:115], v[128:131]
ds_read_b64_tr_b16 a[132:133], v17 offset:21632
v_mfma_f32_16x16x32_bf16 v[132:135], a[136:139], a[116:119], v[132:135]
ds_read_b64_tr_b16 a[134:135], v17 offset:23424
v_mfma_f32_16x16x32_bf16 v[136:139], a[136:139], a[120:123], v[136:139]
v_mfma_f32_16x16x32_bf16 v[140:143], a[136:139], a[124:127], v[140:143]
v_mfma_f32_16x16x32_bf16 v[156:159], a[140:143], a[124:127], v[156:159]
ds_read_b64_tr_b16 a[136:137], v17 offset:7328
s_add_u32 m0, s49, 4096
v_mfma_f32_16x16x32_bf16 v[152:155], a[140:143], a[120:123], v[152:155]
ds_read_b64_tr_b16 a[138:139], v17 offset:9120
s_mov_b32 s98, 4864
v_mfma_f32_16x16x32_bf16 v[148:151], a[140:143], a[116:119], v[148:151]
buffer_load_dwordx4 v2, s[8:11], s98 offen lds
v_mfma_f32_16x16x32_bf16 v[144:147], a[140:143], a[112:115], v[144:147]
s_waitcnt lgkmcnt(6)
v_mfma_f32_16x16x32_bf16 v[160:163], a[144:147], a[112:115], v[160:163]
ds_read_b64_tr_b16 a[140:141], v17 offset:21664
v_mfma_f32_16x16x32_bf16 v[164:167], a[144:147], a[116:119], v[164:167]
ds_read_b64_tr_b16 a[142:143], v17 offset:23456
s_add_u32 m0, s49, 5120
v_mfma_f32_16x16x32_bf16 v[168:171], a[144:147], a[120:123], v[168:171]
buffer_load_dwordx4 v3, s[8:11], s98 offen lds
v_mfma_f32_16x16x32_bf16 v[172:175], a[144:147], a[124:127], v[172:175]
v_mfma_f32_16x16x32_bf16 v[188:191], a[148:151], a[124:127], v[188:191]
ds_read_b64_tr_b16 a[144:145], v17 offset:7360
v_mfma_f32_16x16x32_bf16 v[184:187], a[148:151], a[120:123], v[184:187]
ds_read_b64_tr_b16 a[146:147], v17 offset:9152
v_mfma_f32_16x16x32_bf16 v[180:183], a[148:151], a[116:119], v[180:183]
v_mfma_f32_16x16x32_bf16 v[176:179], a[148:151], a[112:115], v[176:179]
s_waitcnt lgkmcnt(6)
v_mfma_f32_16x16x32_bf16 v[192:195], a[128:131], a[112:115], v[192:195]
ds_read_b64_tr_b16 a[148:149], v17 offset:21696
s_add_u32 m0, s49, 6144
v_mfma_f32_16x16x32_bf16 v[196:199], a[128:131], a[116:119], v[196:199]
ds_read_b64_tr_b16 a[150:151], v17 offset:23488
s_mov_b32 s98, 6912
v_mfma_f32_16x16x32_bf16 v[200:203], a[128:131], a[120:123], v[200:203]
buffer_load_dwordx4 v2, s[8:11], s98 offen lds
v_mfma_f32_16x16x32_bf16 v[204:207], a[128:131], a[124:127], v[204:207]
v_mfma_f32_16x16x32_bf16 v[220:223], a[132:135], a[124:127], v[220:223]
s_waitcnt vmcnt(20)
ds_read_b128 a[96:99], v13 offset:32768
v_mfma_f32_16x16x32_bf16 v[216:219], a[132:135], a[120:123], v[216:219]
ds_read_b128 a[100:103], v13 offset:34816
v_mfma_f32_16x16x32_bf16 v[212:215], a[132:135], a[116:119], v[212:215]
L_pg3:
s_cbranch_execz L_pg7
v_mfma_f32_16x16x32_bf16 v[208:211], a[132:135], a[112:115], v[208:211]
s_waitcnt lgkmcnt(6)
v_mfma_f32_16x16x32_bf16 v[224:227], a[136:139], a[112:115], v[224:227]
ds_read_b128 a[104:107], v13 offset:36864
v_mfma_f32_16x16x32_bf16 v[228:231], a[136:139], a[116:119], v[228:231]
ds_read_b128 a[108:111], v13 offset:38912
s_add_u32 m0, s49, 7168
v_mfma_f32_16x16x32_bf16 v[232:235], a[136:139], a[120:123], v[232:235]
buffer_load_dwordx4 v3, s[8:11], s98 offen lds
v_mfma_f32_16x16x32_bf16 v[236:239], a[136:139], a[124:127], v[236:239]
s_waitcnt vmcnt(12) lgkmcnt(4)
s_barrier
v_mfma_f32_16x16x32_bf16 v[252:255], a[140:143], a[124:127], v[252:255]
ds_read_b128 a[128:131], v15 offset:8192
v_mfma_f32_16x16x32_bf16 v[248:251], a[140:143], a[120:123], v[248:251]
ds_read_b128 a[132:135], v15 offset:10240
v_mfma_f32_16x16x32_bf16 v[244:247], a[140:143], a[116:119], v[244:247]
ds_read_b128 a[136:139], v15 offset:12288
v_mfma_f32_16x16x32_bf16 v[240:243], a[140:143], a[112:115], v[240:243]
v_mfma_f32_16x16x32_bf16 a[0:3], a[144:147], a[112:115], a[0:3]
ds_read_b128 a[140:143], v15 offset:14336
v_mfma_f32_16x16x32_bf16 a[4:7], a[144:147], a[116:119], a[4:7]
v_mfma_f32_16x16x32_bf16 a[8:11], a[144:147], a[120:123], a[8:11]
v_mfma_f32_16x16x32_bf16 a[12:15], a[144:147], a[124:127], a[12:15]
v_mfma_f32_16x16x32_bf16 a[28:31], a[148:151], a[124:127], a[28:31]
ds_read_b64_tr_b16 a[144:145], v17 offset:28672
v_mfma_f32_16x16x32_bf16 a[24:27], a[148:151], a[120:123], a[24:27]
ds_read_b64_tr_b16 a[146:147], v17 offset:30464
v_mfma_f32_16x16x32_bf16 a[20:23], a[148:151], a[116:119], a[20:23]
v_mfma_f32_16x16x32_bf16 a[16:19], a[148:151], a[112:115], a[16:19]
s_waitcnt lgkmcnt(4)
v_mfma_f32_16x16x32_bf16 a[32:35], a[96:99], a[128:131], a[32:35]
ds_read_b64_tr_b16 a[148:149], v17 offset:43008
s_add_u32 m0, s50, 0
v_mfma_f32_16x16x32_bf16 a[36:39], a[100:103], a[128:131], a[36:39]
ds_read_b64_tr_b16 a[150:151], v17 offset:44800
s_mov_b32 s99, 2752512
v_mfma_f32_16x16x32_bf16 a[40:43], a[104:107], a[128:131], a[40:43]
buffer_load_dwordx4 v6, s[12:15], s99 offen  lds
v_mfma_f32_16x16x32_bf16 a[44:47], a[108:111], a[128:131], a[44:47]
v_lshlrev_b32_e64 v20, 16, v52
v_and_b32 v21, 0xffff0000, v52
v_mfma_f32_16x16x32_bf16 a[60:63], a[108:111], a[132:135], a[60:63]
ds_read_b64_tr_b16 a[128:129], v17 offset:28704
v_mfma_f32_16x16x32_bf16 a[56:59], a[104:107], a[132:135], a[56:59]
ds_read_b64_tr_b16 a[130:131], v17 offset:30496
v_add_f32 v40, v40, v20
v_mfma_f32_16x16x32_bf16 a[52:55], a[100:103], a[132:135], a[52:55]
ds_read_b128 a[112:115], v14 offset:32768
v_mfma_f32_16x16x32_bf16 a[48:51], a[96:99], a[132:135], a[48:51]
v_add_f32 v41, v41, v21
s_waitcnt lgkmcnt(7)
v_mfma_f32_16x16x32_bf16 a[64:67], a[96:99], a[136:139], a[64:67]
ds_read_b64_tr_b16 a[132:133], v17 offset:43040
v_mfma_f32_16x16x32_bf16 a[68:71], a[100:103], a[136:139], a[68:71]
ds_read_b64_tr_b16 a[134:135], v17 offset:44832
s_add_u32 m0, s50, 1024
v_mfma_f32_16x16x32_bf16 a[72:75], a[104:107], a[136:139], a[72:75]
buffer_load_dwordx4 v7, s[12:15], s99 offen  lds
v_mfma_f32_16x16x32_bf16 a[76:79], a[108:111], a[136:139], a[76:79]
v_lshlrev_b32 v20, 16, v53
v_mfma_f32_16x16x32_bf16 a[92:95], a[108:111], a[140:143], a[92:95]
ds_read_b64_tr_b16 a[136:137], v17 offset:28736
v_and_b32 v21, 0xffff0000, v53
v_mfma_f32_16x16x32_bf16 a[88:91], a[104:107], a[140:143], a[88:91]
ds_read_b64_tr_b16 a[138:139], v17 offset:30528
v_mfma_f32_16x16x32_bf16 a[84:87], a[100:103], a[140:143], a[84:87]
v_add_f32_e64 v42, v42, v20
v_mfma_f32_16x16x32_bf16 a[80:83], a[96:99], a[140:143], a[80:83]
v_add_f32 v43, v43, v21
s_waitcnt lgkmcnt(7)
v_mfma_f32_16x16x32_bf16 v[64:67], a[144:147], a[96:99], v[64:67]
ds_read_b64_tr_b16 a[140:141], v17 offset:43072
v_mfma_f32_16x16x32_bf16 v[68:71], a[144:147], a[100:103], v[68:71]
ds_read_b64_tr_b16 a[142:143], v17 offset:44864
s_add_u32 m0, s50, 2048
v_mfma_f32_16x16x32_bf16 v[72:75], a[144:147], a[104:107], v[72:75]
buffer_load_dwordx4 v8, s[12:15], s99 offen  lds
v_mfma_f32_16x16x32_bf16 v[76:79], a[144:147], a[108:111], v[76:79]
v_lshlrev_b32_e64 v20, 16, v54
v_mfma_f32_16x16x32_bf16 v[92:95], a[148:151], a[108:111], v[92:95]
ds_read_b64_tr_b16 a[144:145], v17 offset:28768
v_and_b32 v21, 0xffff0000, v54
v_mfma_f32_16x16x32_bf16 v[88:91], a[148:151], a[104:107], v[88:91]
ds_read_b64_tr_b16 a[146:147], v17 offset:30560
v_mfma_f32_16x16x32_bf16 v[84:87], a[148:151], a[100:103], v[84:87]
ds_read_b128 a[116:119], v14 offset:34816
v_add_f32 v44, v44, v20
v_mfma_f32_16x16x32_bf16 v[80:83], a[148:151], a[96:99], v[80:83]
v_add_f32 v45, v45, v21
s_waitcnt lgkmcnt(7)
v_mfma_f32_16x16x32_bf16 v[96:99], a[128:131], a[96:99], v[96:99]
ds_read_b64_tr_b16 a[148:149], v17 offset:43104
v_mfma_f32_16x16x32_bf16 v[100:103], a[128:131], a[100:103], v[100:103]
ds_read_b64_tr_b16 a[150:151], v17 offset:44896
s_add_u32 m0, s50, 3072
v_mfma_f32_16x16x32_bf16 v[104:107], a[128:131], a[104:107], v[104:107]
buffer_load_dwordx4 v9, s[12:15], s99 offen  lds
v_mfma_f32_16x16x32_bf16 v[108:111], a[128:131], a[108:111], v[108:111]
v_lshlrev_b32 v20, 16, v55
v_mfma_f32_16x16x32_bf16 v[124:127], a[132:135], a[108:111], v[124:127]
ds_read_b64_tr_b16 a[128:129], v17 offset:28800
v_and_b32 v21, 0xffff0000, v55
v_mfma_f32_16x16x32_bf16 v[120:123], a[132:135], a[104:107], v[120:123]
ds_read_b64_tr_b16 a[130:131], v17 offset:30592
v_mfma_f32_16x16x32_bf16 v[116:119], a[132:135], a[100:103], v[116:119]
v_add_f32_e64 v46, v46, v20
v_mfma_f32_16x16x32_bf16 v[112:115], a[132:135], a[96:99], v[112:115]
v_add_f32 v47, v47, v21
s_waitcnt lgkmcnt(7)
v_mfma_f32_16x16x32_bf16 v[128:131], a[136:139], a[96:99], v[128:131]
ds_read_b64_tr_b16 a[132:133], v17 offset:43136
v_mfma_f32_16x16x32_bf16 v[132:135], a[136:139], a[100:103], v[132:135]
ds_read_b64_tr_b16 a[134:135], v17 offset:44928
s_add_u32 m0, s50, 4096
v_mfma_f32_16x16x32_bf16 v[136:139], a[136:139], a[104:107], v[136:139]
buffer_load_dwordx4 v10, s[12:15], s99 offen  lds
v_mfma_f32_16x16x32_bf16 v[140:143], a[136:139], a[108:111], v[140:143]
v_lshlrev_b32_e64 v20, 16, v28
v_mfma_f32_16x16x32_bf16 v[156:159], a[140:143], a[108:111], v[156:159]
ds_read_b64_tr_b16 a[136:137], v17 offset:28832
v_and_b32 v21, 0xffff0000, v28
v_mfma_f32_16x16x32_bf16 v[152:155], a[140:143], a[104:107], v[152:155]
ds_read_b64_tr_b16 a[138:139], v17 offset:30624
v_mfma_f32_16x16x32_bf16 v[148:151], a[140:143], a[100:103], v[148:151]
ds_read_b128 a[120:123], v14 offset:36864
v_add_f32 v34, v34, v20
v_mfma_f32_16x16x32_bf16 v[144:147], a[140:143], a[96:99], v[144:147]
s_waitcnt lgkmcnt(7)
v_mfma_f32_16x16x32_bf16 v[160:163], a[144:147], a[96:99], v[160:163]
ds_read_b64_tr_b16 a[140:141], v17 offset:43168
v_add_f32_e64 v34, v34, v21
v_mfma_f32_16x16x32_bf16 v[164:167], a[144:147], a[100:103], v[164:167]
ds_read_b64_tr_b16 a[142:143], v17 offset:44960
s_add_u32 m0, s50, 5120
v_mfma_f32_16x16x32_bf16 v[168:171], a[144:147], a[104:107], v[168:171]
buffer_load_dwordx4 v11, s[12:15], s99 offen  lds
v_mfma_f32_16x16x32_bf16 v[172:175], a[144:147], a[108:111], v[172:175]
v_lshlrev_b32_e64 v20, 16, v29
v_mfma_f32_16x16x32_bf16 v[188:191], a[148:151], a[108:111], v[188:191]
ds_read_b64_tr_b16 a[144:145], v17 offset:28864
v_mfma_f32_16x16x32_bf16 v[184:187], a[148:151], a[104:107], v[184:187]
ds_read_b64_tr_b16 a[146:147], v17 offset:30656
v_and_b32 v21, 0xffff0000, v29
v_mfma_f32_16x16x32_bf16 v[180:183], a[148:151], a[100:103], v[180:183]
v_add_f32 v34, v34, v20
v_mfma_f32_16x16x32_bf16 v[176:179], a[148:151], a[96:99], v[176:179]
v_add_f32_e64 v34, v34, v21
s_waitcnt lgkmcnt(7)
v_mfma_f32_16x16x32_bf16 v[192:195], a[128:131], a[96:99], v[192:195]
ds_read_b64_tr_b16 a[148:149], v17 offset:43200
v_mfma_f32_16x16x32_bf16 v[196:199], a[128:131], a[100:103], v[196:199]
ds_read_b64_tr_b16 a[150:151], v17 offset:44992
s_add_u32 m0, s50, 6144
v_mfma_f32_16x16x32_bf16 v[200:203], a[128:131], a[104:107], v[200:203]
buffer_load_dwordx4 v12, s[12:15], s99 offen  lds
v_mfma_f32_16x16x32_bf16 v[204:207], a[128:131], a[108:111], v[204:207]
v_lshlrev_b32_e64 v20, 16, v30
v_mfma_f32_16x16x32_bf16 v[220:223], a[132:135], a[108:111], v[220:223]
ds_read_b128 a[128:131], v16 offset:8192
v_and_b32 v21, 0xffff0000, v30
v_mfma_f32_16x16x32_bf16 v[216:219], a[132:135], a[104:107], v[216:219]
v_add_f32 v34, v34, v20
v_mfma_f32_16x16x32_bf16 v[212:215], a[132:135], a[100:103], v[212:215]
ds_read_b128 a[124:127], v14 offset:38912
v_mfma_f32_16x16x32_bf16 v[208:211], a[132:135], a[96:99], v[208:211]
v_add_f32 v34, v34, v21
s_waitcnt lgkmcnt(6)
v_mfma_f32_16x16x32_bf16 v[224:227], a[136:139], a[96:99], v[224:227]
ds_read_b128 a[132:135], v16 offset:10240
s_add_u32 m0, s51, 0
v_mfma_f32_16x16x32_bf16 v[228:231], a[136:139], a[100:103], v[228:231]
s_mov_b32 s100, 768
v_lshlrev_b32_e64 v20, 16, v31
v_mfma_f32_16x16x32_bf16 v[232:235], a[136:139], a[104:107], v[232:235]
buffer_load_dwordx4 v4, s[16:19], s100 offen lds
v_mfma_f32_16x16x32_bf16 v[236:239], a[136:139], a[108:111], v[236:239]
v_mfma_f32_16x16x32_bf16 v[252:255], a[140:143], a[108:111], v[252:255]
ds_read_b128 a[136:139], v16 offset:12288
v_and_b32 v21, 0xffff0000, v31
v_mfma_f32_16x16x32_bf16 v[248:251], a[140:143], a[104:107], v[248:251]
v_add_f32 v34, v34, v20
v_mfma_f32_16x16x32_bf16 v[244:247], a[140:143], a[100:103], v[244:247]
v_add_f32 v34, v34, v21
v_mfma_f32_16x16x32_bf16 v[240:243], a[140:143], a[96:99], v[240:243]
s_waitcnt lgkmcnt(4)
v_mfma_f32_16x16x32_bf16 a[0:3], a[144:147], a[96:99], a[0:3]
ds_read_b128 a[140:143], v16 offset:14336
v_mfma_f32_16x16x32_bf16 a[4:7], a[144:147], a[100:103], a[4:7]
s_add_u32 m0, s51, 1024
v_mfma_f32_16x16x32_bf16 a[8:11], a[144:147], a[104:107], a[8:11]
buffer_load_dwordx4 v5, s[16:19], s100 offen lds
v_mfma_f32_16x16x32_bf16 a[12:15], a[144:147], a[108:111], a[12:15]
s_mov_b32 s101, 4128768
v_mfma_f32_16x16x32_bf16 a[28:31], a[148:151], a[108:111], a[28:31]
ds_read_b64_tr_b16 a[144:145], v17 offset:35840
v_mfma_f32_16x16x32_bf16 a[24:27], a[148:151], a[104:107], a[24:27]
ds_read_b64_tr_b16 a[146:147], v17 offset:37632
v_mfma_f32_16x16x32_bf16 a[20:23], a[148:151], a[100:103], a[20:23]
buffer_load_dwordx4 v[52:55], v18, s[12:15], s101 offen
v_mfma_f32_16x16x32_bf16 a[16:19], a[148:151], a[96:99], a[16:19]
s_waitcnt lgkmcnt(4)
v_mfma_f32_16x16x32_bf16 a[32:35], a[112:115], a[128:131], a[32:35]
ds_read_b64_tr_b16 a[148:149], v17 offset:50176
v_mfma_f32_16x16x32_bf16 a[36:39], a[116:119], a[128:131], a[36:39]
ds_read_b64_tr_b16 a[150:151], v17 offset:51968
v_mfma_f32_16x16x32_bf16 a[40:43], a[120:123], a[128:131], a[40:43]
buffer_load_dwordx4 v[28:31], v22, s[16:19], s61 offen offset:1536
v_mfma_f32_16x16x32_bf16 a[44:47], a[124:127], a[128:131], a[44:47]
s_lshl_b32 s63, s55, 10
s_add_u32 s63, s63, 2097152
v_mfma_f32_16x16x32_bf16 a[60:63], a[124:127], a[132:135], a[60:63]
ds_read_b64_tr_b16 a[128:129], v17 offset:35872
v_mfma_f32_16x16x32_bf16 a[56:59], a[120:123], a[132:135], a[56:59]
ds_read_b64_tr_b16 a[130:131], v17 offset:37664
v_mfma_f32_16x16x32_bf16 a[52:55], a[116:119], a[132:135], a[52:55]
buffer_load_dwordx4 v[36:39], v23, s[28:31], s63 offen
v_mfma_f32_16x16x32_bf16 a[48:51], a[112:115], a[132:135], a[48:51]
s_waitcnt lgkmcnt(6)
v_mfma_f32_16x16x32_bf16 a[64:67], a[112:115], a[136:139], a[64:67]
ds_read_b64_tr_b16 a[132:133], v17 offset:50208
v_mfma_f32_16x16x32_bf16 a[68:71], a[116:119], a[136:139], a[68:71]
ds_read_b64_tr_b16 a[134:135], v17 offset:52000
v_mfma_f32_16x16x32_bf16 a[72:75], a[120:123], a[136:139], a[72:75]
v_mfma_f32_16x16x32_bf16 a[76:79], a[124:127], a[136:139], a[76:79]
v_mfma_f32_16x16x32_bf16 a[92:95], a[124:127], a[140:143], a[92:95]
ds_read_b64_tr_b16 a[136:137], v17 offset:35904
s_add_u32 m0, s49, 32768
v_mfma_f32_16x16x32_bf16 a[88:91], a[120:123], a[140:143], a[88:91]
ds_read_b64_tr_b16 a[138:139], v17 offset:37696
s_mov_b32 s98, 896
v_mfma_f32_16x16x32_bf16 a[84:87], a[116:119], a[140:143], a[84:87]
buffer_load_dwordx4 v2, s[8:11], s98 offen lds
v_mfma_f32_16x16x32_bf16 a[80:83], a[112:115], a[140:143], a[80:83]
s_waitcnt lgkmcnt(6)
v_mfma_f32_16x16x32_bf16 v[64:67], a[144:147], a[112:115], v[64:67]
ds_read_b64_tr_b16 a[140:141], v17 offset:50240
v_mfma_f32_16x16x32_bf16 v[68:71], a[144:147], a[116:119], v[68:71]
ds_read_b64_tr_b16 a[142:143], v17 offset:52032
s_add_u32 m0, s49, 33792
v_mfma_f32_16x16x32_bf16 v[72:75], a[144:147], a[120:123], v[72:75]
buffer_load_dwordx4 v3, s[8:11], s98 offen lds
v_mfma_f32_16x16x32_bf16 v[76:79], a[144:147], a[124:127], v[76:79]
v_mfma_f32_16x16x32_bf16 v[92:95], a[148:151], a[124:127], v[92:95]
ds_read_b64_tr_b16 a[144:145], v17 offset:35936
v_mfma_f32_16x16x32_bf16 v[88:91], a[148:151], a[120:123], v[88:91]
ds_read_b64_tr_b16 a[146:147], v17 offset:37728
v_mfma_f32_16x16x32_bf16 v[84:87], a[148:151], a[116:119], v[84:87]
v_mfma_f32_16x16x32_bf16 v[80:83], a[148:151], a[112:115], v[80:83]
s_waitcnt lgkmcnt(6)
v_mfma_f32_16x16x32_bf16 v[96:99], a[128:131], a[112:115], v[96:99]
ds_read_b64_tr_b16 a[148:149], v17 offset:50272
s_add_u32 m0, s49, 34816
v_mfma_f32_16x16x32_bf16 v[100:103], a[128:131], a[116:119], v[100:103]
ds_read_b64_tr_b16 a[150:151], v17 offset:52064
s_mov_b32 s98, 2944
v_mfma_f32_16x16x32_bf16 v[104:107], a[128:131], a[120:123], v[104:107]
buffer_load_dwordx4 v2, s[8:11], s98 offen lds
v_mfma_f32_16x16x32_bf16 v[108:111], a[128:131], a[124:127], v[108:111]
v_mfma_f32_16x16x32_bf16 v[124:127], a[132:135], a[124:127], v[124:127]
ds_read_b64_tr_b16 a[128:129], v17 offset:35968
v_mfma_f32_16x16x32_bf16 v[120:123], a[132:135], a[120:123], v[120:123]
ds_read_b64_tr_b16 a[130:131], v17 offset:37760
s_add_u32 m0, s49, 35840
v_mfma_f32_16x16x32_bf16 v[116:119], a[132:135], a[116:119], v[116:119]
buffer_load_dwordx4 v3, s[8:11], s98 offen lds
v_mfma_f32_16x16x32_bf16 v[112:115], a[132:135], a[112:115], v[112:115]
s_waitcnt lgkmcnt(6)
v_mfma_f32_16x16x32_bf16 v[128:131], a[136:139], a[112:115], v[128:131]
ds_read_b64_tr_b16 a[132:133], v17 offset:50304
v_mfma_f32_16x16x32_bf16 v[132:135], a[136:139], a[116:119], v[132:135]
ds_read_b64_tr_b16 a[134:135], v17 offset:52096
v_mfma_f32_16x16x32_bf16 v[136:139], a[136:139], a[120:123], v[136:139]
v_mfma_f32_16x16x32_bf16 v[140:143], a[136:139], a[124:127], v[140:143]
v_mfma_f32_16x16x32_bf16 v[156:159], a[140:143], a[124:127], v[156:159]
ds_read_b64_tr_b16 a[136:137], v17 offset:36000
s_add_u32 m0, s49, 36864
v_mfma_f32_16x16x32_bf16 v[152:155], a[140:143], a[120:123], v[152:155]
ds_read_b64_tr_b16 a[138:139], v17 offset:37792
s_mov_b32 s98, 4992
v_mfma_f32_16x16x32_bf16 v[148:151], a[140:143], a[116:119], v[148:151]
buffer_load_dwordx4 v2, s[8:11], s98 offen lds
v_mfma_f32_16x16x32_bf16 v[144:147], a[140:143], a[112:115], v[144:147]
s_waitcnt lgkmcnt(6)
v_mfma_f32_16x16x32_bf16 v[160:163], a[144:147], a[112:115], v[160:163]
ds_read_b64_tr_b16 a[140:141], v17 offset:50336
v_mfma_f32_16x16x32_bf16 v[164:167], a[144:147], a[116:119], v[164:167]
ds_read_b64_tr_b16 a[142:143], v17 offset:52128
s_add_u32 m0, s49, 37888
v_mfma_f32_16x16x32_bf16 v[168:171], a[144:147], a[120:123], v[168:171]
buffer_load_dwordx4 v3, s[8:11], s98 offen lds
v_mfma_f32_16x16x32_bf16 v[172:175], a[144:147], a[124:127], v[172:175]
v_mfma_f32_16x16x32_bf16 v[188:191], a[148:151], a[124:127], v[188:191]
ds_read_b64_tr_b16 a[144:145], v17 offset:36032
v_mfma_f32_16x16x32_bf16 v[184:187], a[148:151], a[120:123], v[184:187]
ds_read_b64_tr_b16 a[146:147], v17 offset:37824
v_mfma_f32_16x16x32_bf16 v[180:183], a[148:151], a[116:119], v[180:183]
v_mfma_f32_16x16x32_bf16 v[176:179], a[148:151], a[112:115], v[176:179]
s_waitcnt lgkmcnt(6)
v_mfma_f32_16x16x32_bf16 v[192:195], a[128:131], a[112:115], v[192:195]
ds_read_b64_tr_b16 a[148:149], v17 offset:50368
s_add_u32 m0, s49, 38912
v_mfma_f32_16x16x32_bf16 v[196:199], a[128:131], a[116:119], v[196:199]
ds_read_b64_tr_b16 a[150:151], v17 offset:52160
s_mov_b32 s98, 7040
v_mfma_f32_16x16x32_bf16 v[200:203], a[128:131], a[120:123], v[200:203]
buffer_load_dwordx4 v2, s[8:11], s98 offen lds
v_mfma_f32_16x16x32_bf16 v[204:207], a[128:131], a[124:127], v[204:207]
v_mfma_f32_16x16x32_bf16 v[220:223], a[132:135], a[124:127], v[220:223]
s_waitcnt vmcnt(19)
ds_read_b128 a[96:99], v13 offset:0
v_mfma_f32_16x16x32_bf16 v[216:219], a[132:135], a[120:123], v[216:219]
ds_read_b128 a[100:103], v13 offset:2048
v_mfma_f32_16x16x32_bf16 v[212:215], a[132:135], a[116:119], v[212:215]
v_mfma_f32_16x16x32_bf16 v[208:211], a[132:135], a[112:115], v[208:211]
s_waitcnt lgkmcnt(6)
v_mfma_f32_16x16x32_bf16 v[224:227], a[136:139], a[112:115], v[224:227]
ds_read_b128 a[104:107], v13 offset:4096
v_mfma_f32_16x16x32_bf16 v[228:231], a[136:139], a[116:119], v[228:231]
ds_read_b128 a[108:111], v13 offset:6144
s_add_u32 m0, s49, 39936
v_mfma_f32_16x16x32_bf16 v[232:235], a[136:139], a[120:123], v[232:235]
buffer_load_dwordx4 v3, s[8:11], s98 offen lds
v_mfma_f32_16x16x32_bf16 v[236:239], a[136:139], a[124:127], v[236:239]
s_waitcnt vmcnt(11) lgkmcnt(4)
s_barrier
v_mfma_f32_16x16x32_bf16 v[252:255], a[140:143], a[124:127], v[252:255]
ds_read_b128 a[128:131], v15 offset:0
v_mfma_f32_16x16x32_bf16 v[248:251], a[140:143], a[120:123], v[248:251]
ds_read_b128 a[132:135], v15 offset:2048
v_mfma_f32_16x16x32_bf16 v[244:247], a[140:143], a[116:119], v[244:247]
ds_read_b128 a[136:139], v15 offset:4096
v_mfma_f32_16x16x32_bf16 v[240:243], a[140:143], a[112:115], v[240:243]
v_mfma_f32_16x16x32_bf16 a[0:3], a[144:147], a[112:115], a[0:3]
ds_read_b128 a[140:143], v15 offset:6144
v_mfma_f32_16x16x32_bf16 a[4:7], a[144:147], a[116:119], a[4:7]
v_mfma_f32_16x16x32_bf16 a[8:11], a[144:147], a[120:123], a[8:11]
v_mfma_f32_16x16x32_bf16 a[12:15], a[144:147], a[124:127], a[12:15]
v_mfma_f32_16x16x32_bf16 a[28:31], a[148:151], a[124:127], a[28:31]
ds_read_b64_tr_b16 a[144:145], v17 offset:0
v_mfma_f32_16x16x32_bf16 a[24:27], a[148:151], a[120:123], a[24:27]
ds_read_b64_tr_b16 a[146:147], v17 offset:1792
v_mfma_f32_16x16x32_bf16 a[20:23], a[148:151], a[116:119], a[20:23]
v_mfma_f32_16x16x32_bf16 a[16:19], a[148:151], a[112:115], a[16:19]
s_waitcnt lgkmcnt(4)
v_mfma_f32_16x16x32_bf16 a[32:35], a[96:99], a[128:131], a[32:35]
ds_read_b64_tr_b16 a[148:149], v17 offset:14336
s_add_u32 m0, s50, 28672
v_mfma_f32_16x16x32_bf16 a[36:39], a[100:103], a[128:131], a[36:39]
ds_read_b64_tr_b16 a[150:151], v17 offset:16128
s_mov_b32 s99, 3211264
v_mfma_f32_16x16x32_bf16 a[40:43], a[104:107], a[128:131], a[40:43]
buffer_load_dwordx4 v6, s[12:15], s99 offen  lds
v_mfma_f32_16x16x32_bf16 a[44:47], a[108:111], a[128:131], a[44:47]
v_lshlrev_b32_e64 v20, 16, v48
v_and_b32 v21, 0xffff0000, v48
v_mfma_f32_16x16x32_bf16 a[60:63], a[108:111], a[132:135], a[60:63]
ds_read_b64_tr_b16 a[128:129], v17 offset:32
v_mfma_f32_16x16x32_bf16 a[56:59], a[104:107], a[132:135], a[56:59]
ds_read_b64_tr_b16 a[130:131], v17 offset:1824
v_add_f32 v40, v40, v20
v_mfma_f32_16x16x32_bf16 a[52:55], a[100:103], a[132:135], a[52:55]
ds_read_b128 a[112:115], v14 offset:0
v_add_f32 v41, v41, v21
v_mfma_f32_16x16x32_bf16 a[48:51], a[96:99], a[132:135], a[48:51]
s_waitcnt lgkmcnt(7)
v_mfma_f32_16x16x32_bf16 a[64:67], a[96:99], a[136:139], a[64:67]
ds_read_b64_tr_b16 a[132:133], v17 offset:14368
v_lshlrev_b32 v20, 16, v49
v_mfma_f32_16x16x32_bf16 a[68:71], a[100:103], a[136:139], a[68:71]
ds_read_b64_tr_b16 a[134:135], v17 offset:16160
s_add_u32 m0, s50, 29696
v_mfma_f32_16x16x32_bf16 a[72:75], a[104:107], a[136:139], a[72:75]
buffer_load_dwordx4 v7, s[12:15], s99 offen  lds
v_mfma_f32_16x16x32_bf16 a[76:79], a[108:111], a[136:139], a[76:79]
v_and_b32 v21, 0xffff0000, v49
v_mfma_f32_16x16x32_bf16 a[92:95], a[108:111], a[140:143], a[92:95]
ds_read_b64_tr_b16 a[136:137], v17 offset:64
v_add_f32 v42, v42, v20
v_mfma_f32_16x16x32_bf16 a[88:91], a[104:107], a[140:143], a[88:91]
ds_read_b64_tr_b16 a[138:139], v17 offset:1856
v_add_f32 v43, v43, v21
v_mfma_f32_16x16x32_bf16 a[84:87], a[100:103], a[140:143], a[84:87]
v_lshlrev_b32 v20, 16, v50
v_mfma_f32_16x16x32_bf16 a[80:83], a[96:99], a[140:143], a[80:83]
v_and_b32 v21, 0xffff0000, v50
s_waitcnt lgkmcnt(7)
v_mfma_f32_16x16x32_bf16 v[64:67], a[144:147], a[96:99], v[64:67]
ds_read_b64_tr_b16 a[140:141], v17 offset:14400
v_mfma_f32_16x16x32_bf16 v[68:71], a[144:147], a[100:103], v[68:71]
ds_read_b64_tr_b16 a[142:143], v17 offset:16192
s_add_u32 m0, s50, 30720
v_mfma_f32_16x16x32_bf16 v[72:75], a[144:147], a[104:107], v[72:75]
buffer_load_dwordx4 v8, s[12:15], s99 offen  lds
v_mfma_f32_16x16x32_bf16 v[76:79], a[144:147], a[108:111], v[76:79]
v_add_f32 v44, v44, v20
v_add_f32 v45, v45, v21
v_mfma_f32_16x16x32_bf16 v[92:95], a[148:151], a[108:111], v[92:95]
ds_read_b64_tr_b16 a[144:145], v17 offset:96
v_mfma_f32_16x16x32_bf16 v[88:91], a[148:151], a[104:107], v[88:91]
ds_read_b64_tr_b16 a[146:147], v17 offset:1888
v_lshlrev_b32_e64 v20, 16, v51
v_mfma_f32_16x16x32_bf16 v[84:87], a[148:151], a[100:103], v[84:87]
ds_read_b128 a[116:119], v14 offset:2048
v_and_b32 v21, 0xffff0000, v51
v_mfma_f32_16x16x32_bf16 v[80:83], a[148:151], a[96:99], v[80:83]
s_waitcnt lgkmcnt(7)
v_mfma_f32_16x16x32_bf16 v[96:99], a[128:131], a[96:99], v[96:99]
ds_read_b64_tr_b16 a[148:149], v17 offset:14432
v_add_f32 v46, v46, v20
v_mfma_f32_16x16x32_bf16 v[100:103], a[128:131], a[100:103], v[100:103]
ds_read_b64_tr_b16 a[150:151], v17 offset:16224
s_add_u32 m0, s50, 31744
v_mfma_f32_16x16x32_bf16 v[104:107], a[128:131], a[104:107], v[104:107]
buffer_load_dwordx4 v9, s[12:15], s99 offen  lds
v_mfma_f32_16x16x32_bf16 v[108:111], a[128:131], a[108:111], v[108:111]
v_add_f32_e64 v47, v47, v21
v_mfma_f32_16x16x32_bf16 v[124:127], a[132:135], a[108:111], v[124:127]
ds_read_b64_tr_b16 a[128:129], v17 offset:128
v_lshlrev_b32_e64 v20, 16, v24
v_mfma_f32_16x16x32_bf16 v[120:123], a[132:135], a[104:107], v[120:123]
ds_read_b64_tr_b16 a[130:131], v17 offset:1920
v_and_b32 v21, 0xffff0000, v24
v_mfma_f32_16x16x32_bf16 v[116:119], a[132:135], a[100:103], v[116:119]
v_add_f32 v32, v32, v20
v_mfma_f32_16x16x32_bf16 v[112:115], a[132:135], a[96:99], v[112:115]
v_fmac_f32 v33, v20, v20
s_waitcnt lgkmcnt(7)
v_mfma_f32_16x16x32_bf16 v[128:131], a[136:139], a[96:99], v[128:131]
ds_read_b64_tr_b16 a[132:133], v17 offset:14464
v_mfma_f32_16x16x32_bf16 v[132:135], a[136:139], a[100:103], v[132:135]
ds_read_b64_tr_b16 a[134:135], v17 offset:16256
s_add_u32 m0, s50, 32768
v_mfma_f32_16x16x32_bf16 v[136:139], a[136:139], a[104:107], v[136:139]
buffer_load_dwordx4 v10, s[12:15], s99 offen  lds
v_mfma_f32_16x16x32_bf16 v[140:143], a[136:139], a[108:111], v[140:143]
v_add_f32 v32, v32, v21
v_mfma_f32_16x16x32_bf16 v[156:159], a[140:143], a[108:111], v[156:159]
ds_read_b64_tr_b16 a[136:137], v17 offset:160
v_fmac_f32_e64 v33, v21, v21
v_mfma_f32_16x16x32_bf16 v[152:155], a[140:143], a[104:107], v[152:155]
ds_read_b64_tr_b16 a[138:139], v17 offset:1952
v_lshlrev_b32_e64 v20, 16, v25
v_mfma_f32_16x16x32_bf16 v[148:151], a[140:143], a[100:103], v[148:151]
ds_read_b128 a[120:123], v14 offset:4096
v_mfma_f32_16x16x32_bf16 v[144:147], a[140:143], a[96:99], v[144:147]
v_and_b32 v21, 0xffff0000, v25
s_waitcnt lgkmcnt(7)
v_mfma_f32_16x16x32_bf16 v[160:163], a[144:147], a[96:99], v[160:163]
ds_read_b64_tr_b16 a[140:141], v17 offset:14496
v_add_f32 v32, v32, v20
v_mfma_f32_16x16x32_bf16 v[164:167], a[144:147], a[100:103], v[164:167]
ds_read_b64_tr_b16 a[142:143], v17 offset:16288
s_add_u32 m0, s50, 33792
v_mfma_f32_16x16x32_bf16 v[168:171], a[144:147], a[104:107], v[168:171]
buffer_load_dwordx4 v11, s[12:15], s99 offen  lds
v_mfma_f32_16x16x32_bf16 v[172:175], a[144:147], a[108:111], v[172:175]
v_fmac_f32 v33, v20, v20
v_mfma_f32_16x16x32_bf16 v[188:191], a[148:151], a[108:111], v[188:191]
ds_read_b64_tr_b16 a[144:145], v17 offset:192
v_add_f32 v32, v32, v21
v_mfma_f32_16x16x32_bf16 v[184:187], a[148:151], a[104:107], v[184:187]
ds_read_b64_tr_b16 a[146:147], v17 offset:1984
v_mfma_f32_16x16x32_bf16 v[180:183], a[148:151], a[100:103], v[180:183]
v_fmac_f32 v33, v21, v21
v_lshlrev_b32 v20, 16, v26
v_mfma_f32_16x16x32_bf16 v[176:179], a[148:151], a[96:99], v[176:179]
s_waitcnt lgkmcnt(7)
v_mfma_f32_16x16x32_bf16 v[192:195], a[128:131], a[96:99], v[192:195]
ds_read_b64_tr_b16 a[148:149], v17 offset:14528
v_and_b32 v21, 0xffff0000, v26
v_mfma_f32_16x16x32_bf16 v[196:199], a[128:131], a[100:103], v[196:199]
ds_read_b64_tr_b16 a[150:151], v17 offset:16320
s_add_u32 m0, s50, 34816
v_mfma_f32_16x16x32_bf16 v[200:203], a[128:131], a[104:107], v[200:203]
buffer_load_dwordx4 v12, s[12:15], s99 offen  lds
v_mfma_f32_16x16x32_bf16 v[204:207], a[128:131], a[108:111], v[204:207]
v_add_f32 v32, v32, v20
v_mfma_f32_16x16x32_bf16 v[220:223], a[132:135], a[108:111], v[220:223]
ds_read_b128 a[128:131], v16 offset:0
v_fmac_f32 v33, v20, v20
v_mfma_f32_16x16x32_bf16 v[216:219], a[132:135], a[104:107], v[216:219]
v_add_f32 v32, v32, v21
v_mfma_f32_16x16x32_bf16 v[212:215], a[132:135], a[100:103], v[212:215]
ds_read_b128 a[124:127], v14 offset:6144
v_fmac_f32 v33, v21, v21
v_mfma_f32_16x16x32_bf16 v[208:211], a[132:135], a[96:99], v[208:211]
v_lshlrev_b32_e64 v20, 16, v27
s_waitcnt lgkmcnt(6)
v_mfma_f32_16x16x32_bf16 v[224:227], a[136:139], a[96:99], v[224:227]
ds_read_b128 a[132:135], v16 offset:2048
s_add_u32 m0, s51, 8192
v_mfma_f32_16x16x32_bf16 v[228:231], a[136:139], a[100:103], v[228:231]
s_mov_b32 s100, 896
v_and_b32 v21, 0xffff0000, v27
v_mfma_f32_16x16x32_bf16 v[232:235], a[136:139], a[104:107], v[232:235]
buffer_load_dwordx4 v4, s[16:19], s100 offen lds
v_mfma_f32_16x16x32_bf16 v[236:239], a[136:139], a[108:111], v[236:239]
v_add_f32 v32, v32, v20
v_mfma_f32_16x16x32_bf16 v[252:255], a[140:143], a[108:111], v[252:255]
ds_read_b128 a[136:139], v16 offset:4096
v_mfma_f32_16x16x32_bf16 v[248:251], a[140:143], a[104:107], v[248:251]
v_fmac_f32 v33, v20, v20
v_add_f32 v32, v32, v21
v_mfma_f32_16x16x32_bf16 v[244:247], a[140:143], a[100:103], v[244:247]
v_fmac_f32_e64 v33, v21, v21
v_mfma_f32_16x16x32_bf16 v[240:243], a[140:143], a[96:99], v[240:243]
s_waitcnt lgkmcnt(4)
v_mfma_f32_16x16x32_bf16 a[0:3], a[144:147], a[96:99], a[0:3]
ds_read_b128 a[140:143], v16 offset:6144
v_mfma_f32_16x16x32_bf16 a[4:7], a[144:147], a[100:103], a[4:7]
s_add_u32 m0, s51, 9216
v_mfma_f32_16x16x32_bf16 a[8:11], a[144:147], a[104:107], a[8:11]
buffer_load_dwordx4 v5, s[16:19], s100 offen lds
v_mfma_f32_16x16x32_bf16 a[12:15], a[144:147], a[108:111], a[12:15]
s_mov_b32 s101, 4587520
v_mfma_f32_16x16x32_bf16 a[28:31], a[148:151], a[108:111], a[28:31]
ds_read_b64_tr_b16 a[144:145], v17 offset:7168
v_mfma_f32_16x16x32_bf16 a[24:27], a[148:151], a[104:107], a[24:27]
ds_read_b64_tr_b16 a[146:147], v17 offset:8960
v_mfma_f32_16x16x32_bf16 a[20:23], a[148:151], a[100:103], a[20:23]
buffer_load_dwordx4 v[48:51], v18, s[12:15], s101 offen
v_mfma_f32_16x16x32_bf16 a[16:19], a[148:151], a[96:99], a[16:19]
s_waitcnt lgkmcnt(4)
v_mfma_f32_16x16x32_bf16 a[32:35], a[112:115], a[128:131], a[32:35]
ds_read_b64_tr_b16 a[148:149], v17 offset:21504
v_mfma_f32_16x16x32_bf16 a[36:39], a[116:119], a[128:131], a[36:39]
ds_read_b64_tr_b16 a[150:151], v17 offset:23296
v_mfma_f32_16x16x32_bf16 a[40:43], a[120:123], a[128:131], a[40:43]
buffer_load_dwordx4 v[24:27], v22, s[8:11], s60 offen offset:0
v_mfma_f32_16x16x32_bf16 a[44:47], a[124:127], a[128:131], a[44:47]
s_lshl_b32 s63, s55, 10
s_add_u32 s63, s63, 3145728
v_mfma_f32_16x16x32_bf16 a[60:63], a[124:127], a[132:135], a[60:63]
ds_read_b64_tr_b16 a[128:129], v17 offset:7200
v_mfma_f32_16x16x32_bf16 a[56:59], a[120:123], a[132:135], a[56:59]
ds_read_b64_tr_b16 a[130:131], v17 offset:8992
v_mfma_f32_16x16x32_bf16 a[52:55], a[116:119], a[132:135], a[52:55]
buffer_load_dwordx4 v[36:39], v23, s[28:31], s63 offen
v_mfma_f32_16x16x32_bf16 a[48:51], a[112:115], a[132:135], a[48:51]
s_cmp_eq_u32 s47, 6
s_cselect_b32 s46, 0, 0x1000
s_waitcnt lgkmcnt(6)
v_mfma_f32_16x16x32_bf16 a[64:67], a[112:115], a[136:139], a[64:67]
ds_read_b64_tr_b16 a[132:133], v17 offset:21536
v_mfma_f32_16x16x32_bf16 a[68:71], a[116:119], a[136:139], a[68:71]
ds_read_b64_tr_b16 a[134:135], v17 offset:23328
v_mfma_f32_16x16x32_bf16 a[72:75], a[120:123], a[136:139], a[72:75]
s_mov_b64 exec, 1
buffer_atomic_add v60, v61, s[40:43], s46 offen sc1
s_mov_b64 exec, -1
L_pg4:
s_cbranch_execz L_pg8
v_mfma_f32_16x16x32_bf16 a[76:79], a[124:127], a[136:139], a[76:79]
v_mfma_f32_16x16x32_bf16 a[92:95], a[124:127], a[140:143], a[92:95]
ds_read_b64_tr_b16 a[136:137], v17 offset:7232
s_add_u32 m0, s49, 0
v_mfma_f32_16x16x32_bf16 a[88:91], a[120:123], a[140:143], a[88:91]
ds_read_b64_tr_b16 a[138:139], v17 offset:9024
s_mov_b32 s98, 1024
v_mfma_f32_16x16x32_bf16 a[84:87], a[116:119], a[140:143], a[84:87]
buffer_load_dwordx4 v2, s[8:11], s98 offen lds
v_mfma_f32_16x16x32_bf16 a[80:83], a[112:115], a[140:143], a[80:83]
s_waitcnt lgkmcnt(6)
v_mfma_f32_16x16x32_bf16 v[64:67], a[144:147], a[112:115], v[64:67]
ds_read_b64_tr_b16 a[140:141], v17 offset:21568
v_mfma_f32_16x16x32_bf16 v[68:71], a[144:147], a[116:119], v[68:71]
ds_read_b64_tr_b16 a[142:143], v17 offset:23360
s_add_u32 m0, s49, 1024
v_mfma_f32_16x16x32_bf16 v[72:75], a[144:147], a[120:123], v[72:75]
buffer_load_dwordx4 v3, s[8:11], s98 offen lds
v_mfma_f32_16x16x32_bf16 v[76:79], a[144:147], a[124:127], v[76:79]
v_mfma_f32_16x16x32_bf16 v[92:95], a[148:151], a[124:127], v[92:95]
ds_read_b64_tr_b16 a[144:145], v17 offset:7264
v_mfma_f32_16x16x32_bf16 v[88:91], a[148:151], a[120:123], v[88:91]
ds_read_b64_tr_b16 a[146:147], v17 offset:9056
v_mfma_f32_16x16x32_bf16 v[84:87], a[148:151], a[116:119], v[84:87]
v_mfma_f32_16x16x32_bf16 v[80:83], a[148:151], a[112:115], v[80:83]
s_waitcnt lgkmcnt(6)
v_mfma_f32_16x16x32_bf16 v[96:99], a[128:131], a[112:115], v[96:99]
ds_read_b64_tr_b16 a[148:149], v17 offset:21600
s_add_u32 m0, s49, 2048
v_mfma_f32_16x16x32_bf16 v[100:103], a[128:131], a[116:119], v[100:103]
ds_read_b64_tr_b16 a[150:151], v17 offset:23392
s_mov_b32 s98, 3072
v_mfma_f32_16x16x32_bf16 v[104:107], a[128:131], a[120:123], v[104:107]
buffer_load_dwordx4 v2, s[8:11], s98 offen lds
v_mfma_f32_16x16x32_bf16 v[108:111], a[128:131], a[124:127], v[108:111]
v_mfma_f32_16x16x32_bf16 v[124:127], a[132:135], a[124:127], v[124:127]
ds_read_b64_tr_b16 a[128:129], v17 offset:7296
v_mfma_f32_16x16x32_bf16 v[120:123], a[132:135], a[120:123], v[120:123]
ds_read_b64_tr_b16 a[130:131], v17 offset:9088
s_add_u32 m0, s49, 3072
v_mfma_f32_16x16x32_bf16 v[116:119], a[132:135], a[116:119], v[116:119]
buffer_load_dwordx4 v3, s[8:11], s98 offen lds
v_mfma_f32_16x16x32_bf16 v[112:115], a[132:135], a[112:115], v[112:115]
s_waitcnt lgkmcnt(6)
v_mfma_f32_16x16x32_bf16 v[128:131], a[136:139], a[112:115], v[128:131]
ds_read_b64_tr_b16 a[132:133], v17 offset:21632
v_mfma_f32_16x16x32_bf16 v[132:135], a[136:139], a[116:119], v[132:135]
ds_read_b64_tr_b16 a[134:135], v17 offset:23424
v_mfma_f32_16x16x32_bf16 v[136:139], a[136:139], a[120:123], v[136:139]
v_mfma_f32_16x16x32_bf16 v[140:143], a[136:139], a[124:127], v[140:143]
v_mfma_f32_16x16x32_bf16 v[156:159], a[140:143], a[124:127], v[156:159]
ds_read_b64_tr_b16 a[136:137], v17 offset:7328
s_add_u32 m0, s49, 4096
v_mfma_f32_16x16x32_bf16 v[152:155], a[140:143], a[120:123], v[152:155]
ds_read_b64_tr_b16 a[138:139], v17 offset:9120
s_mov_b32 s98, 5120
v_mfma_f32_16x16x32_bf16 v[148:151], a[140:143], a[116:119], v[148:151]
buffer_load_dwordx4 v2, s[8:11], s98 offen lds
v_mfma_f32_16x16x32_bf16 v[144:147], a[140:143], a[112:115], v[144:147]
s_waitcnt lgkmcnt(6)
v_mfma_f32_16x16x32_bf16 v[160:163], a[144:147], a[112:115], v[160:163]
ds_read_b64_tr_b16 a[140:141], v17 offset:21664
v_mfma_f32_16x16x32_bf16 v[164:167], a[144:147], a[116:119], v[164:167]
ds_read_b64_tr_b16 a[142:143], v17 offset:23456
s_add_u32 m0, s49, 5120
v_mfma_f32_16x16x32_bf16 v[168:171], a[144:147], a[120:123], v[168:171]
buffer_load_dwordx4 v3, s[8:11], s98 offen lds
v_mfma_f32_16x16x32_bf16 v[172:175], a[144:147], a[124:127], v[172:175]
v_mfma_f32_16x16x32_bf16 v[188:191], a[148:151], a[124:127], v[188:191]
ds_read_b64_tr_b16 a[144:145], v17 offset:7360
v_mfma_f32_16x16x32_bf16 v[184:187], a[148:151], a[120:123], v[184:187]
ds_read_b64_tr_b16 a[146:147], v17 offset:9152
v_mfma_f32_16x16x32_bf16 v[180:183], a[148:151], a[116:119], v[180:183]
v_mfma_f32_16x16x32_bf16 v[176:179], a[148:151], a[112:115], v[176:179]
s_waitcnt lgkmcnt(6)
v_mfma_f32_16x16x32_bf16 v[192:195], a[128:131], a[112:115], v[192:195]
ds_read_b64_tr_b16 a[148:149], v17 offset:21696
s_add_u32 m0, s49, 6144
v_mfma_f32_16x16x32_bf16 v[196:199], a[128:131], a[116:119], v[196:199]
ds_read_b64_tr_b16 a[150:151], v17 offset:23488
s_mov_b32 s98, 7168
v_mfma_f32_16x16x32_bf16 v[200:203], a[128:131], a[120:123], v[200:203]
buffer_load_dwordx4 v2, s[8:11], s98 offen lds
v_mfma_f32_16x16x32_bf16 v[204:207], a[128:131], a[124:127], v[204:207]
v_mfma_f32_16x16x32_bf16 v[220:223], a[132:135], a[124:127], v[220:223]
s_waitcnt vmcnt(20)
ds_read_b128 a[96:99], v13 offset:32768
v_mfma_f32_16x16x32_bf16 v[216:219], a[132:135], a[120:123], v[216:219]
ds_read_b128 a[100:103], v13 offset:34816
v_mfma_f32_16x16x32_bf16 v[212:215], a[132:135], a[116:119], v[212:215]
v_mfma_f32_16x16x32_bf16 v[208:211], a[132:135], a[112:115], v[208:211]
s_waitcnt lgkmcnt(6)
v_mfma_f32_16x16x32_bf16 v[224:227], a[136:139], a[112:115], v[224:227]
ds_read_b128 a[104:107], v13 offset:36864
v_mfma_f32_16x16x32_bf16 v[228:231], a[136:139], a[116:119], v[228:231]
ds_read_b128 a[108:111], v13 offset:38912
s_add_u32 m0, s49, 7168
v_mfma_f32_16x16x32_bf16 v[232:235], a[136:139], a[120:123], v[232:235]
buffer_load_dwordx4 v3, s[8:11], s98 offen lds
v_mfma_f32_16x16x32_bf16 v[236:239], a[136:139], a[124:127], v[236:239]
s_waitcnt vmcnt(12) lgkmcnt(4)
s_barrier
v_mfma_f32_16x16x32_bf16 v[252:255], a[140:143], a[124:127], v[252:255]
ds_read_b128 a[128:131], v15 offset:8192
v_mfma_f32_16x16x32_bf16 v[248:251], a[140:143], a[120:123], v[248:251]
ds_read_b128 a[132:135], v15 offset:10240
v_mfma_f32_16x16x32_bf16 v[244:247], a[140:143], a[116:119], v[244:247]
ds_read_b128 a[136:139], v15 offset:12288
v_mfma_f32_16x16x32_bf16 v[240:243], a[140:143], a[112:115], v[240:243]
v_mfma_f32_16x16x32_bf16 a[0:3], a[144:147], a[112:115], a[0:3]
ds_read_b128 a[140:143], v15 offset:14336
v_mfma_f32_16x16x32_bf16 a[4:7], a[144:147], a[116:119], a[4:7]
v_mfma_f32_16x16x32_bf16 a[8:11], a[144:147], a[120:123], a[8:11]
v_mfma_f32_16x16x32_bf16 a[12:15], a[144:147], a[124:127], a[12:15]
v_mfma_f32_16x16x32_bf16 a[28:31], a[148:151], a[124:127], a[28:31]
ds_read_b64_tr_b16 a[144:145], v17 offset:28672
v_mfma_f32_16x16x32_bf16 a[24:27], a[148:151], a[120:123], a[24:27]
ds_read_b64_tr_b16 a[146:147], v17 offset:30464
v_mfma_f32_16x16x32_bf16 a[20:23], a[148:151], a[116:119], a[20:23]
v_mfma_f32_16x16x32_bf16 a[16:19], a[148:151], a[112:115], a[16:19]
s_waitcnt lgkmcnt(4)
v_mfma_f32_16x16x32_bf16 a[32:35], a[96:99], a[128:131], a[32:35]
ds_read_b64_tr_b16 a[148:149], v17 offset:43008
s_add_u32 m0, s50, 0
v_mfma_f32_16x16x32_bf16 a[36:39], a[100:103], a[128:131], a[36:39]
ds_read_b64_tr_b16 a[150:151], v17 offset:44800
s_mov_b32 s99, 3670016
v_mfma_f32_16x16x32_bf16 a[40:43], a[104:107], a[128:131], a[40:43]
buffer_load_dwordx4 v6, s[12:15], s99 offen  lds
v_mfma_f32_16x16x32_bf16 a[44:47], a[108:111], a[128:131], a[44:47]
v_lshlrev_b32 v20, 16, v52
v_and_b32 v21, 0xffff0000, v52
v_mfma_f32_16x16x32_bf16 a[60:63], a[108:111], a[132:135], a[60:63]
ds_read_b64_tr_b16 a[128:129], v17 offset:28704
v_mfma_f32_16x16x32_bf16 a[56:59], a[104:107], a[132:135], a[56:59]
ds_read_b64_tr_b16 a[130:131], v17 offset:30496
v_add_f32_e64 v40, v40, v20
v_mfma_f32_16x16x32_bf16 a[52:55], a[100:103], a[132:135], a[52:55]
ds_read_b128 a[112:115], v14 offset:32768
v_mfma_f32_16x16x32_bf16 a[48:51], a[96:99], a[132:135], a[48:51]
v_add_f32 v41, v41, v21
s_waitcnt lgkmcnt(7)
v_mfma_f32_16x16x32_bf16 a[64:67], a[96:99], a[136:139], a[64:67]
ds_read_b64_tr_b16 a[132:133], v17 offset:43040
v_mfma_f32_16x16x32_bf16 a[68:71], a[100:103], a[136:139], a[68:71]
ds_read_b64_tr_b16 a[134:135], v17 offset:44832
s_add_u32 m0, s50, 1024
v_mfma_f32_16x16x32_bf16 a[72:75], a[104:107], a[136:139], a[72:75]
buffer_load_dwordx4 v7, s[12:15], s99 offen  lds
v_mfma_f32_16x16x32_bf16 a[76:79], a[108:111], a[136:139], a[76:79]
v_lshlrev_b32_e64 v20, 16, v53
v_mfma_f32_16x16x32_bf16 a[92:95], a[108:111], a[140:143], a[92:95]
ds_read_b64_tr_b16 a[136:137], v17 offset:28736
v_and_b32 v21, 0xffff0000, v53
v_mfma_f32_16x16x32_bf16 a[88:91], a[104:107], a[140:143], a[88:91]
ds_read_b64_tr_b16 a[138:139], v17 offset:30528
v_mfma_f32_16x16x32_bf16 a[84:87], a[100:103], a[140:143], a[84:87]
v_add_f32 v42, v42, v20
v_mfma_f32_16x16x32_bf16 a[80:83], a[96:99], a[140:143], a[80:83]
v_add_f32 v43, v43, v21
s_waitcnt lgkmcnt(7)
v_mfma_f32_16x16x32_bf16 v[64:67], a[144:147], a[96:99], v[64:67]
ds_read_b64_tr_b16 a[140:141], v17 offset:43072
v_mfma_f32_16x16x32_bf16 v[68:71], a[144:147], a[100:103], v[68:71]
ds_read_b64_tr_b16 a[142:143], v17 offset:44864
s_add_u32 m0, s50, 2048
v_mfma_f32_16x16x32_bf16 v[72:75], a[144:147], a[104:107], v[72:75]
buffer_load_dwordx4 v8, s[12:15], s99 offen  lds
v_mfma_f32_16x16x32_bf16 v[76:79], a[144:147], a[108:111], v[76:79]
v_lshlrev_b32 v20, 16, v54
v_mfma_f32_16x16x32_bf16 v[92:95], a[148:151], a[108:111], v[92:95]
ds_read_b64_tr_b16 a[144:145], v17 offset:28768
v_and_b32 v21, 0xffff0000, v54
v_mfma_f32_16x16x32_bf16 v[88:91], a[148:151], a[104:107], v[88:91]
ds_read_b64_tr_b16 a[146:147], v17 offset:30560
v_mfma_f32_16x16x32_bf16 v[84:87], a[148:151], a[100:103], v[84:87]
ds_read_b128 a[116:119], v14 offset:34816
v_add_f32 v44, v44, v20
v_mfma_f32_16x16x32_bf16 v[80:83], a[148:151], a[96:99], v[80:83]
v_add_f32_e64 v45, v45, v21
s_waitcnt lgkmcnt(7)
v_mfma_f32_16x16x32_bf16 v[96:99], a[128:131], a[96:99], v[96:99]
ds_read_b64_tr_b16 a[148:149], v17 offset:43104
v_mfma_f32_16x16x32_bf16 v[100:103], a[128:131], a[100:103], v[100:103]
ds_read_b64_tr_b16 a[150:151], v17 offset:44896
s_add_u32 m0, s50, 3072
v_mfma_f32_16x16x32_bf16 v[104:107], a[128:131], a[104:107], v[104:107]
buffer_load_dwordx4 v9, s[12:15], s99 offen  lds
v_mfma_f32_16x16x32_bf16 v[108:111], a[128:131], a[108:111], v[108:111]
v_lshlrev_b32_e64 v20, 16, v55
v_mfma_f32_16x16x32_bf16 v[124:127], a[132:135], a[108:111], v[124:127]
ds_read_b64_tr_b16 a[128:129], v17 offset:28800
v_and_b32 v21, 0xffff0000, v55
v_mfma_f32_16x16x32_bf16 v[120:123], a[132:135], a[104:107], v[120:123]
ds_read_b64_tr_b16 a[130:131], v17 offset:30592
v_mfma_f32_16x16x32_bf16 v[116:119], a[132:135], a[100:103], v[116:119]
v_add_f32 v46, v46, v20
v_mfma_f32_16x16x32_bf16 v[112:115], a[132:135], a[96:99], v[112:115]
v_add_f32 v47, v47, v21
s_waitcnt lgkmcnt(7)
v_mfma_f32_16x16x32_bf16 v[128:131], a[136:139], a[96:99], v[128:131]
ds_read_b64_tr_b16 a[132:133], v17 offset:43136
v_mfma_f32_16x16x32_bf16 v[132:135], a[136:139], a[100:103], v[132:135]
ds_read_b64_tr_b16 a[134:135], v17 offset:44928
s_add_u32 m0, s50, 4096
v_mfma_f32_16x16x32_bf16 v[136:139], a[136:139], a[104:107], v[136:139]
buffer_load_dwordx4 v10, s[12:15], s99 offen  lds
v_mfma_f32_16x16x32_bf16 v[140:143], a[136:139], a[108:111], v[140:143]
v_lshlrev_b32 v20, 16, v28
v_mfma_f32_16x16x32_bf16 v[156:159], a[140:143], a[108:111], v[156:159]
ds_read_b64_tr_b16 a[136:137], v17 offset:28832
v_and_b32 v21, 0xffff0000, v28
v_mfma_f32_16x16x32_bf16 v[152:155], a[140:143], a[104:107], v[152:155]
ds_read_b64_tr_b16 a[138:139], v17 offset:30624
v_mfma_f32_16x16x32_bf16 v[148:151], a[140:143], a[100:103], v[148:151]
ds_read_b128 a[120:123], v14 offset:36864
v_add_f32 v34, v34, v20
v_mfma_f32_16x16x32_bf16 v[144:147], a[140:143], a[96:99], v[144:147]
s_waitcnt lgkmcnt(7)
v_mfma_f32_16x16x32_bf16 v[160:163], a[144:147], a[96:99], v[160:163]
ds_read_b64_tr_b16 a[140:141], v17 offset:43168
v_add_f32_e64 v34, v34, v21
v_mfma_f32_16x16x32_bf16 v[164:167], a[144:147], a[100:103], v[164:167]
ds_read_b64_tr_b16 a[142:143], v17 offset:44960
s_add_u32 m0, s50, 5120
v_mfma_f32_16x16x32_bf16 v[168:171], a[144:147], a[104:107], v[168:171]
buffer_load_dwordx4 v11, s[12:15], s99 offen  lds
v_mfma_f32_16x16x32_bf16 v[172:175], a[144:147], a[108:111], v[172:175]
v_lshlrev_b32_e64 v20, 16, v29
v_mfma_f32_16x16x32_bf16 v[188:191], a[148:151], a[108:111], v[188:191]
ds_read_b64_tr_b16 a[144:145], v17 offset:28864
v_mfma_f32_16x16x32_bf16 v[184:187], a[148:151], a[104:107], v[184:187]
ds_read_b64_tr_b16 a[146:147], v17 offset:30656
v_and_b32 v21, 0xffff0000, v29
v_mfma_f32_16x16x32_bf16 v[180:183], a[148:151], a[100:103], v[180:183]
v_add_f32 v34, v34, v20
v_mfma_f32_16x16x32_bf16 v[176:179], a[148:151], a[96:99], v[176:179]
v_add_f32 v34, v34, v21
s_waitcnt lgkmcnt(7)
v_mfma_f32_16x16x32_bf16 v[192:195], a[128:131], a[96:99], v[192:195]
ds_read_b64_tr_b16 a[148:149], v17 offset:43200
v_mfma_f32_16x16x32_bf16 v[196:199], a[128:131], a[100:103], v[196:199]
ds_read_b64_tr_b16 a[150:151], v17 offset:44992
s_add_u32 m0, s50, 6144
v_mfma_f32_16x16x32_bf16 v[200:203], a[128:131], a[104:107], v[200:203]
buffer_load_dwordx4 v12, s[12:15], s99 offen  lds
v_mfma_f32_16x16x32_bf16 v[204:207], a[128:131], a[108:111], v[204:207]
v_lshlrev_b32 v20, 16, v30
v_mfma_f32_16x16x32_bf16 v[220:223], a[132:135], a[108:111], v[220:223]
ds_read_b128 a[128:131], v16 offset:8192
v_and_b32 v21, 0xffff0000, v30
v_mfma_f32_16x16x32_bf16 v[216:219], a[132:135], a[104:107], v[216:219]
v_add_f32_e64 v34, v34, v20
v_mfma_f32_16x16x32_bf16 v[212:215], a[132:135], a[100:103], v[212:215]
ds_read_b128 a[124:127], v14 offset:38912
v_mfma_f32_16x16x32_bf16 v[208:211], a[132:135], a[96:99], v[208:211]
v_add_f32 v34, v34, v21
s_waitcnt lgkmcnt(6)
v_mfma_f32_16x16x32_bf16 v[224:227], a[136:139], a[96:99], v[224:227]
ds_read_b128 a[132:135], v16 offset:10240
s_add_u32 m0, s51, 0
v_mfma_f32_16x16x32_bf16 v[228:231], a[136:139], a[100:103], v[228:231]
s_mov_b32 s100, 1024
v_lshlrev_b32 v20, 16, v31
v_mfma_f32_16x16x32_bf16 v[232:235], a[136:139], a[104:107], v[232:235]
buffer_load_dwordx4 v4, s[16:19], s100 offen lds
v_mfma_f32_16x16x32_bf16 v[236:239], a[136:139], a[108:111], v[236:239]
v_mfma_f32_16x16x32_bf16 v[252:255], a[140:143], a[108:111], v[252:255]
ds_read_b128 a[136:139], v16 offset:12288
v_and_b32 v21, 0xffff0000, v31
v_mfma_f32_16x16x32_bf16 v[248:251], a[140:143], a[104:107], v[248:251]
v_add_f32 v34, v34, v20
v_mfma_f32_16x16x32_bf16 v[244:247], a[140:143], a[100:103], v[244:247]
v_add_f32 v34, v34, v21
v_mfma_f32_16x16x32_bf16 v[240:243], a[140:143], a[96:99], v[240:243]
s_waitcnt lgkmcnt(4)
v_mfma_f32_16x16x32_bf16 a[0:3], a[144:147], a[96:99], a[0:3]
ds_read_b128 a[140:143], v16 offset:14336
v_mfma_f32_16x16x32_bf16 a[4:7], a[144:147], a[100:103], a[4:7]
s_add_u32 m0, s51, 1024
v_mfma_f32_16x16x32_bf16 a[8:11], a[144:147], a[104:107], a[8:11]
buffer_load_dwordx4 v5, s[16:19], s100 offen lds
v_mfma_f32_16x16x32_bf16 a[12:15], a[144:147], a[108:111], a[12:15]
s_mov_b32 s101, 5046272
v_mfma_f32_16x16x32_bf16 a[28:31], a[148:151], a[108:111], a[28:31]
ds_read_b64_tr_b16 a[144:145], v17 offset:35840
v_mfma_f32_16x16x32_bf16 a[24:27], a[148:151], a[104:107], a[24:27]
ds_read_b64_tr_b16 a[146:147], v17 offset:37632
v_mfma_f32_16x16x32_bf16 a[20:23], a[148:151], a[100:103], a[20:23]
buffer_load_dwordx4 v[52:55], v18, s[12:15], s101 offen
v_mfma_f32_16x16x32_bf16 a[16:19], a[148:151], a[96:99], a[16:19]
s_waitcnt lgkmcnt(4)
v_mfma_f32_16x16x32_bf16 a[32:35], a[112:115], a[128:131], a[32:35]
ds_read_b64_tr_b16 a[148:149], v17 offset:50176
v_mfma_f32_16x16x32_bf16 a[36:39], a[116:119], a[128:131], a[36:39]
ds_read_b64_tr_b16 a[150:151], v17 offset:51968
v_mfma_f32_16x16x32_bf16 a[40:43], a[120:123], a[128:131], a[40:43]
buffer_load_dwordx4 v[28:31], v22, s[16:19], s61 offen offset:0
v_mfma_f32_16x16x32_bf16 a[44:47], a[124:127], a[128:131], a[44:47]
s_lshl_b32 s63, s55, 10
s_add_u32 s63, s63, 4194304
v_mfma_f32_16x16x32_bf16 a[60:63], a[124:127], a[132:135], a[60:63]
ds_read_b64_tr_b16 a[128:129], v17 offset:35872
v_mfma_f32_16x16x32_bf16 a[56:59], a[120:123], a[132:135], a[56:59]
ds_read_b64_tr_b16 a[130:131], v17 offset:37664
v_mfma_f32_16x16x32_bf16 a[52:55], a[116:119], a[132:135], a[52:55]
buffer_load_dwordx4 v[36:39], v23, s[28:31], s63 offen
v_mfma_f32_16x16x32_bf16 a[48:51], a[112:115], a[132:135], a[48:51]
s_waitcnt lgkmcnt(6)
v_mfma_f32_16x16x32_bf16 a[64:67], a[112:115], a[136:139], a[64:67]
ds_read_b64_tr_b16 a[132:133], v17 offset:50208
v_mfma_f32_16x16x32_bf16 a[68:71], a[116:119], a[136:139], a[68:71]
ds_read_b64_tr_b16 a[134:135], v17 offset:52000
v_mfma_f32_16x16x32_bf16 a[72:75], a[120:123], a[136:139], a[72:75]
v_mfma_f32_16x16x32_bf16 a[76:79], a[124:127], a[136:139], a[76:79]
v_mfma_f32_16x16x32_bf16 a[92:95], a[124:127], a[140:143], a[92:95]
ds_read_b64_tr_b16 a[136:137], v17 offset:35904
s_add_u32 m0, s49, 32768
v_mfma_f32_16x16x32_bf16 a[88:91], a[120:123], a[140:143], a[88:91]
ds_read_b64_tr_b16 a[138:139], v17 offset:37696
s_mov_b32 s98, 1152
v_mfma_f32_16x16x32_bf16 a[84:87], a[116:119], a[140:143], a[84:87]
buffer_load_dwordx4 v2, s[8:11], s98 offen lds
v_mfma_f32_16x16x32_bf16 a[80:83], a[112:115], a[140:143], a[80:83]
s_waitcnt lgkmcnt(6)
v_mfma_f32_16x16x32_bf16 v[64:67], a[144:147], a[112:115], v[64:67]
ds_read_b64_tr_b16 a[140:141], v17 offset:50240
v_mfma_f32_16x16x32_bf16 v[68:71], a[144:147], a[116:119], v[68:71]
ds_read_b64_tr_b16 a[142:143], v17 offset:52032
s_add_u32 m0, s49, 33792
v_mfma_f32_16x16x32_bf16 v[72:75], a[144:147], a[120:123], v[72:75]
buffer_load_dwordx4 v3, s[8:11], s98 offen lds
v_mfma_f32_16x16x32_bf16 v[76:79], a[144:147], a[124:127], v[76:79]
v_mfma_f32_16x16x32_bf16 v[92:95], a[148:151], a[124:127], v[92:95]
ds_read_b64_tr_b16 a[144:145], v17 offset:35936
v_mfma_f32_16x16x32_bf16 v[88:91], a[148:151], a[120:123], v[88:91]
ds_read_b64_tr_b16 a[146:147], v17 offset:37728
v_mfma_f32_16x16x32_bf16 v[84:87], a[148:151], a[116:119], v[84:87]
v_mfma_f32_16x16x32_bf16 v[80:83], a[148:151], a[112:115], v[80:83]
s_waitcnt lgkmcnt(6)
v_mfma_f32_16x16x32_bf16 v[96:99], a[128:131], a[112:115], v[96:99]
ds_read_b64_tr_b16 a[148:149], v17 offset:50272
s_add_u32 m0, s49, 34816
v_mfma_f32_16x16x32_bf16 v[100:103], a[128:131], a[116:119], v[100:103]
ds_read_b64_tr_b16 a[150:151], v17 offset:52064
s_mov_b32 s98, 3200
v_mfma_f32_16x16x32_bf16 v[104:107], a[128:131], a[120:123], v[104:107]
buffer_load_dwordx4 v2, s[8:11], s98 offen lds
v_mfma_f32_16x16x32_bf16 v[108:111], a[128:131], a[124:127], v[108:111]
v_mfma_f32_16x16x32_bf16 v[124:127], a[132:135], a[124:127], v[124:127]
ds_read_b64_tr_b16 a[128:129], v17 offset:35968
v_mfma_f32_16x16x32_bf16 v[120:123], a[132:135], a[120:123], v[120:123]
ds_read_b64_tr_b16 a[130:131], v17 offset:37760
s_add_u32 m0, s49, 35840
v_mfma_f32_16x16x32_bf16 v[116:119], a[132:135], a[116:119], v[116:119]
buffer_load_dwordx4 v3, s[8:11], s98 offen lds
v_mfma_f32_16x16x32_bf16 v[112:115], a[132:135], a[112:115], v[112:115]
s_waitcnt lgkmcnt(6)
v_mfma_f32_16x16x32_bf16 v[128:131], a[136:139], a[112:115], v[128:131]
ds_read_b64_tr_b16 a[132:133], v17 offset:50304
v_mfma_f32_16x16x32_bf16 v[132:135], a[136:139], a[116:119], v[132:135]
ds_read_b64_tr_b16 a[134:135], v17 offset:52096
v_mfma_f32_16x16x32_bf16 v[136:139], a[136:139], a[120:123], v[136:139]
v_mfma_f32_16x16x32_bf16 v[140:143], a[136:139], a[124:127], v[140:143]
v_mfma_f32_16x16x32_bf16 v[156:159], a[140:143], a[124:127], v[156:159]
ds_read_b64_tr_b16 a[136:137], v17 offset:36000
s_add_u32 m0, s49, 36864
v_mfma_f32_16x16x32_bf16 v[152:155], a[140:143], a[120:123], v[152:155]
ds_read_b64_tr_b16 a[138:139], v17 offset:37792
s_mov_b32 s98, 5248
v_mfma_f32_16x16x32_bf16 v[148:151], a[140:143], a[116:119], v[148:151]
buffer_load_dwordx4 v2, s[8:11], s98 offen lds
v_mfma_f32_16x16x32_bf16 v[144:147], a[140:143], a[112:115], v[144:147]
s_waitcnt lgkmcnt(6)
v_mfma_f32_16x16x32_bf16 v[160:163], a[144:147], a[112:115], v[160:163]
ds_read_b64_tr_b16 a[140:141], v17 offset:50336
v_mfma_f32_16x16x32_bf16 v[164:167], a[144:147], a[116:119], v[164:167]
ds_read_b64_tr_b16 a[142:143], v17 offset:52128
s_add_u32 m0, s49, 37888
v_mfma_f32_16x16x32_bf16 v[168:171], a[144:147], a[120:123], v[168:171]
buffer_load_dwordx4 v3, s[8:11], s98 offen lds
v_mfma_f32_16x16x32_bf16 v[172:175], a[144:147], a[124:127], v[172:175]
v_mfma_f32_16x16x32_bf16 v[188:191], a[148:151], a[124:127], v[188:191]
ds_read_b64_tr_b16 a[144:145], v17 offset:36032
v_mfma_f32_16x16x32_bf16 v[184:187], a[148:151], a[120:123], v[184:187]
ds_read_b64_tr_b16 a[146:147], v17 offset:37824
v_mfma_f32_16x16x32_bf16 v[180:183], a[148:151], a[116:119], v[180:183]
v_mfma_f32_16x16x32_bf16 v[176:179], a[148:151], a[112:115], v[176:179]
s_waitcnt lgkmcnt(6)
v_mfma_f32_16x16x32_bf16 v[192:195], a[128:131], a[112:115], v[192:195]
ds_read_b64_tr_b16 a[148:149], v17 offset:50368
s_add_u32 m0, s49, 38912
v_mfma_f32_16x16x32_bf16 v[196:199], a[128:131], a[116:119], v[196:199]
ds_read_b64_tr_b16 a[150:151], v17 offset:52160
s_mov_b32 s98, 7296
v_mfma_f32_16x16x32_bf16 v[200:203], a[128:131], a[120:123], v[200:203]
buffer_load_dwordx4 v2, s[8:11], s98 offen lds
v_mfma_f32_16x16x32_bf16 v[204:207], a[128:131], a[124:127], v[204:207]
v_mfma_f32_16x16x32_bf16 v[220:223], a[132:135], a[124:127], v[220:223]
s_waitcnt vmcnt(19)
ds_read_b128 a[96:99], v13 offset:0
v_mfma_f32_16x16x32_bf16 v[216:219], a[132:135], a[120:123], v[216:219]
ds_read_b128 a[100:103], v13 offset:2048
v_mfma_f32_16x16x32_bf16 v[212:215], a[132:135], a[116:119], v[212:215]
v_mfma_f32_16x16x32_bf16 v[208:211], a[132:135], a[112:115], v[208:211]
s_waitcnt lgkmcnt(6)
v_mfma_f32_16x16x32_bf16 v[224:227], a[136:139], a[112:115], v[224:227]
ds_read_b128 a[104:107], v13 offset:4096
v_mfma_f32_16x16x32_bf16 v[228:231], a[136:139], a[116:119], v[228:231]
ds_read_b128 a[108:111], v13 offset:6144
s_add_u32 m0, s49, 39936
v_mfma_f32_16x16x32_bf16 v[232:235], a[136:139], a[120:123], v[232:235]
buffer_load_dwordx4 v3, s[8:11], s98 offen lds
v_mfma_f32_16x16x32_bf16 v[236:239], a[136:139], a[124:127], v[236:239]
s_waitcnt vmcnt(11) lgkmcnt(4)
s_barrier
v_mfma_f32_16x16x32_bf16 v[252:255], a[140:143], a[124:127], v[252:255]
ds_read_b128 a[128:131], v15 offset:0
v_mfma_f32_16x16x32_bf16 v[248:251], a[140:143], a[120:123], v[248:251]
ds_read_b128 a[132:135], v15 offset:2048
v_mfma_f32_16x16x32_bf16 v[244:247], a[140:143], a[116:119], v[244:247]
ds_read_b128 a[136:139], v15 offset:4096
v_mfma_f32_16x16x32_bf16 v[240:243], a[140:143], a[112:115], v[240:243]
v_mfma_f32_16x16x32_bf16 a[0:3], a[144:147], a[112:115], a[0:3]
ds_read_b128 a[140:143], v15 offset:6144
v_mfma_f32_16x16x32_bf16 a[4:7], a[144:147], a[116:119], a[4:7]
v_mfma_f32_16x16x32_bf16 a[8:11], a[144:147], a[120:123], a[8:11]
v_mfma_f32_16x16x32_bf16 a[12:15], a[144:147], a[124:127], a[12:15]
v_mfma_f32_16x16x32_bf16 a[28:31], a[148:151], a[124:127], a[28:31]
ds_read_b64_tr_b16 a[144:145], v17 offset:0
v_mfma_f32_16x16x32_bf16 a[24:27], a[148:151], a[120:123], a[24:27]
ds_read_b64_tr_b16 a[146:147], v17 offset:1792
v_mfma_f32_16x16x32_bf16 a[20:23], a[148:151], a[116:119], a[20:23]
v_mfma_f32_16x16x32_bf16 a[16:19], a[148:151], a[112:115], a[16:19]
s_waitcnt lgkmcnt(4)
v_mfma_f32_16x16x32_bf16 a[32:35], a[96:99], a[128:131], a[32:35]
ds_read_b64_tr_b16 a[148:149], v17 offset:14336
s_add_u32 m0, s50, 28672
v_mfma_f32_16x16x32_bf16 a[36:39], a[100:103], a[128:131], a[36:39]
ds_read_b64_tr_b16 a[150:151], v17 offset:16128
s_mov_b32 s99, 4128768
v_mfma_f32_16x16x32_bf16 a[40:43], a[104:107], a[128:131], a[40:43]
buffer_load_dwordx4 v6, s[12:15], s99 offen  lds
v_mfma_f32_16x16x32_bf16 a[44:47], a[108:111], a[128:131], a[44:47]
v_lshlrev_b32_e64 v20, 16, v48
v_and_b32 v21, 0xffff0000, v48
v_mfma_f32_16x16x32_bf16 a[60:63], a[108:111], a[132:135], a[60:63]
ds_read_b64_tr_b16 a[128:129], v17 offset:32
v_mfma_f32_16x16x32_bf16 a[56:59], a[104:107], a[132:135], a[56:59]
ds_read_b64_tr_b16 a[130:131], v17 offset:1824
v_add_f32 v40, v40, v20
v_mfma_f32_16x16x32_bf16 a[52:55], a[100:103], a[132:135], a[52:55]
ds_read_b128 a[112:115], v14 offset:0
v_add_f32 v41, v41, v21
v_mfma_f32_16x16x32_bf16 a[48:51], a[96:99], a[132:135], a[48:51]
s_waitcnt lgkmcnt(7)
v_mfma_f32_16x16x32_bf16 a[64:67], a[96:99], a[136:139], a[64:67]
ds_read_b64_tr_b16 a[132:133], v17 offset:14368
v_lshlrev_b32 v20, 16, v49
v_mfma_f32_16x16x32_bf16 a[68:71], a[100:103], a[136:139], a[68:71]
ds_read_b64_tr_b16 a[134:135], v17 offset:16160
s_add_u32 m0, s50, 29696
v_mfma_f32_16x16x32_bf16 a[72:75], a[104:107], a[136:139], a[72:75]
buffer_load_dwordx4 v7, s[12:15], s99 offen  lds
v_mfma_f32_16x16x32_bf16 a[76:79], a[108:111], a[136:139], a[76:79]
v_and_b32 v21, 0xffff0000, v49
v_mfma_f32_16x16x32_bf16 a[92:95], a[108:111], a[140:143], a[92:95]
ds_read_b64_tr_b16 a[136:137], v17 offset:64
v_add_f32 v42, v42, v20
v_mfma_f32_16x16x32_bf16 a[88:91], a[104:107], a[140:143], a[88:91]
ds_read_b64_tr_b16 a[138:139], v17 offset:1856
v_add_f32 v43, v43, v21
v_mfma_f32_16x16x32_bf16 a[84:87], a[100:103], a[140:143], a[84:87]
v_lshlrev_b32 v20, 16, v50
v_mfma_f32_16x16x32_bf16 a[80:83], a[96:99], a[140:143], a[80:83]
v_and_b32 v21, 0xffff0000, v50
s_waitcnt lgkmcnt(7)
v_mfma_f32_16x16x32_bf16 v[64:67], a[144:147], a[96:99], v[64:67]
ds_read_b64_tr_b16 a[140:141], v17 offset:14400
v_mfma_f32_16x16x32_bf16 v[68:71], a[144:147], a[100:103], v[68:71]
ds_read_b64_tr_b16 a[142:143], v17 offset:16192
s_add_u32 m0, s50, 30720
v_mfma_f32_16x16x32_bf16 v[72:75], a[144:147], a[104:107], v[72:75]
buffer_load_dwordx4 v8, s[12:15], s99 offen  lds
v_mfma_f32_16x16x32_bf16 v[76:79], a[144:147], a[108:111], v[76:79]
v_add_f32 v44, v44, v20
v_add_f32 v45, v45, v21
v_mfma_f32_16x16x32_bf16 v[92:95], a[148:151], a[108:111], v[92:95]
ds_read_b64_tr_b16 a[144:145], v17 offset:96
v_mfma_f32_16x16x32_bf16 v[88:91], a[148:151], a[104:107], v[88:91]
ds_read_b64_tr_b16 a[146:147], v17 offset:1888
v_lshlrev_b32_e64 v20, 16, v51
v_mfma_f32_16x16x32_bf16 v[84:87], a[148:151], a[100:103], v[84:87]
ds_read_b128 a[116:119], v14 offset:2048
v_and_b32 v21, 0xffff0000, v51
v_mfma_f32_16x16x32_bf16 v[80:83], a[148:151], a[96:99], v[80:83]
s_waitcnt lgkmcnt(7)
v_mfma_f32_16x16x32_bf16 v[96:99], a[128:131], a[96:99], v[96:99]
ds_read_b64_tr_b16 a[148:149], v17 offset:14432
v_add_f32 v46, v46, v20
v_mfma_f32_16x16x32_bf16 v[100:103], a[128:131], a[100:103], v[100:103]
ds_read_b64_tr_b16 a[150:151], v17 offset:16224
s_add_u32 m0, s50, 31744
v_mfma_f32_16x16x32_bf16 v[104:107], a[128:131], a[104:107], v[104:107]
buffer_load_dwordx4 v9, s[12:15], s99 offen  lds
v_mfma_f32_16x16x32_bf16 v[108:111], a[128:131], a[108:111], v[108:111]
v_add_f32_e64 v47, v47, v21
v_mfma_f32_16x16x32_bf16 v[124:127], a[132:135], a[108:111], v[124:127]
ds_read_b64_tr_b16 a[128:129], v17 offset:128
v_lshlrev_b32_e64 v20, 16, v24
v_mfma_f32_16x16x32_bf16 v[120:123], a[132:135], a[104:107], v[120:123]
ds_read_b64_tr_b16 a[130:131], v17 offset:1920
v_and_b32 v21, 0xffff0000, v24
v_mfma_f32_16x16x32_bf16 v[116:119], a[132:135], a[100:103], v[116:119]
v_add_f32_e64 v32, v32, v20
v_mfma_f32_16x16x32_bf16 v[112:115], a[132:135], a[96:99], v[112:115]
v_fmac_f32 v33, v20, v20
s_waitcnt lgkmcnt(7)
v_mfma_f32_16x16x32_bf16 v[128:131], a[136:139], a[96:99], v[128:131]
ds_read_b64_tr_b16 a[132:133], v17 offset:14464
v_mfma_f32_16x16x32_bf16 v[132:135], a[136:139], a[100:103], v[132:135]
ds_read_b64_tr_b16 a[134:135], v17 offset:16256
s_add_u32 m0, s50, 32768
v_mfma_f32_16x16x32_bf16 v[136:139], a[136:139], a[104:107], v[136:139]
buffer_load_dwordx4 v10, s[12:15], s99 offen  lds
v_mfma_f32_16x16x32_bf16 v[140:143], a[136:139], a[108:111], v[140:143]
v_add_f32_e64 v32, v32, v21
v_mfma_f32_16x16x32_bf16 v[156:159], a[140:143], a[108:111], v[156:159]
ds_read_b64_tr_b16 a[136:137], v17 offset:160
v_fmac_f32 v33, v21, v21
v_mfma_f32_16x16x32_bf16 v[152:155], a[140:143], a[104:107], v[152:155]
ds_read_b64_tr_b16 a[138:139], v17 offset:1952
v_lshlrev_b32 v20, 16, v25
v_mfma_f32_16x16x32_bf16 v[148:151], a[140:143], a[100:103], v[148:151]
ds_read_b128 a[120:123], v14 offset:4096
v_mfma_f32_16x16x32_bf16 v[144:147], a[140:143], a[96:99], v[144:147]
v_and_b32 v21, 0xffff0000, v25
s_waitcnt lgkmcnt(7)
v_mfma_f32_16x16x32_bf16 v[160:163], a[144:147], a[96:99], v[160:163]
ds_read_b64_tr_b16 a[140:141], v17 offset:14496
v_add_f32 v32, v32, v20
v_mfma_f32_16x16x32_bf16 v[164:167], a[144:147], a[100:103], v[164:167]
ds_read_b64_tr_b16 a[142:143], v17 offset:16288
s_add_u32 m0, s50, 33792
v_mfma_f32_16x16x32_bf16 v[168:171], a[144:147], a[104:107], v[168:171]
buffer_load_dwordx4 v11, s[12:15], s99 offen  lds
L_pg5:
s_cbranch_execz L_pg9
v_mfma_f32_16x16x32_bf16 v[172:175], a[144:147], a[108:111], v[172:175]
v_fmac_f32 v33, v20, v20
v_mfma_f32_16x16x32_bf16 v[188:191], a[148:151], a[108:111], v[188:191]
ds_read_b64_tr_b16 a[144:145], v17 offset:192
v_add_f32 v32, v32, v21
v_mfma_f32_16x16x32_bf16 v[184:187], a[148:151], a[104:107], v[184:187]
ds_read_b64_tr_b16 a[146:147], v17 offset:1984
v_mfma_f32_16x16x32_bf16 v[180:183], a[148:151], a[100:103], v[180:183]
v_fmac_f32 v33, v21, v21
v_lshlrev_b32 v20, 16, v26
v_mfma_f32_16x16x32_bf16 v[176:179], a[148:151], a[96:99], v[176:179]
s_waitcnt lgkmcnt(7)
v_mfma_f32_16x16x32_bf16 v[192:195], a[128:131], a[96:99], v[192:195]
ds_read_b64_tr_b16 a[148:149], v17 offset:14528
v_and_b32 v21, 0xffff0000, v26
v_mfma_f32_16x16x32_bf16 v[196:199], a[128:131], a[100:103], v[196:199]
ds_read_b64_tr_b16 a[150:151], v17 offset:16320
s_add_u32 m0, s50, 34816
v_mfma_f32_16x16x32_bf16 v[200:203], a[128:131], a[104:107], v[200:203]
buffer_load_dwordx4 v12, s[12:15], s99 offen  lds
v_mfma_f32_16x16x32_bf16 v[204:207], a[128:131], a[108:111], v[204:207]
v_add_f32_e64 v32, v32, v20
v_mfma_f32_16x16x32_bf16 v[220:223], a[132:135], a[108:111], v[220:223]
ds_read_b128 a[128:131], v16 offset:0
v_fmac_f32 v33, v20, v20
v_mfma_f32_16x16x32_bf16 v[216:219], a[132:135], a[104:107], v[216:219]
v_add_f32 v32, v32, v21
v_mfma_f32_16x16x32_bf16 v[212:215], a[132:135], a[100:103], v[212:215]
ds_read_b128 a[124:127], v14 offset:6144
v_fmac_f32 v33, v21, v21
v_mfma_f32_16x16x32_bf16 v[208:211], a[132:135], a[96:99], v[208:211]
v_lshlrev_b32 v20, 16, v27
s_waitcnt lgkmcnt(6)
v_mfma_f32_16x16x32_bf16 v[224:227], a[136:139], a[96:99], v[224:227]
ds_read_b128 a[132:135], v16 offset:2048
s_add_u32 m0, s51, 8192
v_mfma_f32_16x16x32_bf16 v[228:231], a[136:139], a[100:103], v[228:231]
s_mov_b32 s100, 1152
v_and_b32 v21, 0xffff0000, v27
v_mfma_f32_16x16x32_bf16 v[232:235], a[136:139], a[104:107], v[232:235]
buffer_load_dwordx4 v4, s[16:19], s100 offen lds
v_mfma_f32_16x16x32_bf16 v[236:239], a[136:139], a[108:111], v[236:239]
v_add_f32 v32, v32, v20
v_mfma_f32_16x16x32_bf16 v[252:255], a[140:143], a[108:111], v[252:255]
ds_read_b128 a[136:139], v16 offset:4096
v_mfma_f32_16x16x32_bf16 v[248:251], a[140:143], a[104:107], v[248:251]
v_fmac_f32 v33, v20, v20
v_add_f32 v32, v32, v21
v_mfma_f32_16x16x32_bf16 v[244:247], a[140:143], a[100:103], v[244:247]
v_fmac_f32_e64 v33, v21, v21
v_mfma_f32_16x16x32_bf16 v[240:243], a[140:143], a[96:99], v[240:243]
s_waitcnt lgkmcnt(4)
v_mfma_f32_16x16x32_bf16 a[0:3], a[144:147], a[96:99], a[0:3]
ds_read_b128 a[140:143], v16 offset:6144
v_mfma_f32_16x16x32_bf16 a[4:7], a[144:147], a[100:103], a[4:7]
s_add_u32 m0, s51, 9216
v_mfma_f32_16x16x32_bf16 a[8:11], a[144:147], a[104:107], a[8:11]
buffer_load_dwordx4 v5, s[16:19], s100 offen lds
v_mfma_f32_16x16x32_bf16 a[12:15], a[144:147], a[108:111], a[12:15]
s_mov_b32 s101, 5505024
v_mfma_f32_16x16x32_bf16 a[28:31], a[148:151], a[108:111], a[28:31]
ds_read_b64_tr_b16 a[144:145], v17 offset:7168
v_mfma_f32_16x16x32_bf16 a[24:27], a[148:151], a[104:107], a[24:27]
ds_read_b64_tr_b16 a[146:147], v17 offset:8960
v_mfma_f32_16x16x32_bf16 a[20:23], a[148:151], a[100:103], a[20:23]
buffer_load_dwordx4 v[48:51], v18, s[12:15], s101 offen
v_mfma_f32_16x16x32_bf16 a[16:19], a[148:151], a[96:99], a[16:19]
s_lshl_b32 s63, s55, 10
s_add_u32 s63, s63, 5242880
s_waitcnt lgkmcnt(4)
v_mfma_f32_16x16x32_bf16 a[32:35], a[112:115], a[128:131], a[32:35]
ds_read_b64_tr_b16 a[148:149], v17 offset:21504
v_mfma_f32_16x16x32_bf16 a[36:39], a[116:119], a[128:131], a[36:39]
ds_read_b64_tr_b16 a[150:151], v17 offset:23296
v_mfma_f32_16x16x32_bf16 a[40:43], a[120:123], a[128:131], a[40:43]
buffer_load_dwordx4 v[36:39], v23, s[28:31], s63 offen
v_mfma_f32_16x16x32_bf16 a[44:47], a[124:127], a[128:131], a[44:47]
s_lshr_b32 s48, s2, 3
s_lshl_b32 s48, s48, 2
s_add_u32 s48, s48, s3
v_mfma_f32_16x16x32_bf16 a[60:63], a[124:127], a[132:135], a[60:63]
ds_read_b64_tr_b16 a[128:129], v17 offset:7200
s_lshl_b32 s48, s48, 7
v_mfma_f32_16x16x32_bf16 a[56:59], a[120:123], a[132:135], a[56:59]
ds_read_b64_tr_b16 a[130:131], v17 offset:8992
s_add_u32 s48, s48, 32768
v_mfma_f32_16x16x32_bf16 a[52:55], a[116:119], a[132:135], a[52:55]
s_min_u32 s48, s48, L_codeend-L_main-4
v_mov_b32 v19, s48
v_mfma_f32_16x16x32_bf16 a[48:51], a[112:115], a[132:135], a[48:51]
s_waitcnt lgkmcnt(6)
v_mfma_f32_16x16x32_bf16 a[64:67], a[112:115], a[136:139], a[64:67]
ds_read_b64_tr_b16 a[132:133], v17 offset:21536
v_mfma_f32_16x16x32_bf16 a[68:71], a[116:119], a[136:139], a[68:71]
ds_read_b64_tr_b16 a[134:135], v17 offset:23328
v_mfma_f32_16x16x32_bf16 a[72:75], a[120:123], a[136:139], a[72:75]
global_load_dword v39, v19, s[82:83]
v_mfma_f32_16x16x32_bf16 a[76:79], a[124:127], a[136:139], a[76:79]
v_mfma_f32_16x16x32_bf16 a[92:95], a[124:127], a[140:143], a[92:95]
ds_read_b64_tr_b16 a[136:137], v17 offset:7232
s_add_u32 m0, s49, 0
v_mfma_f32_16x16x32_bf16 a[88:91], a[120:123], a[140:143], a[88:91]
ds_read_b64_tr_b16 a[138:139], v17 offset:9024
s_mov_b32 s98, 1280
v_mfma_f32_16x16x32_bf16 a[84:87], a[116:119], a[140:143], a[84:87]
buffer_load_dwordx4 v2, s[8:11], s98 offen lds
v_mfma_f32_16x16x32_bf16 a[80:83], a[112:115], a[140:143], a[80:83]
s_waitcnt lgkmcnt(6)
v_mfma_f32_16x16x32_bf16 v[64:67], a[144:147], a[112:115], v[64:67]
ds_read_b64_tr_b16 a[140:141], v17 offset:21568
v_mfma_f32_16x16x32_bf16 v[68:71], a[144:147], a[116:119], v[68:71]
ds_read_b64_tr_b16 a[142:143], v17 offset:23360
s_add_u32 m0, s49, 1024
v_mfma_f32_16x16x32_bf16 v[72:75], a[144:147], a[120:123], v[72:75]
buffer_load_dwordx4 v3, s[8:11], s98 offen lds
v_mfma_f32_16x16x32_bf16 v[76:79], a[144:147], a[124:127], v[76:79]
v_mfma_f32_16x16x32_bf16 v[92:95], a[148:151], a[124:127], v[92:95]
ds_read_b64_tr_b16 a[144:145], v17 offset:7264
v_mfma_f32_16x16x32_bf16 v[88:91], a[148:151], a[120:123], v[88:91]
ds_read_b64_tr_b16 a[146:147], v17 offset:9056
v_mfma_f32_16x16x32_bf16 v[84:87], a[148:151], a[116:119], v[84:87]
v_mfma_f32_16x16x32_bf16 v[80:83], a[148:151], a[112:115], v[80:83]
s_waitcnt lgkmcnt(6)
v_mfma_f32_16x16x32_bf16 v[96:99], a[128:131], a[112:115], v[96:99]
ds_read_b64_tr_b16 a[148:149], v17 offset:21600
s_add_u32 m0, s49, 2048
v_mfma_f32_16x16x32_bf16 v[100:103], a[128:131], a[116:119], v[100:103]
ds_read_b64_tr_b16 a[150:151], v17 offset:23392
s_mov_b32 s98, 3328
v_mfma_f32_16x16x32_bf16 v[104:107], a[128:131], a[120:123], v[104:107]
buffer_load_dwordx4 v2, s[8:11], s98 offen lds
v_mfma_f32_16x16x32_bf16 v[108:111], a[128:131], a[124:127], v[108:111]
v_mfma_f32_16x16x32_bf16 v[124:127], a[132:135], a[124:127], v[124:127]
ds_read_b64_tr_b16 a[128:129], v17 offset:7296
v_mfma_f32_16x16x32_bf16 v[120:123], a[132:135], a[120:123], v[120:123]
ds_read_b64_tr_b16 a[130:131], v17 offset:9088
s_add_u32 m0, s49, 3072
v_mfma_f32_16x16x32_bf16 v[116:119], a[132:135], a[116:119], v[116:119]
buffer_load_dwordx4 v3, s[8:11], s98 offen lds
v_mfma_f32_16x16x32_bf16 v[112:115], a[132:135], a[112:115], v[112:115]
s_waitcnt lgkmcnt(6)
v_mfma_f32_16x16x32_bf16 v[128:131], a[136:139], a[112:115], v[128:131]
ds_read_b64_tr_b16 a[132:133], v17 offset:21632
v_mfma_f32_16x16x32_bf16 v[132:135], a[136:139], a[116:119], v[132:135]
ds_read_b64_tr_b16 a[134:135], v17 offset:23424
v_mfma_f32_16x16x32_bf16 v[136:139], a[136:139], a[120:123], v[136:139]
v_mfma_f32_16x16x32_bf16 v[140:143], a[136:139], a[124:127], v[140:143]
v_mfma_f32_16x16x32_bf16 v[156:159], a[140:143], a[124:127], v[156:159]
ds_read_b64_tr_b16 a[136:137], v17 offset:7328
s_add_u32 m0, s49, 4096
v_mfma_f32_16x16x32_bf16 v[152:155], a[140:143], a[120:123], v[152:155]
ds_read_b64_tr_b16 a[138:139], v17 offset:9120
s_mov_b32 s98, 5376
v_mfma_f32_16x16x32_bf16 v[148:151], a[140:143], a[116:119], v[148:151]
buffer_load_dwordx4 v2, s[8:11], s98 offen lds
v_mfma_f32_16x16x32_bf16 v[144:147], a[140:143], a[112:115], v[144:147]
s_waitcnt lgkmcnt(6)
v_mfma_f32_16x16x32_bf16 v[160:163], a[144:147], a[112:115], v[160:163]
ds_read_b64_tr_b16 a[140:141], v17 offset:21664
v_mfma_f32_16x16x32_bf16 v[164:167], a[144:147], a[116:119], v[164:167]
ds_read_b64_tr_b16 a[142:143], v17 offset:23456
s_add_u32 m0, s49, 5120
v_mfma_f32_16x16x32_bf16 v[168:171], a[144:147], a[120:123], v[168:171]
buffer_load_dwordx4 v3, s[8:11], s98 offen lds
v_mfma_f32_16x16x32_bf16 v[172:175], a[144:147], a[124:127], v[172:175]
v_mfma_f32_16x16x32_bf16 v[188:191], a[148:151], a[124:127], v[188:191]
ds_read_b64_tr_b16 a[144:145], v17 offset:7360
v_mfma_f32_16x16x32_bf16 v[184:187], a[148:151], a[120:123], v[184:187]
ds_read_b64_tr_b16 a[146:147], v17 offset:9152
v_mfma_f32_16x16x32_bf16 v[180:183], a[148:151], a[116:119], v[180:183]
v_mfma_f32_16x16x32_bf16 v[176:179], a[148:151], a[112:115], v[176:179]
s_waitcnt lgkmcnt(6)
v_mfma_f32_16x16x32_bf16 v[192:195], a[128:131], a[112:115], v[192:195]
ds_read_b64_tr_b16 a[148:149], v17 offset:21696
s_add_u32 m0, s49, 6144
v_mfma_f32_16x16x32_bf16 v[196:199], a[128:131], a[116:119], v[196:199]
ds_read_b64_tr_b16 a[150:151], v17 offset:23488
s_mov_b32 s98, 7424
v_mfma_f32_16x16x32_bf16 v[200:203], a[128:131], a[120:123], v[200:203]
buffer_load_dwordx4 v2, s[8:11], s98 offen lds
v_mfma_f32_16x16x32_bf16 v[204:207], a[128:131], a[124:127], v[204:207]
v_mfma_f32_16x16x32_bf16 v[220:223], a[132:135], a[124:127], v[220:223]
s_waitcnt vmcnt(19)
ds_read_b128 a[96:99], v13 offset:32768
v_mfma_f32_16x16x32_bf16 v[216:219], a[132:135], a[120:123], v[216:219]
ds_read_b128 a[100:103], v13 offset:34816
v_mfma_f32_16x16x32_bf16 v[212:215], a[132:135], a[116:119], v[212:215]
v_mfma_f32_16x16x32_bf16 v[208:211], a[132:135], a[112:115], v[208:211]
s_waitcnt lgkmcnt(6)
v_mfma_f32_16x16x32_bf16 v[224:227], a[136:139], a[112:115], v[224:227]
ds_read_b128 a[104:107], v13 offset:36864
v_mfma_f32_16x16x32_bf16 v[228:231], a[136:139], a[116:119], v[228:231]
ds_read_b128 a[108:111], v13 offset:38912
s_add_u32 m0, s49, 7168
v_mfma_f32_16x16x32_bf16 v[232:235], a[136:139], a[120:123], v[232:235]
buffer_load_dwordx4 v3, s[8:11], s98 offen lds
v_mfma_f32_16x16x32_bf16 v[236:239], a[136:139], a[124:127], v[236:239]
s_waitcnt vmcnt(11) lgkmcnt(4)
s_barrier
v_mfma_f32_16x16x32_bf16 v[252:255], a[140:143], a[124:127], v[252:255]
ds_read_b128 a[128:131], v15 offset:8192
v_mfma_f32_16x16x32_bf16 v[248:251], a[140:143], a[120:123], v[248:251]
ds_read_b128 a[132:135], v15 offset:10240
v_mfma_f32_16x16x32_bf16 v[244:247], a[140:143], a[116:119], v[244:247]
ds_read_b128 a[136:139], v15 offset:12288
v_mfma_f32_16x16x32_bf16 v[240:243], a[140:143], a[112:115], v[240:243]
v_mfma_f32_16x16x32_bf16 a[0:3], a[144:147], a[112:115], a[0:3]
ds_read_b128 a[140:143], v15 offset:14336
v_mfma_f32_16x16x32_bf16 a[4:7], a[144:147], a[116:119], a[4:7]
v_mfma_f32_16x16x32_bf16 a[8:11], a[144:147], a[120:123], a[8:11]
v_mfma_f32_16x16x32_bf16 a[12:15], a[144:147], a[124:127], a[12:15]
v_mfma_f32_16x16x32_bf16 a[28:31], a[148:151], a[124:127], a[28:31]
ds_read_b64_tr_b16 a[144:145], v17 offset:28672
v_mfma_f32_16x16x32_bf16 a[24:27], a[148:151], a[120:123], a[24:27]
ds_read_b64_tr_b16 a[146:147], v17 offset:30464
v_mfma_f32_16x16x32_bf16 a[20:23], a[148:151], a[116:119], a[20:23]
v_mfma_f32_16x16x32_bf16 a[16:19], a[148:151], a[112:115], a[16:19]
s_waitcnt lgkmcnt(4)
v_mfma_f32_16x16x32_bf16 a[32:35], a[96:99], a[128:131], a[32:35]
ds_read_b64_tr_b16 a[148:149], v17 offset:43008
s_add_u32 m0, s50, 0
v_mfma_f32_16x16x32_bf16 a[36:39], a[100:103], a[128:131], a[36:39]
ds_read_b64_tr_b16 a[150:151], v17 offset:44800
s_mov_b32 s99, 4587520
v_mfma_f32_16x16x32_bf16 a[40:43], a[104:107], a[128:131], a[40:43]
buffer_load_dwordx4 v6, s[12:15], s99 offen  lds
v_mfma_f32_16x16x32_bf16 a[44:47], a[108:111], a[128:131], a[44:47]
v_lshlrev_b32 v20, 16, v52
v_and_b32 v21, 0xffff0000, v52
v_mfma_f32_16x16x32_bf16 a[60:63], a[108:111], a[132:135], a[60:63]
ds_read_b64_tr_b16 a[128:129], v17 offset:28704
v_mfma_f32_16x16x32_bf16 a[56:59], a[104:107], a[132:135], a[56:59]
ds_read_b64_tr_b16 a[130:131], v17 offset:30496
v_add_f32 v40, v40, v20
v_mfma_f32_16x16x32_bf16 a[52:55], a[100:103], a[132:135], a[52:55]
ds_read_b128 a[112:115], v14 offset:32768
v_mfma_f32_16x16x32_bf16 a[48:51], a[96:99], a[132:135], a[48:51]
v_add_f32 v41, v41, v21
s_waitcnt lgkmcnt(7)
v_mfma_f32_16x16x32_bf16 a[64:67], a[96:99], a[136:139], a[64:67]
ds_read_b64_tr_b16 a[132:133], v17 offset:43040
v_mfma_f32_16x16x32_bf16 a[68:71], a[100:103], a[136:139], a[68:71]
ds_read_b64_tr_b16 a[134:135], v17 offset:44832
s_add_u32 m0, s50, 1024
v_mfma_f32_16x16x32_bf16 a[72:75], a[104:107], a[136:139], a[72:75]
buffer_load_dwordx4 v7, s[12:15], s99 offen  lds
v_mfma_f32_16x16x32_bf16 a[76:79], a[108:111], a[136:139], a[76:79]
v_lshlrev_b32 v20, 16, v53
v_mfma_f32_16x16x32_bf16 a[92:95], a[108:111], a[140:143], a[92:95]
ds_read_b64_tr_b16 a[136:137], v17 offset:28736
v_and_b32 v21, 0xffff0000, v53
v_mfma_f32_16x16x32_bf16 a[88:91], a[104:107], a[140:143], a[88:91]
ds_read_b64_tr_b16 a[138:139], v17 offset:30528
v_mfma_f32_16x16x32_bf16 a[84:87], a[100:103], a[140:143], a[84:87]
v_add_f32_e64 v42, v42, v20
v_mfma_f32_16x16x32_bf16 a[80:83], a[96:99], a[140:143], a[80:83]
v_add_f32 v43, v43, v21
s_waitcnt lgkmcnt(7)
v_mfma_f32_16x16x32_bf16 v[64:67], a[144:147], a[96:99], v[64:67]
ds_read_b64_tr_b16 a[140:141], v17 offset:43072
v_mfma_f32_16x16x32_bf16 v[68:71], a[144:147], a[100:103], v[68:71]
ds_read_b64_tr_b16 a[142:143], v17 offset:44864
s_add_u32 m0, s50, 2048
v_mfma_f32_16x16x32_bf16 v[72:75], a[144:147], a[104:107], v[72:75]
buffer_load_dwordx4 v8, s[12:15], s99 offen  lds
v_mfma_f32_16x16x32_bf16 v[76:79], a[144:147], a[108:111], v[76:79]
v_lshlrev_b32_e64 v20, 16, v54
v_mfma_f32_16x16x32_bf16 v[92:95], a[148:151], a[108:111], v[92:95]
ds_read_b64_tr_b16 a[144:145], v17 offset:28768
v_and_b32 v21, 0xffff0000, v54
v_mfma_f32_16x16x32_bf16 v[88:91], a[148:151], a[104:107], v[88:91]
ds_read_b64_tr_b16 a[146:147], v17 offset:30560
v_mfma_f32_16x16x32_bf16 v[84:87], a[148:151], a[100:103], v[84:87]
ds_read_b128 a[116:119], v14 offset:34816
v_add_f32 v44, v44, v20
v_mfma_f32_16x16x32_bf16 v[80:83], a[148:151], a[96:99], v[80:83]
v_add_f32 v45, v45, v21
s_waitcnt lgkmcnt(7)
v_mfma_f32_16x16x32_bf16 v[96:99], a[128:131], a[96:99], v[96:99]
ds_read_b64_tr_b16 a[148:149], v17 offset:43104
v_mfma_f32_16x16x32_bf16 v[100:103], a[128:131], a[100:103], v[100:103]
ds_read_b64_tr_b16 a[150:151], v17 offset:44896
s_add_u32 m0, s50, 3072
v_mfma_f32_16x16x32_bf16 v[104:107], a[128:131], a[104:107], v[104:107]
buffer_load_dwordx4 v9, s[12:15], s99 offen  lds
v_mfma_f32_16x16x32_bf16 v[108:111], a[128:131], a[108:111], v[108:111]
v_lshlrev_b32 v20, 16, v55
v_mfma_f32_16x16x32_bf16 v[124:127], a[132:135], a[108:111], v[124:127]
ds_read_b64_tr_b16 a[128:129], v17 offset:28800
v_and_b32 v21, 0xffff0000, v55
v_mfma_f32_16x16x32_bf16 v[120:123], a[132:135], a[104:107], v[120:123]
ds_read_b64_tr_b16 a[130:131], v17 offset:30592
v_mfma_f32_16x16x32_bf16 v[116:119], a[132:135], a[100:103], v[116:119]
v_add_f32_e64 v46, v46, v20
v_mfma_f32_16x16x32_bf16 v[112:115], a[132:135], a[96:99], v[112:115]
v_add_f32 v47, v47, v21
s_waitcnt lgkmcnt(7)
v_mfma_f32_16x16x32_bf16 v[128:131], a[136:139], a[96:99], v[128:131]
ds_read_b64_tr_b16 a[132:133], v17 offset:43136
v_mfma_f32_16x16x32_bf16 v[132:135], a[136:139], a[100:103], v[132:135]
ds_read_b64_tr_b16 a[134:135], v17 offset:44928
s_add_u32 m0, s50, 4096
v_mfma_f32_16x16x32_bf16 v[136:139], a[136:139], a[104:107], v[136:139]
buffer_load_dwordx4 v10, s[12:15], s99 offen  lds
v_mfma_f32_16x16x32_bf16 v[140:143], a[136:139], a[108:111], v[140:143]
v_lshlrev_b32_e64 v20, 16, v28
v_mfma_f32_16x16x32_bf16 v[156:159], a[140:143], a[108:111], v[156:159]
ds_read_b64_tr_b16 a[136:137], v17 offset:28832
v_and_b32 v21, 0xffff0000, v28
v_mfma_f32_16x16x32_bf16 v[152:155], a[140:143], a[104:107], v[152:155]
ds_read_b64_tr_b16 a[138:139], v17 offset:30624
v_mfma_f32_16x16x32_bf16 v[148:151], a[140:143], a[100:103], v[148:151]
ds_read_b128 a[120:123], v14 offset:36864
v_add_f32 v34, v34, v20
v_mfma_f32_16x16x32_bf16 v[144:147], a[140:143], a[96:99], v[144:147]
s_waitcnt lgkmcnt(7)
v_mfma_f32_16x16x32_bf16 v[160:163], a[144:147], a[96:99], v[160:163]
ds_read_b64_tr_b16 a[140:141], v17 offset:43168
v_add_f32_e64 v34, v34, v21
v_mfma_f32_16x16x32_bf16 v[164:167], a[144:147], a[100:103], v[164:167]
ds_read_b64_tr_b16 a[142:143], v17 offset:44960
s_add_u32 m0, s50, 5120
v_mfma_f32_16x16x32_bf16 v[168:171], a[144:147], a[104:107], v[168:171]
buffer_load_dwordx4 v11, s[12:15], s99 offen  lds
v_mfma_f32_16x16x32_bf16 v[172:175], a[144:147], a[108:111], v[172:175]
v_lshlrev_b32_e64 v20, 16, v29
v_mfma_f32_16x16x32_bf16 v[188:191], a[148:151], a[108:111], v[188:191]
ds_read_b64_tr_b16 a[144:145], v17 offset:28864
v_mfma_f32_16x16x32_bf16 v[184:187], a[148:151], a[104:107], v[184:187]
ds_read_b64_tr_b16 a[146:147], v17 offset:30656
v_and_b32 v21, 0xffff0000, v29
v_mfma_f32_16x16x32_bf16 v[180:183], a[148:151], a[100:103], v[180:183]
v_add_f32 v34, v34, v20
v_mfma_f32_16x16x32_bf16 v[176:179], a[148:151], a[96:99], v[176:179]
v_add_f32_e64 v34, v34, v21
s_waitcnt lgkmcnt(7)
v_mfma_f32_16x16x32_bf16 v[192:195], a[128:131], a[96:99], v[192:195]
ds_read_b64_tr_b16 a[148:149], v17 offset:43200
v_mfma_f32_16x16x32_bf16 v[196:199], a[128:131], a[100:103], v[196:199]
ds_read_b64_tr_b16 a[150:151], v17 offset:44992
s_add_u32 m0, s50, 6144
v_mfma_f32_16x16x32_bf16 v[200:203], a[128:131], a[104:107], v[200:203]
buffer_load_dwordx4 v12, s[12:15], s99 offen  lds
v_mfma_f32_16x16x32_bf16 v[204:207], a[128:131], a[108:111], v[204:207]
v_lshlrev_b32_e64 v20, 16, v30
v_mfma_f32_16x16x32_bf16 v[220:223], a[132:135], a[108:111], v[220:223]
ds_read_b128 a[128:131], v16 offset:8192
v_and_b32 v21, 0xffff0000, v30
v_mfma_f32_16x16x32_bf16 v[216:219], a[132:135], a[104:107], v[216:219]
v_add_f32 v34, v34, v20
v_mfma_f32_16x16x32_bf16 v[212:215], a[132:135], a[100:103], v[212:215]
ds_read_b128 a[124:127], v14 offset:38912
v_mfma_f32_16x16x32_bf16 v[208:211], a[132:135], a[96:99], v[208:211]
v_add_f32 v34, v34, v21
s_waitcnt lgkmcnt(6)
v_mfma_f32_16x16x32_bf16 v[224:227], a[136:139], a[96:99], v[224:227]
ds_read_b128 a[132:135], v16 offset:10240
s_add_u32 m0, s51, 0
v_mfma_f32_16x16x32_bf16 v[228:231], a[136:139], a[100:103], v[228:231]
s_mov_b32 s100, 1280
v_lshlrev_b32_e64 v20, 16, v31
v_mfma_f32_16x16x32_bf16 v[232:235], a[136:139], a[104:107], v[232:235]
buffer_load_dwordx4 v4, s[16:19], s100 offen lds
v_mfma_f32_16x16x32_bf16 v[236:239], a[136:139], a[108:111], v[236:239]
v_mfma_f32_16x16x32_bf16 v[252:255], a[140:143], a[108:111], v[252:255]
ds_read_b128 a[136:139], v16 offset:12288
v_and_b32 v21, 0xffff0000, v31
v_mfma_f32_16x16x32_bf16 v[248:251], a[140:143], a[104:107], v[248:251]
v_add_f32 v34, v34, v20
v_mfma_f32_16x16x32_bf16 v[244:247], a[140:143], a[100:103], v[244:247]
v_add_f32 v34, v34, v21
v_mfma_f32_16x16x32_bf16 v[240:243], a[140:143], a[96:99], v[240:243]
s_waitcnt lgkmcnt(4)
v_mfma_f32_16x16x32_bf16 a[0:3], a[144:147], a[96:99], a[0:3]
ds_read_b128 a[140:143], v16 offset:14336
v_mfma_f32_16x16x32_bf16 a[4:7], a[144:147], a[100:103], a[4:7]
s_add_u32 m0, s51, 1024
v_mfma_f32_16x16x32_bf16 a[8:11], a[144:147], a[104:107], a[8:11]
buffer_load_dwordx4 v5, s[16:19], s100 offen lds
v_mfma_f32_16x16x32_bf16 a[12:15], a[144:147], a[108:111], a[12:15]
s_mov_b32 s101, 5963776
v_mfma_f32_16x16x32_bf16 a[28:31], a[148:151], a[108:111], a[28:31]
ds_read_b64_tr_b16 a[144:145], v17 offset:35840
v_mfma_f32_16x16x32_bf16 a[24:27], a[148:151], a[104:107], a[24:27]
ds_read_b64_tr_b16 a[146:147], v17 offset:37632
v_mfma_f32_16x16x32_bf16 a[20:23], a[148:151], a[100:103], a[20:23]
buffer_load_dwordx4 v[52:55], v18, s[12:15], s101 offen
v_mfma_f32_16x16x32_bf16 a[16:19], a[148:151], a[96:99], a[16:19]
s_lshl_b32 s63, s55, 10
s_add_u32 s63, s63, 6291456
s_waitcnt lgkmcnt(4)
v_mfma_f32_16x16x32_bf16 a[32:35], a[112:115], a[128:131], a[32:35]
ds_read_b64_tr_b16 a[148:149], v17 offset:50176
v_mfma_f32_16x16x32_bf16 a[36:39], a[116:119], a[128:131], a[36:39]
ds_read_b64_tr_b16 a[150:151], v17 offset:51968
v_mfma_f32_16x16x32_bf16 a[40:43], a[120:123], a[128:131], a[40:43]
buffer_load_dwordx4 v[36:39], v23, s[28:31], s63 offen
v_mfma_f32_16x16x32_bf16 a[44:47], a[124:127], a[128:131], a[44:47]
v_mfma_f32_16x16x32_bf16 a[60:63], a[124:127], a[132:135], a[60:63]
ds_read_b64_tr_b16 a[128:129], v17 offset:35872
v_mfma_f32_16x16x32_bf16 a[56:59], a[120:123], a[132:135], a[56:59]
ds_read_b64_tr_b16 a[130:131], v17 offset:37664
v_mfma_f32_16x16x32_bf16 a[52:55], a[116:119], a[132:135], a[52:55]
v_mfma_f32_16x16x32_bf16 a[48:51], a[112:115], a[132:135], a[48:51]
s_waitcnt lgkmcnt(6)
v_mfma_f32_16x16x32_bf16 a[64:67], a[112:115], a[136:139], a[64:67]
ds_read_b64_tr_b16 a[132:133], v17 offset:50208
v_mfma_f32_16x16x32_bf16 a[68:71], a[116:119], a[136:139], a[68:71]
ds_read_b64_tr_b16 a[134:135], v17 offset:52000
v_mfma_f32_16x16x32_bf16 a[72:75], a[120:123], a[136:139], a[72:75]
v_mfma_f32_16x16x32_bf16 a[76:79], a[124:127], a[136:139], a[76:79]
v_mfma_f32_16x16x32_bf16 a[92:95], a[124:127], a[140:143], a[92:95]
ds_read_b64_tr_b16 a[136:137], v17 offset:35904
s_add_u32 m0, s49, 32768
v_mfma_f32_16x16x32_bf16 a[88:91], a[120:123], a[140:143], a[88:91]
ds_read_b64_tr_b16 a[138:139], v17 offset:37696
s_mov_b32 s98, 1408
v_mfma_f32_16x16x32_bf16 a[84:87], a[116:119], a[140:143], a[84:87]
buffer_load_dwordx4 v2, s[8:11], s98 offen lds
v_mfma_f32_16x16x32_bf16 a[80:83], a[112:115], a[140:143], a[80:83]
s_waitcnt lgkmcnt(6)
v_mfma_f32_16x16x32_bf16 v[64:67], a[144:147], a[112:115], v[64:67]
ds_read_b64_tr_b16 a[140:141], v17 offset:50240
v_mfma_f32_16x16x32_bf16 v[68:71], a[144:147], a[116:119], v[68:71]
ds_read_b64_tr_b16 a[142:143], v17 offset:52032
s_add_u32 m0, s49, 33792
v_mfma_f32_16x16x32_bf16 v[72:75], a[144:147], a[120:123], v[72:75]
buffer_load_dwordx4 v3, s[8:11], s98 offen lds
v_mfma_f32_16x16x32_bf16 v[76:79], a[144:147], a[124:127], v[76:79]
v_mfma_f32_16x16x32_bf16 v[92:95], a[148:151], a[124:127], v[92:95]
ds_read_b64_tr_b16 a[144:145], v17 offset:35936
v_mfma_f32_16x16x32_bf16 v[88:91], a[148:151], a[120:123], v[88:91]
ds_read_b64_tr_b16 a[146:147], v17 offset:37728
v_mfma_f32_16x16x32_bf16 v[84:87], a[148:151], a[116:119], v[84:87]
v_mfma_f32_16x16x32_bf16 v[80:83], a[148:151], a[112:115], v[80:83]
s_waitcnt lgkmcnt(6)
v_mfma_f32_16x16x32_bf16 v[96:99], a[128:131], a[112:115], v[96:99]
ds_read_b64_tr_b16 a[148:149], v17 offset:50272
s_add_u32 m0, s49, 34816
v_mfma_f32_16x16x32_bf16 v[100:103], a[128:131], a[116:119], v[100:103]
ds_read_b64_tr_b16 a[150:151], v17 offset:52064
s_mov_b32 s98, 3456
v_mfma_f32_16x16x32_bf16 v[104:107], a[128:131], a[120:123], v[104:107]
buffer_load_dwordx4 v2, s[8:11], s98 offen lds
v_mfma_f32_16x16x32_bf16 v[108:111], a[128:131], a[124:127], v[108:111]
v_add_f32_dpp v32, v32, v32 row_ror:8 row_mask:0xf bank_mask:0xf
s_nop 1
v_add_f32_dpp v32, v32, v32 row_ror:4 row_mask:0xf bank_mask:0xf
v_mfma_f32_16x16x32_bf16 v[124:127], a[132:135], a[124:127], v[124:127]
ds_read_b64_tr_b16 a[128:129], v17 offset:35968
v_lshrrev_b32 v61, 4, v1
v_mfma_f32_16x16x32_bf16 v[120:123], a[132:135], a[120:123], v[120:123]
ds_read_b64_tr_b16 a[130:131], v17 offset:37760
s_add_u32 m0, s49, 35840
v_mfma_f32_16x16x32_bf16 v[116:119], a[132:135], a[116:119], v[116:119]
buffer_load_dwordx4 v3, s[8:11], s98 offen lds
v_mfma_f32_16x16x32_bf16 v[112:115], a[132:135], a[112:115], v[112:115]
v_add_f32_dpp v32, v32, v32 row_ror:2 row_mask:0xf bank_mask:0xf
s_waitcnt lgkmcnt(6)
v_mfma_f32_16x16x32_bf16 v[128:131], a[136:139], a[112:115], v[128:131]
ds_read_b64_tr_b16 a[132:133], v17 offset:50304
v_mfma_f32_16x16x32_bf16 v[132:135], a[136:139], a[116:119], v[132:135]
ds_read_b64_tr_b16 a[134:135], v17 offset:52096
v_add_f32_dpp v32, v32, v32 row_ror:1 row_mask:0xf bank_mask:0xf
v_mfma_f32_16x16x32_bf16 v[136:139], a[136:139], a[120:123], v[136:139]
v_mov_b32 v56, v32
v_cvt_f32_u32 v29, v61
v_mfma_f32_16x16x32_bf16 v[140:143], a[136:139], a[124:127], v[140:143]
v_permlane16_swap_b32 v32, v56
v_mfma_f32_16x16x32_bf16 v[156:159], a[140:143], a[124:127], v[156:159]
ds_read_b64_tr_b16 a[136:137], v17 offset:36000
s_add_u32 m0, s49, 36864
v_mfma_f32_16x16x32_bf16 v[152:155], a[140:143], a[120:123], v[152:155]
ds_read_b64_tr_b16 a[138:139], v17 offset:37792
s_mov_b32 s98, 5504
v_mfma_f32_16x16x32_bf16 v[148:151], a[140:143], a[116:119], v[148:151]
buffer_load_dwordx4 v2, s[8:11], s98 offen lds
v_mfma_f32_16x16x32_bf16 v[144:147], a[140:143], a[112:115], v[144:147]
v_mul_f32 v60, 0x41800000, v29
s_waitcnt lgkmcnt(6)
v_mfma_f32_16x16x32_bf16 v[160:163], a[144:147], a[112:115], v[160:163]
ds_read_b64_tr_b16 a[140:141], v17 offset:50336
v_add_f32 v32, v32, v56
v_mfma_f32_16x16x32_bf16 v[164:167], a[144:147], a[116:119], v[164:167]
ds_read_b64_tr_b16 a[142:143], v17 offset:52128
s_add_u32 m0, s49, 37888
v_mfma_f32_16x16x32_bf16 v[168:171], a[144:147], a[120:123], v[168:171]
buffer_load_dwordx4 v3, s[8:11], s98 offen lds
v_mfma_f32_16x16x32_bf16 v[172:175], a[144:147], a[124:127], v[172:175]
v_add_f32_dpp v33, v33, v33 row_ror:8 row_mask:0xf bank_mask:0xf
v_mfma_f32_16x16x32_bf16 v[188:191], a[148:151], a[124:127], v[188:191]
ds_read_b64_tr_b16 a[144:145], v17 offset:36032
v_mul_f32 v61, 0x44000000, v29
v_mfma_f32_16x16x32_bf16 v[184:187], a[148:151], a[120:123], v[184:187]
ds_read_b64_tr_b16 a[146:147], v17 offset:37824
v_add_f32_dpp v33, v33, v33 row_ror:4 row_mask:0xf bank_mask:0xf
v_mfma_f32_16x16x32_bf16 v[180:183], a[148:151], a[116:119], v[180:183]
s_nop 0
v_add_f32_dpp v33, v33, v33 row_ror:2 row_mask:0xf bank_mask:0xf
v_mfma_f32_16x16x32_bf16 v[176:179], a[148:151], a[112:115], v[176:179]
v_cmp_le_u32 s[56:57], 32, v1
s_waitcnt lgkmcnt(6)
v_mfma_f32_16x16x32_bf16 v[192:195], a[128:131], a[112:115], v[192:195]
ds_read_b64_tr_b16 a[148:149], v17 offset:50368
s_add_u32 m0, s49, 38912
v_mfma_f32_16x16x32_bf16 v[196:199], a[128:131], a[116:119], v[196:199]
ds_read_b64_tr_b16 a[150:151], v17 offset:52160
s_mov_b32 s98, 7552
v_mfma_f32_16x16x32_bf16 v[200:203], a[128:131], a[120:123], v[200:203]
buffer_load_dwordx4 v2, s[8:11], s98 offen lds
v_mfma_f32_16x16x32_bf16 v[204:207], a[128:131], a[124:127], v[204:207]
v_add_f32_dpp v33, v33, v33 row_ror:1 row_mask:0xf bank_mask:0xf
v_mfma_f32_16x16x32_bf16 v[220:223], a[132:135], a[124:127], v[220:223]
s_waitcnt vmcnt(18)
ds_read_b128 a[96:99], v13 offset:0
v_mfma_f32_16x16x32_bf16 v[216:219], a[132:135], a[120:123], v[216:219]
ds_read_b128 a[100:103], v13 offset:2048
v_mov_b32 v56, v33
v_mfma_f32_16x16x32_bf16 v[212:215], a[132:135], a[116:119], v[212:215]
s_nop 0
v_permlane16_swap_b32 v33, v56
v_cmp_le_u32 s[58:59], 48, v1
v_mfma_f32_16x16x32_bf16 v[208:211], a[132:135], a[112:115], v[208:211]
s_waitcnt lgkmcnt(6)
v_mfma_f32_16x16x32_bf16 v[224:227], a[136:139], a[112:115], v[224:227]
ds_read_b128 a[104:107], v13 offset:4096
v_add_f32 v33, v33, v56
v_mfma_f32_16x16x32_bf16 v[228:231], a[136:139], a[116:119], v[228:231]
ds_read_b128 a[108:111], v13 offset:6144
s_add_u32 m0, s49, 39936
v_mfma_f32_16x16x32_bf16 v[232:235], a[136:139], a[120:123], v[232:235]
buffer_load_dwordx4 v3, s[8:11], s98 offen lds
v_mfma_f32_16x16x32_bf16 v[236:239], a[136:139], a[124:127], v[236:239]
s_waitcnt vmcnt(10) lgkmcnt(4)
s_barrier
v_mfma_f32_16x16x32_bf16 v[252:255], a[140:143], a[124:127], v[252:255]
ds_read_b128 a[128:131], v15 offset:0
v_accvgpr_read_b32 v24, a154
v_mfma_f32_16x16x32_bf16 v[248:251], a[140:143], a[120:123], v[248:251]
ds_read_b128 a[132:135], v15 offset:2048
v_add_f32_dpp v34, v34, v34 row_ror:8 row_mask:0xf bank_mask:0xf
v_mfma_f32_16x16x32_bf16 v[244:247], a[140:143], a[116:119], v[244:247]
ds_read_b128 a[136:139], v15 offset:4096
v_mfma_f32_16x16x32_bf16 v[240:243], a[140:143], a[112:115], v[240:243]
v_add_f32_dpp v34, v34, v34 row_ror:4 row_mask:0xf bank_mask:0xf
v_mfma_f32_16x16x32_bf16 a[0:3], a[144:147], a[112:115], a[0:3]
ds_read_b128 a[140:143], v15 offset:6144
v_accvgpr_read_b32 v25, a156
v_mfma_f32_16x16x32_bf16 a[4:7], a[144:147], a[116:119], a[4:7]
v_add_f32_dpp v34, v34, v34 row_ror:2 row_mask:0xf bank_mask:0xf
v_mfma_f32_16x16x32_bf16 a[8:11], a[144:147], a[120:123], a[8:11]
s_nop 0
v_add_f32_dpp v34, v34, v34 row_ror:1 row_mask:0xf bank_mask:0xf
L_pg6:
s_cbranch_execz L_pg10
v_accvgpr_read_b32 v26, a158
v_mfma_f32_16x16x32_bf16 a[12:15], a[144:147], a[124:127], a[12:15]
v_mov_b32_e64 v56, v34
v_mfma_f32_16x16x32_bf16 a[28:31], a[148:151], a[124:127], a[28:31]
ds_read_b64_tr_b16 a[144:145], v17 offset:0
v_permlane16_swap_b32 v34, v56
v_mfma_f32_16x16x32_bf16 a[24:27], a[148:151], a[120:123], a[24:27]
ds_read_b64_tr_b16 a[146:147], v17 offset:1792
v_lshlrev_b32 v24, 16, v24
v_mfma_f32_16x16x32_bf16 a[20:23], a[148:151], a[116:119], a[20:23]
v_add_f32_e64 v34, v34, v56
v_mfma_f32_16x16x32_bf16 a[16:19], a[148:151], a[112:115], a[16:19]
v_mul_f32 v32, 0xba800000, v32
s_waitcnt lgkmcnt(4)
v_mfma_f32_16x16x32_bf16 a[32:35], a[96:99], a[128:131], a[32:35]
ds_read_b64_tr_b16 a[148:149], v17 offset:14336
s_add_u32 m0, s50, 28672
v_mfma_f32_16x16x32_bf16 a[36:39], a[100:103], a[128:131], a[36:39]
ds_read_b64_tr_b16 a[150:151], v17 offset:16128
s_mov_b32 s99, 5046272
v_mfma_f32_16x16x32_bf16 a[40:43], a[104:107], a[128:131], a[40:43]
buffer_load_dwordx4 v6, s[12:15], s99 offen  lds
v_mfma_f32_16x16x32_bf16 a[44:47], a[108:111], a[128:131], a[44:47]
v_lshlrev_b32 v20, 16, v48
v_lshlrev_b32_e64 v25, 16, v25
v_mfma_f32_16x16x32_bf16 a[60:63], a[108:111], a[132:135], a[60:63]
ds_read_b64_tr_b16 a[128:129], v17 offset:32
v_mul_f32 v33, 0x3a800000, v33
v_mfma_f32_16x16x32_bf16 a[56:59], a[104:107], a[132:135], a[56:59]
ds_read_b64_tr_b16 a[130:131], v17 offset:1824
v_and_b32 v21, 0xffff0000, v48
v_mfma_f32_16x16x32_bf16 a[52:55], a[100:103], a[132:135], a[52:55]
ds_read_b128 a[112:115], v14 offset:0
v_mfma_f32_16x16x32_bf16 a[48:51], a[96:99], a[132:135], a[48:51]
v_fma_f32 v33, -v32, v32, v33
s_waitcnt lgkmcnt(7)
v_mfma_f32_16x16x32_bf16 a[64:67], a[96:99], a[136:139], a[64:67]
ds_read_b64_tr_b16 a[132:133], v17 offset:14368
v_lshlrev_b32 v26, 16, v26
v_mfma_f32_16x16x32_bf16 a[68:71], a[100:103], a[136:139], a[68:71]
ds_read_b64_tr_b16 a[134:135], v17 offset:16160
s_add_u32 m0, s50, 29696
v_mfma_f32_16x16x32_bf16 a[72:75], a[104:107], a[136:139], a[72:75]
buffer_load_dwordx4 v7, s[12:15], s99 offen  lds
v_mfma_f32_16x16x32_bf16 a[76:79], a[108:111], a[136:139], a[76:79]
v_add_f32 v40, v40, v20
v_max_f32 v33, 0, v33
v_mfma_f32_16x16x32_bf16 a[92:95], a[108:111], a[140:143], a[92:95]
ds_read_b64_tr_b16 a[136:137], v17 offset:64
v_mfma_f32_16x16x32_bf16 a[88:91], a[104:107], a[140:143], a[88:91]
ds_read_b64_tr_b16 a[138:139], v17 offset:1856
v_cvt_pk_bf16_f32 v33, v33, v33
v_mfma_f32_16x16x32_bf16 a[84:87], a[100:103], a[140:143], a[84:87]
v_add_f32_e64 v41, v41, v21
v_mul_f32 v26, 0x3fb8aa3b, v26
v_mfma_f32_16x16x32_bf16 a[80:83], a[96:99], a[140:143], a[80:83]
v_and_b32 v33, 0xffff0000, v33
s_waitcnt lgkmcnt(7)
v_mfma_f32_16x16x32_bf16 v[64:67], a[144:147], a[96:99], v[64:67]
ds_read_b64_tr_b16 a[140:141], v17 offset:14400
v_mfma_f32_16x16x32_bf16 v[68:71], a[144:147], a[100:103], v[68:71]
ds_read_b64_tr_b16 a[142:143], v17 offset:16192
s_add_u32 m0, s50, 30720
v_mfma_f32_16x16x32_bf16 v[72:75], a[144:147], a[104:107], v[72:75]
buffer_load_dwordx4 v8, s[12:15], s99 offen  lds
v_mfma_f32_16x16x32_bf16 v[76:79], a[144:147], a[108:111], v[76:79]
v_lshlrev_b32 v20, 16, v49
v_add_f32 v33, 0x3727c5ac, v33
v_mfma_f32_16x16x32_bf16 v[92:95], a[148:151], a[108:111], v[92:95]
ds_read_b64_tr_b16 a[144:145], v17 offset:96
v_exp_f32_e64 v26, v26
v_mfma_f32_16x16x32_bf16 v[88:91], a[148:151], a[104:107], v[88:91]
ds_read_b64_tr_b16 a[146:147], v17 offset:1888
v_cvt_pk_bf16_f32 v33, v33, v33
v_mfma_f32_16x16x32_bf16 v[84:87], a[148:151], a[100:103], v[84:87]
ds_read_b128 a[116:119], v14 offset:2048
v_and_b32 v21, 0xffff0000, v49
v_mfma_f32_16x16x32_bf16 v[80:83], a[148:151], a[96:99], v[80:83]
s_waitcnt lgkmcnt(7)
v_mfma_f32_16x16x32_bf16 v[96:99], a[128:131], a[96:99], v[96:99]
ds_read_b64_tr_b16 a[148:149], v17 offset:14432
v_and_b32 v33, 0xffff0000, v33
v_mfma_f32_16x16x32_bf16 v[100:103], a[128:131], a[100:103], v[100:103]
ds_read_b64_tr_b16 a[150:151], v17 offset:16224
s_add_u32 m0, s50, 31744
v_mfma_f32_16x16x32_bf16 v[104:107], a[128:131], a[104:107], v[104:107]
buffer_load_dwordx4 v9, s[12:15], s99 offen  lds
v_mfma_f32_16x16x32_bf16 v[108:111], a[128:131], a[108:111], v[108:111]
v_add_f32 v42, v42, v20
v_mfma_f32_16x16x32_bf16 v[124:127], a[132:135], a[108:111], v[124:127]
ds_read_b64_tr_b16 a[128:129], v17 offset:128
v_sqrt_f32_e64 v33, v33
v_mfma_f32_16x16x32_bf16 v[120:123], a[132:135], a[104:107], v[120:123]
ds_read_b64_tr_b16 a[130:131], v17 offset:1920
v_mfma_f32_16x16x32_bf16 v[116:119], a[132:135], a[100:103], v[116:119]
v_add_f32_e64 v43, v43, v21
v_cvt_pk_bf16_f32 v26, v26, v26
v_mfma_f32_16x16x32_bf16 v[112:115], a[132:135], a[96:99], v[112:115]
s_waitcnt lgkmcnt(7)
v_mfma_f32_16x16x32_bf16 v[128:131], a[136:139], a[96:99], v[128:131]
ds_read_b64_tr_b16 a[132:133], v17 offset:14464
v_cvt_pk_bf16_f32 v33, v33, v33
v_mfma_f32_16x16x32_bf16 v[132:135], a[136:139], a[100:103], v[132:135]
ds_read_b64_tr_b16 a[134:135], v17 offset:16256
s_add_u32 m0, s50, 32768
v_mfma_f32_16x16x32_bf16 v[136:139], a[136:139], a[104:107], v[136:139]
buffer_load_dwordx4 v10, s[12:15], s99 offen  lds
v_mfma_f32_16x16x32_bf16 v[140:143], a[136:139], a[108:111], v[140:143]
v_lshlrev_b32 v20, 16, v50
v_and_b32 v26, 0xffff0000, v26
v_mfma_f32_16x16x32_bf16 v[156:159], a[140:143], a[108:111], v[156:159]
ds_read_b64_tr_b16 a[136:137], v17 offset:160
v_and_b32 v33, 0xffff0000, v33
v_mfma_f32_16x16x32_bf16 v[152:155], a[140:143], a[104:107], v[152:155]
ds_read_b64_tr_b16 a[138:139], v17 offset:1952
v_mfma_f32_16x16x32_bf16 v[148:151], a[140:143], a[100:103], v[148:151]
ds_read_b128 a[120:123], v14 offset:4096
v_and_b32 v21, 0xffff0000, v50
v_mfma_f32_16x16x32_bf16 v[144:147], a[140:143], a[96:99], v[144:147]
v_cvt_pk_bf16_f32 v32, v32, v32
s_waitcnt lgkmcnt(7)
v_mfma_f32_16x16x32_bf16 v[160:163], a[144:147], a[96:99], v[160:163]
ds_read_b64_tr_b16 a[140:141], v17 offset:14496
v_mul_f32 v27, v26, v24
v_mfma_f32_16x16x32_bf16 v[164:167], a[144:147], a[100:103], v[164:167]
ds_read_b64_tr_b16 a[142:143], v17 offset:16288
s_add_u32 m0, s50, 33792
v_mfma_f32_16x16x32_bf16 v[168:171], a[144:147], a[104:107], v[168:171]
buffer_load_dwordx4 v11, s[12:15], s99 offen  lds
v_mfma_f32_16x16x32_bf16 v[172:175], a[144:147], a[108:111], v[172:175]
v_add_f32_e64 v44, v44, v20
v_and_b32 v32, 0xffff0000, v32
v_mfma_f32_16x16x32_bf16 v[188:191], a[148:151], a[108:111], v[188:191]
ds_read_b64_tr_b16 a[144:145], v17 offset:192
v_mfma_f32_16x16x32_bf16 v[184:187], a[148:151], a[104:107], v[184:187]
ds_read_b64_tr_b16 a[146:147], v17 offset:1984
v_min_u32 v34, -2, v34
v_mfma_f32_16x16x32_bf16 v[180:183], a[148:151], a[100:103], v[180:183]
v_add_f32 v45, v45, v21
v_mul_f32_e64 v28, v26, v25
v_mfma_f32_16x16x32_bf16 v[176:179], a[148:151], a[96:99], v[176:179]
v_and_b32 v56, 31, v1
s_waitcnt lgkmcnt(7)
v_mfma_f32_16x16x32_bf16 v[192:195], a[128:131], a[96:99], v[192:195]
ds_read_b64_tr_b16 a[148:149], v17 offset:14528
v_mfma_f32_16x16x32_bf16 v[196:199], a[128:131], a[100:103], v[196:199]
ds_read_b64_tr_b16 a[150:151], v17 offset:16320
s_add_u32 m0, s50, 34816
v_mfma_f32_16x16x32_bf16 v[200:203], a[128:131], a[104:107], v[200:203]
buffer_load_dwordx4 v12, s[12:15], s99 offen  lds
v_mfma_f32_16x16x32_bf16 v[204:207], a[128:131], a[108:111], v[204:207]
v_lshlrev_b32 v20, 16, v51
v_lshlrev_b32 v56, 28, v56
v_mfma_f32_16x16x32_bf16 v[220:223], a[132:135], a[108:111], v[220:223]
ds_read_b128 a[128:131], v16 offset:0
v_mul_f32 v27, 0x3fb8aa3b, v27
v_mfma_f32_16x16x32_bf16 v[216:219], a[132:135], a[104:107], v[216:219]
v_and_b32 v21, 0xffff0000, v51
v_and_b32_e64 v57, 16, v1
v_mfma_f32_16x16x32_bf16 v[212:215], a[132:135], a[100:103], v[212:215]
ds_read_b128 a[124:127], v14 offset:6144
v_mfma_f32_16x16x32_bf16 v[208:211], a[132:135], a[96:99], v[208:211]
v_lshl_or_b32 v56, v57, 24, v56
s_waitcnt lgkmcnt(6)
v_mfma_f32_16x16x32_bf16 v[224:227], a[136:139], a[96:99], v[224:227]
ds_read_b128 a[132:135], v16 offset:2048
s_add_u32 m0, s51, 8192
v_mfma_f32_16x16x32_bf16 v[228:231], a[136:139], a[100:103], v[228:231]
s_mov_b32 s100, 1408
v_add_f32 v46, v46, v20
v_mul_f32_e64 v28, 0x3e22f983, v28
v_mfma_f32_16x16x32_bf16 v[232:235], a[136:139], a[104:107], v[232:235]
buffer_load_dwordx4 v4, s[16:19], s100 offen lds
v_mfma_f32_16x16x32_bf16 v[236:239], a[136:139], a[108:111], v[236:239]
v_lshrrev_b32_e64 v57, 5, v1
v_mfma_f32_16x16x32_bf16 v[252:255], a[140:143], a[108:111], v[252:255]
ds_read_b128 a[136:139], v16 offset:4096
v_mfma_f32_16x16x32_bf16 v[248:251], a[140:143], a[104:107], v[248:251]
v_add_f32_e64 v47, v47, v21
v_lshl_or_b32 v58, v57, 3, v56
v_mfma_f32_16x16x32_bf16 v[244:247], a[140:143], a[100:103], v[244:247]
v_lshl_or_b32 v59, v57, 2, v56
v_mul_f32_e64 v29, 1.0, v27
v_mfma_f32_16x16x32_bf16 v[240:243], a[140:143], a[96:99], v[240:243]
s_waitcnt lgkmcnt(4)
v_mfma_f32_16x16x32_bf16 a[0:3], a[144:147], a[96:99], a[0:3]
ds_read_b128 a[140:143], v16 offset:6144
v_mul_f32 v30, 1.0, v28
v_mfma_f32_16x16x32_bf16 a[4:7], a[144:147], a[100:103], a[4:7]
s_add_u32 m0, s51, 9216
v_fract_f32_e64 v30, v30
v_mfma_f32_16x16x32_bf16 a[8:11], a[144:147], a[104:107], a[8:11]
buffer_load_dwordx4 v5, s[16:19], s100 offen lds
v_mfma_f32_16x16x32_bf16 a[12:15], a[144:147], a[108:111], a[12:15]
s_mov_b32 s101, 6422528
v_exp_f32_e64 v29, v29
v_mfma_f32_16x16x32_bf16 a[28:31], a[148:151], a[108:111], a[28:31]
ds_read_b64_tr_b16 a[144:145], v17 offset:7168
s_lshr_b32 s62, s60, 8
v_mfma_f32_16x16x32_bf16 a[24:27], a[148:151], a[104:107], a[24:27]
ds_read_b64_tr_b16 a[146:147], v17 offset:8960
s_add_u32 s62, s62, 25165824
v_mfma_f32_16x16x32_bf16 a[20:23], a[148:151], a[100:103], a[20:23]
buffer_load_dwordx4 v[48:51], v18, s[12:15], s101 offen
v_mfma_f32_16x16x32_bf16 a[16:19], a[148:151], a[96:99], a[16:19]
s_lshl_b32 s63, s55, 10
s_add_u32 s63, s63, 0
s_waitcnt lgkmcnt(4)
v_mfma_f32_16x16x32_bf16 a[32:35], a[112:115], a[128:131], a[32:35]
ds_read_b64_tr_b16 a[148:149], v17 offset:21504
v_mfma_f32_16x16x32_bf16 a[36:39], a[116:119], a[128:131], a[36:39]
ds_read_b64_tr_b16 a[150:151], v17 offset:23296
v_mfma_f32_16x16x32_bf16 a[40:43], a[120:123], a[128:131], a[40:43]
buffer_load_dwordx4 v[36:39], v23, s[32:35], s63 offen
v_mfma_f32_16x16x32_bf16 a[44:47], a[124:127], a[128:131], a[44:47]
v_cos_f32_e64 v31, v30
v_mfma_f32_16x16x32_bf16 a[60:63], a[124:127], a[132:135], a[60:63]
ds_read_b64_tr_b16 a[128:129], v17 offset:7200
v_mfma_f32_16x16x32_bf16 a[56:59], a[120:123], a[132:135], a[56:59]
ds_read_b64_tr_b16 a[130:131], v17 offset:8992
v_mfma_f32_16x16x32_bf16 a[52:55], a[116:119], a[132:135], a[52:55]
buffer_store_dwordx2 v[32:33], v58, s[20:23], s62 offen sc1
v_mfma_f32_16x16x32_bf16 a[48:51], a[112:115], a[132:135], a[48:51]
s_lshr_b32 s62, s61, 9
s_and_b32 s45, s3, 1
s_waitcnt lgkmcnt(6)
v_mfma_f32_16x16x32_bf16 a[64:67], a[112:115], a[136:139], a[64:67]
ds_read_b64_tr_b16 a[132:133], v17 offset:21536
s_lshl_b32 s45, s45, 12
v_mfma_f32_16x16x32_bf16 a[68:71], a[116:119], a[136:139], a[68:71]
ds_read_b64_tr_b16 a[134:135], v17 offset:23328
s_add_u32 s62, s62, s45
v_mfma_f32_16x16x32_bf16 a[72:75], a[120:123], a[136:139], a[72:75]
s_add_u32 s62, s62, 25182208
buffer_store_dword v34, v59, s[20:23], s62 offen sc1
v_mfma_f32_16x16x32_bf16 a[76:79], a[124:127], a[136:139], a[76:79]
v_sin_f32 v35, v30
v_mfma_f32_16x16x32_bf16 a[92:95], a[124:127], a[140:143], a[92:95]
ds_read_b64_tr_b16 a[136:137], v17 offset:7232
s_add_u32 m0, s49, 0
v_mfma_f32_16x16x32_bf16 a[88:91], a[120:123], a[140:143], a[88:91]
ds_read_b64_tr_b16 a[138:139], v17 offset:9024
s_mov_b32 s98, 1536
v_mfma_f32_16x16x32_bf16 a[84:87], a[116:119], a[140:143], a[84:87]
buffer_load_dwordx4 v2, s[8:11], s98 offen lds
v_mfma_f32_16x16x32_bf16 a[80:83], a[112:115], a[140:143], a[80:83]
s_waitcnt lgkmcnt(6)
v_mfma_f32_16x16x32_bf16 v[64:67], a[144:147], a[112:115], v[64:67]
ds_read_b64_tr_b16 a[140:141], v17 offset:21568
v_mfma_f32_16x16x32_bf16 v[68:71], a[144:147], a[116:119], v[68:71]
ds_read_b64_tr_b16 a[142:143], v17 offset:23360
s_add_u32 m0, s49, 1024
v_mfma_f32_16x16x32_bf16 v[72:75], a[144:147], a[120:123], v[72:75]
buffer_load_dwordx4 v3, s[8:11], s98 offen lds
v_mfma_f32_16x16x32_bf16 v[76:79], a[144:147], a[124:127], v[76:79]
v_mul_f32_e64 v31, v29, v31
v_mfma_f32_16x16x32_bf16 v[92:95], a[148:151], a[124:127], v[92:95]
ds_read_b64_tr_b16 a[144:145], v17 offset:7264
v_mfma_f32_16x16x32_bf16 v[88:91], a[148:151], a[120:123], v[88:91]
ds_read_b64_tr_b16 a[146:147], v17 offset:9056
v_mul_f32_e64 v35, v29, v35
v_mfma_f32_16x16x32_bf16 v[84:87], a[148:151], a[116:119], v[84:87]
v_accvgpr_write_b32 a192, v31
v_mfma_f32_16x16x32_bf16 v[80:83], a[148:151], a[112:115], v[80:83]
s_waitcnt lgkmcnt(6)
v_mfma_f32_16x16x32_bf16 v[96:99], a[128:131], a[112:115], v[96:99]
ds_read_b64_tr_b16 a[148:149], v17 offset:21600
s_add_u32 m0, s49, 2048
v_mfma_f32_16x16x32_bf16 v[100:103], a[128:131], a[116:119], v[100:103]
ds_read_b64_tr_b16 a[150:151], v17 offset:23392
s_mov_b32 s98, 3584
v_mfma_f32_16x16x32_bf16 v[104:107], a[128:131], a[120:123], v[104:107]
buffer_load_dwordx4 v2, s[8:11], s98 offen lds
v_mfma_f32_16x16x32_bf16 v[108:111], a[128:131], a[124:127], v[108:111]
v_accvgpr_write_b32 a193, v35
v_mfma_f32_16x16x32_bf16 v[124:127], a[132:135], a[124:127], v[124:127]
ds_read_b64_tr_b16 a[128:129], v17 offset:7296
v_add_f32 v31, -1.0, v31
v_mfma_f32_16x16x32_bf16 v[120:123], a[132:135], a[120:123], v[120:123]
ds_read_b64_tr_b16 a[130:131], v17 offset:9088
s_add_u32 m0, s49, 3072
v_mfma_f32_16x16x32_bf16 v[116:119], a[132:135], a[116:119], v[116:119]
buffer_load_dwordx4 v3, s[8:11], s98 offen lds
v_mfma_f32_16x16x32_bf16 v[112:115], a[132:135], a[112:115], v[112:115]
s_waitcnt lgkmcnt(6)
v_mfma_f32_16x16x32_bf16 v[128:131], a[136:139], a[112:115], v[128:131]
ds_read_b64_tr_b16 a[132:133], v17 offset:21632
v_mul_f32 v26, v24, v24
v_mfma_f32_16x16x32_bf16 v[132:135], a[136:139], a[116:119], v[132:135]
ds_read_b64_tr_b16 a[134:135], v17 offset:23424
v_mfma_f32_16x16x32_bf16 v[136:139], a[136:139], a[120:123], v[136:139]
v_fmac_f32_e64 v26, v25, v25
v_mfma_f32_16x16x32_bf16 v[140:143], a[136:139], a[124:127], v[140:143]
v_rcp_f32_e64 v26, v26
v_mfma_f32_16x16x32_bf16 v[156:159], a[140:143], a[124:127], v[156:159]
ds_read_b64_tr_b16 a[136:137], v17 offset:7328
s_add_u32 m0, s49, 4096
v_mfma_f32_16x16x32_bf16 v[152:155], a[140:143], a[120:123], v[152:155]
ds_read_b64_tr_b16 a[138:139], v17 offset:9120
s_mov_b32 s98, 5632
v_mfma_f32_16x16x32_bf16 v[148:151], a[140:143], a[116:119], v[148:151]
buffer_load_dwordx4 v2, s[8:11], s98 offen lds
v_mfma_f32_16x16x32_bf16 v[144:147], a[140:143], a[112:115], v[144:147]
s_waitcnt lgkmcnt(6)
v_mfma_f32_16x16x32_bf16 v[160:163], a[144:147], a[112:115], v[160:163]
ds_read_b64_tr_b16 a[140:141], v17 offset:21664
v_mfma_f32_16x16x32_bf16 v[164:167], a[144:147], a[116:119], v[164:167]
ds_read_b64_tr_b16 a[142:143], v17 offset:23456
s_add_u32 m0, s49, 5120
v_mfma_f32_16x16x32_bf16 v[168:171], a[144:147], a[120:123], v[168:171]
buffer_load_dwordx4 v3, s[8:11], s98 offen lds
v_mfma_f32_16x16x32_bf16 v[172:175], a[144:147], a[124:127], v[172:175]
v_mul_f32 v62, v31, v24
v_mfma_f32_16x16x32_bf16 v[188:191], a[148:151], a[124:127], v[188:191]
ds_read_b64_tr_b16 a[144:145], v17 offset:7360
v_fmac_f32_e64 v62, v35, v25
v_mfma_f32_16x16x32_bf16 v[184:187], a[148:151], a[120:123], v[184:187]
ds_read_b64_tr_b16 a[146:147], v17 offset:9152
v_mfma_f32_16x16x32_bf16 v[180:183], a[148:151], a[116:119], v[180:183]
v_mul_f32_e64 v63, v35, v24
v_mfma_f32_16x16x32_bf16 v[176:179], a[148:151], a[112:115], v[176:179]
v_fma_f32 v63, -v31, v25, v63
s_waitcnt lgkmcnt(6)
v_mfma_f32_16x16x32_bf16 v[192:195], a[128:131], a[112:115], v[192:195]
ds_read_b64_tr_b16 a[148:149], v17 offset:21696
s_add_u32 m0, s49, 6144
v_mfma_f32_16x16x32_bf16 v[196:199], a[128:131], a[116:119], v[196:199]
ds_read_b64_tr_b16 a[150:151], v17 offset:23488
s_mov_b32 s98, 7680
v_mfma_f32_16x16x32_bf16 v[200:203], a[128:131], a[120:123], v[200:203]
buffer_load_dwordx4 v2, s[8:11], s98 offen lds
v_mfma_f32_16x16x32_bf16 v[204:207], a[128:131], a[124:127], v[204:207]
v_add_f32 v26, v26, v26
v_mfma_f32_16x16x32_bf16 v[220:223], a[132:135], a[124:127], v[220:223]
s_waitcnt vmcnt(20)
ds_read_b128 a[96:99], v13 offset:32768
v_mfma_f32_16x16x32_bf16 v[216:219], a[132:135], a[120:123], v[216:219]
ds_read_b128 a[100:103], v13 offset:34816
v_mfma_f32_16x16x32_bf16 v[212:215], a[132:135], a[116:119], v[212:215]
v_mul_f32 v62, v62, v26
v_mfma_f32_16x16x32_bf16 v[208:211], a[132:135], a[112:115], v[208:211]
v_mul_f32 v63, v63, v26
s_waitcnt lgkmcnt(6)
v_mfma_f32_16x16x32_bf16 v[224:227], a[136:139], a[112:115], v[224:227]
ds_read_b128 a[104:107], v13 offset:36864
v_mfma_f32_16x16x32_bf16 v[228:231], a[136:139], a[116:119], v[228:231]
ds_read_b128 a[108:111], v13 offset:38912
s_add_u32 m0, s49, 7168
v_mfma_f32_16x16x32_bf16 v[232:235], a[136:139], a[120:123], v[232:235]
buffer_load_dwordx4 v3, s[8:11], s98 offen lds
v_mfma_f32_16x16x32_bf16 v[236:239], a[136:139], a[124:127], v[236:239]
s_waitcnt vmcnt(12) lgkmcnt(4)
s_barrier
v_mfma_f32_16x16x32_bf16 v[252:255], a[140:143], a[124:127], v[252:255]
ds_read_b128 a[128:131], v15 offset:8192
v_accvgpr_write_b32 a194, v62
v_mfma_f32_16x16x32_bf16 v[248:251], a[140:143], a[120:123], v[248:251]
ds_read_b128 a[132:135], v15 offset:10240
v_mfma_f32_16x16x32_bf16 v[244:247], a[140:143], a[116:119], v[244:247]
ds_read_b128 a[136:139], v15 offset:12288
v_accvgpr_write_b32 a195, v63
v_mfma_f32_16x16x32_bf16 v[240:243], a[140:143], a[112:115], v[240:243]
v_mfma_f32_16x16x32_bf16 a[0:3], a[144:147], a[112:115], a[0:3]
ds_read_b128 a[140:143], v15 offset:14336
v_mul_f32 v29, 0x41800000, v27
v_mfma_f32_16x16x32_bf16 a[4:7], a[144:147], a[116:119], a[4:7]
v_mul_f32 v30, 0x41800000, v28
v_mfma_f32_16x16x32_bf16 a[8:11], a[144:147], a[120:123], a[8:11]
v_fract_f32_e64 v30, v30
v_mfma_f32_16x16x32_bf16 a[12:15], a[144:147], a[124:127], a[12:15]
v_exp_f32_e64 v29, v29
v_mfma_f32_16x16x32_bf16 a[28:31], a[148:151], a[124:127], a[28:31]
ds_read_b64_tr_b16 a[144:145], v17 offset:28672
v_mfma_f32_16x16x32_bf16 a[24:27], a[148:151], a[120:123], a[24:27]
ds_read_b64_tr_b16 a[146:147], v17 offset:30464
v_mfma_f32_16x16x32_bf16 a[20:23], a[148:151], a[116:119], a[20:23]
v_cos_f32_e64 v31, v30
v_mfma_f32_16x16x32_bf16 a[16:19], a[148:151], a[112:115], a[16:19]
s_waitcnt lgkmcnt(4)
v_mfma_f32_16x16x32_bf16 a[32:35], a[96:99], a[128:131], a[32:35]
ds_read_b64_tr_b16 a[148:149], v17 offset:43008
s_add_u32 m0, s50, 0
v_mfma_f32_16x16x32_bf16 a[36:39], a[100:103], a[128:131], a[36:39]
ds_read_b64_tr_b16 a[150:151], v17 offset:44800
s_mov_b32 s99, 5505024
v_mfma_f32_16x16x32_bf16 a[40:43], a[104:107], a[128:131], a[40:43]
buffer_load_dwordx4 v6, s[12:15], s99 offen  lds
v_mfma_f32_16x16x32_bf16 a[44:47], a[108:111], a[128:131], a[44:47]
v_lshlrev_b32_e64 v20, 16, v52
v_mfma_f32_16x16x32_bf16 a[60:63], a[108:111], a[132:135], a[60:63]
ds_read_b64_tr_b16 a[128:129], v17 offset:28704
v_mfma_f32_16x16x32_bf16 a[56:59], a[104:107], a[132:135], a[56:59]
ds_read_b64_tr_b16 a[130:131], v17 offset:30496
v_and_b32 v21, 0xffff0000, v52
v_mfma_f32_16x16x32_bf16 a[52:55], a[100:103], a[132:135], a[52:55]
ds_read_b128 a[112:115], v14 offset:32768
v_sin_f32 v35, v30
v_mfma_f32_16x16x32_bf16 a[48:51], a[96:99], a[132:135], a[48:51]
s_waitcnt lgkmcnt(7)
v_mfma_f32_16x16x32_bf16 a[64:67], a[96:99], a[136:139], a[64:67]
ds_read_b64_tr_b16 a[132:133], v17 offset:43040
v_mfma_f32_16x16x32_bf16 a[68:71], a[100:103], a[136:139], a[68:71]
ds_read_b64_tr_b16 a[134:135], v17 offset:44832
s_add_u32 m0, s50, 1024
v_mfma_f32_16x16x32_bf16 a[72:75], a[104:107], a[136:139], a[72:75]
buffer_load_dwordx4 v7, s[12:15], s99 offen  lds
v_mfma_f32_16x16x32_bf16 a[76:79], a[108:111], a[136:139], a[76:79]
v_add_f32 v40, v40, v20
v_mfma_f32_16x16x32_bf16 a[92:95], a[108:111], a[140:143], a[92:95]
ds_read_b64_tr_b16 a[136:137], v17 offset:28736
v_mul_f32 v31, v29, v31
v_mfma_f32_16x16x32_bf16 a[88:91], a[104:107], a[140:143], a[88:91]
ds_read_b64_tr_b16 a[138:139], v17 offset:30528
v_mfma_f32_16x16x32_bf16 a[84:87], a[100:103], a[140:143], a[84:87]
v_add_f32 v41, v41, v21
v_mul_f32 v35, v29, v35
v_mfma_f32_16x16x32_bf16 a[80:83], a[96:99], a[140:143], a[80:83]
s_waitcnt lgkmcnt(7)
v_mfma_f32_16x16x32_bf16 v[64:67], a[144:147], a[96:99], v[64:67]
ds_read_b64_tr_b16 a[140:141], v17 offset:43072
v_accvgpr_write_b32 a196, v31
v_mfma_f32_16x16x32_bf16 v[68:71], a[144:147], a[100:103], v[68:71]
ds_read_b64_tr_b16 a[142:143], v17 offset:44864
s_add_u32 m0, s50, 2048
v_mfma_f32_16x16x32_bf16 v[72:75], a[144:147], a[104:107], v[72:75]
buffer_load_dwordx4 v8, s[12:15], s99 offen  lds
v_mfma_f32_16x16x32_bf16 v[76:79], a[144:147], a[108:111], v[76:79]
v_lshlrev_b32 v20, 16, v53
v_mfma_f32_16x16x32_bf16 v[92:95], a[148:151], a[108:111], v[92:95]
ds_read_b64_tr_b16 a[144:145], v17 offset:28768
v_accvgpr_write_b32 a197, v35
v_mfma_f32_16x16x32_bf16 v[88:91], a[148:151], a[104:107], v[88:91]
ds_read_b64_tr_b16 a[146:147], v17 offset:30560
v_mfma_f32_16x16x32_bf16 v[84:87], a[148:151], a[100:103], v[84:87]
ds_read_b128 a[116:119], v14 offset:34816
v_and_b32 v21, 0xffff0000, v53
v_mfma_f32_16x16x32_bf16 v[80:83], a[148:151], a[96:99], v[80:83]
v_cndmask_b32 v62, 0, 1.0, s[56:57]
s_waitcnt lgkmcnt(7)
v_mfma_f32_16x16x32_bf16 v[96:99], a[128:131], a[96:99], v[96:99]
ds_read_b64_tr_b16 a[148:149], v17 offset:43104
v_mfma_f32_16x16x32_bf16 v[100:103], a[128:131], a[100:103], v[100:103]
ds_read_b64_tr_b16 a[150:151], v17 offset:44896
s_add_u32 m0, s50, 3072
v_mfma_f32_16x16x32_bf16 v[104:107], a[128:131], a[104:107], v[104:107]
buffer_load_dwordx4 v9, s[12:15], s99 offen  lds
v_mfma_f32_16x16x32_bf16 v[108:111], a[128:131], a[108:111], v[108:111]
v_add_f32 v42, v42, v20
v_cndmask_b32 v62, v62, v31, s[58:59]
v_mfma_f32_16x16x32_bf16 v[124:127], a[132:135], a[108:111], v[124:127]
ds_read_b64_tr_b16 a[128:129], v17 offset:28800
v_mfma_f32_16x16x32_bf16 v[120:123], a[132:135], a[104:107], v[120:123]
ds_read_b64_tr_b16 a[130:131], v17 offset:30592
v_cndmask_b32 v63, 0, v35, s[58:59]
v_mfma_f32_16x16x32_bf16 v[116:119], a[132:135], a[100:103], v[116:119]
v_add_f32 v43, v43, v21
v_mfma_f32_16x16x32_bf16 v[112:115], a[132:135], a[96:99], v[112:115]
v_accvgpr_write_b32 a206, v62
s_waitcnt lgkmcnt(7)
v_mfma_f32_16x16x32_bf16 v[128:131], a[136:139], a[96:99], v[128:131]
ds_read_b64_tr_b16 a[132:133], v17 offset:43136
v_mfma_f32_16x16x32_bf16 v[132:135], a[136:139], a[100:103], v[132:135]
ds_read_b64_tr_b16 a[134:135], v17 offset:44928
s_add_u32 m0, s50, 4096
v_mfma_f32_16x16x32_bf16 v[136:139], a[136:139], a[104:107], v[136:139]
buffer_load_dwordx4 v10, s[12:15], s99 offen  lds
v_mfma_f32_16x16x32_bf16 v[140:143], a[136:139], a[108:111], v[140:143]
v_lshlrev_b32_e64 v20, 16, v54
v_accvgpr_write_b32 a207, v63
v_mfma_f32_16x16x32_bf16 v[156:159], a[140:143], a[108:111], v[156:159]
ds_read_b64_tr_b16 a[136:137], v17 offset:28832
v_mfma_f32_16x16x32_bf16 v[152:155], a[140:143], a[104:107], v[152:155]
ds_read_b64_tr_b16 a[138:139], v17 offset:30624
v_mul_f32_e64 v29, v35, v35
v_mfma_f32_16x16x32_bf16 v[148:151], a[140:143], a[100:103], v[148:151]
ds_read_b128 a[120:123], v14 offset:36864
v_and_b32 v21, 0xffff0000, v54
v_mfma_f32_16x16x32_bf16 v[144:147], a[140:143], a[96:99], v[144:147]
s_waitcnt lgkmcnt(7)
v_mfma_f32_16x16x32_bf16 v[160:163], a[144:147], a[96:99], v[160:163]
ds_read_b64_tr_b16 a[140:141], v17 offset:43168
v_mul_f32 v35, v31, v35
v_mfma_f32_16x16x32_bf16 v[164:167], a[144:147], a[100:103], v[164:167]
ds_read_b64_tr_b16 a[142:143], v17 offset:44960
s_add_u32 m0, s50, 5120
v_mfma_f32_16x16x32_bf16 v[168:171], a[144:147], a[104:107], v[168:171]
buffer_load_dwordx4 v11, s[12:15], s99 offen  lds
v_mfma_f32_16x16x32_bf16 v[172:175], a[144:147], a[108:111], v[172:175]
v_add_f32_e64 v44, v44, v20
v_mfma_f32_16x16x32_bf16 v[188:191], a[148:151], a[108:111], v[188:191]
ds_read_b64_tr_b16 a[144:145], v17 offset:28864
v_fma_f32 v31, v31, v31, -v29
v_mfma_f32_16x16x32_bf16 v[184:187], a[148:151], a[104:107], v[184:187]
ds_read_b64_tr_b16 a[146:147], v17 offset:30656
v_mfma_f32_16x16x32_bf16 v[180:183], a[148:151], a[100:103], v[180:183]
v_add_f32 v45, v45, v21
v_add_f32 v35, v35, v35
v_mfma_f32_16x16x32_bf16 v[176:179], a[148:151], a[96:99], v[176:179]
s_waitcnt lgkmcnt(7)
v_mfma_f32_16x16x32_bf16 v[192:195], a[128:131], a[96:99], v[192:195]
ds_read_b64_tr_b16 a[148:149], v17 offset:43200
v_accvgpr_write_b32 a198, v31
v_mfma_f32_16x16x32_bf16 v[196:199], a[128:131], a[100:103], v[196:199]
ds_read_b64_tr_b16 a[150:151], v17 offset:44992
s_add_u32 m0, s50, 6144
v_mfma_f32_16x16x32_bf16 v[200:203], a[128:131], a[104:107], v[200:203]
buffer_load_dwordx4 v12, s[12:15], s99 offen  lds
v_mfma_f32_16x16x32_bf16 v[204:207], a[128:131], a[108:111], v[204:207]
v_lshlrev_b32 v20, 16, v55
v_mfma_f32_16x16x32_bf16 v[220:223], a[132:135], a[108:111], v[220:223]
ds_read_b128 a[128:131], v16 offset:8192
v_accvgpr_write_b32 a199, v35
v_mfma_f32_16x16x32_bf16 v[216:219], a[132:135], a[104:107], v[216:219]
v_and_b32 v21, 0xffff0000, v55
v_mfma_f32_16x16x32_bf16 v[212:215], a[132:135], a[100:103], v[212:215]
ds_read_b128 a[124:127], v14 offset:38912
v_mul_f32 v29, v35, v35
v_mfma_f32_16x16x32_bf16 v[208:211], a[132:135], a[96:99], v[208:211]
s_waitcnt lgkmcnt(6)
v_mfma_f32_16x16x32_bf16 v[224:227], a[136:139], a[96:99], v[224:227]
ds_read_b128 a[132:135], v16 offset:10240
s_add_u32 m0, s51, 0
v_mfma_f32_16x16x32_bf16 v[228:231], a[136:139], a[100:103], v[228:231]
s_mov_b32 s100, 1536
v_add_f32 v46, v46, v20
v_mul_f32_e64 v35, v31, v35
v_mfma_f32_16x16x32_bf16 v[232:235], a[136:139], a[104:107], v[232:235]
buffer_load_dwordx4 v4, s[16:19], s100 offen lds
v_mfma_f32_16x16x32_bf16 v[236:239], a[136:139], a[108:111], v[236:239]
v_mfma_f32_16x16x32_bf16 v[252:255], a[140:143], a[108:111], v[252:255]
ds_read_b128 a[136:139], v16 offset:12288
v_fma_f32 v31, v31, v31, -v29
v_mfma_f32_16x16x32_bf16 v[248:251], a[140:143], a[104:107], v[248:251]
v_add_f32 v47, v47, v21
v_mfma_f32_16x16x32_bf16 v[244:247], a[140:143], a[100:103], v[244:247]
v_add_f32 v35, v35, v35
v_mfma_f32_16x16x32_bf16 v[240:243], a[140:143], a[96:99], v[240:243]
v_accvgpr_write_b32 a200, v31
s_waitcnt lgkmcnt(4)
v_mfma_f32_16x16x32_bf16 a[0:3], a[144:147], a[96:99], a[0:3]
ds_read_b128 a[140:143], v16 offset:14336
v_mfma_f32_16x16x32_bf16 a[4:7], a[144:147], a[100:103], a[4:7]
s_add_u32 m0, s51, 1024
v_accvgpr_write_b32 a201, v35
v_mfma_f32_16x16x32_bf16 a[8:11], a[144:147], a[104:107], a[8:11]
buffer_load_dwordx4 v5, s[16:19], s100 offen lds
v_mfma_f32_16x16x32_bf16 a[12:15], a[144:147], a[108:111], a[12:15]
s_mov_b32 s101, 6881280
v_mul_f32 v29, v60, v27
v_mfma_f32_16x16x32_bf16 a[28:31], a[148:151], a[108:111], a[28:31]
ds_read_b64_tr_b16 a[144:145], v17 offset:35840
L_pg7:
s_cbranch_execz L_pg11
v_mul_f32 v30, v60, v28
v_mfma_f32_16x16x32_bf16 a[24:27], a[148:151], a[104:107], a[24:27]
ds_read_b64_tr_b16 a[146:147], v17 offset:37632
v_mfma_f32_16x16x32_bf16 a[20:23], a[148:151], a[100:103], a[20:23]
buffer_load_dwordx4 v[52:55], v18, s[12:15], s101 offen
v_mfma_f32_16x16x32_bf16 a[16:19], a[148:151], a[96:99], a[16:19]
s_lshl_b32 s63, s55, 10
s_add_u32 s63, s63, 0
s_waitcnt lgkmcnt(4)
v_mfma_f32_16x16x32_bf16 a[32:35], a[112:115], a[128:131], a[32:35]
ds_read_b64_tr_b16 a[148:149], v17 offset:50176
v_lshrrev_b32 v56, 5, v1
v_mfma_f32_16x16x32_bf16 a[36:39], a[116:119], a[128:131], a[36:39]
ds_read_b64_tr_b16 a[150:151], v17 offset:51968
v_lshlrev_b32 v56, 7, v56
v_mfma_f32_16x16x32_bf16 a[40:43], a[120:123], a[128:131], a[40:43]
buffer_load_dwordx4 v[36:39], v23, s[36:39], s63 offen
v_mfma_f32_16x16x32_bf16 a[44:47], a[124:127], a[128:131], a[44:47]
v_fract_f32 v30, v30
v_mfma_f32_16x16x32_bf16 a[60:63], a[124:127], a[132:135], a[60:63]
ds_read_b64_tr_b16 a[128:129], v17 offset:35872
v_mfma_f32_16x16x32_bf16 a[56:59], a[120:123], a[132:135], a[56:59]
ds_read_b64_tr_b16 a[130:131], v17 offset:37664
v_mfma_f32_16x16x32_bf16 a[52:55], a[116:119], a[132:135], a[52:55]
global_load_dword v57, v56, s[92:93] sc1
v_mfma_f32_16x16x32_bf16 a[48:51], a[112:115], a[132:135], a[48:51]
s_waitcnt lgkmcnt(6)
v_mfma_f32_16x16x32_bf16 a[64:67], a[112:115], a[136:139], a[64:67]
ds_read_b64_tr_b16 a[132:133], v17 offset:50208
v_mfma_f32_16x16x32_bf16 a[68:71], a[116:119], a[136:139], a[68:71]
ds_read_b64_tr_b16 a[134:135], v17 offset:52000
v_mfma_f32_16x16x32_bf16 a[72:75], a[120:123], a[136:139], a[72:75]
v_exp_f32 v29, v29
v_mfma_f32_16x16x32_bf16 a[76:79], a[124:127], a[136:139], a[76:79]
v_cos_f32_e64 v31, v30
v_mfma_f32_16x16x32_bf16 a[92:95], a[124:127], a[140:143], a[92:95]
ds_read_b64_tr_b16 a[136:137], v17 offset:35904
s_add_u32 m0, s49, 32768
v_mfma_f32_16x16x32_bf16 a[88:91], a[120:123], a[140:143], a[88:91]
ds_read_b64_tr_b16 a[138:139], v17 offset:37696
s_mov_b32 s98, 1664
v_mfma_f32_16x16x32_bf16 a[84:87], a[116:119], a[140:143], a[84:87]
buffer_load_dwordx4 v2, s[8:11], s98 offen lds
v_mfma_f32_16x16x32_bf16 a[80:83], a[112:115], a[140:143], a[80:83]
s_waitcnt lgkmcnt(6)
v_mfma_f32_16x16x32_bf16 v[64:67], a[144:147], a[112:115], v[64:67]
ds_read_b64_tr_b16 a[140:141], v17 offset:50240
v_mfma_f32_16x16x32_bf16 v[68:71], a[144:147], a[116:119], v[68:71]
ds_read_b64_tr_b16 a[142:143], v17 offset:52032
s_add_u32 m0, s49, 33792
v_mfma_f32_16x16x32_bf16 v[72:75], a[144:147], a[120:123], v[72:75]
buffer_load_dwordx4 v3, s[8:11], s98 offen lds
v_mfma_f32_16x16x32_bf16 v[76:79], a[144:147], a[124:127], v[76:79]
v_sin_f32 v35, v30
v_mfma_f32_16x16x32_bf16 v[92:95], a[148:151], a[124:127], v[92:95]
ds_read_b64_tr_b16 a[144:145], v17 offset:35936
v_mul_f32_e64 v31, v29, v31
v_mfma_f32_16x16x32_bf16 v[88:91], a[148:151], a[120:123], v[88:91]
ds_read_b64_tr_b16 a[146:147], v17 offset:37728
v_mul_f32_e64 v35, v29, v35
v_mfma_f32_16x16x32_bf16 v[84:87], a[148:151], a[116:119], v[84:87]
v_accvgpr_write_b32 a202, v31
v_mfma_f32_16x16x32_bf16 v[80:83], a[148:151], a[112:115], v[80:83]
s_waitcnt lgkmcnt(6)
v_mfma_f32_16x16x32_bf16 v[96:99], a[128:131], a[112:115], v[96:99]
ds_read_b64_tr_b16 a[148:149], v17 offset:50272
s_add_u32 m0, s49, 34816
v_mfma_f32_16x16x32_bf16 v[100:103], a[128:131], a[116:119], v[100:103]
ds_read_b64_tr_b16 a[150:151], v17 offset:52064
s_mov_b32 s98, 3712
v_mfma_f32_16x16x32_bf16 v[104:107], a[128:131], a[120:123], v[104:107]
buffer_load_dwordx4 v2, s[8:11], s98 offen lds
v_mfma_f32_16x16x32_bf16 v[108:111], a[128:131], a[124:127], v[108:111]
v_accvgpr_write_b32 a203, v35
v_mfma_f32_16x16x32_bf16 v[124:127], a[132:135], a[124:127], v[124:127]
ds_read_b64_tr_b16 a[128:129], v17 offset:35968
v_mul_f32 v29, v61, v27
v_mfma_f32_16x16x32_bf16 v[120:123], a[132:135], a[120:123], v[120:123]
ds_read_b64_tr_b16 a[130:131], v17 offset:37760
s_add_u32 m0, s49, 35840
v_mfma_f32_16x16x32_bf16 v[116:119], a[132:135], a[116:119], v[116:119]
buffer_load_dwordx4 v3, s[8:11], s98 offen lds
v_mfma_f32_16x16x32_bf16 v[112:115], a[132:135], a[112:115], v[112:115]
s_waitcnt lgkmcnt(6)
v_mfma_f32_16x16x32_bf16 v[128:131], a[136:139], a[112:115], v[128:131]
ds_read_b64_tr_b16 a[132:133], v17 offset:50304
v_mul_f32 v30, v61, v28
v_mfma_f32_16x16x32_bf16 v[132:135], a[136:139], a[116:119], v[132:135]
ds_read_b64_tr_b16 a[134:135], v17 offset:52096
v_mfma_f32_16x16x32_bf16 v[136:139], a[136:139], a[120:123], v[136:139]
v_fract_f32_e64 v30, v30
v_mfma_f32_16x16x32_bf16 v[140:143], a[136:139], a[124:127], v[140:143]
v_exp_f32_e64 v29, v29
v_mfma_f32_16x16x32_bf16 v[156:159], a[140:143], a[124:127], v[156:159]
ds_read_b64_tr_b16 a[136:137], v17 offset:36000
s_add_u32 m0, s49, 36864
v_mfma_f32_16x16x32_bf16 v[152:155], a[140:143], a[120:123], v[152:155]
ds_read_b64_tr_b16 a[138:139], v17 offset:37792
s_mov_b32 s98, 5760
v_mfma_f32_16x16x32_bf16 v[148:151], a[140:143], a[116:119], v[148:151]
buffer_load_dwordx4 v2, s[8:11], s98 offen lds
v_mfma_f32_16x16x32_bf16 v[144:147], a[140:143], a[112:115], v[144:147]
s_waitcnt lgkmcnt(6)
v_mfma_f32_16x16x32_bf16 v[160:163], a[144:147], a[112:115], v[160:163]
ds_read_b64_tr_b16 a[140:141], v17 offset:50336
v_mfma_f32_16x16x32_bf16 v[164:167], a[144:147], a[116:119], v[164:167]
ds_read_b64_tr_b16 a[142:143], v17 offset:52128
s_add_u32 m0, s49, 37888
v_mfma_f32_16x16x32_bf16 v[168:171], a[144:147], a[120:123], v[168:171]
buffer_load_dwordx4 v3, s[8:11], s98 offen lds
v_mfma_f32_16x16x32_bf16 v[172:175], a[144:147], a[124:127], v[172:175]
v_cos_f32 v31, v30
v_mfma_f32_16x16x32_bf16 v[188:191], a[148:151], a[124:127], v[188:191]
ds_read_b64_tr_b16 a[144:145], v17 offset:36032
v_mfma_f32_16x16x32_bf16 v[184:187], a[148:151], a[120:123], v[184:187]
ds_read_b64_tr_b16 a[146:147], v17 offset:37824
v_mfma_f32_16x16x32_bf16 v[180:183], a[148:151], a[116:119], v[180:183]
v_sin_f32 v35, v30
v_mfma_f32_16x16x32_bf16 v[176:179], a[148:151], a[112:115], v[176:179]
s_waitcnt lgkmcnt(6)
v_mfma_f32_16x16x32_bf16 v[192:195], a[128:131], a[112:115], v[192:195]
ds_read_b64_tr_b16 a[148:149], v17 offset:50368
s_add_u32 m0, s49, 38912
v_mfma_f32_16x16x32_bf16 v[196:199], a[128:131], a[116:119], v[196:199]
ds_read_b64_tr_b16 a[150:151], v17 offset:52160
s_mov_b32 s98, 7808
v_mfma_f32_16x16x32_bf16 v[200:203], a[128:131], a[120:123], v[200:203]
buffer_load_dwordx4 v2, s[8:11], s98 offen lds
v_mfma_f32_16x16x32_bf16 v[204:207], a[128:131], a[124:127], v[204:207]
v_mul_f32 v31, v29, v31
v_mfma_f32_16x16x32_bf16 v[220:223], a[132:135], a[124:127], v[220:223]
s_waitcnt vmcnt(19)
ds_read_b128 a[96:99], v13 offset:0
v_mfma_f32_16x16x32_bf16 v[216:219], a[132:135], a[120:123], v[216:219]
ds_read_b128 a[100:103], v13 offset:2048
v_mfma_f32_16x16x32_bf16 v[212:215], a[132:135], a[116:119], v[212:215]
v_mul_f32_e64 v35, v29, v35
v_mfma_f32_16x16x32_bf16 v[208:211], a[132:135], a[112:115], v[208:211]
v_accvgpr_write_b32 a204, v31
s_waitcnt lgkmcnt(6)
v_mfma_f32_16x16x32_bf16 v[224:227], a[136:139], a[112:115], v[224:227]
ds_read_b128 a[104:107], v13 offset:4096
v_mfma_f32_16x16x32_bf16 v[228:231], a[136:139], a[116:119], v[228:231]
ds_read_b128 a[108:111], v13 offset:6144
s_add_u32 m0, s49, 39936
v_mfma_f32_16x16x32_bf16 v[232:235], a[136:139], a[120:123], v[232:235]
buffer_load_dwordx4 v3, s[8:11], s98 offen lds
v_mfma_f32_16x16x32_bf16 v[236:239], a[136:139], a[124:127], v[236:239]
s_waitcnt vmcnt(11) lgkmcnt(4)
s_barrier
v_mfma_f32_16x16x32_bf16 v[252:255], a[140:143], a[124:127], v[252:255]
ds_read_b128 a[128:131], v15 offset:0
v_accvgpr_write_b32 a205, v35
v_mfma_f32_16x16x32_bf16 v[248:251], a[140:143], a[120:123], v[248:251]
ds_read_b128 a[132:135], v15 offset:2048
v_mfma_f32_16x16x32_bf16 v[244:247], a[140:143], a[116:119], v[244:247]
ds_read_b128 a[136:139], v15 offset:4096
v_accvgpr_read_b32 v24, a155
v_mfma_f32_16x16x32_bf16 v[240:243], a[140:143], a[112:115], v[240:243]
v_mfma_f32_16x16x32_bf16 a[0:3], a[144:147], a[112:115], a[0:3]
ds_read_b128 a[140:143], v15 offset:6144
v_mfma_f32_16x16x32_bf16 a[4:7], a[144:147], a[116:119], a[4:7]
v_accvgpr_read_b32 v25, a157
v_mfma_f32_16x16x32_bf16 a[8:11], a[144:147], a[120:123], a[8:11]
v_accvgpr_read_b32 v26, a159
v_mfma_f32_16x16x32_bf16 a[12:15], a[144:147], a[124:127], a[12:15]
v_lshlrev_b32 v24, 16, v24
v_mfma_f32_16x16x32_bf16 a[28:31], a[148:151], a[124:127], a[28:31]
ds_read_b64_tr_b16 a[144:145], v17 offset:0
v_lshlrev_b32_e64 v25, 16, v25
v_mfma_f32_16x16x32_bf16 a[24:27], a[148:151], a[120:123], a[24:27]
ds_read_b64_tr_b16 a[146:147], v17 offset:1792
v_mfma_f32_16x16x32_bf16 a[20:23], a[148:151], a[116:119], a[20:23]
v_lshlrev_b32 v26, 16, v26
v_mfma_f32_16x16x32_bf16 a[16:19], a[148:151], a[112:115], a[16:19]
v_mul_f32 v26, 0x3fb8aa3b, v26
s_waitcnt lgkmcnt(4)
v_mfma_f32_16x16x32_bf16 a[32:35], a[96:99], a[128:131], a[32:35]
ds_read_b64_tr_b16 a[148:149], v17 offset:14336
s_add_u32 m0, s50, 28672
v_mfma_f32_16x16x32_bf16 a[36:39], a[100:103], a[128:131], a[36:39]
ds_read_b64_tr_b16 a[150:151], v17 offset:16128
s_mov_b32 s99, 5963776
v_mfma_f32_16x16x32_bf16 a[40:43], a[104:107], a[128:131], a[40:43]
buffer_load_dwordx4 v6, s[12:15], s99 offen  lds
v_mfma_f32_16x16x32_bf16 a[44:47], a[108:111], a[128:131], a[44:47]
v_lshlrev_b32 v20, 16, v48
v_mfma_f32_16x16x32_bf16 a[60:63], a[108:111], a[132:135], a[60:63]
ds_read_b64_tr_b16 a[128:129], v17 offset:32
v_exp_f32 v26, v26
v_mfma_f32_16x16x32_bf16 a[56:59], a[104:107], a[132:135], a[56:59]
ds_read_b64_tr_b16 a[130:131], v17 offset:1824
v_and_b32 v21, 0xffff0000, v48
v_mfma_f32_16x16x32_bf16 a[52:55], a[100:103], a[132:135], a[52:55]
ds_read_b128 a[112:115], v14 offset:0
v_mfma_f32_16x16x32_bf16 a[48:51], a[96:99], a[132:135], a[48:51]
s_waitcnt lgkmcnt(7)
v_mfma_f32_16x16x32_bf16 a[64:67], a[96:99], a[136:139], a[64:67]
ds_read_b64_tr_b16 a[132:133], v17 offset:14368
v_mfma_f32_16x16x32_bf16 a[68:71], a[100:103], a[136:139], a[68:71]
ds_read_b64_tr_b16 a[134:135], v17 offset:16160
s_add_u32 m0, s50, 29696
v_mfma_f32_16x16x32_bf16 a[72:75], a[104:107], a[136:139], a[72:75]
buffer_load_dwordx4 v7, s[12:15], s99 offen  lds
v_mfma_f32_16x16x32_bf16 a[76:79], a[108:111], a[136:139], a[76:79]
v_add_f32 v40, v40, v20
v_cvt_pk_bf16_f32 v26, v26, v26
v_mfma_f32_16x16x32_bf16 a[92:95], a[108:111], a[140:143], a[92:95]
ds_read_b64_tr_b16 a[136:137], v17 offset:64
v_mfma_f32_16x16x32_bf16 a[88:91], a[104:107], a[140:143], a[88:91]
ds_read_b64_tr_b16 a[138:139], v17 offset:1856
v_and_b32 v26, 0xffff0000, v26
v_mfma_f32_16x16x32_bf16 a[84:87], a[100:103], a[140:143], a[84:87]
v_add_f32 v41, v41, v21
v_mfma_f32_16x16x32_bf16 a[80:83], a[96:99], a[140:143], a[80:83]
v_mul_f32 v27, v26, v24
s_waitcnt lgkmcnt(7)
v_mfma_f32_16x16x32_bf16 v[64:67], a[144:147], a[96:99], v[64:67]
ds_read_b64_tr_b16 a[140:141], v17 offset:14400
v_mfma_f32_16x16x32_bf16 v[68:71], a[144:147], a[100:103], v[68:71]
ds_read_b64_tr_b16 a[142:143], v17 offset:16192
s_add_u32 m0, s50, 30720
v_mfma_f32_16x16x32_bf16 v[72:75], a[144:147], a[104:107], v[72:75]
buffer_load_dwordx4 v8, s[12:15], s99 offen  lds
v_mfma_f32_16x16x32_bf16 v[76:79], a[144:147], a[108:111], v[76:79]
v_lshlrev_b32 v20, 16, v49
v_mul_f32_e64 v28, v26, v25
v_mfma_f32_16x16x32_bf16 v[92:95], a[148:151], a[108:111], v[92:95]
ds_read_b64_tr_b16 a[144:145], v17 offset:96
v_mfma_f32_16x16x32_bf16 v[88:91], a[148:151], a[104:107], v[88:91]
ds_read_b64_tr_b16 a[146:147], v17 offset:1888
v_mul_f32 v27, 0x3fb8aa3b, v27
v_mfma_f32_16x16x32_bf16 v[84:87], a[148:151], a[100:103], v[84:87]
ds_read_b128 a[116:119], v14 offset:2048
v_and_b32 v21, 0xffff0000, v49
v_mfma_f32_16x16x32_bf16 v[80:83], a[148:151], a[96:99], v[80:83]
s_waitcnt lgkmcnt(7)
v_mfma_f32_16x16x32_bf16 v[96:99], a[128:131], a[96:99], v[96:99]
ds_read_b64_tr_b16 a[148:149], v17 offset:14432
v_mul_f32 v28, 0x3e22f983, v28
v_mfma_f32_16x16x32_bf16 v[100:103], a[128:131], a[100:103], v[100:103]
ds_read_b64_tr_b16 a[150:151], v17 offset:16224
s_add_u32 m0, s50, 31744
v_mfma_f32_16x16x32_bf16 v[104:107], a[128:131], a[104:107], v[104:107]
buffer_load_dwordx4 v9, s[12:15], s99 offen  lds
v_mfma_f32_16x16x32_bf16 v[108:111], a[128:131], a[108:111], v[108:111]
v_add_f32 v42, v42, v20
v_mfma_f32_16x16x32_bf16 v[124:127], a[132:135], a[108:111], v[124:127]
ds_read_b64_tr_b16 a[128:129], v17 offset:128
v_mul_f32 v29, 1.0, v27
v_mfma_f32_16x16x32_bf16 v[120:123], a[132:135], a[104:107], v[120:123]
ds_read_b64_tr_b16 a[130:131], v17 offset:1920
v_mfma_f32_16x16x32_bf16 v[116:119], a[132:135], a[100:103], v[116:119]
v_add_f32 v43, v43, v21
v_mul_f32 v30, 1.0, v28
v_mfma_f32_16x16x32_bf16 v[112:115], a[132:135], a[96:99], v[112:115]
s_waitcnt lgkmcnt(7)
v_mfma_f32_16x16x32_bf16 v[128:131], a[136:139], a[96:99], v[128:131]
ds_read_b64_tr_b16 a[132:133], v17 offset:14464
v_fract_f32 v30, v30
v_mfma_f32_16x16x32_bf16 v[132:135], a[136:139], a[100:103], v[132:135]
ds_read_b64_tr_b16 a[134:135], v17 offset:16256
s_add_u32 m0, s50, 32768
v_mfma_f32_16x16x32_bf16 v[136:139], a[136:139], a[104:107], v[136:139]
buffer_load_dwordx4 v10, s[12:15], s99 offen  lds
v_mfma_f32_16x16x32_bf16 v[140:143], a[136:139], a[108:111], v[140:143]
v_lshlrev_b32 v20, 16, v50
v_mfma_f32_16x16x32_bf16 v[156:159], a[140:143], a[108:111], v[156:159]
ds_read_b64_tr_b16 a[136:137], v17 offset:160
v_exp_f32 v29, v29
v_mfma_f32_16x16x32_bf16 v[152:155], a[140:143], a[104:107], v[152:155]
ds_read_b64_tr_b16 a[138:139], v17 offset:1952
v_mfma_f32_16x16x32_bf16 v[148:151], a[140:143], a[100:103], v[148:151]
ds_read_b128 a[120:123], v14 offset:4096
v_and_b32 v21, 0xffff0000, v50
v_mfma_f32_16x16x32_bf16 v[144:147], a[140:143], a[96:99], v[144:147]
s_waitcnt lgkmcnt(7)
v_mfma_f32_16x16x32_bf16 v[160:163], a[144:147], a[96:99], v[160:163]
ds_read_b64_tr_b16 a[140:141], v17 offset:14496
v_mfma_f32_16x16x32_bf16 v[164:167], a[144:147], a[100:103], v[164:167]
ds_read_b64_tr_b16 a[142:143], v17 offset:16288
s_add_u32 m0, s50, 33792
v_mfma_f32_16x16x32_bf16 v[168:171], a[144:147], a[104:107], v[168:171]
buffer_load_dwordx4 v11, s[12:15], s99 offen  lds
v_mfma_f32_16x16x32_bf16 v[172:175], a[144:147], a[108:111], v[172:175]
v_add_f32 v44, v44, v20
v_cos_f32_e64 v31, v30
v_mfma_f32_16x16x32_bf16 v[188:191], a[148:151], a[108:111], v[188:191]
ds_read_b64_tr_b16 a[144:145], v17 offset:192
v_mfma_f32_16x16x32_bf16 v[184:187], a[148:151], a[104:107], v[184:187]
ds_read_b64_tr_b16 a[146:147], v17 offset:1984
v_mfma_f32_16x16x32_bf16 v[180:183], a[148:151], a[100:103], v[180:183]
v_add_f32 v45, v45, v21
v_mfma_f32_16x16x32_bf16 v[176:179], a[148:151], a[96:99], v[176:179]
v_sin_f32_e64 v35, v30
s_waitcnt lgkmcnt(7)
v_mfma_f32_16x16x32_bf16 v[192:195], a[128:131], a[96:99], v[192:195]
ds_read_b64_tr_b16 a[148:149], v17 offset:14528
v_mfma_f32_16x16x32_bf16 v[196:199], a[128:131], a[100:103], v[196:199]
ds_read_b64_tr_b16 a[150:151], v17 offset:16320
s_add_u32 m0, s50, 34816
v_mfma_f32_16x16x32_bf16 v[200:203], a[128:131], a[104:107], v[200:203]
buffer_load_dwordx4 v12, s[12:15], s99 offen  lds
v_mfma_f32_16x16x32_bf16 v[204:207], a[128:131], a[108:111], v[204:207]
v_lshlrev_b32_e64 v20, 16, v51
v_mfma_f32_16x16x32_bf16 v[220:223], a[132:135], a[108:111], v[220:223]
ds_read_b128 a[128:131], v16 offset:0
v_mfma_f32_16x16x32_bf16 v[216:219], a[132:135], a[104:107], v[216:219]
v_and_b32 v21, 0xffff0000, v51
v_mul_f32_e64 v31, v29, v31
v_mfma_f32_16x16x32_bf16 v[212:215], a[132:135], a[100:103], v[212:215]
ds_read_b128 a[124:127], v14 offset:6144
v_mfma_f32_16x16x32_bf16 v[208:211], a[132:135], a[96:99], v[208:211]
v_mul_f32 v35, v29, v35
s_waitcnt lgkmcnt(6)
v_mfma_f32_16x16x32_bf16 v[224:227], a[136:139], a[96:99], v[224:227]
ds_read_b128 a[132:135], v16 offset:2048
s_add_u32 m0, s51, 8192
v_mfma_f32_16x16x32_bf16 v[228:231], a[136:139], a[100:103], v[228:231]
s_mov_b32 s100, 1664
v_add_f32_e64 v46, v46, v20
v_mfma_f32_16x16x32_bf16 v[232:235], a[136:139], a[104:107], v[232:235]
buffer_load_dwordx4 v4, s[16:19], s100 offen lds
v_mfma_f32_16x16x32_bf16 v[236:239], a[136:139], a[108:111], v[236:239]
v_accvgpr_write_b32 a208, v31
v_mfma_f32_16x16x32_bf16 v[252:255], a[140:143], a[108:111], v[252:255]
ds_read_b128 a[136:139], v16 offset:4096
v_mfma_f32_16x16x32_bf16 v[248:251], a[140:143], a[104:107], v[248:251]
v_add_f32_e64 v47, v47, v21
v_accvgpr_write_b32 a209, v35
v_mfma_f32_16x16x32_bf16 v[244:247], a[140:143], a[100:103], v[244:247]
v_add_f32 v31, -1.0, v31
v_mfma_f32_16x16x32_bf16 v[240:243], a[140:143], a[96:99], v[240:243]
s_waitcnt lgkmcnt(4)
v_mfma_f32_16x16x32_bf16 a[0:3], a[144:147], a[96:99], a[0:3]
ds_read_b128 a[140:143], v16 offset:6144
v_mul_f32_e64 v26, v24, v24
v_mfma_f32_16x16x32_bf16 a[4:7], a[144:147], a[100:103], a[4:7]
s_add_u32 m0, s51, 9216
v_fmac_f32_e64 v26, v25, v25
v_mfma_f32_16x16x32_bf16 a[8:11], a[144:147], a[104:107], a[8:11]
buffer_load_dwordx4 v5, s[16:19], s100 offen lds
v_mfma_f32_16x16x32_bf16 a[12:15], a[144:147], a[108:111], a[12:15]
s_lshl_b32 s63, s55, 10
s_add_u32 s63, s63, 1048576
v_mfma_f32_16x16x32_bf16 a[28:31], a[148:151], a[108:111], a[28:31]
ds_read_b64_tr_b16 a[144:145], v17 offset:7168
v_rcp_f32 v26, v26
v_mfma_f32_16x16x32_bf16 a[24:27], a[148:151], a[104:107], a[24:27]
ds_read_b64_tr_b16 a[146:147], v17 offset:8960
v_mfma_f32_16x16x32_bf16 a[20:23], a[148:151], a[100:103], a[20:23]
buffer_load_dwordx4 v[36:39], v23, s[32:35], s63 offen
v_mfma_f32_16x16x32_bf16 a[16:19], a[148:151], a[96:99], a[16:19]
s_lshr_b32 s48, s2, 3
s_lshl_b32 s48, s48, 2
s_waitcnt lgkmcnt(4)
v_mfma_f32_16x16x32_bf16 a[32:35], a[112:115], a[128:131], a[32:35]
ds_read_b64_tr_b16 a[148:149], v17 offset:21504
s_add_u32 s48, s48, s3
v_mfma_f32_16x16x32_bf16 a[36:39], a[116:119], a[128:131], a[36:39]
ds_read_b64_tr_b16 a[150:151], v17 offset:23296
s_lshl_b32 s48, s48, 7
v_mfma_f32_16x16x32_bf16 a[40:43], a[120:123], a[128:131], a[40:43]
s_add_u32 s48, s48, 65536
s_min_u32 s48, s48, L_codeend-L_main-4
v_mov_b32 v19, s48
v_mfma_f32_16x16x32_bf16 a[44:47], a[124:127], a[128:131], a[44:47]
global_load_dword v39, v19, s[82:83]
v_mfma_f32_16x16x32_bf16 a[60:63], a[124:127], a[132:135], a[60:63]
ds_read_b64_tr_b16 a[128:129], v17 offset:7200
v_mfma_f32_16x16x32_bf16 a[56:59], a[120:123], a[132:135], a[56:59]
ds_read_b64_tr_b16 a[130:131], v17 offset:8992
v_mfma_f32_16x16x32_bf16 a[52:55], a[116:119], a[132:135], a[52:55]
v_mul_f32_e64 v62, v31, v24
v_mfma_f32_16x16x32_bf16 a[48:51], a[112:115], a[132:135], a[48:51]
v_fmac_f32 v62, v35, v25
s_waitcnt lgkmcnt(6)
v_mfma_f32_16x16x32_bf16 a[64:67], a[112:115], a[136:139], a[64:67]
ds_read_b64_tr_b16 a[132:133], v17 offset:21536
v_mfma_f32_16x16x32_bf16 a[68:71], a[116:119], a[136:139], a[68:71]
ds_read_b64_tr_b16 a[134:135], v17 offset:23328
v_mul_f32_e64 v63, v35, v24
v_mfma_f32_16x16x32_bf16 a[72:75], a[120:123], a[136:139], a[72:75]
v_fma_f32 v63, -v31, v25, v63
v_mfma_f32_16x16x32_bf16 a[76:79], a[124:127], a[136:139], a[76:79]
v_add_f32_e64 v26, v26, v26
v_mfma_f32_16x16x32_bf16 a[92:95], a[124:127], a[140:143], a[92:95]
ds_read_b64_tr_b16 a[136:137], v17 offset:7232
s_add_u32 m0, s49, 0
v_mfma_f32_16x16x32_bf16 a[88:91], a[120:123], a[140:143], a[88:91]
ds_read_b64_tr_b16 a[138:139], v17 offset:9024
s_mov_b32 s98, 1792
v_mfma_f32_16x16x32_bf16 a[84:87], a[116:119], a[140:143], a[84:87]
buffer_load_dwordx4 v2, s[8:11], s98 offen lds
v_mfma_f32_16x16x32_bf16 a[80:83], a[112:115], a[140:143], a[80:83]
s_waitcnt lgkmcnt(6)
v_mfma_f32_16x16x32_bf16 v[64:67], a[144:147], a[112:115], v[64:67]
ds_read_b64_tr_b16 a[140:141], v17 offset:21568
v_mul_f32_e64 v62, v62, v26
v_mfma_f32_16x16x32_bf16 v[68:71], a[144:147], a[116:119], v[68:71]
ds_read_b64_tr_b16 a[142:143], v17 offset:23360
s_add_u32 m0, s49, 1024
v_mfma_f32_16x16x32_bf16 v[72:75], a[144:147], a[120:123], v[72:75]
buffer_load_dwordx4 v3, s[8:11], s98 offen lds
v_mfma_f32_16x16x32_bf16 v[76:79], a[144:147], a[124:127], v[76:79]
v_mul_f32_e64 v63, v63, v26
v_mfma_f32_16x16x32_bf16 v[92:95], a[148:151], a[124:127], v[92:95]
ds_read_b64_tr_b16 a[144:145], v17 offset:7264
v_mfma_f32_16x16x32_bf16 v[88:91], a[148:151], a[120:123], v[88:91]
ds_read_b64_tr_b16 a[146:147], v17 offset:9056
v_accvgpr_write_b32 a210, v62
v_mfma_f32_16x16x32_bf16 v[84:87], a[148:151], a[116:119], v[84:87]
v_accvgpr_write_b32 a211, v63
v_mfma_f32_16x16x32_bf16 v[80:83], a[148:151], a[112:115], v[80:83]
s_waitcnt lgkmcnt(6)
v_mfma_f32_16x16x32_bf16 v[96:99], a[128:131], a[112:115], v[96:99]
ds_read_b64_tr_b16 a[148:149], v17 offset:21600
s_add_u32 m0, s49, 2048
v_mfma_f32_16x16x32_bf16 v[100:103], a[128:131], a[116:119], v[100:103]
ds_read_b64_tr_b16 a[150:151], v17 offset:23392
s_mov_b32 s98, 3840
v_mfma_f32_16x16x32_bf16 v[104:107], a[128:131], a[120:123], v[104:107]
buffer_load_dwordx4 v2, s[8:11], s98 offen lds
v_mfma_f32_16x16x32_bf16 v[108:111], a[128:131], a[124:127], v[108:111]
v_mul_f32 v29, 0x41800000, v27
v_mfma_f32_16x16x32_bf16 v[124:127], a[132:135], a[124:127], v[124:127]
ds_read_b64_tr_b16 a[128:129], v17 offset:7296
v_mul_f32 v30, 0x41800000, v28
v_mfma_f32_16x16x32_bf16 v[120:123], a[132:135], a[120:123], v[120:123]
ds_read_b64_tr_b16 a[130:131], v17 offset:9088
s_add_u32 m0, s49, 3072
v_mfma_f32_16x16x32_bf16 v[116:119], a[132:135], a[116:119], v[116:119]
buffer_load_dwordx4 v3, s[8:11], s98 offen lds
v_mfma_f32_16x16x32_bf16 v[112:115], a[132:135], a[112:115], v[112:115]
s_waitcnt lgkmcnt(6)
v_mfma_f32_16x16x32_bf16 v[128:131], a[136:139], a[112:115], v[128:131]
ds_read_b64_tr_b16 a[132:133], v17 offset:21632
v_fract_f32 v30, v30
v_mfma_f32_16x16x32_bf16 v[132:135], a[136:139], a[116:119], v[132:135]
ds_read_b64_tr_b16 a[134:135], v17 offset:23424
v_mfma_f32_16x16x32_bf16 v[136:139], a[136:139], a[120:123], v[136:139]
v_exp_f32 v29, v29
v_mfma_f32_16x16x32_bf16 v[140:143], a[136:139], a[124:127], v[140:143]
v_mfma_f32_16x16x32_bf16 v[156:159], a[140:143], a[124:127], v[156:159]
ds_read_b64_tr_b16 a[136:137], v17 offset:7328
s_add_u32 m0, s49, 4096
v_mfma_f32_16x16x32_bf16 v[152:155], a[140:143], a[120:123], v[152:155]
ds_read_b64_tr_b16 a[138:139], v17 offset:9120
s_mov_b32 s98, 5888
v_mfma_f32_16x16x32_bf16 v[148:151], a[140:143], a[116:119], v[148:151]
buffer_load_dwordx4 v2, s[8:11], s98 offen lds
v_mfma_f32_16x16x32_bf16 v[144:147], a[140:143], a[112:115], v[144:147]
s_waitcnt lgkmcnt(6)
v_mfma_f32_16x16x32_bf16 v[160:163], a[144:147], a[112:115], v[160:163]
ds_read_b64_tr_b16 a[140:141], v17 offset:21664
v_mfma_f32_16x16x32_bf16 v[164:167], a[144:147], a[116:119], v[164:167]
ds_read_b64_tr_b16 a[142:143], v17 offset:23456
s_add_u32 m0, s49, 5120
v_mfma_f32_16x16x32_bf16 v[168:171], a[144:147], a[120:123], v[168:171]
buffer_load_dwordx4 v3, s[8:11], s98 offen lds
v_mfma_f32_16x16x32_bf16 v[172:175], a[144:147], a[124:127], v[172:175]
v_cos_f32 v31, v30
v_mfma_f32_16x16x32_bf16 v[188:191], a[148:151], a[124:127], v[188:191]
ds_read_b64_tr_b16 a[144:145], v17 offset:7360
v_mfma_f32_16x16x32_bf16 v[184:187], a[148:151], a[120:123], v[184:187]
ds_read_b64_tr_b16 a[146:147], v17 offset:9152
v_mfma_f32_16x16x32_bf16 v[180:183], a[148:151], a[116:119], v[180:183]
v_sin_f32 v35, v30
v_mfma_f32_16x16x32_bf16 v[176:179], a[148:151], a[112:115], v[176:179]
v_mul_f32_e64 v31, v29, v31
s_waitcnt lgkmcnt(6)
v_mfma_f32_16x16x32_bf16 v[192:195], a[128:131], a[112:115], v[192:195]
ds_read_b64_tr_b16 a[148:149], v17 offset:21696
s_add_u32 m0, s49, 6144
v_mfma_f32_16x16x32_bf16 v[196:199], a[128:131], a[116:119], v[196:199]
ds_read_b64_tr_b16 a[150:151], v17 offset:23488
s_mov_b32 s98, 7936
v_mfma_f32_16x16x32_bf16 v[200:203], a[128:131], a[120:123], v[200:203]
buffer_load_dwordx4 v2, s[8:11], s98 offen lds
v_mfma_f32_16x16x32_bf16 v[204:207], a[128:131], a[124:127], v[204:207]
v_mul_f32 v35, v29, v35
v_mfma_f32_16x16x32_bf16 v[220:223], a[132:135], a[124:127], v[220:223]
s_waitcnt vmcnt(18)
ds_read_b128 a[96:99], v13 offset:32768
v_mfma_f32_16x16x32_bf16 v[216:219], a[132:135], a[120:123], v[216:219]
ds_read_b128 a[100:103], v13 offset:34816
v_mfma_f32_16x16x32_bf16 v[212:215], a[132:135], a[116:119], v[212:215]
v_accvgpr_write_b32 a212, v31
v_mfma_f32_16x16x32_bf16 v[208:211], a[132:135], a[112:115], v[208:211]
v_accvgpr_write_b32 a213, v35
s_waitcnt lgkmcnt(6)
v_mfma_f32_16x16x32_bf16 v[224:227], a[136:139], a[112:115], v[224:227]
ds_read_b128 a[104:107], v13 offset:36864
v_mfma_f32_16x16x32_bf16 v[228:231], a[136:139], a[116:119], v[228:231]
ds_read_b128 a[108:111], v13 offset:38912
s_add_u32 m0, s49, 7168
v_mfma_f32_16x16x32_bf16 v[232:235], a[136:139], a[120:123], v[232:235]
buffer_load_dwordx4 v3, s[8:11], s98 offen lds
v_mfma_f32_16x16x32_bf16 v[236:239], a[136:139], a[124:127], v[236:239]
s_waitcnt vmcnt(10) lgkmcnt(4)
s_barrier
v_mfma_f32_16x16x32_bf16 v[252:255], a[140:143], a[124:127], v[252:255]
ds_read_b128 a[128:131], v15 offset:8192
v_cmp_gt_u32 vcc, 128, v57
v_mfma_f32_16x16x32_bf16 v[248:251], a[140:143], a[120:123], v[248:251]
ds_read_b128 a[132:135], v15 offset:10240
v_cndmask_b32 v62, 0, 1.0, s[56:57]
v_mfma_f32_16x16x32_bf16 v[244:247], a[140:143], a[116:119], v[244:247]
ds_read_b128 a[136:139], v15 offset:12288
v_mfma_f32_16x16x32_bf16 v[240:243], a[140:143], a[112:115], v[240:243]
v_cndmask_b32 v62, v62, v31, s[58:59]
v_mfma_f32_16x16x32_bf16 a[0:3], a[144:147], a[112:115], a[0:3]
ds_read_b128 a[140:143], v15 offset:14336
v_mfma_f32_16x16x32_bf16 a[4:7], a[144:147], a[116:119], a[4:7]
v_cndmask_b32 v63, 0, v35, s[58:59]
v_mfma_f32_16x16x32_bf16 a[8:11], a[144:147], a[120:123], a[8:11]
v_accvgpr_write_b32 a222, v62
v_mfma_f32_16x16x32_bf16 a[12:15], a[144:147], a[124:127], a[12:15]
s_cbranch_vccnz L_slow1
L_back2:
v_accvgpr_write_b32 a223, v63
v_mfma_f32_16x16x32_bf16 a[28:31], a[148:151], a[124:127], a[28:31]
ds_read_b64_tr_b16 a[144:145], v17 offset:28672
v_mul_f32_e64 v29, v35, v35
v_mfma_f32_16x16x32_bf16 a[24:27], a[148:151], a[120:123], a[24:27]
ds_read_b64_tr_b16 a[146:147], v17 offset:30464
v_mfma_f32_16x16x32_bf16 a[20:23], a[148:151], a[116:119], a[20:23]
v_mul_f32_e64 v35, v31, v35
v_mfma_f32_16x16x32_bf16 a[16:19], a[148:151], a[112:115], a[16:19]
v_fma_f32 v31, v31, v31, -v29
s_waitcnt lgkmcnt(4)
v_mfma_f32_16x16x32_bf16 a[32:35], a[96:99], a[128:131], a[32:35]
ds_read_b64_tr_b16 a[148:149], v17 offset:43008
s_add_u32 m0, s50, 0
v_mfma_f32_16x16x32_bf16 a[36:39], a[100:103], a[128:131], a[36:39]
ds_read_b64_tr_b16 a[150:151], v17 offset:44800
s_mov_b32 s99, 6422528
v_mfma_f32_16x16x32_bf16 a[40:43], a[104:107], a[128:131], a[40:43]
buffer_load_dwordx4 v6, s[12:15], s99 offen  lds
v_mfma_f32_16x16x32_bf16 a[44:47], a[108:111], a[128:131], a[44:47]
v_lshlrev_b32_e64 v20, 16, v52
v_mfma_f32_16x16x32_bf16 a[60:63], a[108:111], a[132:135], a[60:63]
ds_read_b64_tr_b16 a[128:129], v17 offset:28704
v_add_f32_e64 v35, v35, v35
v_mfma_f32_16x16x32_bf16 a[56:59], a[104:107], a[132:135], a[56:59]
ds_read_b64_tr_b16 a[130:131], v17 offset:30496
v_and_b32 v21, 0xffff0000, v52
v_mfma_f32_16x16x32_bf16 a[52:55], a[100:103], a[132:135], a[52:55]
ds_read_b128 a[112:115], v14 offset:32768
v_mfma_f32_16x16x32_bf16 a[48:51], a[96:99], a[132:135], a[48:51]
v_accvgpr_write_b32 a214, v31
s_waitcnt lgkmcnt(7)
v_mfma_f32_16x16x32_bf16 a[64:67], a[96:99], a[136:139], a[64:67]
ds_read_b64_tr_b16 a[132:133], v17 offset:43040
L_pg8:
s_cbranch_execz L_ret0
v_mfma_f32_16x16x32_bf16 a[68:71], a[100:103], a[136:139], a[68:71]
ds_read_b64_tr_b16 a[134:135], v17 offset:44832
s_add_u32 m0, s50, 1024
v_mfma_f32_16x16x32_bf16 a[72:75], a[104:107], a[136:139], a[72:75]
buffer_load_dwordx4 v7, s[12:15], s99 offen  lds
v_mfma_f32_16x16x32_bf16 a[76:79], a[108:111], a[136:139], a[76:79]
v_add_f32_e64 v40, v40, v20
v_accvgpr_write_b32 a215, v35
v_mfma_f32_16x16x32_bf16 a[92:95], a[108:111], a[140:143], a[92:95]
ds_read_b64_tr_b16 a[136:137], v17 offset:28736
v_mfma_f32_16x16x32_bf16 a[88:91], a[104:107], a[140:143], a[88:91]
ds_read_b64_tr_b16 a[138:139], v17 offset:30528
v_mul_f32 v29, v35, v35
v_mfma_f32_16x16x32_bf16 a[84:87], a[100:103], a[140:143], a[84:87]
v_add_f32 v41, v41, v21
v_mfma_f32_16x16x32_bf16 a[80:83], a[96:99], a[140:143], a[80:83]
v_mul_f32 v35, v31, v35
s_waitcnt lgkmcnt(7)
v_mfma_f32_16x16x32_bf16 v[64:67], a[144:147], a[96:99], v[64:67]
ds_read_b64_tr_b16 a[140:141], v17 offset:43072
v_mfma_f32_16x16x32_bf16 v[68:71], a[144:147], a[100:103], v[68:71]
ds_read_b64_tr_b16 a[142:143], v17 offset:44864
s_add_u32 m0, s50, 2048
v_mfma_f32_16x16x32_bf16 v[72:75], a[144:147], a[104:107], v[72:75]
buffer_load_dwordx4 v8, s[12:15], s99 offen  lds
v_mfma_f32_16x16x32_bf16 v[76:79], a[144:147], a[108:111], v[76:79]
v_lshlrev_b32_e64 v20, 16, v53
v_fma_f32 v31, v31, v31, -v29
v_mfma_f32_16x16x32_bf16 v[92:95], a[148:151], a[108:111], v[92:95]
ds_read_b64_tr_b16 a[144:145], v17 offset:28768
v_mfma_f32_16x16x32_bf16 v[88:91], a[148:151], a[104:107], v[88:91]
ds_read_b64_tr_b16 a[146:147], v17 offset:30560
v_add_f32_e64 v35, v35, v35
v_mfma_f32_16x16x32_bf16 v[84:87], a[148:151], a[100:103], v[84:87]
ds_read_b128 a[116:119], v14 offset:34816
v_and_b32 v21, 0xffff0000, v53
v_mfma_f32_16x16x32_bf16 v[80:83], a[148:151], a[96:99], v[80:83]
s_waitcnt lgkmcnt(7)
v_mfma_f32_16x16x32_bf16 v[96:99], a[128:131], a[96:99], v[96:99]
ds_read_b64_tr_b16 a[148:149], v17 offset:43104
v_accvgpr_write_b32 a216, v31
v_mfma_f32_16x16x32_bf16 v[100:103], a[128:131], a[100:103], v[100:103]
ds_read_b64_tr_b16 a[150:151], v17 offset:44896
s_add_u32 m0, s50, 3072
v_mfma_f32_16x16x32_bf16 v[104:107], a[128:131], a[104:107], v[104:107]
buffer_load_dwordx4 v9, s[12:15], s99 offen  lds
v_mfma_f32_16x16x32_bf16 v[108:111], a[128:131], a[108:111], v[108:111]
v_add_f32 v42, v42, v20
v_mfma_f32_16x16x32_bf16 v[124:127], a[132:135], a[108:111], v[124:127]
ds_read_b64_tr_b16 a[128:129], v17 offset:28800
v_accvgpr_write_b32 a217, v35
v_mfma_f32_16x16x32_bf16 v[120:123], a[132:135], a[104:107], v[120:123]
ds_read_b64_tr_b16 a[130:131], v17 offset:30592
v_mfma_f32_16x16x32_bf16 v[116:119], a[132:135], a[100:103], v[116:119]
v_add_f32 v43, v43, v21
v_mul_f32_e64 v29, v60, v27
v_mfma_f32_16x16x32_bf16 v[112:115], a[132:135], a[96:99], v[112:115]
s_waitcnt lgkmcnt(7)
v_mfma_f32_16x16x32_bf16 v[128:131], a[136:139], a[96:99], v[128:131]
ds_read_b64_tr_b16 a[132:133], v17 offset:43136
v_mul_f32_e64 v30, v60, v28
v_mfma_f32_16x16x32_bf16 v[132:135], a[136:139], a[100:103], v[132:135]
ds_read_b64_tr_b16 a[134:135], v17 offset:44928
s_add_u32 m0, s50, 4096
v_mfma_f32_16x16x32_bf16 v[136:139], a[136:139], a[104:107], v[136:139]
buffer_load_dwordx4 v10, s[12:15], s99 offen  lds
v_mfma_f32_16x16x32_bf16 v[140:143], a[136:139], a[108:111], v[140:143]
v_lshlrev_b32 v20, 16, v54
v_mfma_f32_16x16x32_bf16 v[156:159], a[140:143], a[108:111], v[156:159]
ds_read_b64_tr_b16 a[136:137], v17 offset:28832
v_fract_f32 v30, v30
v_mfma_f32_16x16x32_bf16 v[152:155], a[140:143], a[104:107], v[152:155]
ds_read_b64_tr_b16 a[138:139], v17 offset:30624
v_mfma_f32_16x16x32_bf16 v[148:151], a[140:143], a[100:103], v[148:151]
ds_read_b128 a[120:123], v14 offset:36864
v_and_b32 v21, 0xffff0000, v54
v_mfma_f32_16x16x32_bf16 v[144:147], a[140:143], a[96:99], v[144:147]
v_exp_f32 v29, v29
s_waitcnt lgkmcnt(7)
v_mfma_f32_16x16x32_bf16 v[160:163], a[144:147], a[96:99], v[160:163]
ds_read_b64_tr_b16 a[140:141], v17 offset:43168
v_mfma_f32_16x16x32_bf16 v[164:167], a[144:147], a[100:103], v[164:167]
ds_read_b64_tr_b16 a[142:143], v17 offset:44960
s_add_u32 m0, s50, 5120
v_mfma_f32_16x16x32_bf16 v[168:171], a[144:147], a[104:107], v[168:171]
buffer_load_dwordx4 v11, s[12:15], s99 offen  lds
v_mfma_f32_16x16x32_bf16 v[172:175], a[144:147], a[108:111], v[172:175]
v_add_f32_e64 v44, v44, v20
v_mfma_f32_16x16x32_bf16 v[188:191], a[148:151], a[108:111], v[188:191]
ds_read_b64_tr_b16 a[144:145], v17 offset:28864
v_mfma_f32_16x16x32_bf16 v[184:187], a[148:151], a[104:107], v[184:187]
ds_read_b64_tr_b16 a[146:147], v17 offset:30656
v_cos_f32_e64 v31, v30
v_mfma_f32_16x16x32_bf16 v[180:183], a[148:151], a[100:103], v[180:183]
v_add_f32 v45, v45, v21
v_mfma_f32_16x16x32_bf16 v[176:179], a[148:151], a[96:99], v[176:179]
s_waitcnt lgkmcnt(7)
v_mfma_f32_16x16x32_bf16 v[192:195], a[128:131], a[96:99], v[192:195]
ds_read_b64_tr_b16 a[148:149], v17 offset:43200
v_mfma_f32_16x16x32_bf16 v[196:199], a[128:131], a[100:103], v[196:199]
ds_read_b64_tr_b16 a[150:151], v17 offset:44992
s_add_u32 m0, s50, 6144
v_mfma_f32_16x16x32_bf16 v[200:203], a[128:131], a[104:107], v[200:203]
buffer_load_dwordx4 v12, s[12:15], s99 offen  lds
v_mfma_f32_16x16x32_bf16 v[204:207], a[128:131], a[108:111], v[204:207]
v_lshlrev_b32 v20, 16, v55
v_sin_f32 v35, v30
v_mfma_f32_16x16x32_bf16 v[220:223], a[132:135], a[108:111], v[220:223]
ds_read_b128 a[128:131], v16 offset:8192
v_mfma_f32_16x16x32_bf16 v[216:219], a[132:135], a[104:107], v[216:219]
v_and_b32 v21, 0xffff0000, v55
v_mfma_f32_16x16x32_bf16 v[212:215], a[132:135], a[100:103], v[212:215]
ds_read_b128 a[124:127], v14 offset:38912
v_mfma_f32_16x16x32_bf16 v[208:211], a[132:135], a[96:99], v[208:211]
v_mul_f32 v31, v29, v31
s_waitcnt lgkmcnt(6)
v_mfma_f32_16x16x32_bf16 v[224:227], a[136:139], a[96:99], v[224:227]
ds_read_b128 a[132:135], v16 offset:10240
s_add_u32 m0, s51, 0
v_mfma_f32_16x16x32_bf16 v[228:231], a[136:139], a[100:103], v[228:231]
s_mov_b32 s100, 1792
v_add_f32 v46, v46, v20
v_mfma_f32_16x16x32_bf16 v[232:235], a[136:139], a[104:107], v[232:235]
buffer_load_dwordx4 v4, s[16:19], s100 offen lds
v_mfma_f32_16x16x32_bf16 v[236:239], a[136:139], a[108:111], v[236:239]
v_mul_f32 v35, v29, v35
v_mfma_f32_16x16x32_bf16 v[252:255], a[140:143], a[108:111], v[252:255]
ds_read_b128 a[136:139], v16 offset:12288
v_mfma_f32_16x16x32_bf16 v[248:251], a[140:143], a[104:107], v[248:251]
v_add_f32 v47, v47, v21
v_accvgpr_write_b32 a218, v31
v_mfma_f32_16x16x32_bf16 v[244:247], a[140:143], a[100:103], v[244:247]
v_accvgpr_write_b32 a219, v35
v_mfma_f32_16x16x32_bf16 v[240:243], a[140:143], a[96:99], v[240:243]
s_waitcnt lgkmcnt(4)
v_mfma_f32_16x16x32_bf16 a[0:3], a[144:147], a[96:99], a[0:3]
ds_read_b128 a[140:143], v16 offset:14336
s_and_b32 s62, s3, 1
v_mfma_f32_16x16x32_bf16 a[4:7], a[144:147], a[100:103], a[4:7]
s_add_u32 m0, s51, 1024
v_mul_f32_e64 v29, v61, v27
v_mfma_f32_16x16x32_bf16 a[8:11], a[144:147], a[104:107], a[8:11]
buffer_load_dwordx4 v5, s[16:19], s100 offen lds
v_mfma_f32_16x16x32_bf16 a[12:15], a[144:147], a[108:111], a[12:15]
s_lshl_b32 s62, s62, 12
s_lshl_b32 s63, s55, 10
s_add_u32 s63, s63, 1048576
v_mfma_f32_16x16x32_bf16 a[28:31], a[148:151], a[108:111], a[28:31]
ds_read_b64_tr_b16 a[144:145], v17 offset:35840
v_mul_f32_e64 v30, v61, v28
v_mfma_f32_16x16x32_bf16 a[24:27], a[148:151], a[104:107], a[24:27]
ds_read_b64_tr_b16 a[146:147], v17 offset:37632
v_mfma_f32_16x16x32_bf16 a[20:23], a[148:151], a[100:103], a[20:23]
s_lshr_b32 s45, s3, 1
v_fract_f32 v30, v30
v_mfma_f32_16x16x32_bf16 a[16:19], a[148:151], a[96:99], a[16:19]
v_exp_f32 v29, v29
s_waitcnt lgkmcnt(4)
v_mfma_f32_16x16x32_bf16 a[32:35], a[112:115], a[128:131], a[32:35]
ds_read_b64_tr_b16 a[148:149], v17 offset:50176
s_lshl_b32 s45, s45, 11
v_mfma_f32_16x16x32_bf16 a[36:39], a[116:119], a[128:131], a[36:39]
ds_read_b64_tr_b16 a[150:151], v17 offset:51968
v_mfma_f32_16x16x32_bf16 a[40:43], a[120:123], a[128:131], a[40:43]
buffer_load_dwordx4 v[36:39], v23, s[36:39], s63 offen
v_mfma_f32_16x16x32_bf16 a[44:47], a[124:127], a[128:131], a[44:47]
s_add_u32 s62, s62, s45
s_lshr_b32 s48, s2, 3
s_lshl_b32 s48, s48, 2
v_mfma_f32_16x16x32_bf16 a[60:63], a[124:127], a[132:135], a[60:63]
ds_read_b64_tr_b16 a[128:129], v17 offset:35872
s_add_u32 s48, s48, s3
v_mfma_f32_16x16x32_bf16 a[56:59], a[120:123], a[132:135], a[56:59]
ds_read_b64_tr_b16 a[130:131], v17 offset:37664
s_lshl_b32 s48, s48, 7
v_mfma_f32_16x16x32_bf16 a[52:55], a[116:119], a[132:135], a[52:55]
s_add_u32 s62, s62, 139264
s_add_u32 s48, s48, 53248
s_min_u32 s48, s48, L_codeend-L_main-4
v_mfma_f32_16x16x32_bf16 a[48:51], a[112:115], a[132:135], a[48:51]
v_mov_b32 v19, s48
s_waitcnt lgkmcnt(6)
v_mfma_f32_16x16x32_bf16 a[64:67], a[112:115], a[136:139], a[64:67]
ds_read_b64_tr_b16 a[132:133], v17 offset:50208
v_lshl_add_u32 v58, v1, 5, s62
v_mfma_f32_16x16x32_bf16 a[68:71], a[116:119], a[136:139], a[68:71]
ds_read_b64_tr_b16 a[134:135], v17 offset:52000
v_mfma_f32_16x16x32_bf16 a[72:75], a[120:123], a[136:139], a[72:75]
global_load_dword v39, v19, s[82:83]
v_mfma_f32_16x16x32_bf16 a[76:79], a[124:127], a[136:139], a[76:79]
ds_write_b128 v58, v[40:43]
v_mfma_f32_16x16x32_bf16 a[92:95], a[124:127], a[140:143], a[92:95]
ds_read_b64_tr_b16 a[136:137], v17 offset:35904
s_add_u32 m0, s49, 32768
v_mfma_f32_16x16x32_bf16 a[88:91], a[120:123], a[140:143], a[88:91]
ds_read_b64_tr_b16 a[138:139], v17 offset:37696
s_mov_b32 s98, 1920
v_mfma_f32_16x16x32_bf16 a[84:87], a[116:119], a[140:143], a[84:87]
buffer_load_dwordx4 v2, s[8:11], s98 offen lds
v_mfma_f32_16x16x32_bf16 a[80:83], a[112:115], a[140:143], a[80:83]
s_waitcnt lgkmcnt(7)
v_mfma_f32_16x16x32_bf16 v[64:67], a[144:147], a[112:115], v[64:67]
ds_read_b64_tr_b16 a[140:141], v17 offset:50240
v_mfma_f32_16x16x32_bf16 v[68:71], a[144:147], a[116:119], v[68:71]
ds_read_b64_tr_b16 a[142:143], v17 offset:52032
s_add_u32 m0, s49, 33792
v_mfma_f32_16x16x32_bf16 v[72:75], a[144:147], a[120:123], v[72:75]
buffer_load_dwordx4 v3, s[8:11], s98 offen lds
v_mfma_f32_16x16x32_bf16 v[76:79], a[144:147], a[124:127], v[76:79]
v_cos_f32 v31, v30
v_mfma_f32_16x16x32_bf16 v[92:95], a[148:151], a[124:127], v[92:95]
ds_read_b64_tr_b16 a[144:145], v17 offset:35936
v_mfma_f32_16x16x32_bf16 v[88:91], a[148:151], a[120:123], v[88:91]
ds_read_b64_tr_b16 a[146:147], v17 offset:37728
v_mfma_f32_16x16x32_bf16 v[84:87], a[148:151], a[116:119], v[84:87]
ds_write_b128 v58, v[44:47] offset:16
v_mfma_f32_16x16x32_bf16 v[80:83], a[148:151], a[112:115], v[80:83]
s_waitcnt lgkmcnt(8)
v_mfma_f32_16x16x32_bf16 v[96:99], a[128:131], a[112:115], v[96:99]
ds_read_b64_tr_b16 a[148:149], v17 offset:50272
s_add_u32 m0, s49, 34816
v_mfma_f32_16x16x32_bf16 v[100:103], a[128:131], a[116:119], v[100:103]
ds_read_b64_tr_b16 a[150:151], v17 offset:52064
s_mov_b32 s98, 3968
v_mfma_f32_16x16x32_bf16 v[104:107], a[128:131], a[120:123], v[104:107]
buffer_load_dwordx4 v2, s[8:11], s98 offen lds
v_mfma_f32_16x16x32_bf16 v[108:111], a[128:131], a[124:127], v[108:111]
v_sin_f32 v35, v30
v_mfma_f32_16x16x32_bf16 v[124:127], a[132:135], a[124:127], v[124:127]
ds_read_b64_tr_b16 a[128:129], v17 offset:35968
v_mul_f32_e64 v31, v29, v31
v_mfma_f32_16x16x32_bf16 v[120:123], a[132:135], a[120:123], v[120:123]
ds_read_b64_tr_b16 a[130:131], v17 offset:37760
s_add_u32 m0, s49, 35840
v_mfma_f32_16x16x32_bf16 v[116:119], a[132:135], a[116:119], v[116:119]
buffer_load_dwordx4 v3, s[8:11], s98 offen lds
v_mfma_f32_16x16x32_bf16 v[112:115], a[132:135], a[112:115], v[112:115]
s_waitcnt lgkmcnt(7)
v_mfma_f32_16x16x32_bf16 v[128:131], a[136:139], a[112:115], v[128:131]
ds_read_b64_tr_b16 a[132:133], v17 offset:50304
v_mul_f32 v35, v29, v35
v_mfma_f32_16x16x32_bf16 v[132:135], a[136:139], a[116:119], v[132:135]
ds_read_b64_tr_b16 a[134:135], v17 offset:52096
v_mfma_f32_16x16x32_bf16 v[136:139], a[136:139], a[120:123], v[136:139]
v_accvgpr_write_b32 a220, v31
v_mfma_f32_16x16x32_bf16 v[140:143], a[136:139], a[124:127], v[140:143]
v_accvgpr_write_b32 a221, v35
v_mfma_f32_16x16x32_bf16 v[156:159], a[140:143], a[124:127], v[156:159]
ds_read_b64_tr_b16 a[136:137], v17 offset:36000
s_add_u32 m0, s49, 36864
v_mfma_f32_16x16x32_bf16 v[152:155], a[140:143], a[120:123], v[152:155]
ds_read_b64_tr_b16 a[138:139], v17 offset:37792
s_mov_b32 s98, 6016
v_mfma_f32_16x16x32_bf16 v[148:151], a[140:143], a[116:119], v[148:151]
buffer_load_dwordx4 v2, s[8:11], s98 offen lds
v_mfma_f32_16x16x32_bf16 v[144:147], a[140:143], a[112:115], v[144:147]
s_lshl_b32 s46, s5, 13
s_waitcnt lgkmcnt(6)
v_mfma_f32_16x16x32_bf16 v[160:163], a[144:147], a[112:115], v[160:163]
ds_read_b64_tr_b16 a[140:141], v17 offset:50336
v_mfma_f32_16x16x32_bf16 v[164:167], a[144:147], a[116:119], v[164:167]
ds_read_b64_tr_b16 a[142:143], v17 offset:52128
s_add_u32 m0, s49, 37888
v_mfma_f32_16x16x32_bf16 v[168:171], a[144:147], a[120:123], v[168:171]
buffer_load_dwordx4 v3, s[8:11], s98 offen lds
v_mfma_f32_16x16x32_bf16 v[172:175], a[144:147], a[124:127], v[172:175]
s_add_u32 s46, s46, 27262976
v_mfma_f32_16x16x32_bf16 v[188:191], a[148:151], a[124:127], v[188:191]
ds_read_b64_tr_b16 a[144:145], v17 offset:36032
v_mfma_f32_16x16x32_bf16 v[184:187], a[148:151], a[120:123], v[184:187]
ds_read_b64_tr_b16 a[146:147], v17 offset:37824
v_mfma_f32_16x16x32_bf16 v[180:183], a[148:151], a[116:119], v[180:183]
s_add_u32 s40, s94, s46
s_addc_u32 s41, s95, 0
v_mfma_f32_16x16x32_bf16 v[176:179], a[148:151], a[112:115], v[176:179]
s_mov_b32 s42, 8192
s_waitcnt lgkmcnt(6)
v_mfma_f32_16x16x32_bf16 v[192:195], a[128:131], a[112:115], v[192:195]
ds_read_b64_tr_b16 a[148:149], v17 offset:50368
s_add_u32 m0, s49, 38912
v_mfma_f32_16x16x32_bf16 v[196:199], a[128:131], a[116:119], v[196:199]
ds_read_b64_tr_b16 a[150:151], v17 offset:52160
s_mov_b32 s98, 8064
v_mfma_f32_16x16x32_bf16 v[200:203], a[128:131], a[120:123], v[200:203]
buffer_load_dwordx4 v2, s[8:11], s98 offen lds
v_mfma_f32_16x16x32_bf16 v[204:207], a[128:131], a[124:127], v[204:207]
s_mov_b32 s56, 0xffff0000
v_mfma_f32_16x16x32_bf16 v[220:223], a[132:135], a[124:127], v[220:223]
s_waitcnt vmcnt(18)
ds_read_b128 a[96:99], v13 offset:0
v_mfma_f32_16x16x32_bf16 v[216:219], a[132:135], a[120:123], v[216:219]
ds_read_b128 a[100:103], v13 offset:2048
v_mfma_f32_16x16x32_bf16 v[212:215], a[132:135], a[116:119], v[212:215]
s_mov_b32 s57, 0xffff0000
v_mfma_f32_16x16x32_bf16 v[208:211], a[132:135], a[112:115], v[208:211]
s_waitcnt lgkmcnt(6)
v_mfma_f32_16x16x32_bf16 v[224:227], a[136:139], a[112:115], v[224:227]
ds_read_b128 a[104:107], v13 offset:4096
v_mfma_f32_16x16x32_bf16 v[228:231], a[136:139], a[116:119], v[228:231]
ds_read_b128 a[108:111], v13 offset:6144
s_add_u32 m0, s49, 39936
v_mfma_f32_16x16x32_bf16 v[232:235], a[136:139], a[120:123], v[232:235]
buffer_load_dwordx4 v3, s[8:11], s98 offen lds
v_mfma_f32_16x16x32_bf16 v[236:239], a[136:139], a[124:127], v[236:239]
s_waitcnt vmcnt(10) lgkmcnt(4)
s_barrier
v_mfma_f32_16x16x32_bf16 v[252:255], a[140:143], a[124:127], v[252:255]
ds_read_b128 a[128:131], v15 offset:0
v_lshrrev_b32 v44, 7, v0
v_mfma_f32_16x16x32_bf16 v[248:251], a[140:143], a[120:123], v[248:251]
ds_read_b128 a[132:135], v15 offset:2048
v_lshlrev_b32_e64 v44, 12, v44
v_mfma_f32_16x16x32_bf16 v[244:247], a[140:143], a[116:119], v[244:247]
ds_read_b128 a[136:139], v15 offset:4096
v_and_b32 v45, 127, v0
v_mfma_f32_16x16x32_bf16 v[240:243], a[140:143], a[112:115], v[240:243]
v_lshl_add_u32 v44, v45, 2, v44
v_mfma_f32_16x16x32_bf16 a[0:3], a[144:147], a[112:115], a[0:3]
ds_read_b128 a[140:143], v15 offset:6144
v_add_u32 v44, 139264, v44
v_mfma_f32_16x16x32_bf16 a[4:7], a[144:147], a[116:119], a[4:7]
ds_read_b32 v24, v44 offset:0
v_mfma_f32_16x16x32_bf16 a[8:11], a[144:147], a[120:123], a[8:11]
ds_read_b32 v25, v44 offset:448
v_mfma_f32_16x16x32_bf16 a[12:15], a[144:147], a[124:127], a[12:15]
ds_read_b32 v26, v44 offset:896
v_mfma_f32_16x16x32_bf16 a[28:31], a[148:151], a[124:127], a[28:31]
ds_read_b64_tr_b16 a[144:145], v17 offset:0
v_mfma_f32_16x16x32_bf16 a[24:27], a[148:151], a[120:123], a[24:27]
ds_read_b64_tr_b16 a[146:147], v17 offset:1792
v_mfma_f32_16x16x32_bf16 a[20:23], a[148:151], a[116:119], a[20:23]
ds_read_b32 v27, v44 offset:1344
v_mfma_f32_16x16x32_bf16 a[16:19], a[148:151], a[112:115], a[16:19]
ds_read_b32 v28, v44 offset:2048
s_waitcnt lgkmcnt(9)
v_mfma_f32_16x16x32_bf16 a[32:35], a[96:99], a[128:131], a[32:35]
ds_read_b64_tr_b16 a[148:149], v17 offset:14336
s_add_u32 m0, s50, 28672
v_mfma_f32_16x16x32_bf16 a[36:39], a[100:103], a[128:131], a[36:39]
ds_read_b64_tr_b16 a[150:151], v17 offset:16128
s_mov_b32 s99, 6881280
v_mfma_f32_16x16x32_bf16 a[40:43], a[104:107], a[128:131], a[40:43]
buffer_load_dwordx4 v6, s[12:15], s99 offen  lds
v_mfma_f32_16x16x32_bf16 a[44:47], a[108:111], a[128:131], a[44:47]
ds_read_b32 v29, v44 offset:2496
v_mfma_f32_16x16x32_bf16 a[60:63], a[108:111], a[132:135], a[60:63]
ds_read_b64_tr_b16 a[128:129], v17 offset:32
v_mfma_f32_16x16x32_bf16 a[56:59], a[104:107], a[132:135], a[56:59]
ds_read_b64_tr_b16 a[130:131], v17 offset:1824
v_mfma_f32_16x16x32_bf16 a[52:55], a[100:103], a[132:135], a[52:55]
ds_read_b128 a[112:115], v14 offset:0
v_mfma_f32_16x16x32_bf16 a[48:51], a[96:99], a[132:135], a[48:51]
ds_read_b32 v30, v44 offset:2944
s_waitcnt lgkmcnt(14)
v_mfma_f32_16x16x32_bf16 a[64:67], a[96:99], a[136:139], a[64:67]
ds_read_b64_tr_b16 a[132:133], v17 offset:14368
v_mfma_f32_16x16x32_bf16 a[68:71], a[100:103], a[136:139], a[68:71]
ds_read_b64_tr_b16 a[134:135], v17 offset:16160
s_add_u32 m0, s50, 29696
v_mfma_f32_16x16x32_bf16 a[72:75], a[104:107], a[136:139], a[72:75]
buffer_load_dwordx4 v7, s[12:15], s99 offen  lds
v_mfma_f32_16x16x32_bf16 a[76:79], a[108:111], a[136:139], a[76:79]
ds_read_b32 v31, v44 offset:3392
s_lshl_b32 s46, s5, 13
v_mfma_f32_16x16x32_bf16 a[92:95], a[108:111], a[140:143], a[92:95]
ds_read_b64_tr_b16 a[136:137], v17 offset:64
s_add_u32 s46, s46, 26214400
v_mfma_f32_16x16x32_bf16 a[88:91], a[104:107], a[140:143], a[88:91]
ds_read_b64_tr_b16 a[138:139], v17 offset:1856
s_lshl_b32 s45, s4, 10
v_mfma_f32_16x16x32_bf16 a[84:87], a[100:103], a[140:143], a[84:87]
s_add_u32 s45, s45, s46
s_add_u32 s47, s46, 4096
v_lshlrev_b32 v44, 2, v0
v_mfma_f32_16x16x32_bf16 a[80:83], a[96:99], a[140:143], a[80:83]
s_waitcnt lgkmcnt(15)
v_add_f32_e64 v24, v24, v25
s_waitcnt lgkmcnt(10)
v_mfma_f32_16x16x32_bf16 v[64:67], a[144:147], a[96:99], v[64:67]
ds_read_b64_tr_b16 a[140:141], v17 offset:14400
v_add_f32_e64 v24, v24, v26
v_mfma_f32_16x16x32_bf16 v[68:71], a[144:147], a[100:103], v[68:71]
ds_read_b64_tr_b16 a[142:143], v17 offset:16192
s_add_u32 m0, s50, 30720
v_mfma_f32_16x16x32_bf16 v[72:75], a[144:147], a[104:107], v[72:75]
buffer_load_dwordx4 v8, s[12:15], s99 offen  lds
v_mfma_f32_16x16x32_bf16 v[76:79], a[144:147], a[108:111], v[76:79]
v_add_f32 v24, v24, v27
v_add_f32 v24, v24, v28
v_mfma_f32_16x16x32_bf16 v[92:95], a[148:151], a[108:111], v[92:95]
ds_read_b64_tr_b16 a[144:145], v17 offset:96
s_waitcnt lgkmcnt(12)
v_add_f32 v24, v24, v29
v_mfma_f32_16x16x32_bf16 v[88:91], a[148:151], a[104:107], v[88:91]
ds_read_b64_tr_b16 a[146:147], v17 offset:1888
s_waitcnt lgkmcnt(9)
v_add_f32 v24, v24, v30
v_mfma_f32_16x16x32_bf16 v[84:87], a[148:151], a[100:103], v[84:87]
ds_read_b128 a[116:119], v14 offset:2048
s_waitcnt lgkmcnt(7)
v_add_f32 v24, v24, v31
v_mfma_f32_16x16x32_bf16 v[80:83], a[148:151], a[96:99], v[80:83]
v_min_u32_e64 v24, -2, v24
v_mfma_f32_16x16x32_bf16 v[96:99], a[128:131], a[96:99], v[96:99]
ds_read_b64_tr_b16 a[148:149], v17 offset:14432
v_mfma_f32_16x16x32_bf16 v[100:103], a[128:131], a[100:103], v[100:103]
ds_read_b64_tr_b16 a[150:151], v17 offset:16224
s_add_u32 m0, s50, 31744
v_mfma_f32_16x16x32_bf16 v[104:107], a[128:131], a[104:107], v[104:107]
buffer_load_dwordx4 v9, s[12:15], s99 offen  lds
v_mfma_f32_16x16x32_bf16 v[108:111], a[128:131], a[108:111], v[108:111]
v_mfma_f32_16x16x32_bf16 v[124:127], a[132:135], a[108:111], v[124:127]
ds_read_b64_tr_b16 a[128:129], v17 offset:128
v_mfma_f32_16x16x32_bf16 v[120:123], a[132:135], a[104:107], v[120:123]
ds_read_b64_tr_b16 a[130:131], v17 offset:1920
v_mfma_f32_16x16x32_bf16 v[116:119], a[132:135], a[100:103], v[116:119]
buffer_store_dword v24, v44, s[20:23], s45 offen sc1
v_mfma_f32_16x16x32_bf16 v[112:115], a[132:135], a[96:99], v[112:115]
s_waitcnt lgkmcnt(7)
v_mfma_f32_16x16x32_bf16 v[128:131], a[136:139], a[96:99], v[128:131]
ds_read_b64_tr_b16 a[132:133], v17 offset:14464
v_and_b32 v60, 15, v1
v_mfma_f32_16x16x32_bf16 v[132:135], a[136:139], a[100:103], v[132:135]
ds_read_b64_tr_b16 a[134:135], v17 offset:16256
s_add_u32 m0, s50, 32768
v_mfma_f32_16x16x32_bf16 v[136:139], a[136:139], a[104:107], v[136:139]
buffer_load_dwordx4 v10, s[12:15], s99 offen  lds
v_mfma_f32_16x16x32_bf16 v[140:143], a[136:139], a[108:111], v[140:143]
v_mfma_f32_16x16x32_bf16 v[156:159], a[140:143], a[108:111], v[156:159]
ds_read_b64_tr_b16 a[136:137], v17 offset:160
v_mfma_f32_16x16x32_bf16 v[152:155], a[140:143], a[104:107], v[152:155]
ds_read_b64_tr_b16 a[138:139], v17 offset:1952
v_lshlrev_b32_e64 v60, 5, v60
v_mfma_f32_16x16x32_bf16 v[148:151], a[140:143], a[100:103], v[148:151]
ds_read_b128 a[120:123], v14 offset:4096
v_mfma_f32_16x16x32_bf16 v[144:147], a[140:143], a[96:99], v[144:147]
s_waitcnt lgkmcnt(7)
v_mfma_f32_16x16x32_bf16 v[160:163], a[144:147], a[96:99], v[160:163]
ds_read_b64_tr_b16 a[140:141], v17 offset:14496
v_mfma_f32_16x16x32_bf16 v[164:167], a[144:147], a[100:103], v[164:167]
ds_read_b64_tr_b16 a[142:143], v17 offset:16288
s_add_u32 m0, s50, 33792
v_mfma_f32_16x16x32_bf16 v[168:171], a[144:147], a[104:107], v[168:171]
buffer_load_dwordx4 v11, s[12:15], s99 offen  lds
v_mfma_f32_16x16x32_bf16 v[172:175], a[144:147], a[108:111], v[172:175]
s_lshl_b32 s60, s6, 9
v_mfma_f32_16x16x32_bf16 v[188:191], a[148:151], a[108:111], v[188:191]
ds_read_b64_tr_b16 a[144:145], v17 offset:192
v_mfma_f32_16x16x32_bf16 v[184:187], a[148:151], a[104:107], v[184:187]
ds_read_b64_tr_b16 a[146:147], v17 offset:1984
v_mfma_f32_16x16x32_bf16 v[180:183], a[148:151], a[100:103], v[180:183]
s_add_u32 s60, s60, 25165824
v_mfma_f32_16x16x32_bf16 v[176:179], a[148:151], a[96:99], v[176:179]
s_waitcnt lgkmcnt(7)
v_mfma_f32_16x16x32_bf16 v[192:195], a[128:131], a[96:99], v[192:195]
ds_read_b64_tr_b16 a[148:149], v17 offset:14528
v_mfma_f32_16x16x32_bf16 v[196:199], a[128:131], a[100:103], v[196:199]
ds_read_b64_tr_b16 a[150:151], v17 offset:16320
s_add_u32 m0, s50, 34816
v_mfma_f32_16x16x32_bf16 v[200:203], a[128:131], a[104:107], v[200:203]
buffer_load_dwordx4 v12, s[12:15], s99 offen  lds
v_mfma_f32_16x16x32_bf16 v[204:207], a[128:131], a[108:111], v[204:207]
buffer_load_dwordx4 v[52:55], v60, s[20:23], s60 offen sc1
v_mfma_f32_16x16x32_bf16 v[220:223], a[132:135], a[108:111], v[220:223]
ds_read_b128 a[128:131], v16 offset:0
v_mfma_f32_16x16x32_bf16 v[216:219], a[132:135], a[104:107], v[216:219]
v_mfma_f32_16x16x32_bf16 v[212:215], a[132:135], a[100:103], v[212:215]
ds_read_b128 a[124:127], v14 offset:6144
v_mfma_f32_16x16x32_bf16 v[208:211], a[132:135], a[96:99], v[208:211]
s_waitcnt lgkmcnt(6)
v_mfma_f32_16x16x32_bf16 v[224:227], a[136:139], a[96:99], v[224:227]
ds_read_b128 a[132:135], v16 offset:2048
s_add_u32 m0, s51, 8192
v_mfma_f32_16x16x32_bf16 v[228:231], a[136:139], a[100:103], v[228:231]
s_mov_b32 s100, 1920
v_mfma_f32_16x16x32_bf16 v[232:235], a[136:139], a[104:107], v[232:235]
buffer_load_dwordx4 v4, s[16:19], s100 offen lds
v_mfma_f32_16x16x32_bf16 v[236:239], a[136:139], a[108:111], v[236:239]
v_mfma_f32_16x16x32_bf16 v[252:255], a[140:143], a[108:111], v[252:255]
ds_read_b128 a[136:139], v16 offset:4096
v_mfma_f32_16x16x32_bf16 v[248:251], a[140:143], a[104:107], v[248:251]
v_mfma_f32_16x16x32_bf16 v[244:247], a[140:143], a[100:103], v[244:247]
buffer_load_dwordx4 v[56:59], v60, s[20:23], s60 offen offset:16 sc1
v_mfma_f32_16x16x32_bf16 v[240:243], a[140:143], a[96:99], v[240:243]
s_waitcnt lgkmcnt(4)
v_mfma_f32_16x16x32_bf16 a[0:3], a[144:147], a[96:99], a[0:3]
ds_read_b128 a[140:143], v16 offset:6144
v_mfma_f32_16x16x32_bf16 a[4:7], a[144:147], a[100:103], a[4:7]
s_add_u32 m0, s51, 9216
v_mfma_f32_16x16x32_bf16 a[8:11], a[144:147], a[104:107], a[8:11]
buffer_load_dwordx4 v5, s[16:19], s100 offen lds
v_mfma_f32_16x16x32_bf16 a[12:15], a[144:147], a[108:111], a[12:15]
s_lshr_b32 s48, s2, 3
s_lshl_b32 s48, s48, 2
s_add_u32 s48, s48, s3
v_mfma_f32_16x16x32_bf16 a[28:31], a[148:151], a[108:111], a[28:31]
ds_read_b64_tr_b16 a[144:145], v17 offset:7168
s_lshl_b32 s48, s48, 7
v_mfma_f32_16x16x32_bf16 a[24:27], a[148:151], a[104:107], a[24:27]
ds_read_b64_tr_b16 a[146:147], v17 offset:8960
s_add_u32 s48, s48, 36864
v_mfma_f32_16x16x32_bf16 a[20:23], a[148:151], a[100:103], a[20:23]
s_min_u32 s48, s48, L_codeend-L_main-4
v_mov_b32 v19, s48
v_mfma_f32_16x16x32_bf16 a[16:19], a[148:151], a[96:99], a[16:19]
s_waitcnt lgkmcnt(4)
v_mfma_f32_16x16x32_bf16 a[32:35], a[112:115], a[128:131], a[32:35]
ds_read_b64_tr_b16 a[148:149], v17 offset:21504
v_mfma_f32_16x16x32_bf16 a[36:39], a[116:119], a[128:131], a[36:39]
ds_read_b64_tr_b16 a[150:151], v17 offset:23296
v_mfma_f32_16x16x32_bf16 a[40:43], a[120:123], a[128:131], a[40:43]
global_load_dword v39, v19, s[82:83]
v_mfma_f32_16x16x32_bf16 a[44:47], a[124:127], a[128:131], a[44:47]
v_mfma_f32_16x16x32_bf16 a[60:63], a[124:127], a[132:135], a[60:63]
ds_read_b64_tr_b16 a[128:129], v17 offset:7200
v_mfma_f32_16x16x32_bf16 a[56:59], a[120:123], a[132:135], a[56:59]
ds_read_b64_tr_b16 a[130:131], v17 offset:8992
v_mfma_f32_16x16x32_bf16 a[52:55], a[116:119], a[132:135], a[52:55]
v_mfma_f32_16x16x32_bf16 a[48:51], a[112:115], a[132:135], a[48:51]
s_waitcnt lgkmcnt(6)
v_mfma_f32_16x16x32_bf16 a[64:67], a[112:115], a[136:139], a[64:67]
ds_read_b64_tr_b16 a[132:133], v17 offset:21536
v_mfma_f32_16x16x32_bf16 a[68:71], a[116:119], a[136:139], a[68:71]
ds_read_b64_tr_b16 a[134:135], v17 offset:23328
v_mfma_f32_16x16x32_bf16 a[72:75], a[120:123], a[136:139], a[72:75]
v_mfma_f32_16x16x32_bf16 a[76:79], a[124:127], a[136:139], a[76:79]
v_mfma_f32_16x16x32_bf16 a[92:95], a[124:127], a[140:143], a[92:95]
ds_read_b64_tr_b16 a[136:137], v17 offset:7232
v_mfma_f32_16x16x32_bf16 a[88:91], a[120:123], a[140:143], a[88:91]
ds_read_b64_tr_b16 a[138:139], v17 offset:9024
v_mfma_f32_16x16x32_bf16 a[84:87], a[116:119], a[140:143], a[84:87]
v_mfma_f32_16x16x32_bf16 a[80:83], a[112:115], a[140:143], a[80:83]
s_waitcnt lgkmcnt(6)
v_mfma_f32_16x16x32_bf16 v[64:67], a[144:147], a[112:115], v[64:67]
ds_read_b64_tr_b16 a[140:141], v17 offset:21568
v_mfma_f32_16x16x32_bf16 v[68:71], a[144:147], a[116:119], v[68:71]
ds_read_b64_tr_b16 a[142:143], v17 offset:23360
v_mfma_f32_16x16x32_bf16 v[72:75], a[144:147], a[120:123], v[72:75]
v_mfma_f32_16x16x32_bf16 v[76:79], a[144:147], a[124:127], v[76:79]
v_mfma_f32_16x16x32_bf16 v[92:95], a[148:151], a[124:127], v[92:95]
ds_read_b64_tr_b16 a[144:145], v17 offset:7264
v_mfma_f32_16x16x32_bf16 v[88:91], a[148:151], a[120:123], v[88:91]
ds_read_b64_tr_b16 a[146:147], v17 offset:9056
v_mfma_f32_16x16x32_bf16 v[84:87], a[148:151], a[116:119], v[84:87]
v_mfma_f32_16x16x32_bf16 v[80:83], a[148:151], a[112:115], v[80:83]
s_waitcnt lgkmcnt(6)
v_mfma_f32_16x16x32_bf16 v[96:99], a[128:131], a[112:115], v[96:99]
ds_read_b64_tr_b16 a[148:149], v17 offset:21600
s_bfe_u32 s52, s2, 0x20001
v_mfma_f32_16x16x32_bf16 v[100:103], a[128:131], a[116:119], v[100:103]
ds_read_b64_tr_b16 a[150:151], v17 offset:23392
s_lshr_b32 s53, s2, 5
v_mfma_f32_16x16x32_bf16 v[104:107], a[128:131], a[120:123], v[104:107]
s_and_b32 s54, s2, 1
s_lshl_b32 s54, s54, 2
v_mfma_f32_16x16x32_bf16 v[108:111], a[128:131], a[124:127], v[108:111]
L_pg9:
s_cbranch_execz L_ret0
s_bfe_u32 s45, s2, 0x20003
s_add_u32 s54, s54, s45
v_mfma_f32_16x16x32_bf16 v[124:127], a[132:135], a[124:127], v[124:127]
ds_read_b64_tr_b16 a[128:129], v17 offset:7296
v_and_b32_e64 v12, 15, v1
v_mfma_f32_16x16x32_bf16 v[120:123], a[132:135], a[120:123], v[120:123]
ds_read_b64_tr_b16 a[130:131], v17 offset:9088
s_lshl_b32 s54, s54, 2
v_mfma_f32_16x16x32_bf16 v[116:119], a[132:135], a[116:119], v[116:119]
s_add_u32 s54, s54, s3
v_lshlrev_b32 v2, 4, v1
v_mfma_f32_16x16x32_bf16 v[112:115], a[132:135], a[112:115], v[112:115]
v_lshlrev_b32 v12, 2, v12
s_waitcnt lgkmcnt(6)
v_mfma_f32_16x16x32_bf16 v[128:131], a[136:139], a[112:115], v[128:131]
ds_read_b64_tr_b16 a[132:133], v17 offset:21632
s_lshl_b32 s101, s54, 2
v_mfma_f32_16x16x32_bf16 v[132:135], a[136:139], a[116:119], v[132:135]
ds_read_b64_tr_b16 a[134:135], v17 offset:23424
s_add_u32 s101, s101, s52
v_mfma_f32_16x16x32_bf16 v[136:139], a[136:139], a[120:123], v[136:139]
s_lshl_b32 s50, s5, 7
s_mul_i32 s101, s101, 180224
v_lshrrev_b32 v46, 4, v1
v_mfma_f32_16x16x32_bf16 v[140:143], a[136:139], a[124:127], v[140:143]
v_lshlrev_b32 v47, 1, v46
v_and_b32 v48, 15, v1
v_mfma_f32_16x16x32_bf16 v[156:159], a[140:143], a[124:127], v[156:159]
ds_read_b64_tr_b16 a[136:137], v17 offset:7328
v_xor_b32_e64 v47, v47, v48
v_mfma_f32_16x16x32_bf16 v[152:155], a[140:143], a[120:123], v[152:155]
ds_read_b64_tr_b16 a[138:139], v17 offset:9120
s_add_u32 s50, s50, 25182208
v_mfma_f32_16x16x32_bf16 v[148:151], a[140:143], a[116:119], v[148:151]
v_lshlrev_b32 v47, 4, v47
s_and_b32 s45, s3, 1
v_mfma_f32_16x16x32_bf16 v[144:147], a[140:143], a[112:115], v[144:147]
s_lshl_b32 s45, s45, 7
s_waitcnt lgkmcnt(6)
v_mfma_f32_16x16x32_bf16 v[160:163], a[144:147], a[112:115], v[160:163]
ds_read_b64_tr_b16 a[140:141], v17 offset:21664
s_add_u32 s51, s50, 4096
v_mfma_f32_16x16x32_bf16 v[164:167], a[144:147], a[116:119], v[164:167]
ds_read_b64_tr_b16 a[142:143], v17 offset:23456
s_add_u32 s45, s45, s53
v_mfma_f32_16x16x32_bf16 v[168:171], a[144:147], a[120:123], v[168:171]
s_lshl_b32 s45, s45, 8
v_lshl_add_u32 v6, v46, 11, v47
v_mfma_f32_16x16x32_bf16 v[172:175], a[144:147], a[124:127], v[172:175]
buffer_load_dword v4, v12, s[20:23], s50 offen offset:0 sc1
v_mfma_f32_16x16x32_bf16 v[188:191], a[148:151], a[124:127], v[188:191]
ds_read_b64_tr_b16 a[144:145], v17 offset:7360
v_add_u32 v6, s45, v6
v_mfma_f32_16x16x32_bf16 v[184:187], a[148:151], a[120:123], v[184:187]
ds_read_b64_tr_b16 a[146:147], v17 offset:9152
s_lshl_b32 s45, s52, 6
v_mfma_f32_16x16x32_bf16 v[180:183], a[148:151], a[116:119], v[180:183]
v_xor_b32 v6, s45, v6
v_mfma_f32_16x16x32_bf16 v[176:179], a[148:151], a[112:115], v[176:179]
v_xor_b32 v7, 128, v6
s_waitcnt lgkmcnt(6)
v_mfma_f32_16x16x32_bf16 v[192:195], a[128:131], a[112:115], v[192:195]
ds_read_b64_tr_b16 a[148:149], v17 offset:21696
v_add_u32 v7, 8192, v7
v_mfma_f32_16x16x32_bf16 v[196:199], a[128:131], a[116:119], v[196:199]
ds_read_b64_tr_b16 a[150:151], v17 offset:23488
s_mul_i32 s98, s52, 1835008
v_mfma_f32_16x16x32_bf16 v[200:203], a[128:131], a[120:123], v[200:203]
buffer_load_dword v5, v12, s[20:23], s51 offen offset:0 sc1
v_mfma_f32_16x16x32_bf16 v[204:207], a[128:131], a[124:127], v[204:207]
s_lshr_b32 s45, s3, 1
s_mul_i32 s99, s45, 458752
v_mfma_f32_16x16x32_bf16 v[220:223], a[132:135], a[124:127], v[220:223]
s_waitcnt vmcnt(15)
ds_read_b128 a[96:99], v13 offset:32768
v_mfma_f32_16x16x32_bf16 v[216:219], a[132:135], a[120:123], v[216:219]
ds_read_b128 a[100:103], v13 offset:34816
s_add_u32 s99, s99, s98
v_mfma_f32_16x16x32_bf16 v[212:215], a[132:135], a[116:119], v[212:215]
s_lshl_b32 s45, s45, 18
s_add_u32 s98, s98, s45
v_mfma_f32_16x16x32_bf16 v[208:211], a[132:135], a[112:115], v[208:211]
v_and_b32_e64 v47, 7, v1
s_waitcnt lgkmcnt(6)
v_mfma_f32_16x16x32_bf16 v[224:227], a[136:139], a[112:115], v[224:227]
ds_read_b128 a[104:107], v13 offset:36864
v_xor_b32 v47, v47, v46
v_mfma_f32_16x16x32_bf16 v[228:231], a[136:139], a[116:119], v[228:231]
ds_read_b128 a[108:111], v13 offset:38912
v_lshlrev_b32 v47, 4, v47
v_mfma_f32_16x16x32_bf16 v[232:235], a[136:139], a[120:123], v[232:235]
buffer_load_dword v18, v12, s[20:23], s50 offen offset:64 sc1
v_mfma_f32_16x16x32_bf16 v[236:239], a[136:139], a[124:127], v[236:239]
s_waitcnt vmcnt(4) lgkmcnt(4)
s_barrier
v_mfma_f32_16x16x32_bf16 v[252:255], a[140:143], a[124:127], v[252:255]
ds_read_b128 a[128:131], v15 offset:8192
v_lshrrev_b32_e64 v49, 3, v1
v_mfma_f32_16x16x32_bf16 v[248:251], a[140:143], a[120:123], v[248:251]
ds_read_b128 a[132:135], v15 offset:10240
s_lshl_b32 s45, s53, 18
v_mfma_f32_16x16x32_bf16 v[244:247], a[140:143], a[116:119], v[244:247]
ds_read_b128 a[136:139], v15 offset:12288
v_lshl_add_u32 v8, v49, 11, v47
v_mfma_f32_16x16x32_bf16 v[240:243], a[140:143], a[112:115], v[240:243]
v_add_u32 v8, s45, v8
v_mfma_f32_16x16x32_bf16 a[0:3], a[144:147], a[112:115], a[0:3]
ds_read_b128 a[140:143], v15 offset:14336
v_xor_b32_e64 v9, 64, v8
v_mfma_f32_16x16x32_bf16 a[4:7], a[144:147], a[116:119], a[4:7]
buffer_load_dword v19, v12, s[20:23], s51 offen offset:64 sc1
v_mfma_f32_16x16x32_bf16 a[8:11], a[144:147], a[120:123], a[8:11]
v_add_u32 v9, 16384, v9
s_xor_b32 s100, s52, s3
v_mfma_f32_16x16x32_bf16 a[12:15], a[144:147], a[124:127], a[12:15]
s_lshl_b32 s100, s100, 7
s_add_u32 s100, s100, s52
v_mfma_f32_16x16x32_bf16 a[28:31], a[148:151], a[124:127], a[28:31]
ds_read_b64_tr_b16 a[144:145], v17 offset:28672
s_lshl_b32 s100, s100, 9
v_mfma_f32_16x16x32_bf16 a[24:27], a[148:151], a[120:123], a[24:27]
ds_read_b64_tr_b16 a[146:147], v17 offset:30464
s_lshl_b32 s7, s3, 12
v_mfma_f32_16x16x32_bf16 a[20:23], a[148:151], a[116:119], a[20:23]
v_subrev_u32 v10, 122880, v15
v_xor_b32 v11, 64, v10
v_mfma_f32_16x16x32_bf16 a[16:19], a[148:151], a[112:115], a[16:19]
s_waitcnt lgkmcnt(4)
v_mfma_f32_16x16x32_bf16 a[32:35], a[96:99], a[128:131], a[32:35]
ds_read_b64_tr_b16 a[148:149], v17 offset:43008
v_max_u32 v61, v52, v53
v_max3_u32 v61, v61, v54, v55
v_mfma_f32_16x16x32_bf16 a[36:39], a[100:103], a[128:131], a[36:39]
ds_read_b64_tr_b16 a[150:151], v17 offset:44800
v_max3_u32 v61, v61, v56, v57
v_mfma_f32_16x16x32_bf16 a[40:43], a[104:107], a[128:131], a[40:43]
buffer_load_dword v36, v44, s[20:23], s46 offen offset:0 sc1
v_mfma_f32_16x16x32_bf16 a[44:47], a[108:111], a[128:131], a[44:47]
v_max3_u32 v61, v61, v58, v59
v_cmp_eq_u32 vcc, -1, v61
v_mfma_f32_16x16x32_bf16 a[60:63], a[108:111], a[132:135], a[60:63]
ds_read_b64_tr_b16 a[128:129], v17 offset:28704
s_cbranch_vccnz L_slow4
L_back5:
v_mfma_f32_16x16x32_bf16 a[56:59], a[104:107], a[132:135], a[56:59]
ds_read_b64_tr_b16 a[130:131], v17 offset:30496
v_mov_b32 v20, v52
v_mfma_f32_16x16x32_bf16 a[52:55], a[100:103], a[132:135], a[52:55]
ds_read_b128 a[112:115], v14 offset:32768
v_mul_f32 v21, v53, v53
v_mfma_f32_16x16x32_bf16 a[48:51], a[96:99], a[132:135], a[48:51]
v_rcp_f32 v53, v53
s_waitcnt lgkmcnt(7)
v_mfma_f32_16x16x32_bf16 a[64:67], a[96:99], a[136:139], a[64:67]
ds_read_b64_tr_b16 a[132:133], v17 offset:43040
v_mfma_f32_16x16x32_bf16 a[68:71], a[100:103], a[136:139], a[68:71]
ds_read_b64_tr_b16 a[134:135], v17 offset:44832
v_mul_f32 v22, 0xc0135761, v53
v_mfma_f32_16x16x32_bf16 a[72:75], a[104:107], a[136:139], a[72:75]
buffer_load_dword v37, v44, s[20:23], s46 offen offset:1024 sc1
v_mfma_f32_16x16x32_bf16 a[76:79], a[108:111], a[136:139], a[76:79]
v_mul_f32 v61, v53, v53
v_mul_f32 v61, v61, v53
v_mfma_f32_16x16x32_bf16 a[92:95], a[108:111], a[140:143], a[92:95]
ds_read_b64_tr_b16 a[136:137], v17 offset:28736
v_mul_f32 v23, 0xbdd2d3e8, v61
v_mfma_f32_16x16x32_bf16 a[88:91], a[104:107], a[140:143], a[88:91]
ds_read_b64_tr_b16 a[138:139], v17 offset:30528
v_mov_b32_e64 v24, v54
v_mfma_f32_16x16x32_bf16 a[84:87], a[100:103], a[140:143], a[84:87]
buffer_load_dword v38, v44, s[20:23], s46 offen offset:2048 sc1
v_mfma_f32_16x16x32_bf16 a[80:83], a[96:99], a[140:143], a[80:83]
v_mul_f32 v25, v55, v55
s_waitcnt lgkmcnt(7)
v_mfma_f32_16x16x32_bf16 v[64:67], a[144:147], a[96:99], v[64:67]
ds_read_b64_tr_b16 a[140:141], v17 offset:43072
v_rcp_f32_e64 v55, v55
v_mfma_f32_16x16x32_bf16 v[68:71], a[144:147], a[100:103], v[68:71]
ds_read_b64_tr_b16 a[142:143], v17 offset:44864
v_mfma_f32_16x16x32_bf16 v[72:75], a[144:147], a[104:107], v[72:75]
buffer_load_dword v39, v44, s[20:23], s46 offen offset:3072 sc1
v_mfma_f32_16x16x32_bf16 v[76:79], a[144:147], a[108:111], v[76:79]
v_mul_f32 v26, 0xc0135761, v55
v_mul_f32 v61, v55, v55
v_mfma_f32_16x16x32_bf16 v[92:95], a[148:151], a[108:111], v[92:95]
ds_read_b64_tr_b16 a[144:145], v17 offset:28768
v_mul_f32 v61, v61, v55
v_mfma_f32_16x16x32_bf16 v[88:91], a[148:151], a[104:107], v[88:91]
ds_read_b64_tr_b16 a[146:147], v17 offset:30560
v_mul_f32 v27, 0xbdd2d3e8, v61
v_mfma_f32_16x16x32_bf16 v[84:87], a[148:151], a[100:103], v[84:87]
ds_read_b128 a[116:119], v14 offset:34816
v_mov_b32 v28, v56
v_mfma_f32_16x16x32_bf16 v[80:83], a[148:151], a[96:99], v[80:83]
v_mul_f32_e64 v29, v57, v57
s_waitcnt lgkmcnt(7)
v_mfma_f32_16x16x32_bf16 v[96:99], a[128:131], a[96:99], v[96:99]
ds_read_b64_tr_b16 a[148:149], v17 offset:43104
v_rcp_f32_e64 v57, v57
v_mfma_f32_16x16x32_bf16 v[100:103], a[128:131], a[100:103], v[100:103]
ds_read_b64_tr_b16 a[150:151], v17 offset:44896
v_mfma_f32_16x16x32_bf16 v[104:107], a[128:131], a[104:107], v[104:107]
buffer_load_dword v40, v44, s[20:23], s47 offen offset:0 sc1
v_mfma_f32_16x16x32_bf16 v[108:111], a[128:131], a[108:111], v[108:111]
v_mul_f32 v30, 0xc0135761, v57
v_mul_f32 v61, v57, v57
v_mfma_f32_16x16x32_bf16 v[124:127], a[132:135], a[108:111], v[124:127]
ds_read_b64_tr_b16 a[128:129], v17 offset:28800
v_mul_f32 v61, v61, v57
v_mfma_f32_16x16x32_bf16 v[120:123], a[132:135], a[104:107], v[120:123]
ds_read_b64_tr_b16 a[130:131], v17 offset:30592
v_mul_f32 v31, 0xbdd2d3e8, v61
v_mfma_f32_16x16x32_bf16 v[116:119], a[132:135], a[100:103], v[116:119]
buffer_load_dword v41, v44, s[20:23], s47 offen offset:1024 sc1
v_mfma_f32_16x16x32_bf16 v[112:115], a[132:135], a[96:99], v[112:115]
v_mov_b32 v32, v58
s_waitcnt lgkmcnt(7)
v_mfma_f32_16x16x32_bf16 v[128:131], a[136:139], a[96:99], v[128:131]
ds_read_b64_tr_b16 a[132:133], v17 offset:43136
v_mul_f32_e64 v33, v59, v59
v_mfma_f32_16x16x32_bf16 v[132:135], a[136:139], a[100:103], v[132:135]
ds_read_b64_tr_b16 a[134:135], v17 offset:44928
v_mfma_f32_16x16x32_bf16 v[136:139], a[136:139], a[104:107], v[136:139]
buffer_load_dword v42, v44, s[20:23], s47 offen offset:2048 sc1
v_mfma_f32_16x16x32_bf16 v[140:143], a[136:139], a[108:111], v[140:143]
v_rcp_f32 v59, v59
s_nop 0
v_mul_f32 v34, 0xc0135761, v59
v_mfma_f32_16x16x32_bf16 v[156:159], a[140:143], a[108:111], v[156:159]
ds_read_b64_tr_b16 a[136:137], v17 offset:28832
v_mul_f32_e64 v61, v59, v59
v_mfma_f32_16x16x32_bf16 v[152:155], a[140:143], a[104:107], v[152:155]
ds_read_b64_tr_b16 a[138:139], v17 offset:30624
v_mul_f32_e64 v61, v61, v59
v_mfma_f32_16x16x32_bf16 v[148:151], a[140:143], a[100:103], v[148:151]
ds_read_b128 a[120:123], v14 offset:36864
v_mul_f32 v35, 0xbdd2d3e8, v61
v_mfma_f32_16x16x32_bf16 v[144:147], a[140:143], a[96:99], v[144:147]
s_lshl_b32 s60, s3, 9
s_waitcnt lgkmcnt(7)
v_mfma_f32_16x16x32_bf16 v[160:163], a[144:147], a[96:99], v[160:163]
ds_read_b64_tr_b16 a[140:141], v17 offset:43168
s_add_u32 m0, s7, 0
v_mfma_f32_16x16x32_bf16 v[164:167], a[144:147], a[100:103], v[164:167]
ds_read_b64_tr_b16 a[142:143], v17 offset:44960
s_add_u32 s60, s60, 156672
v_mfma_f32_16x16x32_bf16 v[168:171], a[144:147], a[104:107], v[168:171]
buffer_load_dword v43, v44, s[20:23], s47 offen offset:3072 sc1
v_mfma_f32_16x16x32_bf16 v[172:175], a[144:147], a[108:111], v[172:175]
s_add_u32 s44, s98, 0
v_add_u32_e64 v60, s60, v60
v_mfma_f32_16x16x32_bf16 v[188:191], a[148:151], a[108:111], v[188:191]
ds_read_b64_tr_b16 a[144:145], v17 offset:28864
ds_write_b128 v60, v[52:55]
v_mfma_f32_16x16x32_bf16 v[184:187], a[148:151], a[104:107], v[184:187]
ds_read_b64_tr_b16 a[146:147], v17 offset:30656
v_mfma_f32_16x16x32_bf16 v[180:183], a[148:151], a[100:103], v[180:183]
buffer_load_dwordx4 v6, s[28:31], s44 offen lds
v_mfma_f32_16x16x32_bf16 v[176:179], a[148:151], a[96:99], v[176:179]
ds_write_b128 v60, v[56:59] offset:16
s_waitcnt lgkmcnt(9)
v_mfma_f32_16x16x32_bf16 v[192:195], a[128:131], a[96:99], v[192:195]
ds_read_b64_tr_b16 a[148:149], v17 offset:43200
v_lshrrev_b32 v60, 4, v1
v_mfma_f32_16x16x32_bf16 v[196:199], a[128:131], a[100:103], v[196:199]
ds_read_b64_tr_b16 a[150:151], v17 offset:44992
v_mfma_f32_16x16x32_bf16 v[200:203], a[128:131], a[104:107], v[200:203]
s_add_u32 m0, s7, 1024
v_lshlrev_b32_e64 v60, 4, v60
v_mfma_f32_16x16x32_bf16 v[204:207], a[128:131], a[108:111], v[204:207]
v_add_u32 v60, 147456, v60
v_mfma_f32_16x16x32_bf16 v[220:223], a[132:135], a[108:111], v[220:223]
ds_read_b128 a[128:131], v16 offset:8192
v_mfma_f32_16x16x32_bf16 v[216:219], a[132:135], a[104:107], v[216:219]
buffer_load_dwordx4 v7, s[28:31], s44 offen lds
v_mfma_f32_16x16x32_bf16 v[212:215], a[132:135], a[100:103], v[212:215]
ds_read_b128 a[124:127], v14 offset:38912
v_mfma_f32_16x16x32_bf16 v[208:211], a[132:135], a[96:99], v[208:211]
v_lshlrev_b32 v61, 4, v1
s_waitcnt lgkmcnt(8)
v_mfma_f32_16x16x32_bf16 v[224:227], a[136:139], a[96:99], v[224:227]
ds_read_b128 a[132:135], v16 offset:10240
v_mfma_f32_16x16x32_bf16 v[228:231], a[136:139], a[100:103], v[228:231]
s_add_u32 m0, s7, 2048
v_lshrrev_b32_e64 v62, 5, v1
v_mfma_f32_16x16x32_bf16 v[232:235], a[136:139], a[104:107], v[232:235]
s_add_u32 s44, s98, 16384
v_mfma_f32_16x16x32_bf16 v[236:239], a[136:139], a[108:111], v[236:239]
v_lshl_add_u32 v62, v62, 9, v61
v_mfma_f32_16x16x32_bf16 v[252:255], a[140:143], a[108:111], v[252:255]
ds_read_b128 a[136:139], v16 offset:12288
v_mfma_f32_16x16x32_bf16 v[248:251], a[140:143], a[104:107], v[248:251]
buffer_load_dwordx4 v6, s[28:31], s44 offen lds
v_mfma_f32_16x16x32_bf16 v[244:247], a[140:143], a[100:103], v[244:247]
s_lshr_b32 s45, s5, 3
v_mfma_f32_16x16x32_bf16 v[240:243], a[140:143], a[96:99], v[240:243]
s_waitcnt lgkmcnt(4)
v_mfma_f32_16x16x32_bf16 a[0:3], a[144:147], a[96:99], a[0:3]
ds_read_b128 a[140:143], v16 offset:14336
v_mfma_f32_16x16x32_bf16 a[4:7], a[144:147], a[100:103], a[4:7]
s_add_u32 m0, s7, 3072
s_lshl_b32 s62, s6, 2
v_mfma_f32_16x16x32_bf16 a[8:11], a[144:147], a[104:107], a[8:11]
buffer_load_dwordx4 v7, s[28:31], s44 offen lds
v_mfma_f32_16x16x32_bf16 a[12:15], a[144:147], a[108:111], a[12:15]
s_add_u32 s45, s45, s62
v_mfma_f32_16x16x32_bf16 a[28:31], a[148:151], a[108:111], a[28:31]
ds_read_b64_tr_b16 a[144:145], v17 offset:35840
v_mfma_f32_16x16x32_bf16 a[24:27], a[148:151], a[104:107], a[24:27]
ds_read_b64_tr_b16 a[146:147], v17 offset:37632
v_mfma_f32_16x16x32_bf16 a[20:23], a[148:151], a[100:103], a[20:23]
s_mul_i32 s61, s45, 180224
v_mfma_f32_16x16x32_bf16 a[16:19], a[148:151], a[96:99], a[16:19]
s_add_u32 m0, s7, 16384
s_waitcnt lgkmcnt(4)
v_mfma_f32_16x16x32_bf16 a[32:35], a[112:115], a[128:131], a[32:35]
ds_read_b64_tr_b16 a[148:149], v17 offset:50176
s_and_b32 s45, s5, 7
v_mfma_f32_16x16x32_bf16 a[36:39], a[116:119], a[128:131], a[36:39]
ds_read_b64_tr_b16 a[150:151], v17 offset:51968
v_mfma_f32_16x16x32_bf16 a[40:43], a[120:123], a[128:131], a[40:43]
s_add_u32 s44, s98, 458752
s_lshl_b32 s45, s45, 12
v_mfma_f32_16x16x32_bf16 a[44:47], a[124:127], a[128:131], a[44:47]
buffer_load_dwordx4 v6, s[28:31], s44 offen lds
v_mfma_f32_16x16x32_bf16 a[60:63], a[124:127], a[132:135], a[60:63]
ds_read_b64_tr_b16 a[128:129], v17 offset:35872
v_mfma_f32_16x16x32_bf16 a[56:59], a[120:123], a[132:135], a[56:59]
ds_read_b64_tr_b16 a[130:131], v17 offset:37664
s_add_u32 s62, s61, s45
v_mfma_f32_16x16x32_bf16 a[52:55], a[116:119], a[132:135], a[52:55]
v_mfma_f32_16x16x32_bf16 a[48:51], a[112:115], a[132:135], a[48:51]
s_bfe_u32 s45, s5, 0x20001
s_waitcnt lgkmcnt(6)
v_mfma_f32_16x16x32_bf16 a[64:67], a[112:115], a[136:139], a[64:67]
ds_read_b64_tr_b16 a[132:133], v17 offset:50208
s_add_u32 m0, s7, 17408
v_mfma_f32_16x16x32_bf16 a[68:71], a[116:119], a[136:139], a[68:71]
ds_read_b64_tr_b16 a[134:135], v17 offset:52000
v_mfma_f32_16x16x32_bf16 a[72:75], a[120:123], a[136:139], a[72:75]
buffer_load_dwordx4 v7, s[28:31], s44 offen lds
v_mfma_f32_16x16x32_bf16 a[76:79], a[124:127], a[136:139], a[76:79]
s_lshl_b32 s45, s45, 12
v_mfma_f32_16x16x32_bf16 a[92:95], a[124:127], a[140:143], a[92:95]
ds_read_b64_tr_b16 a[136:137], v17 offset:35904
v_mfma_f32_16x16x32_bf16 a[88:91], a[120:123], a[140:143], a[88:91]
ds_read_b64_tr_b16 a[138:139], v17 offset:37696
v_mfma_f32_16x16x32_bf16 a[84:87], a[116:119], a[140:143], a[84:87]
s_add_u32 m0, s7, 18432
s_add_u32 s63, s61, s45
v_mfma_f32_16x16x32_bf16 a[80:83], a[112:115], a[140:143], a[80:83]
s_waitcnt lgkmcnt(6)
v_mfma_f32_16x16x32_bf16 v[64:67], a[144:147], a[112:115], v[64:67]
ds_read_b64_tr_b16 a[140:141], v17 offset:50240
s_and_b32 s45, s5, 1
v_mfma_f32_16x16x32_bf16 v[68:71], a[144:147], a[116:119], v[68:71]
ds_read_b64_tr_b16 a[142:143], v17 offset:52032
s_add_u32 s44, s98, 475136
v_mfma_f32_16x16x32_bf16 v[72:75], a[144:147], a[120:123], v[72:75]
v_mfma_f32_16x16x32_bf16 v[76:79], a[144:147], a[124:127], v[76:79]
buffer_load_dwordx4 v6, s[28:31], s44 offen lds
v_mfma_f32_16x16x32_bf16 v[92:95], a[148:151], a[124:127], v[92:95]
ds_read_b64_tr_b16 a[144:145], v17 offset:35936
s_lshl_b32 s45, s45, 9
v_mfma_f32_16x16x32_bf16 v[88:91], a[148:151], a[120:123], v[88:91]
ds_read_b64_tr_b16 a[146:147], v17 offset:37728
v_mfma_f32_16x16x32_bf16 v[84:87], a[148:151], a[116:119], v[84:87]
s_add_u32 s63, s63, s45
v_mfma_f32_16x16x32_bf16 v[80:83], a[148:151], a[112:115], v[80:83]
s_add_u32 m0, s7, 19456
s_waitcnt lgkmcnt(6)
v_mfma_f32_16x16x32_bf16 v[96:99], a[128:131], a[112:115], v[96:99]
ds_read_b64_tr_b16 a[148:149], v17 offset:50272
v_mfma_f32_16x16x32_bf16 v[100:103], a[128:131], a[116:119], v[100:103]
ds_read_b64_tr_b16 a[150:151], v17 offset:52064
s_add_u32 s63, s63, 98304
v_mfma_f32_16x16x32_bf16 v[104:107], a[128:131], a[120:123], v[104:107]
buffer_load_dwordx4 v7, s[28:31], s44 offen lds
v_mfma_f32_16x16x32_bf16 v[108:111], a[128:131], a[124:127], v[108:111]
v_mfma_f32_16x16x32_bf16 v[124:127], a[132:135], a[124:127], v[124:127]
ds_read_b64_tr_b16 a[128:129], v17 offset:35968
s_waitcnt vmcnt(14)
v_max_u32 v45, v36, v37
v_mfma_f32_16x16x32_bf16 v[120:123], a[132:135], a[120:123], v[120:123]
ds_read_b64_tr_b16 a[130:131], v17 offset:37760
s_waitcnt vmcnt(12)
v_max3_u32 v45, v45, v38, v39
v_mfma_f32_16x16x32_bf16 v[116:119], a[132:135], a[116:119], v[116:119]
s_add_u32 m0, s7, 65536
s_waitcnt vmcnt(10)
v_max3_u32 v45, v45, v40, v41
v_mfma_f32_16x16x32_bf16 v[112:115], a[132:135], a[112:115], v[112:115]
s_waitcnt vmcnt(8)
v_max3_u32 v45, v45, v42, v43
s_waitcnt lgkmcnt(6)
v_mfma_f32_16x16x32_bf16 v[128:131], a[136:139], a[112:115], v[128:131]
ds_read_b64_tr_b16 a[132:133], v17 offset:50304
v_mfma_f32_16x16x32_bf16 v[132:135], a[136:139], a[116:119], v[132:135]
ds_read_b64_tr_b16 a[134:135], v17 offset:52096
s_add_u32 s44, s98, 917504
v_mfma_f32_16x16x32_bf16 v[136:139], a[136:139], a[120:123], v[136:139]
v_cmp_eq_u32 vcc, -1, v45
s_nop 1
s_cbranch_vccnz L_slow7
L_back8:
v_mfma_f32_16x16x32_bf16 v[140:143], a[136:139], a[124:127], v[140:143]
buffer_load_dwordx4 v6, s[28:31], s44 offen lds
v_mfma_f32_16x16x32_bf16 v[156:159], a[140:143], a[124:127], v[156:159]
ds_read_b64_tr_b16 a[136:137], v17 offset:36000
v_mfma_f32_16x16x32_bf16 v[152:155], a[140:143], a[120:123], v[152:155]
ds_read_b64_tr_b16 a[138:139], v17 offset:37792
v_add_f32 v36, v36, v37
v_mfma_f32_16x16x32_bf16 v[148:151], a[140:143], a[116:119], v[148:151]
v_add_f32 v36, v36, v38
v_mfma_f32_16x16x32_bf16 v[144:147], a[140:143], a[112:115], v[144:147]
s_add_u32 m0, s7, 66560
v_add_f32_e64 v36, v36, v39
s_waitcnt lgkmcnt(6)
v_mfma_f32_16x16x32_bf16 v[160:163], a[144:147], a[112:115], v[160:163]
ds_read_b64_tr_b16 a[140:141], v17 offset:50336
v_mfma_f32_16x16x32_bf16 v[164:167], a[144:147], a[116:119], v[164:167]
ds_read_b64_tr_b16 a[142:143], v17 offset:52128
v_add_f32 v36, v36, v40
v_mfma_f32_16x16x32_bf16 v[168:171], a[144:147], a[120:123], v[168:171]
buffer_load_dwordx4 v7, s[28:31], s44 offen lds
v_mfma_f32_16x16x32_bf16 v[172:175], a[144:147], a[124:127], v[172:175]
v_add_f32 v36, v36, v41
v_mfma_f32_16x16x32_bf16 v[188:191], a[148:151], a[124:127], v[188:191]
ds_read_b64_tr_b16 a[144:145], v17 offset:36032
v_add_f32_e64 v36, v36, v42
v_mfma_f32_16x16x32_bf16 v[184:187], a[148:151], a[120:123], v[184:187]
ds_read_b64_tr_b16 a[146:147], v17 offset:37824
v_add_f32_e64 v36, v36, v43
v_mfma_f32_16x16x32_bf16 v[180:183], a[148:151], a[116:119], v[180:183]
s_add_u32 m0, s7, 67584
v_add_u32 v44, 147456, v44
v_mfma_f32_16x16x32_bf16 v[176:179], a[148:151], a[112:115], v[176:179]
s_waitcnt lgkmcnt(6)
v_mfma_f32_16x16x32_bf16 v[192:195], a[128:131], a[112:115], v[192:195]
ds_read_b64_tr_b16 a[148:149], v17 offset:50368
s_add_u32 s44, s98, 933888
v_mfma_f32_16x16x32_bf16 v[196:199], a[128:131], a[116:119], v[196:199]
ds_read_b64_tr_b16 a[150:151], v17 offset:52160
v_mfma_f32_16x16x32_bf16 v[200:203], a[128:131], a[120:123], v[200:203]
buffer_load_dwordx4 v6, s[28:31], s44 offen lds
v_mfma_f32_16x16x32_bf16 v[204:207], a[128:131], a[124:127], v[204:207]
ds_write_b32 v44, v36
v_mfma_f32_16x16x32_bf16 v[220:223], a[132:135], a[124:127], v[220:223]
v_mfma_f32_16x16x32_bf16 v[216:219], a[132:135], a[120:123], v[216:219]
s_add_u32 m0, s7, 68608
v_mfma_f32_16x16x32_bf16 v[212:215], a[132:135], a[116:119], v[212:215]
v_mfma_f32_16x16x32_bf16 v[208:211], a[132:135], a[112:115], v[208:211]
s_waitcnt lgkmcnt(5)
v_mfma_f32_16x16x32_bf16 v[224:227], a[136:139], a[112:115], v[224:227]
buffer_load_dwordx4 v7, s[28:31], s44 offen lds
v_mfma_f32_16x16x32_bf16 v[228:231], a[136:139], a[116:119], v[228:231]
v_mfma_f32_16x16x32_bf16 v[232:235], a[136:139], a[120:123], v[232:235]
v_mfma_f32_16x16x32_bf16 v[236:239], a[136:139], a[124:127], v[236:239]
s_mov_b64 exec, 0
s_cmp_eq_u32 s3, 1
s_cbranch_scc1 L_pg13
s_cmp_eq_u32 s3, 2
s_cbranch_scc1 L_pg14
s_cmp_eq_u32 s3, 3
s_cbranch_scc1 L_pg15
s_branch L_pg12
L_ret3:
s_mov_b64 exec, -1
s_waitcnt lgkmcnt(0)
s_barrier
v_mfma_f32_16x16x32_bf16 v[252:255], a[140:143], a[124:127], v[252:255]
ds_read_b128 v[36:39], v60 offset:0
v_mfma_f32_16x16x32_bf16 v[248:251], a[140:143], a[120:123], v[248:251]
ds_read_b128 v[40:43], v60 offset:512
v_mfma_f32_16x16x32_bf16 v[244:247], a[140:143], a[116:119], v[244:247]
v_mfma_f32_16x16x32_bf16 v[240:243], a[140:143], a[112:115], v[240:243]
v_mfma_f32_16x16x32_bf16 a[0:3], a[144:147], a[112:115], a[0:3]
v_mfma_f32_16x16x32_bf16 a[4:7], a[144:147], a[116:119], a[4:7]
v_mfma_f32_16x16x32_bf16 a[8:11], a[144:147], a[120:123], a[8:11]
v_mfma_f32_16x16x32_bf16 a[12:15], a[144:147], a[124:127], a[12:15]
v_mfma_f32_16x16x32_bf16 a[28:31], a[148:151], a[124:127], a[28:31]
v_mfma_f32_16x16x32_bf16 a[24:27], a[148:151], a[120:123], a[24:27]
v_mfma_f32_16x16x32_bf16 a[20:23], a[148:151], a[116:119], a[20:23]
v_mfma_f32_16x16x32_bf16 a[16:19], a[148:151], a[112:115], a[16:19]
ds_read_b128 v[44:47], v60 offset:64
ds_read_b128 v[48:51], v60 offset:576
s_waitcnt lgkmcnt(3)
v_pk_fma_f32 v[64:65], v[36:37], v[20:21], v[64:65] op_sel_hi:[1,0,1]
v_pk_fma_f32 v[66:67], v[38:39], v[20:21], v[66:67] op_sel_hi:[1,0,1]
v_pk_fma_f32 v[68:69], v[36:37], v[24:25], v[68:69] op_sel_hi:[1,0,1]
v_pk_fma_f32 v[70:71], v[38:39], v[24:25], v[70:71] op_sel_hi:[1,0,1]
v_pk_mul_f32 v[52:53], v[64:65], v[64:65]
v_pk_mul_f32 v[54:55], v[66:67], v[66:67]
s_add_u32 m0, s7, 32768
s_add_u32 s44, s98, 1376256
buffer_load_dwordx4 v6, s[28:31], s44 offen lds
v_pk_mul_f32 v[56:57], v[68:69], v[68:69]
v_pk_mul_f32 v[58:59], v[70:71], v[70:71]
v_pk_fma_f32 v[52:53], v[52:53], v[22:23], v[22:23] op_sel:[0,1,0] op_sel_hi:[1,1,0]
v_pk_fma_f32 v[54:55], v[54:55], v[22:23], v[22:23] op_sel:[0,1,0] op_sel_hi:[1,1,0]
v_pk_fma_f32 v[56:57], v[56:57], v[26:27], v[26:27] op_sel:[0,1,0] op_sel_hi:[1,1,0]
v_pk_fma_f32 v[58:59], v[58:59], v[26:27], v[26:27] op_sel:[0,1,0] op_sel_hi:[1,1,0]
v_pk_mul_f32 v[52:53], v[64:65], v[52:53]
v_pk_mul_f32 v[54:55], v[66:67], v[54:55]
v_pk_mul_f32 v[56:57], v[68:69], v[56:57]
v_pk_mul_f32 v[58:59], v[70:71], v[58:59]
v_exp_f32 v52, v52
v_exp_f32 v53, v53
v_exp_f32 v54, v54
v_exp_f32 v55, v55
v_exp_f32 v56, v56
v_exp_f32 v57, v57
v_exp_f32 v58, v58
v_exp_f32 v59, v59
s_add_u32 m0, s7, 33792
s_nop 0
buffer_load_dwordx4 v7, s[28:31], s44 offen lds
s_waitcnt lgkmcnt(2)
v_pk_fma_f32 v[80:81], v[40:41], v[20:21], v[80:81] op_sel_hi:[1,0,1]
v_pk_fma_f32 v[82:83], v[42:43], v[20:21], v[82:83] op_sel_hi:[1,0,1]
v_pk_fma_f32 v[84:85], v[40:41], v[24:25], v[84:85] op_sel_hi:[1,0,1]
v_pk_fma_f32 v[86:87], v[42:43], v[24:25], v[86:87] op_sel_hi:[1,0,1]
v_pk_fma_f32 v[52:53], v[52:53], v[20:21], v[20:21] op_sel:[0,1,1] op_sel_hi:[1,1,1]
v_pk_fma_f32 v[54:55], v[54:55], v[20:21], v[20:21] op_sel:[0,1,1] op_sel_hi:[1,1,1]
v_pk_fma_f32 v[56:57], v[56:57], v[24:25], v[24:25] op_sel:[0,1,1] op_sel_hi:[1,1,1]
v_pk_fma_f32 v[58:59], v[58:59], v[24:25], v[24:25] op_sel:[0,1,1] op_sel_hi:[1,1,1]
v_rcp_f32 v52, v52
v_rcp_f32 v53, v53
v_rcp_f32 v54, v54
v_rcp_f32 v55, v55
v_rcp_f32 v56, v56
v_rcp_f32 v57, v57
v_rcp_f32 v58, v58
v_rcp_f32 v59, v59
v_pk_mul_f32 v[64:65], v[64:65], v[80:81]
v_pk_mul_f32 v[66:67], v[66:67], v[82:83]
s_add_u32 m0, s7, 34816
s_add_u32 s44, s98, 1392640
buffer_load_dwordx4 v6, s[28:31], s44 offen lds
v_pk_mul_f32 v[68:69], v[68:69], v[84:85]
v_pk_mul_f32 v[70:71], v[70:71], v[86:87]
v_pk_mul_f32 v[64:65], v[64:65], v[52:53]
v_pk_mul_f32 v[66:67], v[66:67], v[54:55]
v_pk_mul_f32 v[68:69], v[68:69], v[56:57]
v_pk_mul_f32 v[70:71], v[70:71], v[58:59]
v_cvt_pk_bf16_f32 v80, v64, v65
v_cvt_pk_bf16_f32 v81, v66, v67
v_cvt_pk_bf16_f32 v84, v68, v69
v_cvt_pk_bf16_f32 v85, v70, v71
v_pk_fma_f32 v[72:73], v[36:37], v[28:29], v[72:73] op_sel_hi:[1,0,1]
v_pk_fma_f32 v[74:75], v[38:39], v[28:29], v[74:75] op_sel_hi:[1,0,1]
v_pk_fma_f32 v[76:77], v[36:37], v[32:33], v[76:77] op_sel_hi:[1,0,1]
v_pk_fma_f32 v[78:79], v[38:39], v[32:33], v[78:79] op_sel_hi:[1,0,1]
v_pk_mul_f32 v[52:53], v[72:73], v[72:73]
v_pk_mul_f32 v[54:55], v[74:75], v[74:75]
v_pk_mul_f32 v[56:57], v[76:77], v[76:77]
s_add_u32 m0, s7, 35840
s_nop 0
buffer_load_dwordx4 v7, s[28:31], s44 offen lds
v_pk_mul_f32 v[58:59], v[78:79], v[78:79]
v_pk_fma_f32 v[52:53], v[52:53], v[30:31], v[30:31] op_sel:[0,1,0] op_sel_hi:[1,1,0]
v_pk_fma_f32 v[54:55], v[54:55], v[30:31], v[30:31] op_sel:[0,1,0] op_sel_hi:[1,1,0]
v_pk_fma_f32 v[56:57], v[56:57], v[34:35], v[34:35] op_sel:[0,1,0] op_sel_hi:[1,1,0]
v_pk_fma_f32 v[58:59], v[58:59], v[34:35], v[34:35] op_sel:[0,1,0] op_sel_hi:[1,1,0]
v_pk_mul_f32 v[52:53], v[72:73], v[52:53]
v_pk_mul_f32 v[54:55], v[74:75], v[54:55]
v_pk_mul_f32 v[56:57], v[76:77], v[56:57]
v_pk_mul_f32 v[58:59], v[78:79], v[58:59]
v_exp_f32 v52, v52
v_exp_f32 v53, v53
v_exp_f32 v54, v54
v_exp_f32 v55, v55
v_exp_f32 v56, v56
v_exp_f32 v57, v57
v_exp_f32 v58, v58
v_exp_f32_e64 v59, v59
v_pk_fma_f32 v[88:89], v[40:41], v[28:29], v[88:89] op_sel_hi:[1,0,1]
s_add_u32 m0, s7, 49152
s_add_u32 s44, s98, 65536
buffer_load_dwordx4 v6, s[28:31], s44 offen lds
v_pk_fma_f32 v[90:91], v[42:43], v[28:29], v[90:91] op_sel_hi:[1,0,1]
v_pk_fma_f32 v[92:93], v[40:41], v[32:33], v[92:93] op_sel_hi:[1,0,1]
v_pk_fma_f32 v[94:95], v[42:43], v[32:33], v[94:95] op_sel_hi:[1,0,1]
v_pk_fma_f32 v[52:53], v[52:53], v[28:29], v[28:29] op_sel:[0,1,1] op_sel_hi:[1,1,1]
L_pg10:
s_cbranch_execz L_ret0
v_pk_fma_f32 v[54:55], v[54:55], v[28:29], v[28:29] op_sel:[0,1,1] op_sel_hi:[1,1,1]
v_pk_fma_f32 v[56:57], v[56:57], v[32:33], v[32:33] op_sel:[0,1,1] op_sel_hi:[1,1,1]
v_pk_fma_f32 v[58:59], v[58:59], v[32:33], v[32:33] op_sel:[0,1,1] op_sel_hi:[1,1,1]
v_rcp_f32 v52, v52
v_rcp_f32 v53, v53
v_rcp_f32 v54, v54
v_rcp_f32 v55, v55
v_rcp_f32 v56, v56
v_rcp_f32 v57, v57
v_rcp_f32 v58, v58
v_rcp_f32_e64 v59, v59
v_pk_mul_f32 v[72:73], v[72:73], v[88:89]
v_pk_mul_f32 v[74:75], v[74:75], v[90:91]
v_pk_mul_f32 v[76:77], v[76:77], v[92:93]
s_add_u32 m0, s7, 50176
s_nop 0
buffer_load_dwordx4 v7, s[28:31], s44 offen lds
v_pk_mul_f32 v[78:79], v[78:79], v[94:95]
v_pk_mul_f32 v[72:73], v[72:73], v[52:53]
v_pk_mul_f32 v[74:75], v[74:75], v[54:55]
v_pk_mul_f32 v[76:77], v[76:77], v[56:57]
v_pk_mul_f32 v[78:79], v[78:79], v[58:59]
v_cvt_pk_bf16_f32 v88, v72, v73
v_cvt_pk_bf16_f32 v89, v74, v75
v_cvt_pk_bf16_f32 v92, v76, v77
v_cvt_pk_bf16_f32 v93, v78, v79
ds_read_b128 v[36:39], v60 offset:128
ds_read_b128 v[40:43], v60 offset:640
s_waitcnt lgkmcnt(3)
v_pk_fma_f32 v[96:97], v[44:45], v[20:21], v[96:97] op_sel_hi:[1,0,1]
v_pk_fma_f32 v[98:99], v[46:47], v[20:21], v[98:99] op_sel_hi:[1,0,1]
v_pk_fma_f32 v[100:101], v[44:45], v[24:25], v[100:101] op_sel_hi:[1,0,1]
v_pk_fma_f32 v[102:103], v[46:47], v[24:25], v[102:103] op_sel_hi:[1,0,1]
v_pk_mul_f32 v[52:53], v[96:97], v[96:97]
v_pk_mul_f32 v[54:55], v[98:99], v[98:99]
s_add_u32 m0, s7, 51200
s_add_u32 s44, s98, 81920
buffer_load_dwordx4 v6, s[28:31], s44 offen lds
v_pk_mul_f32 v[56:57], v[100:101], v[100:101]
v_pk_mul_f32 v[58:59], v[102:103], v[102:103]
v_pk_fma_f32 v[52:53], v[52:53], v[22:23], v[22:23] op_sel:[0,1,0] op_sel_hi:[1,1,0]
v_pk_fma_f32 v[54:55], v[54:55], v[22:23], v[22:23] op_sel:[0,1,0] op_sel_hi:[1,1,0]
v_pk_fma_f32 v[56:57], v[56:57], v[26:27], v[26:27] op_sel:[0,1,0] op_sel_hi:[1,1,0]
v_pk_fma_f32 v[58:59], v[58:59], v[26:27], v[26:27] op_sel:[0,1,0] op_sel_hi:[1,1,0]
v_pk_mul_f32 v[52:53], v[96:97], v[52:53]
v_pk_mul_f32 v[54:55], v[98:99], v[54:55]
v_pk_mul_f32 v[56:57], v[100:101], v[56:57]
v_pk_mul_f32 v[58:59], v[102:103], v[58:59]
v_exp_f32 v52, v52
v_exp_f32 v53, v53
v_exp_f32 v54, v54
v_exp_f32 v55, v55
v_exp_f32 v56, v56
v_exp_f32 v57, v57
v_exp_f32 v58, v58
v_exp_f32 v59, v59
s_add_u32 m0, s7, 52224
s_nop 0
buffer_load_dwordx4 v7, s[28:31], s44 offen lds
s_waitcnt lgkmcnt(2)
v_pk_fma_f32 v[112:113], v[48:49], v[20:21], v[112:113] op_sel_hi:[1,0,1]
v_pk_fma_f32 v[114:115], v[50:51], v[20:21], v[114:115] op_sel_hi:[1,0,1]
v_pk_fma_f32 v[116:117], v[48:49], v[24:25], v[116:117] op_sel_hi:[1,0,1]
v_pk_fma_f32 v[118:119], v[50:51], v[24:25], v[118:119] op_sel_hi:[1,0,1]
v_pk_fma_f32 v[52:53], v[52:53], v[20:21], v[20:21] op_sel:[0,1,1] op_sel_hi:[1,1,1]
v_pk_fma_f32 v[54:55], v[54:55], v[20:21], v[20:21] op_sel:[0,1,1] op_sel_hi:[1,1,1]
v_pk_fma_f32 v[56:57], v[56:57], v[24:25], v[24:25] op_sel:[0,1,1] op_sel_hi:[1,1,1]
v_pk_fma_f32 v[58:59], v[58:59], v[24:25], v[24:25] op_sel:[0,1,1] op_sel_hi:[1,1,1]
v_rcp_f32 v52, v52
v_rcp_f32 v53, v53
v_rcp_f32 v54, v54
v_rcp_f32 v55, v55
v_rcp_f32 v56, v56
v_rcp_f32 v57, v57
v_rcp_f32 v58, v58
v_rcp_f32 v59, v59
v_pk_mul_f32 v[96:97], v[96:97], v[112:113]
v_pk_mul_f32 v[98:99], v[98:99], v[114:115]
s_add_u32 m0, s7, 81920
s_add_u32 s44, s98, 524288
buffer_load_dwordx4 v6, s[28:31], s44 offen lds
v_pk_mul_f32 v[100:101], v[100:101], v[116:117]
v_pk_mul_f32 v[102:103], v[102:103], v[118:119]
v_pk_mul_f32 v[96:97], v[96:97], v[52:53]
v_pk_mul_f32 v[98:99], v[98:99], v[54:55]
v_pk_mul_f32 v[100:101], v[100:101], v[56:57]
v_pk_mul_f32 v[102:103], v[102:103], v[58:59]
v_cvt_pk_bf16_f32 v82, v96, v97
v_cvt_pk_bf16_f32 v83, v98, v99
v_cvt_pk_bf16_f32 v86, v100, v101
v_cvt_pk_bf16_f32 v87, v102, v103
v_pk_fma_f32 v[104:105], v[44:45], v[28:29], v[104:105] op_sel_hi:[1,0,1]
v_pk_fma_f32 v[106:107], v[46:47], v[28:29], v[106:107] op_sel_hi:[1,0,1]
v_pk_fma_f32 v[108:109], v[44:45], v[32:33], v[108:109] op_sel_hi:[1,0,1]
v_pk_fma_f32 v[110:111], v[46:47], v[32:33], v[110:111] op_sel_hi:[1,0,1]
v_pk_mul_f32 v[52:53], v[104:105], v[104:105]
v_pk_mul_f32 v[54:55], v[106:107], v[106:107]
v_pk_mul_f32 v[56:57], v[108:109], v[108:109]
s_add_u32 m0, s7, 82944
s_nop 0
buffer_load_dwordx4 v7, s[28:31], s44 offen lds
v_pk_mul_f32 v[58:59], v[110:111], v[110:111]
v_pk_fma_f32 v[52:53], v[52:53], v[30:31], v[30:31] op_sel:[0,1,0] op_sel_hi:[1,1,0]
v_pk_fma_f32 v[54:55], v[54:55], v[30:31], v[30:31] op_sel:[0,1,0] op_sel_hi:[1,1,0]
v_pk_fma_f32 v[56:57], v[56:57], v[34:35], v[34:35] op_sel:[0,1,0] op_sel_hi:[1,1,0]
v_pk_fma_f32 v[58:59], v[58:59], v[34:35], v[34:35] op_sel:[0,1,0] op_sel_hi:[1,1,0]
v_pk_mul_f32 v[52:53], v[104:105], v[52:53]
v_pk_mul_f32 v[54:55], v[106:107], v[54:55]
v_pk_mul_f32 v[56:57], v[108:109], v[56:57]
v_pk_mul_f32 v[58:59], v[110:111], v[58:59]
v_exp_f32 v52, v52
v_exp_f32 v53, v53
v_exp_f32 v54, v54
v_exp_f32 v55, v55
v_exp_f32 v56, v56
v_exp_f32 v57, v57
v_exp_f32 v58, v58
v_exp_f32_e64 v59, v59
v_pk_fma_f32 v[120:121], v[48:49], v[28:29], v[120:121] op_sel_hi:[1,0,1]
s_add_u32 m0, s7, 83968
s_add_u32 s44, s98, 540672
buffer_load_dwordx4 v6, s[28:31], s44 offen lds
v_pk_fma_f32 v[122:123], v[50:51], v[28:29], v[122:123] op_sel_hi:[1,0,1]
v_pk_fma_f32 v[124:125], v[48:49], v[32:33], v[124:125] op_sel_hi:[1,0,1]
v_pk_fma_f32 v[126:127], v[50:51], v[32:33], v[126:127] op_sel_hi:[1,0,1]
v_pk_fma_f32 v[52:53], v[52:53], v[28:29], v[28:29] op_sel:[0,1,1] op_sel_hi:[1,1,1]
v_pk_fma_f32 v[54:55], v[54:55], v[28:29], v[28:29] op_sel:[0,1,1] op_sel_hi:[1,1,1]
v_pk_fma_f32 v[56:57], v[56:57], v[32:33], v[32:33] op_sel:[0,1,1] op_sel_hi:[1,1,1]
v_pk_fma_f32 v[58:59], v[58:59], v[32:33], v[32:33] op_sel:[0,1,1] op_sel_hi:[1,1,1]
v_rcp_f32 v52, v52
v_rcp_f32 v53, v53
v_rcp_f32 v54, v54
v_rcp_f32 v55, v55
v_rcp_f32 v56, v56
v_rcp_f32 v57, v57
v_rcp_f32 v58, v58
v_rcp_f32 v59, v59
v_pk_mul_f32 v[104:105], v[104:105], v[120:121]
v_pk_mul_f32 v[106:107], v[106:107], v[122:123]
v_pk_mul_f32 v[108:109], v[108:109], v[124:125]
s_add_u32 m0, s7, 84992
s_nop 0
buffer_load_dwordx4 v7, s[28:31], s44 offen lds
v_pk_mul_f32 v[110:111], v[110:111], v[126:127]
v_pk_mul_f32 v[104:105], v[104:105], v[52:53]
v_pk_mul_f32 v[106:107], v[106:107], v[54:55]
v_pk_mul_f32 v[108:109], v[108:109], v[56:57]
v_pk_mul_f32 v[110:111], v[110:111], v[58:59]
v_cvt_pk_bf16_f32 v90, v104, v105
v_cvt_pk_bf16_f32 v91, v106, v107
v_cvt_pk_bf16_f32 v94, v108, v109
v_cvt_pk_bf16_f32 v95, v110, v111
ds_read_b128 v[44:47], v60 offset:192
ds_read_b128 v[48:51], v60 offset:704
s_waitcnt lgkmcnt(3)
v_pk_fma_f32 v[128:129], v[36:37], v[20:21], v[128:129] op_sel_hi:[1,0,1]
v_pk_fma_f32 v[130:131], v[38:39], v[20:21], v[130:131] op_sel_hi:[1,0,1]
v_pk_fma_f32 v[132:133], v[36:37], v[24:25], v[132:133] op_sel_hi:[1,0,1]
v_pk_fma_f32 v[134:135], v[38:39], v[24:25], v[134:135] op_sel_hi:[1,0,1]
v_pk_mul_f32 v[52:53], v[128:129], v[128:129]
v_pk_mul_f32 v[54:55], v[130:131], v[130:131]
v_pk_mul_f32 v[56:57], v[132:133], v[132:133]
v_pk_mul_f32 v[58:59], v[134:135], v[134:135]
v_pk_fma_f32 v[52:53], v[52:53], v[22:23], v[22:23] op_sel:[0,1,0] op_sel_hi:[1,1,0]
v_pk_fma_f32 v[54:55], v[54:55], v[22:23], v[22:23] op_sel:[0,1,0] op_sel_hi:[1,1,0]
v_pk_fma_f32 v[56:57], v[56:57], v[26:27], v[26:27] op_sel:[0,1,0] op_sel_hi:[1,1,0]
v_pk_fma_f32 v[58:59], v[58:59], v[26:27], v[26:27] op_sel:[0,1,0] op_sel_hi:[1,1,0]
v_pk_mul_f32 v[52:53], v[128:129], v[52:53]
v_pk_mul_f32 v[54:55], v[130:131], v[54:55]
v_pk_mul_f32 v[56:57], v[132:133], v[56:57]
v_pk_mul_f32 v[58:59], v[134:135], v[58:59]
v_exp_f32 v52, v52
v_exp_f32 v53, v53
v_exp_f32 v54, v54
buffer_store_dwordx4 v[80:83], v61, s[20:23], s62 offen offset:0 sc1
v_exp_f32 v55, v55
v_exp_f32 v56, v56
v_exp_f32 v57, v57
v_exp_f32 v58, v58
v_exp_f32_e64 v59, v59
s_waitcnt lgkmcnt(2)
v_pk_fma_f32 v[144:145], v[40:41], v[20:21], v[144:145] op_sel_hi:[1,0,1]
v_pk_fma_f32 v[146:147], v[42:43], v[20:21], v[146:147] op_sel_hi:[1,0,1]
v_pk_fma_f32 v[148:149], v[40:41], v[24:25], v[148:149] op_sel_hi:[1,0,1]
v_pk_fma_f32 v[150:151], v[42:43], v[24:25], v[150:151] op_sel_hi:[1,0,1]
v_pk_fma_f32 v[52:53], v[52:53], v[20:21], v[20:21] op_sel:[0,1,1] op_sel_hi:[1,1,1]
v_pk_fma_f32 v[54:55], v[54:55], v[20:21], v[20:21] op_sel:[0,1,1] op_sel_hi:[1,1,1]
v_pk_fma_f32 v[56:57], v[56:57], v[24:25], v[24:25] op_sel:[0,1,1] op_sel_hi:[1,1,1]
v_pk_fma_f32 v[58:59], v[58:59], v[24:25], v[24:25] op_sel:[0,1,1] op_sel_hi:[1,1,1]
v_rcp_f32 v52, v52
v_rcp_f32 v53, v53
v_rcp_f32 v54, v54
v_rcp_f32 v55, v55
v_rcp_f32 v56, v56
v_rcp_f32 v57, v57
v_rcp_f32 v58, v58
v_rcp_f32 v59, v59
v_pk_mul_f32 v[128:129], v[128:129], v[144:145]
v_pk_mul_f32 v[130:131], v[130:131], v[146:147]
v_pk_mul_f32 v[132:133], v[132:133], v[148:149]
v_pk_mul_f32 v[134:135], v[134:135], v[150:151]
v_pk_mul_f32 v[128:129], v[128:129], v[52:53]
v_pk_mul_f32 v[130:131], v[130:131], v[54:55]
v_pk_mul_f32 v[132:133], v[132:133], v[56:57]
v_pk_mul_f32 v[134:135], v[134:135], v[58:59]
v_cvt_pk_bf16_f32 v144, v128, v129
v_cvt_pk_bf16_f32 v145, v130, v131
v_cvt_pk_bf16_f32 v148, v132, v133
v_cvt_pk_bf16_f32 v149, v134, v135
v_pk_fma_f32 v[136:137], v[36:37], v[28:29], v[136:137] op_sel_hi:[1,0,1]
v_pk_fma_f32 v[138:139], v[38:39], v[28:29], v[138:139] op_sel_hi:[1,0,1]
v_pk_fma_f32 v[140:141], v[36:37], v[32:33], v[140:141] op_sel_hi:[1,0,1]
v_pk_fma_f32 v[142:143], v[38:39], v[32:33], v[142:143] op_sel_hi:[1,0,1]
v_pk_mul_f32 v[52:53], v[136:137], v[136:137]
v_pk_mul_f32 v[54:55], v[138:139], v[138:139]
v_pk_mul_f32 v[56:57], v[140:141], v[140:141]
v_pk_mul_f32 v[58:59], v[142:143], v[142:143]
v_pk_fma_f32 v[52:53], v[52:53], v[30:31], v[30:31] op_sel:[0,1,0] op_sel_hi:[1,1,0]
buffer_store_dwordx4 v[84:87], v61, s[20:23], s62 offen offset:1024 sc1
v_pk_fma_f32 v[54:55], v[54:55], v[30:31], v[30:31] op_sel:[0,1,0] op_sel_hi:[1,1,0]
v_pk_fma_f32 v[56:57], v[56:57], v[34:35], v[34:35] op_sel:[0,1,0] op_sel_hi:[1,1,0]
v_pk_fma_f32 v[58:59], v[58:59], v[34:35], v[34:35] op_sel:[0,1,0] op_sel_hi:[1,1,0]
v_pk_mul_f32 v[52:53], v[136:137], v[52:53]
v_pk_mul_f32 v[54:55], v[138:139], v[54:55]
v_pk_mul_f32 v[56:57], v[140:141], v[56:57]
v_pk_mul_f32 v[58:59], v[142:143], v[58:59]
v_exp_f32 v52, v52
v_exp_f32 v53, v53
v_exp_f32 v54, v54
v_exp_f32 v55, v55
v_exp_f32 v56, v56
v_exp_f32 v57, v57
v_exp_f32 v58, v58
v_exp_f32 v59, v59
v_pk_fma_f32 v[152:153], v[40:41], v[28:29], v[152:153] op_sel_hi:[1,0,1]
v_pk_fma_f32 v[154:155], v[42:43], v[28:29], v[154:155] op_sel_hi:[1,0,1]
v_pk_fma_f32 v[156:157], v[40:41], v[32:33], v[156:157] op_sel_hi:[1,0,1]
v_pk_fma_f32 v[158:159], v[42:43], v[32:33], v[158:159] op_sel_hi:[1,0,1]
v_pk_fma_f32 v[52:53], v[52:53], v[28:29], v[28:29] op_sel:[0,1,1] op_sel_hi:[1,1,1]
v_pk_fma_f32 v[54:55], v[54:55], v[28:29], v[28:29] op_sel:[0,1,1] op_sel_hi:[1,1,1]
v_pk_fma_f32 v[56:57], v[56:57], v[32:33], v[32:33] op_sel:[0,1,1] op_sel_hi:[1,1,1]
v_pk_fma_f32 v[58:59], v[58:59], v[32:33], v[32:33] op_sel:[0,1,1] op_sel_hi:[1,1,1]
v_rcp_f32 v52, v52
v_rcp_f32 v53, v53
v_rcp_f32 v54, v54
v_rcp_f32 v55, v55
v_rcp_f32 v56, v56
v_rcp_f32 v57, v57
v_rcp_f32 v58, v58
v_rcp_f32 v59, v59
v_pk_mul_f32 v[136:137], v[136:137], v[152:153]
v_pk_mul_f32 v[138:139], v[138:139], v[154:155]
v_pk_mul_f32 v[140:141], v[140:141], v[156:157]
v_pk_mul_f32 v[142:143], v[142:143], v[158:159]
v_pk_mul_f32 v[136:137], v[136:137], v[52:53]
v_pk_mul_f32 v[138:139], v[138:139], v[54:55]
v_pk_mul_f32 v[140:141], v[140:141], v[56:57]
v_pk_mul_f32 v[142:143], v[142:143], v[58:59]
v_cvt_pk_bf16_f32 v152, v136, v137
v_cvt_pk_bf16_f32 v153, v138, v139
v_cvt_pk_bf16_f32 v156, v140, v141
v_cvt_pk_bf16_f32 v157, v142, v143
buffer_store_dwordx4 v[88:91], v61, s[20:23], s62 offen offset:2048 sc1
ds_read_b128 v[36:39], v60 offset:256
ds_read_b128 v[40:43], v60 offset:768
s_waitcnt lgkmcnt(3)
v_pk_fma_f32 v[160:161], v[44:45], v[20:21], v[160:161] op_sel_hi:[1,0,1]
v_pk_fma_f32 v[162:163], v[46:47], v[20:21], v[162:163] op_sel_hi:[1,0,1]
v_pk_fma_f32 v[164:165], v[44:45], v[24:25], v[164:165] op_sel_hi:[1,0,1]
v_pk_fma_f32 v[166:167], v[46:47], v[24:25], v[166:167] op_sel_hi:[1,0,1]
v_pk_mul_f32 v[52:53], v[160:161], v[160:161]
v_pk_mul_f32 v[54:55], v[162:163], v[162:163]
v_pk_mul_f32 v[56:57], v[164:165], v[164:165]
v_pk_mul_f32 v[58:59], v[166:167], v[166:167]
v_pk_fma_f32 v[52:53], v[52:53], v[22:23], v[22:23] op_sel:[0,1,0] op_sel_hi:[1,1,0]
v_pk_fma_f32 v[54:55], v[54:55], v[22:23], v[22:23] op_sel:[0,1,0] op_sel_hi:[1,1,0]
v_pk_fma_f32 v[56:57], v[56:57], v[26:27], v[26:27] op_sel:[0,1,0] op_sel_hi:[1,1,0]
v_pk_fma_f32 v[58:59], v[58:59], v[26:27], v[26:27] op_sel:[0,1,0] op_sel_hi:[1,1,0]
v_pk_mul_f32 v[52:53], v[160:161], v[52:53]
v_pk_mul_f32 v[54:55], v[162:163], v[54:55]
v_pk_mul_f32 v[56:57], v[164:165], v[56:57]
v_pk_mul_f32 v[58:59], v[166:167], v[58:59]
v_exp_f32 v52, v52
v_exp_f32 v53, v53
v_exp_f32 v54, v54
v_exp_f32 v55, v55
v_exp_f32 v56, v56
v_exp_f32 v57, v57
v_exp_f32 v58, v58
v_exp_f32 v59, v59
s_waitcnt lgkmcnt(2)
v_pk_fma_f32 v[176:177], v[48:49], v[20:21], v[176:177] op_sel_hi:[1,0,1]
v_pk_fma_f32 v[178:179], v[50:51], v[20:21], v[178:179] op_sel_hi:[1,0,1]
v_pk_fma_f32 v[180:181], v[48:49], v[24:25], v[180:181] op_sel_hi:[1,0,1]
v_pk_fma_f32 v[182:183], v[50:51], v[24:25], v[182:183] op_sel_hi:[1,0,1]
v_pk_fma_f32 v[52:53], v[52:53], v[20:21], v[20:21] op_sel:[0,1,1] op_sel_hi:[1,1,1]
v_pk_fma_f32 v[54:55], v[54:55], v[20:21], v[20:21] op_sel:[0,1,1] op_sel_hi:[1,1,1]
v_pk_fma_f32 v[56:57], v[56:57], v[24:25], v[24:25] op_sel:[0,1,1] op_sel_hi:[1,1,1]
v_pk_fma_f32 v[58:59], v[58:59], v[24:25], v[24:25] op_sel:[0,1,1] op_sel_hi:[1,1,1]
v_rcp_f32 v52, v52
v_rcp_f32 v53, v53
v_rcp_f32 v54, v54
v_rcp_f32 v55, v55
v_rcp_f32 v56, v56
v_rcp_f32 v57, v57
v_rcp_f32 v58, v58
v_rcp_f32 v59, v59
buffer_store_dwordx4 v[92:95], v61, s[20:23], s62 offen offset:3072 sc1
s_add_u32 s62, s62, 32768
v_pk_mul_f32 v[160:161], v[160:161], v[176:177]
v_pk_mul_f32 v[162:163], v[162:163], v[178:179]
v_pk_mul_f32 v[164:165], v[164:165], v[180:181]
v_pk_mul_f32 v[166:167], v[166:167], v[182:183]
v_pk_mul_f32 v[160:161], v[160:161], v[52:53]
v_pk_mul_f32 v[162:163], v[162:163], v[54:55]
v_pk_mul_f32 v[164:165], v[164:165], v[56:57]
v_pk_mul_f32 v[166:167], v[166:167], v[58:59]
v_cvt_pk_bf16_f32 v146, v160, v161
v_cvt_pk_bf16_f32 v147, v162, v163
v_cvt_pk_bf16_f32 v150, v164, v165
v_cvt_pk_bf16_f32 v151, v166, v167
v_pk_fma_f32 v[168:169], v[44:45], v[28:29], v[168:169] op_sel_hi:[1,0,1]
v_pk_fma_f32 v[170:171], v[46:47], v[28:29], v[170:171] op_sel_hi:[1,0,1]
v_pk_fma_f32 v[172:173], v[44:45], v[32:33], v[172:173] op_sel_hi:[1,0,1]
v_pk_fma_f32 v[174:175], v[46:47], v[32:33], v[174:175] op_sel_hi:[1,0,1]
v_pk_mul_f32 v[52:53], v[168:169], v[168:169]
v_pk_mul_f32 v[54:55], v[170:171], v[170:171]
v_pk_mul_f32 v[56:57], v[172:173], v[172:173]
v_pk_mul_f32 v[58:59], v[174:175], v[174:175]
v_pk_fma_f32 v[52:53], v[52:53], v[30:31], v[30:31] op_sel:[0,1,0] op_sel_hi:[1,1,0]
v_pk_fma_f32 v[54:55], v[54:55], v[30:31], v[30:31] op_sel:[0,1,0] op_sel_hi:[1,1,0]
v_pk_fma_f32 v[56:57], v[56:57], v[34:35], v[34:35] op_sel:[0,1,0] op_sel_hi:[1,1,0]
v_pk_fma_f32 v[58:59], v[58:59], v[34:35], v[34:35] op_sel:[0,1,0] op_sel_hi:[1,1,0]
v_pk_mul_f32 v[52:53], v[168:169], v[52:53]
v_pk_mul_f32 v[54:55], v[170:171], v[54:55]
v_pk_mul_f32 v[56:57], v[172:173], v[56:57]
v_pk_mul_f32 v[58:59], v[174:175], v[58:59]
v_exp_f32 v52, v52
v_exp_f32 v53, v53
v_exp_f32 v54, v54
v_exp_f32 v55, v55
v_exp_f32 v56, v56
v_exp_f32 v57, v57
v_exp_f32 v58, v58
v_exp_f32 v59, v59
v_pk_fma_f32 v[184:185], v[48:49], v[28:29], v[184:185] op_sel_hi:[1,0,1]
v_pk_fma_f32 v[186:187], v[50:51], v[28:29], v[186:187] op_sel_hi:[1,0,1]
v_pk_fma_f32 v[188:189], v[48:49], v[32:33], v[188:189] op_sel_hi:[1,0,1]
v_pk_fma_f32 v[190:191], v[50:51], v[32:33], v[190:191] op_sel_hi:[1,0,1]
v_pk_fma_f32 v[52:53], v[52:53], v[28:29], v[28:29] op_sel:[0,1,1] op_sel_hi:[1,1,1]
v_pk_fma_f32 v[54:55], v[54:55], v[28:29], v[28:29] op_sel:[0,1,1] op_sel_hi:[1,1,1]
buffer_store_dwordx4 v[144:147], v61, s[20:23], s62 offen offset:0 sc1
v_pk_fma_f32 v[56:57], v[56:57], v[32:33], v[32:33] op_sel:[0,1,1] op_sel_hi:[1,1,1]
v_pk_fma_f32 v[58:59], v[58:59], v[32:33], v[32:33] op_sel:[0,1,1] op_sel_hi:[1,1,1]
v_rcp_f32 v52, v52
v_rcp_f32 v53, v53
v_rcp_f32 v54, v54
v_rcp_f32 v55, v55
v_rcp_f32 v56, v56
v_rcp_f32 v57, v57
v_rcp_f32 v58, v58
v_rcp_f32 v59, v59
v_pk_mul_f32 v[168:169], v[168:169], v[184:185]
v_pk_mul_f32 v[170:171], v[170:171], v[186:187]
v_pk_mul_f32 v[172:173], v[172:173], v[188:189]
v_pk_mul_f32 v[174:175], v[174:175], v[190:191]
v_pk_mul_f32 v[168:169], v[168:169], v[52:53]
v_pk_mul_f32 v[170:171], v[170:171], v[54:55]
v_pk_mul_f32 v[172:173], v[172:173], v[56:57]
v_pk_mul_f32 v[174:175], v[174:175], v[58:59]
v_cvt_pk_bf16_f32 v154, v168, v169
v_cvt_pk_bf16_f32 v155, v170, v171
v_cvt_pk_bf16_f32 v158, v172, v173
v_cvt_pk_bf16_f32 v159, v174, v175
v_lshrrev_b32_e64 v14, 4, v1
v_lshl_add_u32 v13, v14, 7, s60
ds_read_b128 v[160:163], v13 offset:0
ds_read_b128 v[164:167], v13 offset:16
ds_read_b128 v[168:171], v13 offset:32
ds_read_b128 v[172:175], v13 offset:48
ds_read_b128 v[176:179], v13 offset:64
ds_read_b128 v[180:183], v13 offset:80
ds_read_b128 v[184:187], v13 offset:96
ds_read_b128 v[188:191], v13 offset:112
v_max_u32 v13, v4, v5
v_max3_u32 v13, v13, v18, v19
v_cmp_eq_u32 vcc, -1, v13
s_nop 1
s_cbranch_vccnz L_slow10
L_back11:
v_accvgpr_read_b32 v64, a32
v_accvgpr_read_b32 v65, a64
v_accvgpr_read_b32 v66, a36
v_accvgpr_read_b32 v67, a68
v_accvgpr_read_b32 v68, a40
v_accvgpr_read_b32 v69, a72
v_accvgpr_read_b32 v70, a44
v_accvgpr_read_b32 v71, a76
v_accvgpr_read_b32 v72, a33
v_accvgpr_read_b32 v73, a65
buffer_store_dwordx4 v[148:151], v61, s[20:23], s62 offen offset:1024 sc1
v_accvgpr_read_b32 v74, a37
v_accvgpr_read_b32 v75, a69
v_accvgpr_read_b32 v76, a41
v_accvgpr_read_b32 v77, a73
v_accvgpr_read_b32 v78, a45
v_accvgpr_read_b32 v79, a77
v_accvgpr_read_b32 v80, a34
v_accvgpr_read_b32 v81, a66
v_accvgpr_read_b32 v82, a38
v_accvgpr_read_b32 v83, a70
v_accvgpr_read_b32 v84, a42
v_accvgpr_read_b32 v85, a74
v_accvgpr_read_b32 v86, a46
v_accvgpr_read_b32 v87, a78
v_accvgpr_read_b32 v88, a35
v_accvgpr_read_b32 v89, a67
v_accvgpr_read_b32 v90, a39
v_accvgpr_read_b32 v91, a71
v_accvgpr_read_b32 v92, a43
v_accvgpr_read_b32 v93, a75
v_accvgpr_read_b32 v94, a47
v_accvgpr_read_b32 v95, a79
v_accvgpr_read_b32 v96, a48
v_accvgpr_read_b32 v97, a80
v_accvgpr_read_b32 v98, a52
v_accvgpr_read_b32 v99, a84
v_accvgpr_read_b32 v100, a56
v_accvgpr_read_b32 v101, a88
v_accvgpr_read_b32 v102, a60
v_accvgpr_read_b32 v103, a92
v_accvgpr_read_b32 v104, a49
v_accvgpr_read_b32 v105, a81
v_accvgpr_read_b32 v106, a53
v_accvgpr_read_b32 v107, a85
v_accvgpr_read_b32 v108, a57
v_accvgpr_read_b32 v109, a89
v_accvgpr_read_b32 v110, a61
v_accvgpr_read_b32 v111, a93
v_accvgpr_read_b32 v112, a50
v_accvgpr_read_b32 v113, a82
v_accvgpr_read_b32 v114, a54
v_accvgpr_read_b32 v115, a86
v_accvgpr_read_b32 v116, a58
v_accvgpr_read_b32 v117, a90
v_accvgpr_read_b32 v118, a62
v_accvgpr_read_b32 v119, a94
v_accvgpr_read_b32 v120, a51
v_accvgpr_read_b32 v121, a83
v_accvgpr_read_b32 v122, a55
v_accvgpr_read_b32 v123, a87
v_accvgpr_read_b32 v124, a59
v_accvgpr_read_b32 v125, a91
buffer_store_dwordx4 v[152:155], v61, s[20:23], s62 offen offset:2048 sc1
v_accvgpr_read_b32 v126, a63
v_accvgpr_read_b32 v127, a95
v_accvgpr_read_b32 v128, a192
v_accvgpr_read_b32 v129, a193
v_accvgpr_read_b32 v130, a208
v_accvgpr_read_b32 v131, a209
v_accvgpr_read_b32 v132, a196
v_accvgpr_read_b32 v133, a197
v_accvgpr_read_b32 v134, a212
v_accvgpr_read_b32 v135, a213
v_accvgpr_read_b32 v136, a198
v_accvgpr_read_b32 v137, a199
v_accvgpr_read_b32 v138, a214
v_accvgpr_read_b32 v139, a215
v_accvgpr_read_b32 v140, a206
v_accvgpr_read_b32 v141, a207
v_accvgpr_read_b32 v142, a222
v_accvgpr_read_b32 v143, a223
s_waitcnt lgkmcnt(7)
v_pk_fma_f32 v[64:65], v[4:5], v[160:161], v[64:65] op_sel_hi:[1,0,1]
v_pk_fma_f32 v[96:97], v[18:19], v[160:161], v[96:97] op_sel_hi:[1,0,1]
v_pk_fma_f32 v[66:67], v[4:5], v[162:163], v[66:67] op_sel_hi:[1,0,1]
v_pk_fma_f32 v[98:99], v[18:19], v[162:163], v[98:99] op_sel_hi:[1,0,1]
s_waitcnt lgkmcnt(6)
v_pk_fma_f32 v[68:69], v[4:5], v[164:165], v[68:69] op_sel_hi:[1,0,1]
v_pk_fma_f32 v[100:101], v[18:19], v[164:165], v[100:101] op_sel_hi:[1,0,1]
v_pk_fma_f32 v[70:71], v[4:5], v[166:167], v[70:71] op_sel_hi:[1,0,1]
v_pk_fma_f32 v[102:103], v[18:19], v[166:167], v[102:103] op_sel_hi:[1,0,1]
s_waitcnt lgkmcnt(5)
v_pk_fma_f32 v[72:73], v[4:5], v[168:169], v[72:73] op_sel_hi:[1,0,1]
v_pk_fma_f32 v[104:105], v[18:19], v[168:169], v[104:105] op_sel_hi:[1,0,1]
v_pk_fma_f32 v[74:75], v[4:5], v[170:171], v[74:75] op_sel_hi:[1,0,1]
v_pk_fma_f32 v[106:107], v[18:19], v[170:171], v[106:107] op_sel_hi:[1,0,1]
s_waitcnt lgkmcnt(4)
v_pk_fma_f32 v[76:77], v[4:5], v[172:173], v[76:77] op_sel_hi:[1,0,1]
v_pk_fma_f32 v[108:109], v[18:19], v[172:173], v[108:109] op_sel_hi:[1,0,1]
v_pk_fma_f32 v[78:79], v[4:5], v[174:175], v[78:79] op_sel_hi:[1,0,1]
v_pk_fma_f32 v[110:111], v[18:19], v[174:175], v[110:111] op_sel_hi:[1,0,1]
s_waitcnt lgkmcnt(3)
v_pk_fma_f32 v[80:81], v[4:5], v[176:177], v[80:81] op_sel_hi:[1,0,1]
v_pk_fma_f32 v[112:113], v[18:19], v[176:177], v[112:113] op_sel_hi:[1,0,1]
v_pk_fma_f32 v[82:83], v[4:5], v[178:179], v[82:83] op_sel_hi:[1,0,1]
v_pk_fma_f32 v[114:115], v[18:19], v[178:179], v[114:115] op_sel_hi:[1,0,1]
s_waitcnt lgkmcnt(2)
v_pk_fma_f32 v[84:85], v[4:5], v[180:181], v[84:85] op_sel_hi:[1,0,1]
v_pk_fma_f32 v[116:117], v[18:19], v[180:181], v[116:117] op_sel_hi:[1,0,1]
v_pk_fma_f32 v[86:87], v[4:5], v[182:183], v[86:87] op_sel_hi:[1,0,1]
v_pk_fma_f32 v[118:119], v[18:19], v[182:183], v[118:119] op_sel_hi:[1,0,1]
s_waitcnt lgkmcnt(1)
v_pk_fma_f32 v[88:89], v[4:5], v[184:185], v[88:89] op_sel_hi:[1,0,1]
v_pk_fma_f32 v[120:121], v[18:19], v[184:185], v[120:121] op_sel_hi:[1,0,1]
v_pk_fma_f32 v[90:91], v[4:5], v[186:187], v[90:91] op_sel_hi:[1,0,1]
v_pk_fma_f32 v[122:123], v[18:19], v[186:187], v[122:123] op_sel_hi:[1,0,1]
s_waitcnt lgkmcnt(0)
v_pk_fma_f32 v[92:93], v[4:5], v[188:189], v[92:93] op_sel_hi:[1,0,1]
v_pk_fma_f32 v[124:125], v[18:19], v[188:189], v[124:125] op_sel_hi:[1,0,1]
v_pk_fma_f32 v[94:95], v[4:5], v[190:191], v[94:95] op_sel_hi:[1,0,1]
v_pk_fma_f32 v[126:127], v[18:19], v[190:191], v[126:127] op_sel_hi:[1,0,1]
v_pk_mul_f32 v[64:65], v[64:65], v[160:161] op_sel:[0,1] op_sel_hi:[1,1]
v_pk_mul_f32 v[96:97], v[96:97], v[160:161] op_sel:[0,1] op_sel_hi:[1,1]
buffer_store_dwordx4 v[156:159], v61, s[20:23], s62 offen offset:3072 sc1
s_add_u32 s62, s62, 32768
v_pk_mul_f32 v[66:67], v[66:67], v[162:163] op_sel:[0,1] op_sel_hi:[1,1]
v_pk_mul_f32 v[98:99], v[98:99], v[162:163] op_sel:[0,1] op_sel_hi:[1,1]
v_pk_mul_f32 v[68:69], v[68:69], v[164:165] op_sel:[0,1] op_sel_hi:[1,1]
v_pk_mul_f32 v[100:101], v[100:101], v[164:165] op_sel:[0,1] op_sel_hi:[1,1]
v_pk_mul_f32 v[70:71], v[70:71], v[166:167] op_sel:[0,1] op_sel_hi:[1,1]
v_pk_mul_f32 v[102:103], v[102:103], v[166:167] op_sel:[0,1] op_sel_hi:[1,1]
v_pk_mul_f32 v[72:73], v[72:73], v[168:169] op_sel:[0,1] op_sel_hi:[1,1]
v_pk_mul_f32 v[104:105], v[104:105], v[168:169] op_sel:[0,1] op_sel_hi:[1,1]
v_pk_mul_f32 v[74:75], v[74:75], v[170:171] op_sel:[0,1] op_sel_hi:[1,1]
v_pk_mul_f32 v[106:107], v[106:107], v[170:171] op_sel:[0,1] op_sel_hi:[1,1]
v_pk_mul_f32 v[76:77], v[76:77], v[172:173] op_sel:[0,1] op_sel_hi:[1,1]
v_pk_mul_f32 v[108:109], v[108:109], v[172:173] op_sel:[0,1] op_sel_hi:[1,1]
v_pk_mul_f32 v[78:79], v[78:79], v[174:175] op_sel:[0,1] op_sel_hi:[1,1]
v_pk_mul_f32 v[110:111], v[110:111], v[174:175] op_sel:[0,1] op_sel_hi:[1,1]
v_pk_mul_f32 v[80:81], v[80:81], v[176:177] op_sel:[0,1] op_sel_hi:[1,1]
v_pk_mul_f32 v[112:113], v[112:113], v[176:177] op_sel:[0,1] op_sel_hi:[1,1]
v_pk_mul_f32 v[82:83], v[82:83], v[178:179] op_sel:[0,1] op_sel_hi:[1,1]
v_pk_mul_f32 v[114:115], v[114:115], v[178:179] op_sel:[0,1] op_sel_hi:[1,1]
v_pk_mul_f32 v[84:85], v[84:85], v[180:181] op_sel:[0,1] op_sel_hi:[1,1]
v_pk_mul_f32 v[116:117], v[116:117], v[180:181] op_sel:[0,1] op_sel_hi:[1,1]
v_pk_mul_f32 v[86:87], v[86:87], v[182:183] op_sel:[0,1] op_sel_hi:[1,1]
v_pk_mul_f32 v[118:119], v[118:119], v[182:183] op_sel:[0,1] op_sel_hi:[1,1]
v_pk_mul_f32 v[88:89], v[88:89], v[184:185] op_sel:[0,1] op_sel_hi:[1,1]
v_pk_mul_f32 v[120:121], v[120:121], v[184:185] op_sel:[0,1] op_sel_hi:[1,1]
v_pk_mul_f32 v[90:91], v[90:91], v[186:187] op_sel:[0,1] op_sel_hi:[1,1]
v_pk_mul_f32 v[122:123], v[122:123], v[186:187] op_sel:[0,1] op_sel_hi:[1,1]
v_pk_mul_f32 v[92:93], v[92:93], v[188:189] op_sel:[0,1] op_sel_hi:[1,1]
v_pk_mul_f32 v[124:125], v[124:125], v[188:189] op_sel:[0,1] op_sel_hi:[1,1]
v_pk_mul_f32 v[94:95], v[94:95], v[190:191] op_sel:[0,1] op_sel_hi:[1,1]
v_pk_mul_f32 v[126:127], v[126:127], v[190:191] op_sel:[0,1] op_sel_hi:[1,1]
v_pk_fma_f32 v[164:165], v[64:65], v[128:129], v[66:67] op_sel_hi:[1,0,1]
v_pk_fma_f32 v[166:167], v[96:97], v[130:131], v[98:99] op_sel_hi:[1,0,1]
v_pk_fma_f32 v[164:165], v[64:65], v[128:129], v[164:165] op_sel:[1,1,0] op_sel_hi:[0,1,1] neg_lo:[0,1,0]
v_pk_fma_f32 v[166:167], v[96:97], v[130:131], v[166:167] op_sel:[1,1,0] op_sel_hi:[0,1,1] neg_lo:[0,1,0]
v_pk_fma_f32 v[160:161], v[164:165], v[128:129], v[68:69] op_sel_hi:[1,0,1]
v_pk_fma_f32 v[162:163], v[166:167], v[130:131], v[100:101] op_sel_hi:[1,0,1]
v_pk_fma_f32 v[160:161], v[164:165], v[128:129], v[160:161] op_sel:[1,1,0] op_sel_hi:[0,1,1] neg_lo:[0,1,0]
v_pk_fma_f32 v[162:163], v[166:167], v[130:131], v[162:163] op_sel:[1,1,0] op_sel_hi:[0,1,1] neg_lo:[0,1,0]
v_pk_fma_f32 v[164:165], v[160:161], v[128:129], v[70:71] op_sel_hi:[1,0,1]
v_pk_fma_f32 v[166:167], v[162:163], v[130:131], v[102:103] op_sel_hi:[1,0,1]
v_pk_fma_f32 v[164:165], v[160:161], v[128:129], v[164:165] op_sel:[1,1,0] op_sel_hi:[0,1,1] neg_lo:[0,1,0]
v_pk_fma_f32 v[166:167], v[162:163], v[130:131], v[166:167] op_sel:[1,1,0] op_sel_hi:[0,1,1] neg_lo:[0,1,0]
v_pk_fma_f32 v[160:161], v[164:165], v[128:129], v[72:73] op_sel_hi:[1,0,1]
v_pk_fma_f32 v[162:163], v[166:167], v[130:131], v[104:105] op_sel_hi:[1,0,1]
v_pk_fma_f32 v[160:161], v[164:165], v[128:129], v[160:161] op_sel:[1,1,0] op_sel_hi:[0,1,1] neg_lo:[0,1,0]
v_pk_fma_f32 v[162:163], v[166:167], v[130:131], v[162:163] op_sel:[1,1,0] op_sel_hi:[0,1,1] neg_lo:[0,1,0]
v_pk_fma_f32 v[164:165], v[160:161], v[128:129], v[74:75] op_sel_hi:[1,0,1]
v_pk_fma_f32 v[166:167], v[162:163], v[130:131], v[106:107] op_sel_hi:[1,0,1]
v_pk_fma_f32 v[164:165], v[160:161], v[128:129], v[164:165] op_sel:[1,1,0] op_sel_hi:[0,1,1] neg_lo:[0,1,0]
v_pk_fma_f32 v[166:167], v[162:163], v[130:131], v[166:167] op_sel:[1,1,0] op_sel_hi:[0,1,1] neg_lo:[0,1,0]
v_pk_fma_f32 v[160:161], v[164:165], v[128:129], v[76:77] op_sel_hi:[1,0,1]
v_pk_fma_f32 v[162:163], v[166:167], v[130:131], v[108:109] op_sel_hi:[1,0,1]
v_pk_fma_f32 v[160:161], v[164:165], v[128:129], v[160:161] op_sel:[1,1,0] op_sel_hi:[0,1,1] neg_lo:[0,1,0]
v_pk_fma_f32 v[162:163], v[166:167], v[130:131], v[162:163] op_sel:[1,1,0] op_sel_hi:[0,1,1] neg_lo:[0,1,0]
v_pk_fma_f32 v[164:165], v[160:161], v[128:129], v[78:79] op_sel_hi:[1,0,1]
v_pk_fma_f32 v[166:167], v[162:163], v[130:131], v[110:111] op_sel_hi:[1,0,1]
v_pk_fma_f32 v[164:165], v[160:161], v[128:129], v[164:165] op_sel:[1,1,0] op_sel_hi:[0,1,1] neg_lo:[0,1,0]
v_pk_fma_f32 v[166:167], v[162:163], v[130:131], v[166:167] op_sel:[1,1,0] op_sel_hi:[0,1,1] neg_lo:[0,1,0]
L_pg11:
s_cbranch_execz L_ret0
v_pk_fma_f32 v[160:161], v[164:165], v[128:129], v[80:81] op_sel_hi:[1,0,1]
v_pk_fma_f32 v[162:163], v[166:167], v[130:131], v[112:113] op_sel_hi:[1,0,1]
v_pk_fma_f32 v[160:161], v[164:165], v[128:129], v[160:161] op_sel:[1,1,0] op_sel_hi:[0,1,1] neg_lo:[0,1,0]
v_pk_fma_f32 v[162:163], v[166:167], v[130:131], v[162:163] op_sel:[1,1,0] op_sel_hi:[0,1,1] neg_lo:[0,1,0]
v_pk_fma_f32 v[164:165], v[160:161], v[128:129], v[82:83] op_sel_hi:[1,0,1]
v_pk_fma_f32 v[166:167], v[162:163], v[130:131], v[114:115] op_sel_hi:[1,0,1]
v_pk_fma_f32 v[164:165], v[160:161], v[128:129], v[164:165] op_sel:[1,1,0] op_sel_hi:[0,1,1] neg_lo:[0,1,0]
v_pk_fma_f32 v[166:167], v[162:163], v[130:131], v[166:167] op_sel:[1,1,0] op_sel_hi:[0,1,1] neg_lo:[0,1,0]
v_pk_fma_f32 v[160:161], v[164:165], v[128:129], v[84:85] op_sel_hi:[1,0,1]
v_pk_fma_f32 v[162:163], v[166:167], v[130:131], v[116:117] op_sel_hi:[1,0,1]
v_pk_fma_f32 v[160:161], v[164:165], v[128:129], v[160:161] op_sel:[1,1,0] op_sel_hi:[0,1,1] neg_lo:[0,1,0]
v_pk_fma_f32 v[162:163], v[166:167], v[130:131], v[162:163] op_sel:[1,1,0] op_sel_hi:[0,1,1] neg_lo:[0,1,0]
v_pk_fma_f32 v[164:165], v[160:161], v[128:129], v[86:87] op_sel_hi:[1,0,1]
v_pk_fma_f32 v[166:167], v[162:163], v[130:131], v[118:119] op_sel_hi:[1,0,1]
v_pk_fma_f32 v[164:165], v[160:161], v[128:129], v[164:165] op_sel:[1,1,0] op_sel_hi:[0,1,1] neg_lo:[0,1,0]
v_pk_fma_f32 v[166:167], v[162:163], v[130:131], v[166:167] op_sel:[1,1,0] op_sel_hi:[0,1,1] neg_lo:[0,1,0]
v_pk_fma_f32 v[160:161], v[164:165], v[128:129], v[88:89] op_sel_hi:[1,0,1]
v_pk_fma_f32 v[162:163], v[166:167], v[130:131], v[120:121] op_sel_hi:[1,0,1]
v_pk_fma_f32 v[160:161], v[164:165], v[128:129], v[160:161] op_sel:[1,1,0] op_sel_hi:[0,1,1] neg_lo:[0,1,0]
v_pk_fma_f32 v[162:163], v[166:167], v[130:131], v[162:163] op_sel:[1,1,0] op_sel_hi:[0,1,1] neg_lo:[0,1,0]
v_pk_fma_f32 v[164:165], v[160:161], v[128:129], v[90:91] op_sel_hi:[1,0,1]
v_pk_fma_f32 v[166:167], v[162:163], v[130:131], v[122:123] op_sel_hi:[1,0,1]
v_pk_fma_f32 v[164:165], v[160:161], v[128:129], v[164:165] op_sel:[1,1,0] op_sel_hi:[0,1,1] neg_lo:[0,1,0]
v_pk_fma_f32 v[166:167], v[162:163], v[130:131], v[166:167] op_sel:[1,1,0] op_sel_hi:[0,1,1] neg_lo:[0,1,0]
v_pk_fma_f32 v[160:161], v[164:165], v[128:129], v[92:93] op_sel_hi:[1,0,1]
v_pk_fma_f32 v[162:163], v[166:167], v[130:131], v[124:125] op_sel_hi:[1,0,1]
v_pk_fma_f32 v[160:161], v[164:165], v[128:129], v[160:161] op_sel:[1,1,0] op_sel_hi:[0,1,1] neg_lo:[0,1,0]
v_pk_fma_f32 v[162:163], v[166:167], v[130:131], v[162:163] op_sel:[1,1,0] op_sel_hi:[0,1,1] neg_lo:[0,1,0]
v_pk_fma_f32 v[164:165], v[160:161], v[128:129], v[94:95] op_sel_hi:[1,0,1]
v_pk_fma_f32 v[166:167], v[162:163], v[130:131], v[126:127] op_sel_hi:[1,0,1]
v_pk_fma_f32 v[164:165], v[160:161], v[128:129], v[164:165] op_sel:[1,1,0] op_sel_hi:[0,1,1] neg_lo:[0,1,0]
v_pk_fma_f32 v[166:167], v[162:163], v[130:131], v[166:167] op_sel:[1,1,0] op_sel_hi:[0,1,1] neg_lo:[0,1,0]
v_pk_mov_b32 v[160:161], v[164:165], v[164:165] op_sel:[0,1]
v_pk_mov_b32 v[162:163], v[166:167], v[166:167] op_sel:[0,1]
v_lshlrev_b32 v12, 2, v12
s_sub_u32 s50, 31, s6
v_permlane16_swap_b32 v164, v160
v_permlane16_swap_b32 v165, v161
v_permlane16_swap_b32 v166, v162
v_permlane16_swap_b32 v167, v163
v_pk_fma_f32 v[160:161], v[164:165], v[132:133], v[160:161] op_sel_hi:[1,0,1]
v_pk_fma_f32 v[162:163], v[166:167], v[134:135], v[162:163] op_sel_hi:[1,0,1]
v_pk_fma_f32 v[160:161], v[164:165], v[132:133], v[160:161] op_sel:[1,1,0] op_sel_hi:[0,1,1] neg_lo:[0,1,0]
v_pk_fma_f32 v[162:163], v[166:167], v[134:135], v[162:163] op_sel:[1,1,0] op_sel_hi:[0,1,1] neg_lo:[0,1,0]
v_pk_mov_b32 v[168:169], v[160:161], v[160:161] op_sel:[0,1]
v_pk_mov_b32 v[170:171], v[162:163], v[162:163] op_sel:[0,1]
v_lshl_add_u32 v13, v14, 11, v12
s_lshl_b32 s50, s50, 8
v_permlane32_swap_b32 v160, v168
v_permlane32_swap_b32 v161, v169
v_permlane32_swap_b32 v162, v170
v_permlane32_swap_b32 v163, v171
v_pk_fma_f32 v[168:169], v[160:161], v[136:137], v[168:169] op_sel_hi:[1,0,1]
v_pk_fma_f32 v[170:171], v[162:163], v[138:139], v[170:171] op_sel_hi:[1,0,1]
v_pk_fma_f32 v[168:169], v[160:161], v[136:137], v[168:169] op_sel:[1,1,0] op_sel_hi:[0,1,1] neg_lo:[0,1,0]
v_pk_fma_f32 v[170:171], v[162:163], v[138:139], v[170:171] op_sel:[1,1,0] op_sel_hi:[0,1,1] neg_lo:[0,1,0]
v_min_u32 v168, -2, v168
v_min_u32 v169, -2, v169
v_min_u32 v170, -2, v170
v_min_u32_e64 v171, -2, v171
s_mov_b64 exec, 0xffff
buffer_store_dwordx4 v[168:171], v12, s[40:43], s50 offen sc1
s_mov_b64 exec, -1
v_cndmask_b32 v164, 0, v164, s[56:57]
v_cndmask_b32 v165, 0, v165, s[56:57]
v_cndmask_b32 v166, 0, v166, s[56:57]
v_cndmask_b32 v167, 0, v167, s[56:57]
v_pk_fma_f32 v[164:165], v[160:161], v[140:141], v[164:165] op_sel_hi:[1,0,1]
v_pk_fma_f32 v[166:167], v[162:163], v[142:143], v[166:167] op_sel_hi:[1,0,1]
v_pk_fma_f32 v[164:165], v[160:161], v[140:141], v[164:165] op_sel:[1,1,0] op_sel_hi:[0,1,1] neg_lo:[0,1,0]
v_pk_fma_f32 v[166:167], v[162:163], v[142:143], v[166:167] op_sel:[1,1,0] op_sel_hi:[0,1,1] neg_lo:[0,1,0]
ds_read_b128 v[44:47], v60 offset:320
ds_read_b128 v[48:51], v60 offset:832
v_pk_fma_f32 v[192:193], v[36:37], v[20:21], v[192:193] op_sel_hi:[1,0,1]
v_pk_fma_f32 v[194:195], v[38:39], v[20:21], v[194:195] op_sel_hi:[1,0,1]
v_pk_fma_f32 v[196:197], v[36:37], v[24:25], v[196:197] op_sel_hi:[1,0,1]
v_pk_fma_f32 v[198:199], v[38:39], v[24:25], v[198:199] op_sel_hi:[1,0,1]
v_pk_mul_f32 v[52:53], v[192:193], v[192:193]
v_pk_mul_f32 v[54:55], v[194:195], v[194:195]
v_pk_mul_f32 v[56:57], v[196:197], v[196:197]
v_pk_mul_f32 v[58:59], v[198:199], v[198:199]
v_pk_fma_f32 v[52:53], v[52:53], v[22:23], v[22:23] op_sel:[0,1,0] op_sel_hi:[1,1,0]
v_pk_fma_f32 v[54:55], v[54:55], v[22:23], v[22:23] op_sel:[0,1,0] op_sel_hi:[1,1,0]
v_pk_fma_f32 v[56:57], v[56:57], v[26:27], v[26:27] op_sel:[0,1,0] op_sel_hi:[1,1,0]
v_pk_fma_f32 v[58:59], v[58:59], v[26:27], v[26:27] op_sel:[0,1,0] op_sel_hi:[1,1,0]
v_pk_mul_f32 v[52:53], v[192:193], v[52:53]
v_pk_mul_f32 v[54:55], v[194:195], v[54:55]
v_pk_mul_f32 v[56:57], v[196:197], v[56:57]
v_pk_mul_f32 v[58:59], v[198:199], v[58:59]
v_exp_f32 v52, v52
v_exp_f32 v53, v53
v_exp_f32 v54, v54
v_exp_f32 v55, v55
v_exp_f32 v56, v56
v_exp_f32 v57, v57
v_exp_f32 v58, v58
s_lshl_b32 s45, s6, 6
s_add_u32 s45, s45, s5
s_lshl_b32 s45, s45, 2
s_add_u32 s45, s45, 28311552
v_mov_b32 v14, 1
v_min_u32 v15, 1, v1
v_lshlrev_b32 v15, 30, v15
s_waitcnt vmcnt(1)
buffer_store_dword v14, v15, s[20:23], s45 offen sc1
v_exp_f32_e64 v59, v59
v_pk_fma_f32 v[208:209], v[40:41], v[20:21], v[208:209] op_sel_hi:[1,0,1]
v_pk_fma_f32 v[210:211], v[42:43], v[20:21], v[210:211] op_sel_hi:[1,0,1]
v_pk_fma_f32 v[212:213], v[40:41], v[24:25], v[212:213] op_sel_hi:[1,0,1]
v_pk_fma_f32 v[214:215], v[42:43], v[24:25], v[214:215] op_sel_hi:[1,0,1]
v_pk_fma_f32 v[52:53], v[52:53], v[20:21], v[20:21] op_sel:[0,1,1] op_sel_hi:[1,1,1]
v_pk_fma_f32 v[54:55], v[54:55], v[20:21], v[20:21] op_sel:[0,1,1] op_sel_hi:[1,1,1]
v_pk_fma_f32 v[56:57], v[56:57], v[24:25], v[24:25] op_sel:[0,1,1] op_sel_hi:[1,1,1]
v_pk_fma_f32 v[58:59], v[58:59], v[24:25], v[24:25] op_sel:[0,1,1] op_sel_hi:[1,1,1]
v_rcp_f32 v52, v52
s_add_u32 m0, s7, 98304
s_add_u32 s44, s98, 983040
buffer_load_dwordx4 v6, s[28:31], s44 offen lds
v_rcp_f32 v53, v53
v_rcp_f32 v54, v54
v_rcp_f32 v55, v55
v_rcp_f32 v56, v56
v_rcp_f32 v57, v57
v_rcp_f32 v58, v58
v_rcp_f32 v59, v59
v_pk_mul_f32 v[192:193], v[192:193], v[208:209]
v_pk_mul_f32 v[194:195], v[194:195], v[210:211]
s_add_u32 m0, s7, 99328
s_nop 0
buffer_load_dwordx4 v7, s[28:31], s44 offen lds
v_pk_mul_f32 v[196:197], v[196:197], v[212:213]
v_pk_mul_f32 v[198:199], v[198:199], v[214:215]
v_pk_mul_f32 v[192:193], v[192:193], v[52:53]
v_pk_mul_f32 v[194:195], v[194:195], v[54:55]
v_pk_mul_f32 v[196:197], v[196:197], v[56:57]
v_pk_mul_f32 v[198:199], v[198:199], v[58:59]
v_cvt_pk_bf16_f32 v128, v192, v193
v_cvt_pk_bf16_f32 v129, v194, v195
v_cvt_pk_bf16_f32 v132, v196, v197
v_cvt_pk_bf16_f32 v133, v198, v199
s_add_u32 m0, s7, 100352
s_add_u32 s44, s98, 999424
buffer_load_dwordx4 v6, s[28:31], s44 offen lds
v_pk_fma_f32 v[200:201], v[36:37], v[28:29], v[200:201] op_sel_hi:[1,0,1]
v_pk_fma_f32 v[202:203], v[38:39], v[28:29], v[202:203] op_sel_hi:[1,0,1]
v_pk_fma_f32 v[204:205], v[36:37], v[32:33], v[204:205] op_sel_hi:[1,0,1]
v_pk_fma_f32 v[206:207], v[38:39], v[32:33], v[206:207] op_sel_hi:[1,0,1]
v_pk_mul_f32 v[52:53], v[200:201], v[200:201]
v_pk_mul_f32 v[54:55], v[202:203], v[202:203]
v_pk_mul_f32 v[56:57], v[204:205], v[204:205]
v_pk_mul_f32 v[58:59], v[206:207], v[206:207]
v_pk_fma_f32 v[52:53], v[52:53], v[30:31], v[30:31] op_sel:[0,1,0] op_sel_hi:[1,1,0]
s_add_u32 m0, s7, 101376
s_nop 0
buffer_load_dwordx4 v7, s[28:31], s44 offen lds
v_pk_fma_f32 v[54:55], v[54:55], v[30:31], v[30:31] op_sel:[0,1,0] op_sel_hi:[1,1,0]
v_pk_fma_f32 v[56:57], v[56:57], v[34:35], v[34:35] op_sel:[0,1,0] op_sel_hi:[1,1,0]
v_pk_fma_f32 v[58:59], v[58:59], v[34:35], v[34:35] op_sel:[0,1,0] op_sel_hi:[1,1,0]
v_pk_mul_f32 v[52:53], v[200:201], v[52:53]
v_pk_mul_f32 v[54:55], v[202:203], v[54:55]
v_pk_mul_f32 v[56:57], v[204:205], v[56:57]
v_pk_mul_f32 v[58:59], v[206:207], v[58:59]
v_exp_f32 v52, v52
v_exp_f32 v53, v53
v_exp_f32 v54, v54
s_add_u32 m0, s7, 114688
s_add_u32 s44, s98, 1441792
buffer_load_dwordx4 v6, s[28:31], s44 offen lds
v_exp_f32 v55, v55
v_exp_f32 v56, v56
v_exp_f32 v57, v57
v_exp_f32 v58, v58
v_exp_f32 v59, v59
v_pk_fma_f32 v[216:217], v[40:41], v[28:29], v[216:217] op_sel_hi:[1,0,1]
v_pk_fma_f32 v[218:219], v[42:43], v[28:29], v[218:219] op_sel_hi:[1,0,1]
v_pk_fma_f32 v[220:221], v[40:41], v[32:33], v[220:221] op_sel_hi:[1,0,1]
v_pk_fma_f32 v[222:223], v[42:43], v[32:33], v[222:223] op_sel_hi:[1,0,1]
s_add_u32 m0, s7, 115712
s_nop 0
buffer_load_dwordx4 v7, s[28:31], s44 offen lds
v_pk_fma_f32 v[52:53], v[52:53], v[28:29], v[28:29] op_sel:[0,1,1] op_sel_hi:[1,1,1]
v_pk_fma_f32 v[54:55], v[54:55], v[28:29], v[28:29] op_sel:[0,1,1] op_sel_hi:[1,1,1]
v_pk_fma_f32 v[56:57], v[56:57], v[32:33], v[32:33] op_sel:[0,1,1] op_sel_hi:[1,1,1]
v_pk_fma_f32 v[58:59], v[58:59], v[32:33], v[32:33] op_sel:[0,1,1] op_sel_hi:[1,1,1]
v_rcp_f32 v52, v52
v_rcp_f32 v53, v53
v_rcp_f32 v54, v54
v_rcp_f32 v55, v55
v_rcp_f32 v56, v56
s_add_u32 m0, s7, 116736
s_add_u32 s44, s98, 1458176
buffer_load_dwordx4 v6, s[28:31], s44 offen lds
v_rcp_f32 v57, v57
v_rcp_f32 v58, v58
v_rcp_f32_e64 v59, v59
v_pk_mul_f32 v[200:201], v[200:201], v[216:217]
v_pk_mul_f32 v[202:203], v[202:203], v[218:219]
v_pk_mul_f32 v[204:205], v[204:205], v[220:221]
v_pk_mul_f32 v[206:207], v[206:207], v[222:223]
v_pk_mul_f32 v[200:201], v[200:201], v[52:53]
v_pk_mul_f32 v[202:203], v[202:203], v[54:55]
v_pk_mul_f32 v[204:205], v[204:205], v[56:57]
s_add_u32 m0, s7, 117760
s_nop 0
buffer_load_dwordx4 v7, s[28:31], s44 offen lds
v_pk_mul_f32 v[206:207], v[206:207], v[58:59]
v_cvt_pk_bf16_f32 v136, v200, v201
v_cvt_pk_bf16_f32 v137, v202, v203
v_cvt_pk_bf16_f32 v140, v204, v205
v_cvt_pk_bf16_f32 v141, v206, v207
ds_read_b128 v[36:39], v60 offset:384
ds_read_b128 v[40:43], v60 offset:896
s_waitcnt lgkmcnt(3)
v_pk_fma_f32 v[224:225], v[44:45], v[20:21], v[224:225] op_sel_hi:[1,0,1]
v_pk_fma_f32 v[226:227], v[46:47], v[20:21], v[226:227] op_sel_hi:[1,0,1]
v_pk_fma_f32 v[228:229], v[44:45], v[24:25], v[228:229] op_sel_hi:[1,0,1]
v_pk_fma_f32 v[230:231], v[46:47], v[24:25], v[230:231] op_sel_hi:[1,0,1]
v_pk_mul_f32 v[52:53], v[224:225], v[224:225]
v_pk_mul_f32 v[54:55], v[226:227], v[226:227]
v_pk_mul_f32 v[56:57], v[228:229], v[228:229]
v_pk_mul_f32 v[58:59], v[230:231], v[230:231]
v_pk_fma_f32 v[52:53], v[52:53], v[22:23], v[22:23] op_sel:[0,1,0] op_sel_hi:[1,1,0]
v_pk_fma_f32 v[54:55], v[54:55], v[22:23], v[22:23] op_sel:[0,1,0] op_sel_hi:[1,1,0]
v_pk_fma_f32 v[56:57], v[56:57], v[26:27], v[26:27] op_sel:[0,1,0] op_sel_hi:[1,1,0]
v_pk_fma_f32 v[58:59], v[58:59], v[26:27], v[26:27] op_sel:[0,1,0] op_sel_hi:[1,1,0]
v_pk_mul_f32 v[52:53], v[224:225], v[52:53]
v_pk_mul_f32 v[54:55], v[226:227], v[54:55]
v_pk_mul_f32 v[56:57], v[228:229], v[56:57]
v_pk_mul_f32 v[58:59], v[230:231], v[58:59]
v_exp_f32 v52, v52
v_exp_f32 v53, v53
v_exp_f32 v54, v54
v_exp_f32 v55, v55
v_exp_f32 v56, v56
v_exp_f32 v57, v57
v_exp_f32 v58, v58
v_exp_f32_e64 v59, v59
s_waitcnt lgkmcnt(2)
v_pk_fma_f32 v[240:241], v[48:49], v[20:21], v[240:241] op_sel_hi:[1,0,1]
v_pk_fma_f32 v[242:243], v[50:51], v[20:21], v[242:243] op_sel_hi:[1,0,1]
v_pk_fma_f32 v[244:245], v[48:49], v[24:25], v[244:245] op_sel_hi:[1,0,1]
v_pk_fma_f32 v[246:247], v[50:51], v[24:25], v[246:247] op_sel_hi:[1,0,1]
v_pk_fma_f32 v[52:53], v[52:53], v[20:21], v[20:21] op_sel:[0,1,1] op_sel_hi:[1,1,1]
v_pk_fma_f32 v[54:55], v[54:55], v[20:21], v[20:21] op_sel:[0,1,1] op_sel_hi:[1,1,1]
v_pk_fma_f32 v[56:57], v[56:57], v[24:25], v[24:25] op_sel:[0,1,1] op_sel_hi:[1,1,1]
v_pk_fma_f32 v[58:59], v[58:59], v[24:25], v[24:25] op_sel:[0,1,1] op_sel_hi:[1,1,1]
v_rcp_f32 v52, v52
v_rcp_f32 v53, v53
v_rcp_f32 v54, v54
v_rcp_f32 v55, v55
v_rcp_f32 v56, v56
v_rcp_f32 v57, v57
v_rcp_f32 v58, v58
v_rcp_f32 v59, v59
v_pk_mul_f32 v[224:225], v[224:225], v[240:241]
v_pk_mul_f32 v[226:227], v[226:227], v[242:243]
v_pk_mul_f32 v[228:229], v[228:229], v[244:245]
v_pk_mul_f32 v[230:231], v[230:231], v[246:247]
buffer_load_dwordx4 v[192:195], v13, s[40:43], s50 offen offset:256 sc1
v_pk_mul_f32 v[224:225], v[224:225], v[52:53]
v_pk_mul_f32 v[226:227], v[226:227], v[54:55]
v_pk_mul_f32 v[228:229], v[228:229], v[56:57]
v_pk_mul_f32 v[230:231], v[230:231], v[58:59]
v_cvt_pk_bf16_f32 v130, v224, v225
v_cvt_pk_bf16_f32 v131, v226, v227
v_cvt_pk_bf16_f32 v134, v228, v229
v_cvt_pk_bf16_f32 v135, v230, v231
buffer_load_dwordx4 v[196:199], v13, s[40:43], s50 offen offset:512 sc1
v_pk_fma_f32 v[232:233], v[44:45], v[28:29], v[232:233] op_sel_hi:[1,0,1]
v_pk_fma_f32 v[234:235], v[46:47], v[28:29], v[234:235] op_sel_hi:[1,0,1]
v_pk_fma_f32 v[236:237], v[44:45], v[32:33], v[236:237] op_sel_hi:[1,0,1]
v_pk_fma_f32 v[238:239], v[46:47], v[32:33], v[238:239] op_sel_hi:[1,0,1]
v_pk_mul_f32 v[52:53], v[232:233], v[232:233]
v_pk_mul_f32 v[54:55], v[234:235], v[234:235]
v_pk_mul_f32 v[56:57], v[236:237], v[236:237]
v_pk_mul_f32 v[58:59], v[238:239], v[238:239]
buffer_load_dwordx4 v[200:203], v13, s[40:43], s50 offen offset:768 sc1
v_pk_fma_f32 v[52:53], v[52:53], v[30:31], v[30:31] op_sel:[0,1,0] op_sel_hi:[1,1,0]
v_pk_fma_f32 v[54:55], v[54:55], v[30:31], v[30:31] op_sel:[0,1,0] op_sel_hi:[1,1,0]
v_pk_fma_f32 v[56:57], v[56:57], v[34:35], v[34:35] op_sel:[0,1,0] op_sel_hi:[1,1,0]
v_pk_fma_f32 v[58:59], v[58:59], v[34:35], v[34:35] op_sel:[0,1,0] op_sel_hi:[1,1,0]
v_pk_mul_f32 v[52:53], v[232:233], v[52:53]
v_pk_mul_f32 v[54:55], v[234:235], v[54:55]
v_pk_mul_f32 v[56:57], v[236:237], v[56:57]
v_pk_mul_f32 v[58:59], v[238:239], v[58:59]
buffer_load_dwordx4 v[204:207], v13, s[40:43], s50 offen offset:1024 sc1
v_exp_f32 v52, v52
v_exp_f32 v53, v53
v_exp_f32 v54, v54
v_exp_f32 v55, v55
v_exp_f32 v56, v56
v_exp_f32 v57, v57
v_exp_f32 v58, v58
v_exp_f32 v59, v59
buffer_load_dwordx4 v[208:211], v13, s[40:43], s50 offen offset:1280 sc1
v_pk_fma_f32 v[248:249], v[48:49], v[28:29], v[248:249] op_sel_hi:[1,0,1]
v_pk_fma_f32 v[250:251], v[50:51], v[28:29], v[250:251] op_sel_hi:[1,0,1]
v_pk_fma_f32 v[252:253], v[48:49], v[32:33], v[252:253] op_sel_hi:[1,0,1]
v_pk_fma_f32 v[254:255], v[50:51], v[32:33], v[254:255] op_sel_hi:[1,0,1]
v_pk_fma_f32 v[52:53], v[52:53], v[28:29], v[28:29] op_sel:[0,1,1] op_sel_hi:[1,1,1]
v_pk_fma_f32 v[54:55], v[54:55], v[28:29], v[28:29] op_sel:[0,1,1] op_sel_hi:[1,1,1]
v_pk_fma_f32 v[56:57], v[56:57], v[32:33], v[32:33] op_sel:[0,1,1] op_sel_hi:[1,1,1]
v_pk_fma_f32 v[58:59], v[58:59], v[32:33], v[32:33] op_sel:[0,1,1] op_sel_hi:[1,1,1]
buffer_load_dwordx4 v[212:215], v13, s[40:43], s50 offen offset:1536 sc1
v_rcp_f32 v52, v52
v_rcp_f32 v53, v53
v_rcp_f32 v54, v54
v_rcp_f32 v55, v55
v_rcp_f32 v56, v56
v_rcp_f32 v57, v57
v_rcp_f32 v58, v58
v_rcp_f32 v59, v59
buffer_load_dwordx4 v[216:219], v13, s[40:43], s50 offen offset:1792 sc1
v_pk_mul_f32 v[232:233], v[232:233], v[248:249]
v_pk_mul_f32 v[234:235], v[234:235], v[250:251]
v_pk_mul_f32 v[236:237], v[236:237], v[252:253]
v_pk_mul_f32 v[238:239], v[238:239], v[254:255]
v_pk_mul_f32 v[232:233], v[232:233], v[52:53]
v_pk_mul_f32 v[234:235], v[234:235], v[54:55]
v_pk_mul_f32 v[236:237], v[236:237], v[56:57]
v_pk_mul_f32 v[238:239], v[238:239], v[58:59]
buffer_load_dwordx4 v[220:223], v13, s[40:43], s50 offen offset:2048 sc1
v_cvt_pk_bf16_f32 v138, v232, v233
v_cvt_pk_bf16_f32 v139, v234, v235
v_cvt_pk_bf16_f32 v142, v236, v237
v_cvt_pk_bf16_f32 v143, v238, v239
v_accvgpr_read_b32 v224, a0
v_accvgpr_read_b32 v225, a1
v_accvgpr_read_b32 v226, a2
v_accvgpr_read_b32 v227, a3
v_accvgpr_read_b32 v228, a4
v_accvgpr_read_b32 v229, a5
v_accvgpr_read_b32 v230, a6
v_accvgpr_read_b32 v231, a7
v_accvgpr_read_b32 v232, a8
v_accvgpr_read_b32 v233, a9
v_accvgpr_read_b32 v234, a10
v_accvgpr_read_b32 v235, a11
v_accvgpr_read_b32 v236, a12
v_accvgpr_read_b32 v237, a13
v_accvgpr_read_b32 v238, a14
v_accvgpr_read_b32 v239, a15
v_accvgpr_read_b32 v240, a16
v_accvgpr_read_b32 v241, a17
v_accvgpr_read_b32 v242, a18
v_accvgpr_read_b32 v243, a19
v_accvgpr_read_b32 v244, a20
v_accvgpr_read_b32 v245, a21
v_accvgpr_read_b32 v246, a22
v_accvgpr_read_b32 v247, a23
v_accvgpr_read_b32 v248, a24
v_accvgpr_read_b32 v249, a25
v_accvgpr_read_b32 v250, a26
v_accvgpr_read_b32 v251, a27
v_accvgpr_read_b32 v252, a28
v_accvgpr_read_b32 v253, a29
v_accvgpr_read_b32 v254, a30
v_accvgpr_read_b32 v255, a31
s_waitcnt lgkmcnt(1)
v_pk_fma_f32 v[224:225], v[36:37], v[20:21], v[224:225] op_sel_hi:[1,0,1]
v_pk_fma_f32 v[226:227], v[38:39], v[20:21], v[226:227] op_sel_hi:[1,0,1]
v_pk_fma_f32 v[228:229], v[36:37], v[24:25], v[228:229] op_sel_hi:[1,0,1]
s_lshl_b32 s60, s54, 3
s_add_u32 s60, s60, s52
s_lshl_b32 s60, s60, 5
s_add_u32 s60, s60, 28311552
v_and_b32 v14, 7, v1
v_lshlrev_b32 v14, 2, v14
buffer_load_dword v15, v14, s[20:23], s60 offen sc1
v_pk_fma_f32 v[230:231], v[38:39], v[24:25], v[230:231] op_sel_hi:[1,0,1]
v_pk_mul_f32 v[52:53], v[224:225], v[224:225]
v_pk_mul_f32 v[54:55], v[226:227], v[226:227]
v_pk_mul_f32 v[56:57], v[228:229], v[228:229]
v_pk_mul_f32 v[58:59], v[230:231], v[230:231]
v_pk_fma_f32 v[52:53], v[52:53], v[22:23], v[22:23] op_sel:[0,1,0] op_sel_hi:[1,1,0]
v_pk_fma_f32 v[54:55], v[54:55], v[22:23], v[22:23] op_sel:[0,1,0] op_sel_hi:[1,1,0]
v_pk_fma_f32 v[56:57], v[56:57], v[26:27], v[26:27] op_sel:[0,1,0] op_sel_hi:[1,1,0]
v_pk_fma_f32 v[58:59], v[58:59], v[26:27], v[26:27] op_sel:[0,1,0] op_sel_hi:[1,1,0]
v_pk_mul_f32 v[52:53], v[224:225], v[52:53]
v_pk_mul_f32 v[54:55], v[226:227], v[54:55]
v_pk_mul_f32 v[56:57], v[228:229], v[56:57]
v_pk_mul_f32 v[58:59], v[230:231], v[58:59]
v_exp_f32 v52, v52
v_exp_f32 v53, v53
v_exp_f32 v54, v54
v_exp_f32 v55, v55
v_exp_f32 v56, v56
v_exp_f32 v57, v57
v_exp_f32 v58, v58
v_exp_f32_e64 v59, v59
s_waitcnt lgkmcnt(0)
v_pk_fma_f32 v[240:241], v[40:41], v[20:21], v[240:241] op_sel_hi:[1,0,1]
v_pk_fma_f32 v[242:243], v[42:43], v[20:21], v[242:243] op_sel_hi:[1,0,1]
v_pk_fma_f32 v[244:245], v[40:41], v[24:25], v[244:245] op_sel_hi:[1,0,1]
v_pk_fma_f32 v[246:247], v[42:43], v[24:25], v[246:247] op_sel_hi:[1,0,1]
v_pk_fma_f32 v[52:53], v[52:53], v[20:21], v[20:21] op_sel:[0,1,1] op_sel_hi:[1,1,1]
v_pk_fma_f32 v[54:55], v[54:55], v[20:21], v[20:21] op_sel:[0,1,1] op_sel_hi:[1,1,1]
v_pk_fma_f32 v[56:57], v[56:57], v[24:25], v[24:25] op_sel:[0,1,1] op_sel_hi:[1,1,1]
v_pk_fma_f32 v[58:59], v[58:59], v[24:25], v[24:25] op_sel:[0,1,1] op_sel_hi:[1,1,1]
v_rcp_f32 v52, v52
v_rcp_f32 v53, v53
v_rcp_f32 v54, v54
v_rcp_f32 v55, v55
v_rcp_f32 v56, v56
v_rcp_f32 v57, v57
v_rcp_f32 v58, v58
v_rcp_f32 v59, v59
v_pk_mul_f32 v[224:225], v[224:225], v[240:241]
v_pk_mul_f32 v[226:227], v[226:227], v[242:243]
v_pk_mul_f32 v[228:229], v[228:229], v[244:245]
v_pk_mul_f32 v[230:231], v[230:231], v[246:247]
v_pk_mul_f32 v[224:225], v[224:225], v[52:53]
buffer_store_dwordx4 v[128:131], v61, s[20:23], s62 offen offset:0 sc1
v_pk_mul_f32 v[226:227], v[226:227], v[54:55]
v_pk_mul_f32 v[228:229], v[228:229], v[56:57]
v_pk_mul_f32 v[230:231], v[230:231], v[58:59]
v_cvt_pk_bf16_f32 v144, v224, v225
v_cvt_pk_bf16_f32 v145, v226, v227
v_cvt_pk_bf16_f32 v146, v228, v229
v_cvt_pk_bf16_f32 v147, v230, v231
s_nop 0
v_permlane32_swap_b32 v144, v146
v_permlane32_swap_b32 v145, v147
v_pk_fma_f32 v[232:233], v[36:37], v[28:29], v[232:233] op_sel_hi:[1,0,1]
v_pk_fma_f32 v[234:235], v[38:39], v[28:29], v[234:235] op_sel_hi:[1,0,1]
v_pk_fma_f32 v[236:237], v[36:37], v[32:33], v[236:237] op_sel_hi:[1,0,1]
v_pk_fma_f32 v[238:239], v[38:39], v[32:33], v[238:239] op_sel_hi:[1,0,1]
v_pk_mul_f32 v[52:53], v[232:233], v[232:233]
v_pk_mul_f32 v[54:55], v[234:235], v[234:235]
v_pk_mul_f32 v[56:57], v[236:237], v[236:237]
v_pk_mul_f32 v[58:59], v[238:239], v[238:239]
v_pk_fma_f32 v[52:53], v[52:53], v[30:31], v[30:31] op_sel:[0,1,0] op_sel_hi:[1,1,0]
v_pk_fma_f32 v[54:55], v[54:55], v[30:31], v[30:31] op_sel:[0,1,0] op_sel_hi:[1,1,0]
v_pk_fma_f32 v[56:57], v[56:57], v[34:35], v[34:35] op_sel:[0,1,0] op_sel_hi:[1,1,0]
v_pk_fma_f32 v[58:59], v[58:59], v[34:35], v[34:35] op_sel:[0,1,0] op_sel_hi:[1,1,0]
v_pk_mul_f32 v[52:53], v[232:233], v[52:53]
v_pk_mul_f32 v[54:55], v[234:235], v[54:55]
v_pk_mul_f32 v[56:57], v[236:237], v[56:57]
v_pk_mul_f32 v[58:59], v[238:239], v[58:59]
v_exp_f32 v52, v52
v_exp_f32 v53, v53
v_exp_f32 v54, v54
v_exp_f32 v55, v55
v_exp_f32 v56, v56
v_exp_f32 v57, v57
v_exp_f32 v58, v58
v_exp_f32_e64 v59, v59
v_pk_fma_f32 v[248:249], v[40:41], v[28:29], v[248:249] op_sel_hi:[1,0,1]
v_pk_fma_f32 v[250:251], v[42:43], v[28:29], v[250:251] op_sel_hi:[1,0,1]
v_pk_fma_f32 v[252:253], v[40:41], v[32:33], v[252:253] op_sel_hi:[1,0,1]
v_pk_fma_f32 v[254:255], v[42:43], v[32:33], v[254:255] op_sel_hi:[1,0,1]
v_pk_fma_f32 v[52:53], v[52:53], v[28:29], v[28:29] op_sel:[0,1,1] op_sel_hi:[1,1,1]
v_pk_fma_f32 v[54:55], v[54:55], v[28:29], v[28:29] op_sel:[0,1,1] op_sel_hi:[1,1,1]
v_pk_fma_f32 v[56:57], v[56:57], v[32:33], v[32:33] op_sel:[0,1,1] op_sel_hi:[1,1,1]
v_pk_fma_f32 v[58:59], v[58:59], v[32:33], v[32:33] op_sel:[0,1,1] op_sel_hi:[1,1,1]
v_rcp_f32_e64 v52, v52
buffer_store_dwordx4 v[132:135], v61, s[20:23], s62 offen offset:1024 sc1
v_rcp_f32 v53, v53
v_rcp_f32 v54, v54
v_rcp_f32 v55, v55
v_rcp_f32 v56, v56
v_rcp_f32 v57, v57
v_rcp_f32 v58, v58
v_rcp_f32_e64 v59, v59
v_pk_mul_f32 v[232:233], v[232:233], v[248:249]
v_pk_mul_f32 v[234:235], v[234:235], v[250:251]
v_pk_mul_f32 v[236:237], v[236:237], v[252:253]
v_pk_mul_f32 v[238:239], v[238:239], v[254:255]
v_pk_mul_f32 v[232:233], v[232:233], v[52:53]
v_pk_mul_f32 v[234:235], v[234:235], v[54:55]
v_pk_mul_f32 v[236:237], v[236:237], v[56:57]
v_pk_mul_f32 v[238:239], v[238:239], v[58:59]
v_cvt_pk_bf16_f32 v148, v232, v233
v_cvt_pk_bf16_f32 v149, v234, v235
v_cvt_pk_bf16_f32 v150, v236, v237
v_cvt_pk_bf16_f32 v151, v238, v239
s_nop 0
v_permlane32_swap_b32 v148, v150
v_permlane32_swap_b32 v149, v151
s_waitcnt vmcnt(2)
v_cmp_ne_u32 vcc, 1, v15
s_nop 1
s_cbranch_vccnz L_slow13
L_back14:
v_accvgpr_read_b32 v20, a194
v_accvgpr_read_b32 v21, a195
v_accvgpr_read_b32 v22, a210
v_accvgpr_read_b32 v23, a211
v_accvgpr_read_b32 v24, a192
v_accvgpr_read_b32 v25, a193
buffer_load_dwordx4 a[96:99], v2, s[20:23], s101 offen offset:0 sc1
v_accvgpr_read_b32 v26, a208
v_accvgpr_read_b32 v27, a209
v_accvgpr_read_b32 v28, a200
v_accvgpr_read_b32 v29, a201
v_accvgpr_read_b32 v30, a216
v_accvgpr_read_b32 v31, a217
v_accvgpr_read_b32 v32, a202
v_accvgpr_read_b32 v33, a203
v_accvgpr_read_b32 v34, a218
v_accvgpr_read_b32 v35, a219
v_accvgpr_read_b32 v36, a204
v_accvgpr_read_b32 v37, a205
v_accvgpr_read_b32 v38, a220
buffer_load_dwordx4 a[100:103], v2, s[20:23], s101 offen offset:1024 sc1
v_accvgpr_read_b32 v39, a221
v_max_u32 v168, v192, v193
v_max3_u32 v168, v168, v194, v195
v_max3_u32 v168, v168, v196, v197
v_max3_u32 v168, v168, v198, v199
v_max3_u32 v168, v168, v200, v201
v_max3_u32 v168, v168, v202, v203
v_max3_u32 v168, v168, v204, v205
v_max3_u32 v168, v168, v206, v207
v_max3_u32 v168, v168, v208, v209
v_max3_u32 v168, v168, v210, v211
v_max3_u32 v168, v168, v212, v213
v_max3_u32 v168, v168, v214, v215
buffer_load_dwordx4 a[104:107], v2, s[20:23], s101 offen offset:2048 sc1
v_max3_u32 v168, v168, v216, v217
v_max3_u32 v168, v168, v218, v219
v_max3_u32 v168, v168, v220, v221
v_max3_u32 v168, v168, v222, v223
v_cmp_eq_u32 vcc, -1, v168
s_nop 1
s_cbranch_vccnz L_slow16
L_back17:
v_pk_fma_f32 v[216:217], v[220:221], v[28:29], v[216:217] op_sel_hi:[1,0,1]
v_pk_fma_f32 v[218:219], v[222:223], v[30:31], v[218:219] op_sel_hi:[1,0,1]
v_pk_fma_f32 v[216:217], v[220:221], v[28:29], v[216:217] op_sel:[1,1,0] op_sel_hi:[0,1,1] neg_lo:[0,1,0]
v_pk_fma_f32 v[218:219], v[222:223], v[30:31], v[218:219] op_sel:[1,1,0] op_sel_hi:[0,1,1] neg_lo:[0,1,0]
v_pk_fma_f32 v[212:213], v[216:217], v[28:29], v[212:213] op_sel_hi:[1,0,1]
v_pk_fma_f32 v[214:215], v[218:219], v[30:31], v[214:215] op_sel_hi:[1,0,1]
buffer_load_dwordx4 a[108:111], v2, s[20:23], s101 offen offset:3072 sc1
s_add_u32 s101, s101, 4096
v_pk_fma_f32 v[212:213], v[216:217], v[28:29], v[212:213] op_sel:[1,1,0] op_sel_hi:[0,1,1] neg_lo:[0,1,0]
v_pk_fma_f32 v[214:215], v[218:219], v[30:31], v[214:215] op_sel:[1,1,0] op_sel_hi:[0,1,1] neg_lo:[0,1,0]
v_pk_fma_f32 v[208:209], v[212:213], v[28:29], v[208:209] op_sel_hi:[1,0,1]
v_pk_fma_f32 v[210:211], v[214:215], v[30:31], v[210:211] op_sel_hi:[1,0,1]
v_pk_fma_f32 v[208:209], v[212:213], v[28:29], v[208:209] op_sel:[1,1,0] op_sel_hi:[0,1,1] neg_lo:[0,1,0]
v_pk_fma_f32 v[210:211], v[214:215], v[30:31], v[210:211] op_sel:[1,1,0] op_sel_hi:[0,1,1] neg_lo:[0,1,0]
v_pk_fma_f32 v[204:205], v[208:209], v[28:29], v[204:205] op_sel_hi:[1,0,1]
v_pk_fma_f32 v[206:207], v[210:211], v[30:31], v[206:207] op_sel_hi:[1,0,1]
v_pk_fma_f32 v[204:205], v[208:209], v[28:29], v[204:205] op_sel:[1,1,0] op_sel_hi:[0,1,1] neg_lo:[0,1,0]
v_pk_fma_f32 v[206:207], v[210:211], v[30:31], v[206:207] op_sel:[1,1,0] op_sel_hi:[0,1,1] neg_lo:[0,1,0]
v_pk_fma_f32 v[200:201], v[204:205], v[28:29], v[200:201] op_sel_hi:[1,0,1]
v_pk_fma_f32 v[202:203], v[206:207], v[30:31], v[202:203] op_sel_hi:[1,0,1]
v_pk_fma_f32 v[200:201], v[204:205], v[28:29], v[200:201] op_sel:[1,1,0] op_sel_hi:[0,1,1] neg_lo:[0,1,0]
buffer_load_dwordx4 a[112:115], v2, s[20:23], s101 offen offset:0 sc1
v_pk_fma_f32 v[202:203], v[206:207], v[30:31], v[202:203] op_sel:[1,1,0] op_sel_hi:[0,1,1] neg_lo:[0,1,0]
v_pk_fma_f32 v[196:197], v[200:201], v[28:29], v[196:197] op_sel_hi:[1,0,1]
v_pk_fma_f32 v[198:199], v[202:203], v[30:31], v[198:199] op_sel_hi:[1,0,1]
v_pk_fma_f32 v[196:197], v[200:201], v[28:29], v[196:197] op_sel:[1,1,0] op_sel_hi:[0,1,1] neg_lo:[0,1,0]
v_pk_fma_f32 v[198:199], v[202:203], v[30:31], v[198:199] op_sel:[1,1,0] op_sel_hi:[0,1,1] neg_lo:[0,1,0]
v_pk_fma_f32 v[192:193], v[196:197], v[28:29], v[192:193] op_sel_hi:[1,0,1]
v_pk_fma_f32 v[194:195], v[198:199], v[30:31], v[194:195] op_sel_hi:[1,0,1]
v_pk_fma_f32 v[192:193], v[196:197], v[28:29], v[192:193] op_sel:[1,1,0] op_sel_hi:[0,1,1] neg_lo:[0,1,0]
v_pk_fma_f32 v[194:195], v[198:199], v[30:31], v[194:195] op_sel:[1,1,0] op_sel_hi:[0,1,1] neg_lo:[0,1,0]
v_pk_mul_f32 v[168:169], v[192:193], v[36:37] op_sel_hi:[1,0]
v_pk_mul_f32 v[170:171], v[194:195], v[38:39] op_sel_hi:[1,0]
v_pk_fma_f32 v[168:169], v[192:193], v[36:37], v[168:169] op_sel:[1,1,0] op_sel_hi:[0,1,1] neg_lo:[0,1,0]
v_pk_fma_f32 v[170:171], v[194:195], v[38:39], v[170:171] op_sel:[1,1,0] op_sel_hi:[0,1,1] neg_lo:[0,1,0]
buffer_load_dwordx4 a[116:119], v2, s[20:23], s101 offen offset:1024 sc1
v_pk_mov_b32 v[160:161], v[168:169], v[168:169] op_sel:[0,1]
v_pk_mov_b32 v[162:163], v[170:171], v[170:171] op_sel:[0,1]
s_nop 0
v_permlane32_swap_b32 v168, v160
v_permlane32_swap_b32 v169, v161
v_permlane32_swap_b32 v170, v162
v_permlane32_swap_b32 v171, v163
v_pk_add_f32 v[168:169], v[168:169], v[160:161]
v_pk_add_f32 v[170:171], v[170:171], v[162:163]
v_pk_mov_b32 v[160:161], v[168:169], v[168:169] op_sel:[0,1]
v_pk_mov_b32 v[162:163], v[170:171], v[170:171] op_sel:[0,1]
s_nop 0
v_permlane16_swap_b32 v168, v160
v_permlane16_swap_b32 v169, v161
v_permlane16_swap_b32 v170, v162
buffer_store_dwordx4 v[136:139], v61, s[20:23], s62 offen offset:2048 sc1
v_permlane16_swap_b32 v171, v163
v_pk_add_f32 v[168:169], v[168:169], v[160:161]
v_pk_add_f32 v[170:171], v[170:171], v[162:163]
v_pk_fma_f32 v[164:165], v[168:169], v[32:33], v[164:165] op_sel_hi:[1,0,1]
v_pk_fma_f32 v[166:167], v[170:171], v[34:35], v[166:167] op_sel_hi:[1,0,1]
v_pk_fma_f32 v[164:165], v[168:169], v[32:33], v[164:165] op_sel:[1,1,0] op_sel_hi:[0,1,1] neg_lo:[0,1,0]
v_pk_fma_f32 v[166:167], v[170:171], v[34:35], v[166:167] op_sel:[1,1,0] op_sel_hi:[0,1,1] neg_lo:[0,1,0]
v_pk_fma_f32 v[64:65], v[164:165], v[24:25], v[64:65] op_sel_hi:[1,0,1]
v_pk_fma_f32 v[96:97], v[166:167], v[26:27], v[96:97] op_sel_hi:[1,0,1]
L_pg12:
s_cbranch_execz L_pg16
v_pk_fma_f32 v[64:65], v[164:165], v[24:25], v[64:65] op_sel:[1,1,0] op_sel_hi:[0,1,1] neg_lo:[0,1,0]
v_pk_fma_f32 v[96:97], v[166:167], v[26:27], v[96:97] op_sel:[1,1,0] op_sel_hi:[0,1,1] neg_lo:[0,1,0]
v_pk_fma_f32 v[66:67], v[64:65], v[24:25], v[66:67] op_sel_hi:[1,0,1]
buffer_load_dwordx4 a[120:123], v2, s[20:23], s101 offen offset:2048 sc1
v_pk_fma_f32 v[98:99], v[96:97], v[26:27], v[98:99] op_sel_hi:[1,0,1]
v_pk_fma_f32 v[66:67], v[64:65], v[24:25], v[66:67] op_sel:[1,1,0] op_sel_hi:[0,1,1] neg_lo:[0,1,0]
v_pk_fma_f32 v[98:99], v[96:97], v[26:27], v[98:99] op_sel:[1,1,0] op_sel_hi:[0,1,1] neg_lo:[0,1,0]
v_pk_fma_f32 v[68:69], v[66:67], v[24:25], v[68:69] op_sel_hi:[1,0,1]
v_pk_fma_f32 v[100:101], v[98:99], v[26:27], v[100:101] op_sel_hi:[1,0,1]
v_pk_fma_f32 v[68:69], v[66:67], v[24:25], v[68:69] op_sel:[1,1,0] op_sel_hi:[0,1,1] neg_lo:[0,1,0]
v_pk_fma_f32 v[100:101], v[98:99], v[26:27], v[100:101] op_sel:[1,1,0] op_sel_hi:[0,1,1] neg_lo:[0,1,0]
v_pk_fma_f32 v[70:71], v[68:69], v[24:25], v[70:71] op_sel_hi:[1,0,1]
v_pk_fma_f32 v[102:103], v[100:101], v[26:27], v[102:103] op_sel_hi:[1,0,1]
v_pk_fma_f32 v[70:71], v[68:69], v[24:25], v[70:71] op_sel:[1,1,0] op_sel_hi:[0,1,1] neg_lo:[0,1,0]
buffer_load_dwordx4 a[124:127], v2, s[20:23], s101 offen offset:3072 sc1
s_add_u32 s101, s101, 4096
v_pk_fma_f32 v[102:103], v[100:101], v[26:27], v[102:103] op_sel:[1,1,0] op_sel_hi:[0,1,1] neg_lo:[0,1,0]
v_pk_fma_f32 v[72:73], v[70:71], v[24:25], v[72:73] op_sel_hi:[1,0,1]
v_pk_fma_f32 v[104:105], v[102:103], v[26:27], v[104:105] op_sel_hi:[1,0,1]
v_pk_fma_f32 v[72:73], v[70:71], v[24:25], v[72:73] op_sel:[1,1,0] op_sel_hi:[0,1,1] neg_lo:[0,1,0]
v_pk_fma_f32 v[104:105], v[102:103], v[26:27], v[104:105] op_sel:[1,1,0] op_sel_hi:[0,1,1] neg_lo:[0,1,0]
v_pk_fma_f32 v[74:75], v[72:73], v[24:25], v[74:75] op_sel_hi:[1,0,1]
v_pk_fma_f32 v[106:107], v[104:105], v[26:27], v[106:107] op_sel_hi:[1,0,1]
v_pk_fma_f32 v[74:75], v[72:73], v[24:25], v[74:75] op_sel:[1,1,0] op_sel_hi:[0,1,1] neg_lo:[0,1,0]
v_pk_fma_f32 v[106:107], v[104:105], v[26:27], v[106:107] op_sel:[1,1,0] op_sel_hi:[0,1,1] neg_lo:[0,1,0]
v_pk_fma_f32 v[76:77], v[74:75], v[24:25], v[76:77] op_sel_hi:[1,0,1]
buffer_load_dwordx4 a[128:131], v2, s[20:23], s101 offen offset:0 sc1
v_pk_fma_f32 v[108:109], v[106:107], v[26:27], v[108:109] op_sel_hi:[1,0,1]
v_pk_fma_f32 v[76:77], v[74:75], v[24:25], v[76:77] op_sel:[1,1,0] op_sel_hi:[0,1,1] neg_lo:[0,1,0]
v_pk_fma_f32 v[108:109], v[106:107], v[26:27], v[108:109] op_sel:[1,1,0] op_sel_hi:[0,1,1] neg_lo:[0,1,0]
v_pk_fma_f32 v[78:79], v[76:77], v[24:25], v[78:79] op_sel_hi:[1,0,1]
v_pk_fma_f32 v[110:111], v[108:109], v[26:27], v[110:111] op_sel_hi:[1,0,1]
v_pk_fma_f32 v[78:79], v[76:77], v[24:25], v[78:79] op_sel:[1,1,0] op_sel_hi:[0,1,1] neg_lo:[0,1,0]
v_pk_fma_f32 v[110:111], v[108:109], v[26:27], v[110:111] op_sel:[1,1,0] op_sel_hi:[0,1,1] neg_lo:[0,1,0]
v_pk_fma_f32 v[80:81], v[78:79], v[24:25], v[80:81] op_sel_hi:[1,0,1]
v_pk_fma_f32 v[112:113], v[110:111], v[26:27], v[112:113] op_sel_hi:[1,0,1]
v_pk_fma_f32 v[80:81], v[78:79], v[24:25], v[80:81] op_sel:[1,1,0] op_sel_hi:[0,1,1] neg_lo:[0,1,0]
buffer_store_dwordx4 v[140:143], v61, s[20:23], s62 offen offset:3072 sc1
v_pk_fma_f32 v[112:113], v[110:111], v[26:27], v[112:113] op_sel:[1,1,0] op_sel_hi:[0,1,1] neg_lo:[0,1,0]
v_pk_fma_f32 v[82:83], v[80:81], v[24:25], v[82:83] op_sel_hi:[1,0,1]
v_pk_fma_f32 v[114:115], v[112:113], v[26:27], v[114:115] op_sel_hi:[1,0,1]
v_pk_fma_f32 v[82:83], v[80:81], v[24:25], v[82:83] op_sel:[1,1,0] op_sel_hi:[0,1,1] neg_lo:[0,1,0]
v_pk_fma_f32 v[114:115], v[112:113], v[26:27], v[114:115] op_sel:[1,1,0] op_sel_hi:[0,1,1] neg_lo:[0,1,0]
v_lshrrev_b32 v13, 2, v1
v_and_b32 v14, 7, v13
v_lshlrev_b32 v14, 5, v14
v_lshl_add_u32 v13, v13, 8, v14
v_and_b32 v14, 3, v1
v_lshl_add_u32 v12, v14, 3, v13
v_xor_b32 v13, 32, v12
v_xor_b32 v14, 64, v12
v_xor_b32 v15, 96, v12
v_xor_b32 v16, 128, v12
v_xor_b32 v17, 160, v12
v_xor_b32 v18, 192, v12
v_xor_b32 v19, 224, v12
s_barrier
v_pk_fma_f32 v[84:85], v[82:83], v[24:25], v[84:85] op_sel_hi:[1,0,1]
ds_read_b64_tr_b16 a[160:161], v12 offset:0
ds_read_b64_tr_b16 a[162:163], v12 offset:4096
v_pk_fma_f32 v[116:117], v[114:115], v[26:27], v[116:117] op_sel_hi:[1,0,1]
v_pk_fma_f32 v[84:85], v[82:83], v[24:25], v[84:85] op_sel:[1,1,0] op_sel_hi:[0,1,1] neg_lo:[0,1,0]
buffer_load_dwordx4 a[132:135], v2, s[20:23], s101 offen offset:1024 sc1
v_pk_fma_f32 v[116:117], v[114:115], v[26:27], v[116:117] op_sel:[1,1,0] op_sel_hi:[0,1,1] neg_lo:[0,1,0]
v_pk_fma_f32 v[86:87], v[84:85], v[24:25], v[86:87] op_sel_hi:[1,0,1]
v_pk_fma_f32 v[118:119], v[116:117], v[26:27], v[118:119] op_sel_hi:[1,0,1]
ds_read_b64_tr_b16 a[164:165], v13 offset:0
ds_read_b64_tr_b16 a[166:167], v13 offset:4096
v_pk_fma_f32 v[86:87], v[84:85], v[24:25], v[86:87] op_sel:[1,1,0] op_sel_hi:[0,1,1] neg_lo:[0,1,0]
v_pk_fma_f32 v[118:119], v[116:117], v[26:27], v[118:119] op_sel:[1,1,0] op_sel_hi:[0,1,1] neg_lo:[0,1,0]
buffer_store_dwordx4 v[144:147], v62, s[20:23], s63 offen offset:0 sc1
v_pk_fma_f32 v[88:89], v[86:87], v[24:25], v[88:89] op_sel_hi:[1,0,1]
v_pk_fma_f32 v[120:121], v[118:119], v[26:27], v[120:121] op_sel_hi:[1,0,1]
ds_read_b64_tr_b16 a[168:169], v14 offset:0
ds_read_b64_tr_b16 a[170:171], v14 offset:4096
v_pk_fma_f32 v[88:89], v[86:87], v[24:25], v[88:89] op_sel:[1,1,0] op_sel_hi:[0,1,1] neg_lo:[0,1,0]
v_pk_fma_f32 v[120:121], v[118:119], v[26:27], v[120:121] op_sel:[1,1,0] op_sel_hi:[0,1,1] neg_lo:[0,1,0]
v_pk_fma_f32 v[90:91], v[88:89], v[24:25], v[90:91] op_sel_hi:[1,0,1]
buffer_load_dwordx4 a[136:139], v2, s[20:23], s101 offen offset:2048 sc1
v_pk_fma_f32 v[122:123], v[120:121], v[26:27], v[122:123] op_sel_hi:[1,0,1]
v_pk_fma_f32 v[90:91], v[88:89], v[24:25], v[90:91] op_sel:[1,1,0] op_sel_hi:[0,1,1] neg_lo:[0,1,0]
ds_read_b64_tr_b16 a[172:173], v15 offset:0
ds_read_b64_tr_b16 a[174:175], v15 offset:4096
v_pk_fma_f32 v[122:123], v[120:121], v[26:27], v[122:123] op_sel:[1,1,0] op_sel_hi:[0,1,1] neg_lo:[0,1,0]
v_pk_fma_f32 v[92:93], v[90:91], v[24:25], v[92:93] op_sel_hi:[1,0,1]
v_pk_fma_f32 v[124:125], v[122:123], v[26:27], v[124:125] op_sel_hi:[1,0,1]
buffer_store_dwordx4 v[148:151], v62, s[20:23], s63 offen offset:2048 sc1
v_pk_fma_f32 v[92:93], v[90:91], v[24:25], v[92:93] op_sel:[1,1,0] op_sel_hi:[0,1,1] neg_lo:[0,1,0]
v_pk_fma_f32 v[124:125], v[122:123], v[26:27], v[124:125] op_sel:[1,1,0] op_sel_hi:[0,1,1] neg_lo:[0,1,0]
ds_read_b64_tr_b16 a[176:177], v16 offset:0
ds_read_b64_tr_b16 a[178:179], v16 offset:4096
v_pk_fma_f32 v[94:95], v[92:93], v[24:25], v[94:95] op_sel_hi:[1,0,1]
v_pk_fma_f32 v[126:127], v[124:125], v[26:27], v[126:127] op_sel_hi:[1,0,1]
buffer_load_dwordx4 a[140:143], v2, s[20:23], s101 offen offset:3072 sc1
s_add_u32 s101, s101, 4096
v_pk_fma_f32 v[94:95], v[92:93], v[24:25], v[94:95] op_sel:[1,1,0] op_sel_hi:[0,1,1] neg_lo:[0,1,0]
v_pk_fma_f32 v[126:127], v[124:125], v[26:27], v[126:127] op_sel:[1,1,0] op_sel_hi:[0,1,1] neg_lo:[0,1,0]
s_waitcnt vmcnt(12) lgkmcnt(6)
v_mfma_f32_16x16x32_bf16 v[128:131], a[160:163], a[96:99], 0
ds_read_b64_tr_b16 a[180:181], v17 offset:0
s_lshl_b32 s45, s3, 11
v_mfma_f32_16x16x32_bf16 v[160:163], a[160:163], a[100:103], 0
ds_read_b64_tr_b16 a[182:183], v17 offset:4096
s_add_u32 s45, s45, 148480
v_mfma_f32_16x16x32_bf16 v[192:195], a[160:163], a[104:107], 0
buffer_load_dwordx4 a[144:147], v2, s[20:23], s101 offen offset:0 sc1
v_mfma_f32_16x16x32_bf16 v[224:227], a[160:163], a[108:111], 0
v_lshrrev_b32 v46, 1, v1
v_xor_b32_e64 v46, v46, v1
v_mfma_f32_16x16x32_bf16 v[228:231], a[164:167], a[108:111], 0
ds_read_b64_tr_b16 a[184:185], v18 offset:0
v_accvgpr_read_b32 v26, a152
v_mfma_f32_16x16x32_bf16 v[196:199], a[164:167], a[104:107], 0
ds_read_b64_tr_b16 a[186:187], v18 offset:4096
v_and_b32 v46, 4, v46
v_mfma_f32_16x16x32_bf16 v[164:167], a[164:167], a[100:103], 0
v_mul_u32_u24 v46, 3, v46
v_xor_b32 v46, v46, v1
v_mfma_f32_16x16x32_bf16 v[132:135], a[164:167], a[96:99], 0
v_accvgpr_read_b32 v27, a153
s_waitcnt lgkmcnt(6)
v_mfma_f32_16x16x32_bf16 v[136:139], a[168:171], a[96:99], 0
ds_read_b64_tr_b16 a[188:189], v19 offset:0
v_and_b32 v46, 15, v46
v_mfma_f32_16x16x32_bf16 v[168:171], a[168:171], a[100:103], 0
ds_read_b64_tr_b16 a[190:191], v19 offset:4096
v_lshrrev_b32 v47, 2, v46
v_mfma_f32_16x16x32_bf16 v[200:203], a[168:171], a[104:107], 0
buffer_load_dwordx4 a[148:151], v2, s[20:23], s101 offen offset:1024 sc1
v_mfma_f32_16x16x32_bf16 v[232:235], a[168:171], a[108:111], 0
v_lshrrev_b32_e64 v36, 4, v1
v_mfma_f32_16x16x32_bf16 v[236:239], a[172:175], a[108:111], 0
ds_read_b64_tr_b16 a[160:161], v12 offset:8192
v_xor_b32_e64 v47, v47, v36
v_mfma_f32_16x16x32_bf16 v[204:207], a[172:175], a[104:107], 0
ds_read_b64_tr_b16 a[162:163], v12 offset:12288
v_lshlrev_b32_e64 v46, 5, v46
v_mfma_f32_16x16x32_bf16 v[172:175], a[172:175], a[100:103], 0
v_lshl_add_u32 v46, v47, 3, v46
v_mfma_f32_16x16x32_bf16 v[140:143], a[172:175], a[96:99], 0
v_add_u32 v46, s45, v46
s_waitcnt lgkmcnt(6)
v_mfma_f32_16x16x32_bf16 v[144:147], a[176:179], a[96:99], 0
ds_read_b64_tr_b16 a[164:165], v13 offset:8192
v_and_b32 v36, 1, v36
v_mfma_f32_16x16x32_bf16 v[176:179], a[176:179], a[100:103], 0
ds_read_b64_tr_b16 a[166:167], v13 offset:12288
v_xor_b32 v36, v36, v1
v_mfma_f32_16x16x32_bf16 v[208:211], a[176:179], a[104:107], 0
buffer_load_dwordx4 a[152:155], v2, s[20:23], s101 offen offset:2048 sc1
v_mfma_f32_16x16x32_bf16 v[240:243], a[176:179], a[108:111], 0
v_lshrrev_b32_e64 v47, 5, v1
v_mfma_f32_16x16x32_bf16 v[244:247], a[180:183], a[108:111], 0
ds_read_b64_tr_b16 a[168:169], v14 offset:8192
v_lshlrev_b32_e64 v47, 8, v47
v_mfma_f32_16x16x32_bf16 v[212:215], a[180:183], a[104:107], 0
ds_read_b64_tr_b16 a[170:171], v14 offset:12288
v_lshl_add_u32 v47, v36, 3, v47
v_mfma_f32_16x16x32_bf16 v[180:183], a[180:183], a[100:103], 0
v_add_u32 v47, s45, v47
v_mfma_f32_16x16x32_bf16 v[148:151], a[180:183], a[96:99], 0
v_xor_b32 v36, 16, v47
s_waitcnt lgkmcnt(6)
v_mfma_f32_16x16x32_bf16 v[152:155], a[184:187], a[96:99], 0
ds_read_b64_tr_b16 a[172:173], v15 offset:8192
s_bfe_u32 s45, s5, 0x20001
v_mfma_f32_16x16x32_bf16 v[184:187], a[184:187], a[100:103], 0
ds_read_b64_tr_b16 a[174:175], v15 offset:12288
v_mfma_f32_16x16x32_bf16 v[216:219], a[184:187], a[104:107], 0
buffer_load_dwordx4 a[156:159], v2, s[20:23], s101 offen offset:3072 sc1
v_mfma_f32_16x16x32_bf16 v[248:251], a[184:187], a[108:111], 0
s_add_u32 s101, s101, 4096
s_lshl_b32 s45, s45, 2
s_and_b32 s46, s5, 1
v_mfma_f32_16x16x32_bf16 v[252:255], a[188:191], a[108:111], 0
ds_read_b64_tr_b16 a[176:177], v16 offset:8192
s_add_u32 s45, s45, s46
v_mfma_f32_16x16x32_bf16 v[220:223], a[188:191], a[104:107], 0
ds_read_b64_tr_b16 a[178:179], v16 offset:12288
v_mfma_f32_16x16x32_bf16 v[188:191], a[188:191], a[100:103], 0
s_add_u32 s45, s45, 28
s_lshl_b32 s45, s45, 12
v_mfma_f32_16x16x32_bf16 v[156:159], a[188:191], a[96:99], 0
s_add_u32 s46, s45, s61
s_waitcnt vmcnt(11) lgkmcnt(6)
v_mfma_f32_16x16x32_bf16 v[128:131], a[160:163], a[112:115], v[128:131]
ds_read_b64_tr_b16 a[180:181], v17 offset:8192
v_mfma_f32_16x16x32_bf16 v[160:163], a[160:163], a[116:119], v[160:163]
ds_read_b64_tr_b16 a[182:183], v17 offset:12288
s_add_u32 s47, s46, 8192
v_mfma_f32_16x16x32_bf16 v[192:195], a[160:163], a[120:123], v[192:195]
buffer_load_dwordx4 a[96:99], v2, s[20:23], s101 offen offset:0 sc1
v_mfma_f32_16x16x32_bf16 v[224:227], a[160:163], a[124:127], v[224:227]
v_mul_f32 v38, v64, v20
v_mul_f32 v42, v64, v21
v_mfma_f32_16x16x32_bf16 v[228:231], a[164:167], a[124:127], v[228:231]
ds_read_b64_tr_b16 a[184:185], v18 offset:8192
v_mfma_f32_16x16x32_bf16 v[196:199], a[164:167], a[120:123], v[196:199]
ds_read_b64_tr_b16 a[186:187], v18 offset:12288
v_fma_f32 v38, -v65, v21, v38
v_mfma_f32_16x16x32_bf16 v[164:167], a[164:167], a[116:119], v[164:167]
v_fmac_f32 v42, v65, v20
v_mul_f32 v39, v72, v20
v_mfma_f32_16x16x32_bf16 v[132:135], a[164:167], a[112:115], v[132:135]
s_waitcnt lgkmcnt(6)
v_mfma_f32_16x16x32_bf16 v[136:139], a[168:171], a[112:115], v[136:139]
ds_read_b64_tr_b16 a[188:189], v19 offset:8192
v_mul_f32 v43, v72, v21
v_mfma_f32_16x16x32_bf16 v[168:171], a[168:171], a[116:119], v[168:171]
ds_read_b64_tr_b16 a[190:191], v19 offset:12288
v_fma_f32 v39, -v73, v21, v39
v_mfma_f32_16x16x32_bf16 v[200:203], a[168:171], a[120:123], v[200:203]
buffer_load_dwordx4 a[100:103], v2, s[20:23], s101 offen offset:1024 sc1
v_mfma_f32_16x16x32_bf16 v[232:235], a[168:171], a[124:127], v[232:235]
v_fmac_f32 v43, v73, v20
v_mfma_f32_16x16x32_bf16 v[236:239], a[172:175], a[124:127], v[236:239]
ds_read_b64_tr_b16 a[160:161], v12 offset:16384
v_mul_f32 v40, v80, v20
v_mfma_f32_16x16x32_bf16 v[204:207], a[172:175], a[120:123], v[204:207]
ds_read_b64_tr_b16 a[162:163], v12 offset:20480
v_mul_f32_e64 v44, v80, v21
v_mfma_f32_16x16x32_bf16 v[172:175], a[172:175], a[116:119], v[172:175]
v_fma_f32 v40, -v81, v21, v40
v_fmac_f32 v44, v81, v20
v_mfma_f32_16x16x32_bf16 v[140:143], a[172:175], a[112:115], v[140:143]
s_waitcnt lgkmcnt(6)
v_mfma_f32_16x16x32_bf16 v[144:147], a[176:179], a[112:115], v[144:147]
ds_read_b64_tr_b16 a[164:165], v13 offset:16384
v_mul_f32 v41, v88, v20
v_mfma_f32_16x16x32_bf16 v[176:179], a[176:179], a[116:119], v[176:179]
ds_read_b64_tr_b16 a[166:167], v13 offset:20480
v_mul_f32 v45, v88, v21
v_mfma_f32_16x16x32_bf16 v[208:211], a[176:179], a[120:123], v[208:211]
buffer_load_dwordx4 a[104:107], v2, s[20:23], s101 offen offset:2048 sc1
v_mfma_f32_16x16x32_bf16 v[240:243], a[176:179], a[124:127], v[240:243]
v_fma_f32 v41, -v89, v21, v41
v_mfma_f32_16x16x32_bf16 v[244:247], a[180:183], a[124:127], v[244:247]
ds_read_b64_tr_b16 a[168:169], v14 offset:16384
v_fmac_f32_e64 v45, v89, v20
v_mfma_f32_16x16x32_bf16 v[212:215], a[180:183], a[120:123], v[212:215]
ds_read_b64_tr_b16 a[170:171], v14 offset:20480
v_cvt_pk_bf16_f32 v28, v38, v39
v_mfma_f32_16x16x32_bf16 v[180:183], a[180:183], a[116:119], v[180:183]
v_cvt_pk_bf16_f32 v29, v40, v41
v_mfma_f32_16x16x32_bf16 v[148:151], a[180:183], a[112:115], v[148:151]
v_cvt_pk_bf16_f32 v30, -v42, -v43
s_waitcnt lgkmcnt(6)
v_mfma_f32_16x16x32_bf16 v[152:155], a[184:187], a[112:115], v[152:155]
ds_read_b64_tr_b16 a[172:173], v15 offset:16384
v_cvt_pk_bf16_f32 v31, -v44, -v45
v_mfma_f32_16x16x32_bf16 v[184:187], a[184:187], a[116:119], v[184:187]
ds_read_b64_tr_b16 a[174:175], v15 offset:20480
v_mfma_f32_16x16x32_bf16 v[216:219], a[184:187], a[120:123], v[216:219]
buffer_load_dwordx4 a[108:111], v2, s[20:23], s101 offen offset:3072 sc1
v_mfma_f32_16x16x32_bf16 v[248:251], a[184:187], a[124:127], v[248:251]
s_add_u32 s101, s101, 4096
v_mfma_f32_16x16x32_bf16 v[252:255], a[188:191], a[124:127], v[252:255]
ds_read_b64_tr_b16 a[176:177], v16 offset:16384
v_mfma_f32_16x16x32_bf16 v[220:223], a[188:191], a[120:123], v[220:223]
ds_read_b64_tr_b16 a[178:179], v16 offset:20480
v_mfma_f32_16x16x32_bf16 v[188:191], a[188:191], a[116:119], v[188:191]
ds_write_b64 v46, v[28:29] offset:0
v_mfma_f32_16x16x32_bf16 v[156:159], a[188:191], a[112:115], v[156:159]
s_waitcnt vmcnt(8) lgkmcnt(7)
v_mfma_f32_16x16x32_bf16 v[128:131], a[160:163], a[128:131], v[128:131]
ds_read_b64_tr_b16 a[180:181], v17 offset:16384
s_lshl_b32 s50, s6, 6
v_mfma_f32_16x16x32_bf16 v[160:163], a[160:163], a[132:135], v[160:163]
ds_read_b64_tr_b16 a[182:183], v17 offset:20480
s_add_u32 s50, s50, s5
v_mfma_f32_16x16x32_bf16 v[192:195], a[160:163], a[136:139], v[192:195]
buffer_load_dwordx4 a[112:115], v2, s[20:23], s101 offen offset:0 sc1
v_mfma_f32_16x16x32_bf16 v[224:227], a[160:163], a[140:143], v[224:227]
ds_write_b64 v46, v[30:31] offset:1024
v_mfma_f32_16x16x32_bf16 v[228:231], a[164:167], a[140:143], v[228:231]
ds_read_b64_tr_b16 a[184:185], v18 offset:16384
v_mul_f32_e64 v38, v96, v22
v_mfma_f32_16x16x32_bf16 v[196:199], a[164:167], a[136:139], v[196:199]
ds_read_b64_tr_b16 a[186:187], v18 offset:20480
v_mul_f32 v42, v96, v23
v_mfma_f32_16x16x32_bf16 v[164:167], a[164:167], a[132:135], v[164:167]
v_fma_f32 v38, -v97, v23, v38
v_fmac_f32 v42, v97, v22
v_mfma_f32_16x16x32_bf16 v[132:135], a[164:167], a[128:131], v[132:135]
v_mul_f32 v39, v104, v22
s_waitcnt lgkmcnt(8)
v_mfma_f32_16x16x32_bf16 v[136:139], a[168:171], a[128:131], v[136:139]
ds_read_b64_tr_b16 a[188:189], v19 offset:16384
v_mul_f32_e64 v43, v104, v23
v_mfma_f32_16x16x32_bf16 v[168:171], a[168:171], a[132:135], v[168:171]
ds_read_b64_tr_b16 a[190:191], v19 offset:20480
v_fma_f32 v39, -v105, v23, v39
v_mfma_f32_16x16x32_bf16 v[200:203], a[168:171], a[136:139], v[200:203]
buffer_load_dwordx4 a[116:119], v2, s[20:23], s101 offen offset:1024 sc1
v_mfma_f32_16x16x32_bf16 v[232:235], a[168:171], a[140:143], v[232:235]
v_fmac_f32 v43, v105, v22
v_mul_f32 v40, v112, v22
v_mfma_f32_16x16x32_bf16 v[236:239], a[172:175], a[140:143], v[236:239]
ds_read_b64_tr_b16 a[160:161], v12 offset:24576
v_mul_f32_e64 v44, v112, v23
v_mfma_f32_16x16x32_bf16 v[204:207], a[172:175], a[136:139], v[204:207]
ds_read_b64_tr_b16 a[162:163], v12 offset:28672
v_fma_f32 v40, -v113, v23, v40
v_mfma_f32_16x16x32_bf16 v[172:175], a[172:175], a[132:135], v[172:175]
v_fmac_f32 v44, v113, v22
v_mul_f32 v41, v120, v22
v_mfma_f32_16x16x32_bf16 v[140:143], a[172:175], a[128:131], v[140:143]
v_mul_f32 v45, v120, v23
s_waitcnt lgkmcnt(7)
v_mfma_f32_16x16x32_bf16 v[144:147], a[176:179], a[128:131], v[144:147]
ds_read_b64_tr_b16 a[164:165], v13 offset:24576
v_fma_f32 v41, -v121, v23, v41
v_mfma_f32_16x16x32_bf16 v[176:179], a[176:179], a[132:135], v[176:179]
ds_read_b64_tr_b16 a[166:167], v13 offset:28672
v_fmac_f32_e64 v45, v121, v22
v_mfma_f32_16x16x32_bf16 v[208:211], a[176:179], a[136:139], v[208:211]
buffer_load_dwordx4 a[120:123], v2, s[20:23], s101 offen offset:2048 sc1
v_mfma_f32_16x16x32_bf16 v[240:243], a[176:179], a[140:143], v[240:243]
v_cvt_pk_bf16_f32 v32, v38, v39
v_cvt_pk_bf16_f32 v33, v40, v41
v_mfma_f32_16x16x32_bf16 v[244:247], a[180:183], a[140:143], v[244:247]
ds_read_b64_tr_b16 a[168:169], v14 offset:24576
v_cvt_pk_bf16_f32 v34, -v42, -v43
v_mfma_f32_16x16x32_bf16 v[212:215], a[180:183], a[136:139], v[212:215]
ds_read_b64_tr_b16 a[170:171], v14 offset:28672
v_cvt_pk_bf16_f32 v35, -v44, -v45
v_mfma_f32_16x16x32_bf16 v[180:183], a[180:183], a[132:135], v[180:183]
ds_write_b64 v46, v[32:33] offset:512
v_mfma_f32_16x16x32_bf16 v[148:151], a[180:183], a[128:131], v[148:151]
s_lshl_b32 s50, s50, 2
v_add_u32 v52, 65536, v12
v_add_u32 v53, 65536, v13
s_waitcnt lgkmcnt(7)
v_mfma_f32_16x16x32_bf16 v[152:155], a[184:187], a[128:131], v[152:155]
ds_read_b64_tr_b16 a[172:173], v15 offset:24576
s_add_u32 s50, s50, 28311680
v_mfma_f32_16x16x32_bf16 v[184:187], a[184:187], a[132:135], v[184:187]
ds_read_b64_tr_b16 a[174:175], v15 offset:28672
v_mov_b32_e64 v24, 1
v_mfma_f32_16x16x32_bf16 v[216:219], a[184:187], a[136:139], v[216:219]
buffer_load_dwordx4 a[124:127], v2, s[20:23], s101 offen offset:3072 sc1
v_mfma_f32_16x16x32_bf16 v[248:251], a[184:187], a[140:143], v[248:251]
s_add_u32 s101, s101, 4096
v_min_u32 v25, 1, v1
v_lshlrev_b32 v25, 30, v25
v_mfma_f32_16x16x32_bf16 v[252:255], a[188:191], a[140:143], v[252:255]
ds_read_b64_tr_b16 a[176:177], v16 offset:24576
buffer_store_dword v24, v25, s[20:23], s50 offen sc1
v_mfma_f32_16x16x32_bf16 v[220:223], a[188:191], a[136:139], v[220:223]
ds_read_b64_tr_b16 a[178:179], v16 offset:28672
v_add_u32 v54, 65536, v14
v_mfma_f32_16x16x32_bf16 v[188:191], a[188:191], a[132:135], v[188:191]
ds_write_b64 v46, v[34:35] offset:1536
v_mfma_f32_16x16x32_bf16 v[156:159], a[188:191], a[128:131], v[156:159]
ds_read_b64_tr_b16 a[0:1], v47 offset:0
s_waitcnt vmcnt(9) lgkmcnt(9)
v_mfma_f32_16x16x32_bf16 v[128:131], a[160:163], a[144:147], v[128:131]
ds_read_b64_tr_b16 a[180:181], v17 offset:24576
v_add_u32 v55, 65536, v15
v_mfma_f32_16x16x32_bf16 v[160:163], a[160:163], a[148:151], v[160:163]
ds_read_b64_tr_b16 a[182:183], v17 offset:28672
v_add_u32 v56, 65536, v16
v_mfma_f32_16x16x32_bf16 v[192:195], a[160:163], a[152:155], v[192:195]
buffer_load_dwordx4 a[128:131], v2, s[20:23], s101 offen offset:0 sc1
v_mfma_f32_16x16x32_bf16 v[224:227], a[160:163], a[156:159], v[224:227]
ds_read_b64_tr_b16 a[2:3], v36 offset:256
v_add_u32 v57, 65536, v17
v_add_u32 v58, 65536, v18
v_mfma_f32_16x16x32_bf16 v[228:231], a[164:167], a[156:159], v[228:231]
ds_read_b64_tr_b16 a[184:185], v18 offset:24576
v_add_u32 v59, 65536, v19
v_mfma_f32_16x16x32_bf16 v[196:199], a[164:167], a[152:155], v[196:199]
ds_read_b64_tr_b16 a[186:187], v18 offset:28672
v_add_u32 v3, 65536, v10
v_mfma_f32_16x16x32_bf16 v[164:167], a[164:167], a[148:151], v[164:167]
ds_read_b64_tr_b16 a[4:5], v47 offset:1024
v_add_u32 v4, 65536, v11
v_mfma_f32_16x16x32_bf16 v[132:135], a[164:167], a[144:147], v[132:135]
ds_read_b64_tr_b16 a[6:7], v36 offset:1280
s_waitcnt lgkmcnt(11)
v_mfma_f32_16x16x32_bf16 v[136:139], a[168:171], a[144:147], v[136:139]
ds_read_b64_tr_b16 a[188:189], v19 offset:24576
v_mul_f32 v38, v66, v20
v_mfma_f32_16x16x32_bf16 v[168:171], a[168:171], a[148:151], v[168:171]
ds_read_b64_tr_b16 a[190:191], v19 offset:28672
v_mul_f32 v42, v66, v21
v_mfma_f32_16x16x32_bf16 v[200:203], a[168:171], a[152:155], v[200:203]
buffer_load_dwordx4 a[132:135], v2, s[20:23], s101 offen offset:1024 sc1
v_mfma_f32_16x16x32_bf16 v[232:235], a[168:171], a[156:159], v[232:235]
v_fma_f32 v38, -v67, v21, v38
s_barrier
v_mfma_f32_16x16x32_bf16 v[236:239], a[172:175], a[156:159], v[236:239]
ds_read_b64_tr_b16 a[160:161], v52 offset:0
v_fmac_f32 v42, v67, v20
v_mfma_f32_16x16x32_bf16 v[204:207], a[172:175], a[152:155], v[204:207]
ds_read_b64_tr_b16 a[162:163], v52 offset:4096
v_mul_f32 v39, v74, v20
v_mfma_f32_16x16x32_bf16 v[172:175], a[172:175], a[148:151], v[172:175]
v_mul_f32 v43, v74, v21
v_fma_f32 v39, -v75, v21, v39
v_mfma_f32_16x16x32_bf16 v[140:143], a[172:175], a[144:147], v[140:143]
v_fmac_f32 v43, v75, v20
s_waitcnt lgkmcnt(9)
v_mfma_f32_16x16x32_bf16 v[144:147], a[176:179], a[144:147], v[144:147]
ds_read_b64_tr_b16 a[164:165], v53 offset:0
v_mul_f32_e64 v40, v82, v20
v_mfma_f32_16x16x32_bf16 v[176:179], a[176:179], a[148:151], v[176:179]
ds_read_b64_tr_b16 a[166:167], v53 offset:4096
v_mul_f32_e64 v44, v82, v21
v_mfma_f32_16x16x32_bf16 v[208:211], a[176:179], a[152:155], v[208:211]
buffer_load_dwordx4 a[136:139], v2, s[20:23], s101 offen offset:2048 sc1
v_mfma_f32_16x16x32_bf16 v[240:243], a[176:179], a[156:159], v[240:243]
v_fma_f32 v40, -v83, v21, v40
v_fmac_f32_e64 v44, v83, v20
v_mfma_f32_16x16x32_bf16 v[244:247], a[180:183], a[156:159], v[244:247]
ds_read_b64_tr_b16 a[168:169], v54 offset:0
v_mfma_f32_16x16x32_bf16 v[212:215], a[180:183], a[152:155], v[212:215]
ds_read_b64_tr_b16 a[170:171], v54 offset:4096
v_mfma_f32_16x16x32_bf16 v[180:183], a[180:183], a[148:151], v[180:183]
s_waitcnt lgkmcnt(12)
buffer_store_dwordx4 a[0:3], v61, s[20:23], s46 offen offset:0 sc1
v_mfma_f32_16x16x32_bf16 v[148:151], a[180:183], a[144:147], v[148:151]
v_mul_f32 v41, v90, v20
s_waitcnt lgkmcnt(6)
v_mfma_f32_16x16x32_bf16 v[152:155], a[184:187], a[144:147], v[152:155]
ds_read_b64_tr_b16 a[172:173], v55 offset:0
v_mul_f32 v45, v90, v21
v_mfma_f32_16x16x32_bf16 v[184:187], a[184:187], a[148:151], v[184:187]
ds_read_b64_tr_b16 a[174:175], v55 offset:4096
v_fma_f32 v41, -v91, v21, v41
v_mfma_f32_16x16x32_bf16 v[216:219], a[184:187], a[152:155], v[216:219]
buffer_load_dwordx4 a[140:143], v2, s[20:23], s101 offen offset:3072 sc1
v_mfma_f32_16x16x32_bf16 v[248:251], a[184:187], a[156:159], v[248:251]
s_add_u32 s101, s101, 4096
v_fmac_f32_e64 v45, v91, v20
v_cvt_pk_bf16_f32 v28, v38, v39
v_mfma_f32_16x16x32_bf16 v[252:255], a[188:191], a[156:159], v[252:255]
ds_read_b64_tr_b16 a[176:177], v56 offset:0
v_cvt_pk_bf16_f32 v29, v40, v41
v_mfma_f32_16x16x32_bf16 v[220:223], a[188:191], a[152:155], v[220:223]
ds_read_b64_tr_b16 a[178:179], v56 offset:4096
v_cvt_pk_bf16_f32 v30, -v42, -v43
v_mfma_f32_16x16x32_bf16 v[188:191], a[188:191], a[148:151], v[188:191]
v_cvt_pk_bf16_f32 v31, -v44, -v45
v_mfma_f32_16x16x32_bf16 v[156:159], a[188:191], a[144:147], v[156:159]
s_waitcnt vmcnt(10) lgkmcnt(6)
v_mfma_f32_16x16x32_bf16 v[128:131], a[160:163], a[96:99], v[128:131]
ds_read_b64_tr_b16 a[180:181], v57 offset:0
v_mfma_f32_16x16x32_bf16 v[160:163], a[160:163], a[100:103], v[160:163]
ds_read_b64_tr_b16 a[182:183], v57 offset:4096
v_mfma_f32_16x16x32_bf16 v[192:195], a[160:163], a[104:107], v[192:195]
buffer_load_dwordx4 a[144:147], v2, s[20:23], s101 offen offset:0 sc1
v_mfma_f32_16x16x32_bf16 v[224:227], a[160:163], a[108:111], v[224:227]
ds_write_b64 v46, v[28:29] offset:0
v_mfma_f32_16x16x32_bf16 v[228:231], a[164:167], a[108:111], v[228:231]
ds_read_b64_tr_b16 a[184:185], v58 offset:0
v_mfma_f32_16x16x32_bf16 v[196:199], a[164:167], a[104:107], v[196:199]
ds_read_b64_tr_b16 a[186:187], v58 offset:4096
v_mfma_f32_16x16x32_bf16 v[164:167], a[164:167], a[100:103], v[164:167]
ds_write_b64 v46, v[30:31] offset:1024
v_mfma_f32_16x16x32_bf16 v[132:135], a[164:167], a[96:99], v[132:135]
v_mul_f32 v38, v98, v22
s_waitcnt lgkmcnt(8)
v_mfma_f32_16x16x32_bf16 v[136:139], a[168:171], a[96:99], v[136:139]
ds_read_b64_tr_b16 a[188:189], v59 offset:0
v_mul_f32 v42, v98, v23
v_mfma_f32_16x16x32_bf16 v[168:171], a[168:171], a[100:103], v[168:171]
ds_read_b64_tr_b16 a[190:191], v59 offset:4096
v_fma_f32 v38, -v99, v23, v38
v_mfma_f32_16x16x32_bf16 v[200:203], a[168:171], a[104:107], v[200:203]
buffer_load_dwordx4 a[148:151], v2, s[20:23], s101 offen offset:1024 sc1
v_mfma_f32_16x16x32_bf16 v[232:235], a[168:171], a[108:111], v[232:235]
v_fmac_f32 v42, v99, v22
v_mul_f32 v39, v106, v22
v_mfma_f32_16x16x32_bf16 v[236:239], a[172:175], a[108:111], v[236:239]
ds_read_b64_tr_b16 a[160:161], v52 offset:8192
v_mul_f32_e64 v43, v106, v23
v_mfma_f32_16x16x32_bf16 v[204:207], a[172:175], a[104:107], v[204:207]
ds_read_b64_tr_b16 a[162:163], v52 offset:12288
v_fma_f32 v39, -v107, v23, v39
v_mfma_f32_16x16x32_bf16 v[172:175], a[172:175], a[100:103], v[172:175]
v_fmac_f32 v43, v107, v22
v_mul_f32 v40, v114, v22
v_mfma_f32_16x16x32_bf16 v[140:143], a[172:175], a[96:99], v[140:143]
v_mul_f32 v44, v114, v23
s_waitcnt lgkmcnt(8)
v_mfma_f32_16x16x32_bf16 v[144:147], a[176:179], a[96:99], v[144:147]
ds_read_b64_tr_b16 a[164:165], v53 offset:8192
v_fma_f32 v40, -v115, v23, v40
v_mfma_f32_16x16x32_bf16 v[176:179], a[176:179], a[100:103], v[176:179]
ds_read_b64_tr_b16 a[166:167], v53 offset:12288
v_fmac_f32_e64 v44, v115, v22
v_mfma_f32_16x16x32_bf16 v[208:211], a[176:179], a[104:107], v[208:211]
buffer_load_dwordx4 a[152:155], v2, s[20:23], s101 offen offset:2048 sc1
v_mfma_f32_16x16x32_bf16 v[240:243], a[176:179], a[108:111], v[240:243]
v_mfma_f32_16x16x32_bf16 v[244:247], a[180:183], a[108:111], v[244:247]
ds_read_b64_tr_b16 a[168:169], v54 offset:8192
v_mfma_f32_16x16x32_bf16 v[212:215], a[180:183], a[104:107], v[212:215]
ds_read_b64_tr_b16 a[170:171], v54 offset:12288
v_mfma_f32_16x16x32_bf16 v[180:183], a[180:183], a[100:103], v[180:183]
buffer_store_dwordx4 a[4:7], v61, s[20:23], s47 offen offset:0 sc1
v_mfma_f32_16x16x32_bf16 v[148:151], a[180:183], a[96:99], v[148:151]
v_mul_f32 v41, v122, v22
s_waitcnt lgkmcnt(6)
v_mfma_f32_16x16x32_bf16 v[152:155], a[184:187], a[96:99], v[152:155]
ds_read_b64_tr_b16 a[172:173], v55 offset:8192
v_mul_f32_e64 v45, v122, v23
v_mfma_f32_16x16x32_bf16 v[184:187], a[184:187], a[100:103], v[184:187]
ds_read_b64_tr_b16 a[174:175], v55 offset:12288
v_fma_f32 v41, -v123, v23, v41
v_mfma_f32_16x16x32_bf16 v[216:219], a[184:187], a[104:107], v[216:219]
buffer_load_dwordx4 a[156:159], v2, s[20:23], s101 offen offset:3072 sc1
v_mfma_f32_16x16x32_bf16 v[248:251], a[184:187], a[108:111], v[248:251]
s_add_u32 s101, s101, 4096
v_fmac_f32_e64 v45, v123, v22
v_cvt_pk_bf16_f32 v32, v38, v39
v_mfma_f32_16x16x32_bf16 v[252:255], a[188:191], a[108:111], v[252:255]
ds_read_b64_tr_b16 a[176:177], v56 offset:8192
v_cvt_pk_bf16_f32 v33, v40, v41
v_mfma_f32_16x16x32_bf16 v[220:223], a[188:191], a[104:107], v[220:223]
ds_read_b64_tr_b16 a[178:179], v56 offset:12288
v_cvt_pk_bf16_f32 v34, -v42, -v43
v_mfma_f32_16x16x32_bf16 v[188:191], a[188:191], a[100:103], v[188:191]
v_cvt_pk_bf16_f32 v35, -v44, -v45
v_mfma_f32_16x16x32_bf16 v[156:159], a[188:191], a[96:99], v[156:159]
s_waitcnt vmcnt(11) lgkmcnt(6)
v_mfma_f32_16x16x32_bf16 v[128:131], a[160:163], a[112:115], v[128:131]
ds_read_b64_tr_b16 a[180:181], v57 offset:8192
v_mfma_f32_16x16x32_bf16 v[160:163], a[160:163], a[116:119], v[160:163]
ds_read_b64_tr_b16 a[182:183], v57 offset:12288
v_mfma_f32_16x16x32_bf16 v[192:195], a[160:163], a[120:123], v[192:195]
buffer_load_dwordx4 a[96:99], v2, s[20:23], s101 offen offset:0 sc1
v_mfma_f32_16x16x32_bf16 v[224:227], a[160:163], a[124:127], v[224:227]
ds_write_b64 v46, v[32:33] offset:512
v_mfma_f32_16x16x32_bf16 v[228:231], a[164:167], a[124:127], v[228:231]
ds_read_b64_tr_b16 a[184:185], v58 offset:8192
v_mfma_f32_16x16x32_bf16 v[196:199], a[164:167], a[120:123], v[196:199]
ds_read_b64_tr_b16 a[186:187], v58 offset:12288
v_mfma_f32_16x16x32_bf16 v[164:167], a[164:167], a[116:119], v[164:167]
ds_write_b64 v46, v[34:35] offset:1536
v_mfma_f32_16x16x32_bf16 v[132:135], a[164:167], a[112:115], v[132:135]
ds_read_b64_tr_b16 a[8:9], v47 offset:0
s_waitcnt lgkmcnt(9)
v_mfma_f32_16x16x32_bf16 v[136:139], a[168:171], a[112:115], v[136:139]
ds_read_b64_tr_b16 a[188:189], v59 offset:8192
v_mfma_f32_16x16x32_bf16 v[168:171], a[168:171], a[116:119], v[168:171]
ds_read_b64_tr_b16 a[190:191], v59 offset:12288
v_mfma_f32_16x16x32_bf16 v[200:203], a[168:171], a[120:123], v[200:203]
buffer_load_dwordx4 a[100:103], v2, s[20:23], s101 offen offset:1024 sc1
v_mfma_f32_16x16x32_bf16 v[232:235], a[168:171], a[124:127], v[232:235]
ds_read_b64_tr_b16 a[10:11], v36 offset:256
v_mfma_f32_16x16x32_bf16 v[236:239], a[172:175], a[124:127], v[236:239]
ds_read_b64_tr_b16 a[160:161], v12 offset:32768
v_mfma_f32_16x16x32_bf16 v[204:207], a[172:175], a[120:123], v[204:207]
ds_read_b64_tr_b16 a[162:163], v12 offset:36864
L_pg13:
s_cbranch_execz L_pg17
v_mfma_f32_16x16x32_bf16 v[172:175], a[172:175], a[116:119], v[172:175]
ds_read_b64_tr_b16 a[12:13], v47 offset:1024
v_mfma_f32_16x16x32_bf16 v[140:143], a[172:175], a[112:115], v[140:143]
ds_read_b64_tr_b16 a[14:15], v36 offset:1280
s_waitcnt lgkmcnt(12)
v_mfma_f32_16x16x32_bf16 v[144:147], a[176:179], a[112:115], v[144:147]
ds_read_b64_tr_b16 a[164:165], v13 offset:32768
v_mul_f32_e64 v38, v68, v20
v_mfma_f32_16x16x32_bf16 v[176:179], a[176:179], a[116:119], v[176:179]
ds_read_b64_tr_b16 a[166:167], v13 offset:36864
v_mul_f32_e64 v42, v68, v21
v_mfma_f32_16x16x32_bf16 v[208:211], a[176:179], a[120:123], v[208:211]
buffer_load_dwordx4 a[104:107], v2, s[20:23], s101 offen offset:2048 sc1
v_mfma_f32_16x16x32_bf16 v[240:243], a[176:179], a[124:127], v[240:243]
v_fma_f32 v38, -v69, v21, v38
v_fmac_f32_e64 v42, v69, v20
v_mfma_f32_16x16x32_bf16 v[244:247], a[180:183], a[124:127], v[244:247]
ds_read_b64_tr_b16 a[168:169], v14 offset:32768
v_mul_f32_e64 v39, v76, v20
v_mfma_f32_16x16x32_bf16 v[212:215], a[180:183], a[120:123], v[212:215]
ds_read_b64_tr_b16 a[170:171], v14 offset:36864
v_mul_f32 v43, v76, v21
v_mfma_f32_16x16x32_bf16 v[180:183], a[180:183], a[116:119], v[180:183]
v_fma_f32 v39, -v77, v21, v39
v_fmac_f32 v43, v77, v20
v_mfma_f32_16x16x32_bf16 v[148:151], a[180:183], a[112:115], v[148:151]
v_mul_f32 v40, v84, v20
s_waitcnt lgkmcnt(9)
v_mfma_f32_16x16x32_bf16 v[152:155], a[184:187], a[112:115], v[152:155]
ds_read_b64_tr_b16 a[172:173], v15 offset:32768
v_mul_f32_e64 v44, v84, v21
v_mfma_f32_16x16x32_bf16 v[184:187], a[184:187], a[116:119], v[184:187]
ds_read_b64_tr_b16 a[174:175], v15 offset:36864
v_fma_f32 v40, -v85, v21, v40
v_mfma_f32_16x16x32_bf16 v[216:219], a[184:187], a[120:123], v[216:219]
buffer_load_dwordx4 a[108:111], v2, s[20:23], s101 offen offset:3072 sc1
v_mfma_f32_16x16x32_bf16 v[248:251], a[184:187], a[124:127], v[248:251]
s_add_u32 s101, s101, 4096
v_fmac_f32_e64 v44, v85, v20
v_mfma_f32_16x16x32_bf16 v[252:255], a[188:191], a[124:127], v[252:255]
ds_read_b64_tr_b16 a[176:177], v16 offset:32768
v_mfma_f32_16x16x32_bf16 v[220:223], a[188:191], a[120:123], v[220:223]
ds_read_b64_tr_b16 a[178:179], v16 offset:36864
v_mfma_f32_16x16x32_bf16 v[188:191], a[188:191], a[116:119], v[188:191]
s_waitcnt lgkmcnt(12)
buffer_store_dwordx4 a[8:11], v61, s[20:23], s46 offen offset:1024 sc1
v_mfma_f32_16x16x32_bf16 v[156:159], a[188:191], a[112:115], v[156:159]
v_mul_f32 v41, v92, v20
s_waitcnt vmcnt(10) lgkmcnt(6)
v_mfma_f32_16x16x32_bf16 v[128:131], a[160:163], a[128:131], v[128:131]
ds_read_b64_tr_b16 a[180:181], v17 offset:32768
v_mul_f32 v45, v92, v21
v_mfma_f32_16x16x32_bf16 v[160:163], a[160:163], a[132:135], v[160:163]
ds_read_b64_tr_b16 a[182:183], v17 offset:36864
v_fma_f32 v41, -v93, v21, v41
v_mfma_f32_16x16x32_bf16 v[192:195], a[160:163], a[136:139], v[192:195]
buffer_load_dwordx4 a[112:115], v2, s[20:23], s101 offen offset:0 sc1
v_mfma_f32_16x16x32_bf16 v[224:227], a[160:163], a[140:143], v[224:227]
v_fmac_f32_e64 v45, v93, v20
v_cvt_pk_bf16_f32 v28, v38, v39
v_mfma_f32_16x16x32_bf16 v[228:231], a[164:167], a[140:143], v[228:231]
ds_read_b64_tr_b16 a[184:185], v18 offset:32768
v_cvt_pk_bf16_f32 v29, v40, v41
v_mfma_f32_16x16x32_bf16 v[196:199], a[164:167], a[136:139], v[196:199]
ds_read_b64_tr_b16 a[186:187], v18 offset:36864
v_cvt_pk_bf16_f32 v30, -v42, -v43
v_mfma_f32_16x16x32_bf16 v[164:167], a[164:167], a[132:135], v[164:167]
v_cvt_pk_bf16_f32 v31, -v44, -v45
v_mfma_f32_16x16x32_bf16 v[132:135], a[164:167], a[128:131], v[132:135]
s_waitcnt lgkmcnt(6)
v_mfma_f32_16x16x32_bf16 v[136:139], a[168:171], a[128:131], v[136:139]
ds_read_b64_tr_b16 a[188:189], v19 offset:32768
v_mfma_f32_16x16x32_bf16 v[168:171], a[168:171], a[132:135], v[168:171]
ds_read_b64_tr_b16 a[190:191], v19 offset:36864
v_mfma_f32_16x16x32_bf16 v[200:203], a[168:171], a[136:139], v[200:203]
buffer_load_dwordx4 a[116:119], v2, s[20:23], s101 offen offset:1024 sc1
v_mfma_f32_16x16x32_bf16 v[232:235], a[168:171], a[140:143], v[232:235]
ds_write_b64 v46, v[28:29] offset:0
v_mfma_f32_16x16x32_bf16 v[236:239], a[172:175], a[140:143], v[236:239]
ds_read_b64_tr_b16 a[160:161], v12 offset:40960
v_mfma_f32_16x16x32_bf16 v[204:207], a[172:175], a[136:139], v[204:207]
ds_read_b64_tr_b16 a[162:163], v12 offset:45056
v_mfma_f32_16x16x32_bf16 v[172:175], a[172:175], a[132:135], v[172:175]
ds_write_b64 v46, v[30:31] offset:1024
v_mfma_f32_16x16x32_bf16 v[140:143], a[172:175], a[128:131], v[140:143]
v_mul_f32 v38, v100, v22
s_waitcnt lgkmcnt(8)
v_mfma_f32_16x16x32_bf16 v[144:147], a[176:179], a[128:131], v[144:147]
ds_read_b64_tr_b16 a[164:165], v13 offset:40960
v_mul_f32 v42, v100, v23
v_mfma_f32_16x16x32_bf16 v[176:179], a[176:179], a[132:135], v[176:179]
ds_read_b64_tr_b16 a[166:167], v13 offset:45056
v_fma_f32 v38, -v101, v23, v38
v_mfma_f32_16x16x32_bf16 v[208:211], a[176:179], a[136:139], v[208:211]
buffer_load_dwordx4 a[120:123], v2, s[20:23], s101 offen offset:2048 sc1
v_mfma_f32_16x16x32_bf16 v[240:243], a[176:179], a[140:143], v[240:243]
v_fmac_f32 v42, v101, v22
v_mul_f32 v39, v108, v22
v_mfma_f32_16x16x32_bf16 v[244:247], a[180:183], a[140:143], v[244:247]
ds_read_b64_tr_b16 a[168:169], v14 offset:40960
v_mul_f32_e64 v43, v108, v23
v_mfma_f32_16x16x32_bf16 v[212:215], a[180:183], a[136:139], v[212:215]
ds_read_b64_tr_b16 a[170:171], v14 offset:45056
v_fma_f32 v39, -v109, v23, v39
v_mfma_f32_16x16x32_bf16 v[180:183], a[180:183], a[132:135], v[180:183]
v_fmac_f32 v43, v109, v22
v_mul_f32 v40, v116, v22
v_mfma_f32_16x16x32_bf16 v[148:151], a[180:183], a[128:131], v[148:151]
v_mul_f32 v44, v116, v23
s_waitcnt lgkmcnt(8)
v_mfma_f32_16x16x32_bf16 v[152:155], a[184:187], a[128:131], v[152:155]
ds_read_b64_tr_b16 a[172:173], v15 offset:40960
v_fma_f32 v40, -v117, v23, v40
v_mfma_f32_16x16x32_bf16 v[184:187], a[184:187], a[132:135], v[184:187]
ds_read_b64_tr_b16 a[174:175], v15 offset:45056
v_fmac_f32_e64 v44, v117, v22
v_mfma_f32_16x16x32_bf16 v[216:219], a[184:187], a[136:139], v[216:219]
buffer_load_dwordx4 a[124:127], v2, s[20:23], s101 offen offset:3072 sc1
v_mfma_f32_16x16x32_bf16 v[248:251], a[184:187], a[140:143], v[248:251]
s_add_u32 s101, s101, 4096
v_mfma_f32_16x16x32_bf16 v[252:255], a[188:191], a[140:143], v[252:255]
ds_read_b64_tr_b16 a[176:177], v16 offset:40960
v_mfma_f32_16x16x32_bf16 v[220:223], a[188:191], a[136:139], v[220:223]
ds_read_b64_tr_b16 a[178:179], v16 offset:45056
v_mfma_f32_16x16x32_bf16 v[188:191], a[188:191], a[132:135], v[188:191]
buffer_store_dwordx4 a[12:15], v61, s[20:23], s47 offen offset:1024 sc1
v_mfma_f32_16x16x32_bf16 v[156:159], a[188:191], a[128:131], v[156:159]
v_mul_f32 v41, v124, v22
s_waitcnt vmcnt(10) lgkmcnt(6)
v_mfma_f32_16x16x32_bf16 v[128:131], a[160:163], a[144:147], v[128:131]
ds_read_b64_tr_b16 a[180:181], v17 offset:40960
v_mul_f32_e64 v45, v124, v23
v_mfma_f32_16x16x32_bf16 v[160:163], a[160:163], a[148:151], v[160:163]
ds_read_b64_tr_b16 a[182:183], v17 offset:45056
v_fma_f32 v41, -v125, v23, v41
v_mfma_f32_16x16x32_bf16 v[192:195], a[160:163], a[152:155], v[192:195]
buffer_load_dwordx4 a[128:131], v2, s[20:23], s101 offen offset:0 sc1
v_mfma_f32_16x16x32_bf16 v[224:227], a[160:163], a[156:159], v[224:227]
v_fmac_f32_e64 v45, v125, v22
v_cvt_pk_bf16_f32 v32, v38, v39
v_mfma_f32_16x16x32_bf16 v[228:231], a[164:167], a[156:159], v[228:231]
ds_read_b64_tr_b16 a[184:185], v18 offset:40960
v_cvt_pk_bf16_f32 v33, v40, v41
v_mfma_f32_16x16x32_bf16 v[196:199], a[164:167], a[152:155], v[196:199]
ds_read_b64_tr_b16 a[186:187], v18 offset:45056
v_cvt_pk_bf16_f32 v34, -v42, -v43
v_mfma_f32_16x16x32_bf16 v[164:167], a[164:167], a[148:151], v[164:167]
v_cvt_pk_bf16_f32 v35, -v44, -v45
v_mfma_f32_16x16x32_bf16 v[132:135], a[164:167], a[144:147], v[132:135]
s_waitcnt lgkmcnt(6)
v_mfma_f32_16x16x32_bf16 v[136:139], a[168:171], a[144:147], v[136:139]
ds_read_b64_tr_b16 a[188:189], v19 offset:40960
v_mfma_f32_16x16x32_bf16 v[168:171], a[168:171], a[148:151], v[168:171]
ds_read_b64_tr_b16 a[190:191], v19 offset:45056
v_mfma_f32_16x16x32_bf16 v[200:203], a[168:171], a[152:155], v[200:203]
buffer_load_dwordx4 a[132:135], v2, s[20:23], s101 offen offset:1024 sc1
v_mfma_f32_16x16x32_bf16 v[232:235], a[168:171], a[156:159], v[232:235]
s_barrier
v_mfma_f32_16x16x32_bf16 v[236:239], a[172:175], a[156:159], v[236:239]
ds_read_b64_tr_b16 a[160:161], v12 offset:49152
v_mfma_f32_16x16x32_bf16 v[204:207], a[172:175], a[152:155], v[204:207]
ds_read_b64_tr_b16 a[162:163], v12 offset:53248
v_mfma_f32_16x16x32_bf16 v[172:175], a[172:175], a[148:151], v[172:175]
ds_write_b64 v46, v[32:33] offset:512
v_mfma_f32_16x16x32_bf16 v[140:143], a[172:175], a[144:147], v[140:143]
s_waitcnt lgkmcnt(7)
v_mfma_f32_16x16x32_bf16 v[144:147], a[176:179], a[144:147], v[144:147]
ds_read_b64_tr_b16 a[164:165], v13 offset:49152
v_mfma_f32_16x16x32_bf16 v[176:179], a[176:179], a[148:151], v[176:179]
ds_read_b64_tr_b16 a[166:167], v13 offset:53248
v_mfma_f32_16x16x32_bf16 v[208:211], a[176:179], a[152:155], v[208:211]
buffer_load_dwordx4 a[136:139], v2, s[20:23], s101 offen offset:2048 sc1
v_mfma_f32_16x16x32_bf16 v[240:243], a[176:179], a[156:159], v[240:243]
ds_write_b64 v46, v[34:35] offset:1536
v_mfma_f32_16x16x32_bf16 v[244:247], a[180:183], a[156:159], v[244:247]
ds_read_b64_tr_b16 a[168:169], v14 offset:49152
v_mfma_f32_16x16x32_bf16 v[212:215], a[180:183], a[152:155], v[212:215]
ds_read_b64_tr_b16 a[170:171], v14 offset:53248
v_mfma_f32_16x16x32_bf16 v[180:183], a[180:183], a[148:151], v[180:183]
ds_read_b64_tr_b16 a[16:17], v47 offset:0
v_mfma_f32_16x16x32_bf16 v[148:151], a[180:183], a[144:147], v[148:151]
ds_read_b64_tr_b16 a[18:19], v36 offset:256
s_waitcnt lgkmcnt(10)
v_mfma_f32_16x16x32_bf16 v[152:155], a[184:187], a[144:147], v[152:155]
ds_read_b64_tr_b16 a[172:173], v15 offset:49152
v_mfma_f32_16x16x32_bf16 v[184:187], a[184:187], a[148:151], v[184:187]
ds_read_b64_tr_b16 a[174:175], v15 offset:53248
v_mfma_f32_16x16x32_bf16 v[216:219], a[184:187], a[152:155], v[216:219]
buffer_load_dwordx4 a[140:143], v2, s[20:23], s101 offen offset:3072 sc1
v_mfma_f32_16x16x32_bf16 v[248:251], a[184:187], a[156:159], v[248:251]
s_add_u32 s101, s101, 4096
ds_read_b64_tr_b16 a[20:21], v47 offset:1024
v_mfma_f32_16x16x32_bf16 v[252:255], a[188:191], a[156:159], v[252:255]
ds_read_b64_tr_b16 a[176:177], v16 offset:49152
v_mfma_f32_16x16x32_bf16 v[220:223], a[188:191], a[152:155], v[220:223]
ds_read_b64_tr_b16 a[178:179], v16 offset:53248
v_mfma_f32_16x16x32_bf16 v[188:191], a[188:191], a[148:151], v[188:191]
ds_read_b64_tr_b16 a[22:23], v36 offset:1280
v_mul_f32 v38, v70, v20
v_mfma_f32_16x16x32_bf16 v[156:159], a[188:191], a[144:147], v[156:159]
v_mul_f32 v42, v70, v21
s_waitcnt vmcnt(10) lgkmcnt(11)
v_mfma_f32_16x16x32_bf16 v[128:131], a[160:163], a[96:99], v[128:131]
ds_read_b64_tr_b16 a[180:181], v17 offset:49152
v_fma_f32 v38, -v71, v21, v38
v_mfma_f32_16x16x32_bf16 v[160:163], a[160:163], a[100:103], v[160:163]
ds_read_b64_tr_b16 a[182:183], v17 offset:53248
v_fmac_f32 v42, v71, v20
v_mfma_f32_16x16x32_bf16 v[192:195], a[160:163], a[104:107], v[192:195]
buffer_load_dwordx4 a[144:147], v2, s[20:23], s101 offen offset:0 sc1
v_mfma_f32_16x16x32_bf16 v[224:227], a[160:163], a[108:111], v[224:227]
v_mul_f32 v39, v78, v20
v_mul_f32 v43, v78, v21
v_mfma_f32_16x16x32_bf16 v[228:231], a[164:167], a[108:111], v[228:231]
ds_read_b64_tr_b16 a[184:185], v18 offset:49152
v_fma_f32 v39, -v79, v21, v39
v_mfma_f32_16x16x32_bf16 v[196:199], a[164:167], a[104:107], v[196:199]
ds_read_b64_tr_b16 a[186:187], v18 offset:53248
v_fmac_f32_e64 v43, v79, v20
v_mfma_f32_16x16x32_bf16 v[164:167], a[164:167], a[100:103], v[164:167]
v_mul_f32 v40, v86, v20
v_mul_f32 v44, v86, v21
v_mfma_f32_16x16x32_bf16 v[132:135], a[164:167], a[96:99], v[132:135]
v_fma_f32 v40, -v87, v21, v40
s_waitcnt lgkmcnt(8)
v_mfma_f32_16x16x32_bf16 v[136:139], a[168:171], a[96:99], v[136:139]
ds_read_b64_tr_b16 a[188:189], v19 offset:49152
v_fmac_f32 v44, v87, v20
v_mfma_f32_16x16x32_bf16 v[168:171], a[168:171], a[100:103], v[168:171]
ds_read_b64_tr_b16 a[190:191], v19 offset:53248
v_mfma_f32_16x16x32_bf16 v[200:203], a[168:171], a[104:107], v[200:203]
buffer_load_dwordx4 a[148:151], v2, s[20:23], s101 offen offset:1024 sc1
v_mfma_f32_16x16x32_bf16 v[232:235], a[168:171], a[108:111], v[232:235]
v_mfma_f32_16x16x32_bf16 v[236:239], a[172:175], a[108:111], v[236:239]
ds_read_b64_tr_b16 a[160:161], v12 offset:57344
v_mfma_f32_16x16x32_bf16 v[204:207], a[172:175], a[104:107], v[204:207]
ds_read_b64_tr_b16 a[162:163], v12 offset:61440
v_mfma_f32_16x16x32_bf16 v[172:175], a[172:175], a[100:103], v[172:175]
buffer_store_dwordx4 a[16:19], v61, s[20:23], s46 offen offset:2048 sc1
v_mfma_f32_16x16x32_bf16 v[140:143], a[172:175], a[96:99], v[140:143]
v_mul_f32 v41, v94, v20
s_waitcnt lgkmcnt(6)
v_mfma_f32_16x16x32_bf16 v[144:147], a[176:179], a[96:99], v[144:147]
ds_read_b64_tr_b16 a[164:165], v13 offset:57344
v_mul_f32_e64 v45, v94, v21
v_mfma_f32_16x16x32_bf16 v[176:179], a[176:179], a[100:103], v[176:179]
ds_read_b64_tr_b16 a[166:167], v13 offset:61440
v_fma_f32 v41, -v95, v21, v41
v_mfma_f32_16x16x32_bf16 v[208:211], a[176:179], a[104:107], v[208:211]
buffer_load_dwordx4 a[152:155], v2, s[20:23], s101 offen offset:2048 sc1
v_mfma_f32_16x16x32_bf16 v[240:243], a[176:179], a[108:111], v[240:243]
v_fmac_f32_e64 v45, v95, v20
v_cvt_pk_bf16_f32 v28, v38, v39
v_mfma_f32_16x16x32_bf16 v[244:247], a[180:183], a[108:111], v[244:247]
ds_read_b64_tr_b16 a[168:169], v14 offset:57344
v_cvt_pk_bf16_f32 v29, v40, v41
v_mfma_f32_16x16x32_bf16 v[212:215], a[180:183], a[104:107], v[212:215]
ds_read_b64_tr_b16 a[170:171], v14 offset:61440
v_cvt_pk_bf16_f32 v30, -v42, -v43
v_mfma_f32_16x16x32_bf16 v[180:183], a[180:183], a[100:103], v[180:183]
v_cvt_pk_bf16_f32 v31, -v44, -v45
v_mfma_f32_16x16x32_bf16 v[148:151], a[180:183], a[96:99], v[148:151]
ds_write_b64 v46, v[28:29] offset:0
s_waitcnt lgkmcnt(7)
v_mfma_f32_16x16x32_bf16 v[152:155], a[184:187], a[96:99], v[152:155]
ds_read_b64_tr_b16 a[172:173], v15 offset:57344
v_mfma_f32_16x16x32_bf16 v[184:187], a[184:187], a[100:103], v[184:187]
ds_read_b64_tr_b16 a[174:175], v15 offset:61440
v_mfma_f32_16x16x32_bf16 v[216:219], a[184:187], a[104:107], v[216:219]
buffer_load_dwordx4 a[156:159], v2, s[20:23], s101 offen offset:3072 sc1
v_mfma_f32_16x16x32_bf16 v[248:251], a[184:187], a[108:111], v[248:251]
s_add_u32 s101, s101, 4096
ds_write_b64 v46, v[30:31] offset:1024
v_mfma_f32_16x16x32_bf16 v[252:255], a[188:191], a[108:111], v[252:255]
ds_read_b64_tr_b16 a[176:177], v16 offset:57344
v_mul_f32 v38, v102, v22
v_mfma_f32_16x16x32_bf16 v[220:223], a[188:191], a[104:107], v[220:223]
ds_read_b64_tr_b16 a[178:179], v16 offset:61440
v_mul_f32_e64 v42, v102, v23
v_mfma_f32_16x16x32_bf16 v[188:191], a[188:191], a[100:103], v[188:191]
v_fma_f32 v38, -v103, v23, v38
v_fmac_f32 v42, v103, v22
v_mfma_f32_16x16x32_bf16 v[156:159], a[188:191], a[96:99], v[156:159]
v_mul_f32 v39, v110, v22
s_waitcnt vmcnt(10) lgkmcnt(8)
v_mfma_f32_16x16x32_bf16 v[128:131], a[160:163], a[112:115], v[128:131]
ds_read_b64_tr_b16 a[180:181], v17 offset:57344
v_mul_f32 v43, v110, v23
v_mfma_f32_16x16x32_bf16 v[160:163], a[160:163], a[116:119], v[160:163]
ds_read_b64_tr_b16 a[182:183], v17 offset:61440
v_fma_f32 v39, -v111, v23, v39
v_mfma_f32_16x16x32_bf16 v[192:195], a[160:163], a[120:123], v[192:195]
buffer_load_dwordx4 a[96:99], v2, s[20:23], s101 offen offset:0 sc1
v_mfma_f32_16x16x32_bf16 v[224:227], a[160:163], a[124:127], v[224:227]
v_fmac_f32 v43, v111, v22
v_mul_f32 v40, v118, v22
v_mfma_f32_16x16x32_bf16 v[228:231], a[164:167], a[124:127], v[228:231]
ds_read_b64_tr_b16 a[184:185], v18 offset:57344
v_mul_f32_e64 v44, v118, v23
v_mfma_f32_16x16x32_bf16 v[196:199], a[164:167], a[120:123], v[196:199]
ds_read_b64_tr_b16 a[186:187], v18 offset:61440
v_fma_f32 v40, -v119, v23, v40
v_mfma_f32_16x16x32_bf16 v[164:167], a[164:167], a[116:119], v[164:167]
v_fmac_f32 v44, v119, v22
buffer_store_dwordx4 a[20:23], v61, s[20:23], s47 offen offset:2048 sc1
v_mfma_f32_16x16x32_bf16 v[132:135], a[164:167], a[112:115], v[132:135]
v_mul_f32 v41, v126, v22
s_waitcnt lgkmcnt(7)
v_mfma_f32_16x16x32_bf16 v[136:139], a[168:171], a[112:115], v[136:139]
ds_read_b64_tr_b16 a[188:189], v19 offset:57344
v_mul_f32 v45, v126, v23
v_mfma_f32_16x16x32_bf16 v[168:171], a[168:171], a[116:119], v[168:171]
ds_read_b64_tr_b16 a[190:191], v19 offset:61440
v_fma_f32 v41, -v127, v23, v41
v_mfma_f32_16x16x32_bf16 v[200:203], a[168:171], a[120:123], v[200:203]
buffer_load_dwordx4 a[100:103], v2, s[20:23], s101 offen offset:1024 sc1
v_mfma_f32_16x16x32_bf16 v[232:235], a[168:171], a[124:127], v[232:235]
v_fmac_f32_e64 v45, v127, v22
v_cvt_pk_bf16_f32 v32, v38, v39
v_mfma_f32_16x16x32_bf16 v[236:239], a[172:175], a[124:127], v[236:239]
ds_read_b64_tr_b16 a[160:161], v52 offset:16384
v_cvt_pk_bf16_f32 v33, v40, v41
v_mfma_f32_16x16x32_bf16 v[204:207], a[172:175], a[120:123], v[204:207]
ds_read_b64_tr_b16 a[162:163], v52 offset:20480
v_cvt_pk_bf16_f32 v34, -v42, -v43
v_mfma_f32_16x16x32_bf16 v[172:175], a[172:175], a[116:119], v[172:175]
v_cvt_pk_bf16_f32 v35, -v44, -v45
s_lshl_b32 s51, s54, 3
s_add_u32 s51, s51, s52
v_mfma_f32_16x16x32_bf16 v[140:143], a[172:175], a[112:115], v[140:143]
ds_write_b64 v46, v[32:33] offset:512
s_waitcnt lgkmcnt(7)
v_mfma_f32_16x16x32_bf16 v[144:147], a[176:179], a[112:115], v[144:147]
ds_read_b64_tr_b16 a[164:165], v53 offset:16384
s_lshl_b32 s51, s51, 5
v_mfma_f32_16x16x32_bf16 v[176:179], a[176:179], a[116:119], v[176:179]
ds_read_b64_tr_b16 a[166:167], v53 offset:20480
s_add_u32 s51, s51, 28311680
v_mfma_f32_16x16x32_bf16 v[208:211], a[176:179], a[120:123], v[208:211]
buffer_load_dwordx4 a[104:107], v2, s[20:23], s101 offen offset:2048 sc1
v_mfma_f32_16x16x32_bf16 v[240:243], a[176:179], a[124:127], v[240:243]
ds_write_b64 v46, v[34:35] offset:1536
v_mfma_f32_16x16x32_bf16 v[244:247], a[180:183], a[124:127], v[244:247]
ds_read_b64_tr_b16 a[168:169], v54 offset:16384
s_add_u32 m0, s7, 0
v_mfma_f32_16x16x32_bf16 v[212:215], a[180:183], a[120:123], v[212:215]
ds_read_b64_tr_b16 a[170:171], v54 offset:20480
s_add_u32 s44, s98, 131072
v_mfma_f32_16x16x32_bf16 v[180:183], a[180:183], a[116:119], v[180:183]
buffer_load_dwordx4 v6, s[28:31], s44 offen lds
v_mfma_f32_16x16x32_bf16 v[148:151], a[180:183], a[112:115], v[148:151]
ds_read_b64_tr_b16 a[24:25], v47 offset:0
s_waitcnt lgkmcnt(9)
v_mfma_f32_16x16x32_bf16 v[152:155], a[184:187], a[112:115], v[152:155]
ds_read_b64_tr_b16 a[172:173], v55 offset:16384
ds_read_b64_tr_b16 a[26:27], v36 offset:256
v_mfma_f32_16x16x32_bf16 v[184:187], a[184:187], a[116:119], v[184:187]
ds_read_b64_tr_b16 a[174:175], v55 offset:20480
v_and_b32_e64 v48, 7, v1
v_mfma_f32_16x16x32_bf16 v[216:219], a[184:187], a[120:123], v[216:219]
buffer_load_dwordx4 a[108:111], v2, s[20:23], s101 offen offset:3072 sc1
v_mfma_f32_16x16x32_bf16 v[248:251], a[184:187], a[124:127], v[248:251]
s_add_u32 s101, s101, 4096
ds_read_b64_tr_b16 a[28:29], v47 offset:1024
v_mfma_f32_16x16x32_bf16 v[252:255], a[188:191], a[124:127], v[252:255]
ds_read_b64_tr_b16 a[176:177], v56 offset:16384
v_lshlrev_b32_e64 v48, 2, v48
v_mfma_f32_16x16x32_bf16 v[220:223], a[188:191], a[120:123], v[220:223]
ds_read_b64_tr_b16 a[178:179], v56 offset:20480
s_add_u32 m0, s7, 1024
v_mfma_f32_16x16x32_bf16 v[188:191], a[188:191], a[116:119], v[188:191]
buffer_load_dwordx4 v7, s[28:31], s44 offen lds
v_mfma_f32_16x16x32_bf16 v[156:159], a[188:191], a[112:115], v[156:159]
ds_read_b64_tr_b16 a[30:31], v36 offset:1280
s_waitcnt vmcnt(12) lgkmcnt(11)
v_mfma_f32_16x16x32_bf16 v[128:131], a[160:163], a[128:131], v[128:131]
ds_read_b64_tr_b16 a[180:181], v57 offset:16384
v_mfma_f32_16x16x32_bf16 v[160:163], a[160:163], a[132:135], v[160:163]
ds_read_b64_tr_b16 a[182:183], v57 offset:20480
v_mfma_f32_16x16x32_bf16 v[192:195], a[160:163], a[136:139], v[192:195]
buffer_load_dwordx4 a[112:115], v2, s[20:23], s101 offen offset:0 sc1
v_mfma_f32_16x16x32_bf16 v[224:227], a[160:163], a[140:143], v[224:227]
v_mfma_f32_16x16x32_bf16 v[228:231], a[164:167], a[140:143], v[228:231]
ds_read_b64_tr_b16 a[184:185], v58 offset:16384
v_mfma_f32_16x16x32_bf16 v[196:199], a[164:167], a[136:139], v[196:199]
ds_read_b64_tr_b16 a[186:187], v58 offset:20480
v_mfma_f32_16x16x32_bf16 v[164:167], a[164:167], a[132:135], v[164:167]
s_waitcnt lgkmcnt(9)
buffer_store_dwordx4 a[24:27], v61, s[20:23], s46 offen offset:3072 sc1
v_mfma_f32_16x16x32_bf16 v[132:135], a[164:167], a[128:131], v[132:135]
s_waitcnt lgkmcnt(8)
v_mfma_f32_16x16x32_bf16 v[136:139], a[168:171], a[128:131], v[136:139]
ds_read_b64_tr_b16 a[188:189], v59 offset:16384
v_mfma_f32_16x16x32_bf16 v[168:171], a[168:171], a[132:135], v[168:171]
ds_read_b64_tr_b16 a[190:191], v59 offset:20480
v_mfma_f32_16x16x32_bf16 v[200:203], a[168:171], a[136:139], v[200:203]
buffer_load_dwordx4 a[116:119], v2, s[20:23], s101 offen offset:1024 sc1
v_mfma_f32_16x16x32_bf16 v[232:235], a[168:171], a[140:143], v[232:235]
v_mfma_f32_16x16x32_bf16 v[236:239], a[172:175], a[140:143], v[236:239]
ds_read_b64_tr_b16 a[160:161], v52 offset:24576
v_mfma_f32_16x16x32_bf16 v[204:207], a[172:175], a[136:139], v[204:207]
ds_read_b64_tr_b16 a[162:163], v52 offset:28672
v_mfma_f32_16x16x32_bf16 v[172:175], a[172:175], a[132:135], v[172:175]
buffer_load_dword v49, v48, s[20:23], s51 offen sc1
v_mfma_f32_16x16x32_bf16 v[140:143], a[172:175], a[128:131], v[140:143]
s_waitcnt lgkmcnt(6)
v_mfma_f32_16x16x32_bf16 v[144:147], a[176:179], a[128:131], v[144:147]
ds_read_b64_tr_b16 a[164:165], v53 offset:24576
v_mfma_f32_16x16x32_bf16 v[176:179], a[176:179], a[132:135], v[176:179]
ds_read_b64_tr_b16 a[166:167], v53 offset:28672
v_mfma_f32_16x16x32_bf16 v[208:211], a[176:179], a[136:139], v[208:211]
buffer_load_dwordx4 a[120:123], v2, s[20:23], s101 offen offset:2048 sc1
v_mfma_f32_16x16x32_bf16 v[240:243], a[176:179], a[140:143], v[240:243]
v_mfma_f32_16x16x32_bf16 v[244:247], a[180:183], a[140:143], v[244:247]
ds_read_b64_tr_b16 a[168:169], v54 offset:24576
s_add_u32 m0, s7, 2048
v_mfma_f32_16x16x32_bf16 v[212:215], a[180:183], a[136:139], v[212:215]
ds_read_b64_tr_b16 a[170:171], v54 offset:28672
s_add_u32 s44, s98, 147456
v_mfma_f32_16x16x32_bf16 v[180:183], a[180:183], a[132:135], v[180:183]
buffer_load_dwordx4 v6, s[28:31], s44 offen lds
v_mfma_f32_16x16x32_bf16 v[148:151], a[180:183], a[128:131], v[148:151]
s_waitcnt lgkmcnt(6)
v_mfma_f32_16x16x32_bf16 v[152:155], a[184:187], a[128:131], v[152:155]
ds_read_b64_tr_b16 a[172:173], v55 offset:24576
v_mfma_f32_16x16x32_bf16 v[184:187], a[184:187], a[132:135], v[184:187]
ds_read_b64_tr_b16 a[174:175], v55 offset:28672
v_mfma_f32_16x16x32_bf16 v[216:219], a[184:187], a[136:139], v[216:219]
buffer_load_dwordx4 a[124:127], v2, s[20:23], s101 offen offset:3072 sc1
v_mfma_f32_16x16x32_bf16 v[248:251], a[184:187], a[140:143], v[248:251]
s_add_u32 s101, s101, 4096
v_mfma_f32_16x16x32_bf16 v[252:255], a[188:191], a[140:143], v[252:255]
ds_read_b64_tr_b16 a[176:177], v56 offset:24576
v_mfma_f32_16x16x32_bf16 v[220:223], a[188:191], a[136:139], v[220:223]
ds_read_b64_tr_b16 a[178:179], v56 offset:28672
s_add_u32 m0, s7, 3072
v_mfma_f32_16x16x32_bf16 v[188:191], a[188:191], a[132:135], v[188:191]
buffer_load_dwordx4 v7, s[28:31], s44 offen lds
v_mfma_f32_16x16x32_bf16 v[156:159], a[188:191], a[128:131], v[156:159]
s_waitcnt vmcnt(15) lgkmcnt(6)
v_mfma_f32_16x16x32_bf16 v[128:131], a[160:163], a[144:147], v[128:131]
ds_read_b64_tr_b16 a[180:181], v57 offset:24576
v_mfma_f32_16x16x32_bf16 v[160:163], a[160:163], a[148:151], v[160:163]
ds_read_b64_tr_b16 a[182:183], v57 offset:28672
v_mfma_f32_16x16x32_bf16 v[192:195], a[160:163], a[152:155], v[192:195]
buffer_load_dwordx4 a[128:131], v2, s[20:23], s101 offen offset:0 sc1
v_mfma_f32_16x16x32_bf16 v[224:227], a[160:163], a[156:159], v[224:227]
v_mfma_f32_16x16x32_bf16 v[228:231], a[164:167], a[156:159], v[228:231]
ds_read_b64_tr_b16 a[184:185], v58 offset:24576
v_mfma_f32_16x16x32_bf16 v[196:199], a[164:167], a[152:155], v[196:199]
ds_read_b64_tr_b16 a[186:187], v58 offset:28672
v_mfma_f32_16x16x32_bf16 v[164:167], a[164:167], a[148:151], v[164:167]
buffer_store_dwordx4 a[28:31], v61, s[20:23], s47 offen offset:3072 sc1
v_mfma_f32_16x16x32_bf16 v[132:135], a[164:167], a[144:147], v[132:135]
s_waitcnt lgkmcnt(6)
v_mfma_f32_16x16x32_bf16 v[136:139], a[168:171], a[144:147], v[136:139]
ds_read_b64_tr_b16 a[188:189], v59 offset:24576
v_mfma_f32_16x16x32_bf16 v[168:171], a[168:171], a[148:151], v[168:171]
ds_read_b64_tr_b16 a[190:191], v59 offset:28672
v_mfma_f32_16x16x32_bf16 v[200:203], a[168:171], a[152:155], v[200:203]
buffer_load_dwordx4 a[132:135], v2, s[20:23], s101 offen offset:1024 sc1
v_mfma_f32_16x16x32_bf16 v[232:235], a[168:171], a[156:159], v[232:235]
s_barrier
v_mfma_f32_16x16x32_bf16 v[236:239], a[172:175], a[156:159], v[236:239]
ds_read_b64_tr_b16 a[160:161], v52 offset:32768
v_mfma_f32_16x16x32_bf16 v[204:207], a[172:175], a[152:155], v[204:207]
ds_read_b64_tr_b16 a[162:163], v52 offset:36864
v_mfma_f32_16x16x32_bf16 v[172:175], a[172:175], a[148:151], v[172:175]
v_mfma_f32_16x16x32_bf16 v[140:143], a[172:175], a[144:147], v[140:143]
s_waitcnt lgkmcnt(6)
v_mfma_f32_16x16x32_bf16 v[144:147], a[176:179], a[144:147], v[144:147]
ds_read_b64_tr_b16 a[164:165], v53 offset:32768
v_mfma_f32_16x16x32_bf16 v[176:179], a[176:179], a[148:151], v[176:179]
ds_read_b64_tr_b16 a[166:167], v53 offset:36864
v_mfma_f32_16x16x32_bf16 v[208:211], a[176:179], a[152:155], v[208:211]
buffer_load_dwordx4 a[136:139], v2, s[20:23], s101 offen offset:2048 sc1
v_mfma_f32_16x16x32_bf16 v[240:243], a[176:179], a[156:159], v[240:243]
v_mfma_f32_16x16x32_bf16 v[244:247], a[180:183], a[156:159], v[244:247]
ds_read_b64_tr_b16 a[168:169], v54 offset:32768
s_add_u32 m0, s7, 16384
v_mfma_f32_16x16x32_bf16 v[212:215], a[180:183], a[152:155], v[212:215]
ds_read_b64_tr_b16 a[170:171], v54 offset:36864
s_add_u32 s44, s98, 589824
v_mfma_f32_16x16x32_bf16 v[180:183], a[180:183], a[148:151], v[180:183]
buffer_load_dwordx4 v6, s[28:31], s44 offen lds
v_mfma_f32_16x16x32_bf16 v[148:151], a[180:183], a[144:147], v[148:151]
s_waitcnt lgkmcnt(6)
v_mfma_f32_16x16x32_bf16 v[152:155], a[184:187], a[144:147], v[152:155]
ds_read_b64_tr_b16 a[172:173], v55 offset:32768
v_mfma_f32_16x16x32_bf16 v[184:187], a[184:187], a[148:151], v[184:187]
ds_read_b64_tr_b16 a[174:175], v55 offset:36864
v_mfma_f32_16x16x32_bf16 v[216:219], a[184:187], a[152:155], v[216:219]
buffer_load_dwordx4 a[140:143], v2, s[20:23], s101 offen offset:3072 sc1
v_mfma_f32_16x16x32_bf16 v[248:251], a[184:187], a[156:159], v[248:251]
s_add_u32 s101, s101, 4096
v_mfma_f32_16x16x32_bf16 v[252:255], a[188:191], a[156:159], v[252:255]
ds_read_b64_tr_b16 a[176:177], v56 offset:32768
v_mfma_f32_16x16x32_bf16 v[220:223], a[188:191], a[152:155], v[220:223]
ds_read_b64_tr_b16 a[178:179], v56 offset:36864
s_add_u32 m0, s7, 17408
v_mfma_f32_16x16x32_bf16 v[188:191], a[188:191], a[148:151], v[188:191]
buffer_load_dwordx4 v7, s[28:31], s44 offen lds
v_mfma_f32_16x16x32_bf16 v[156:159], a[188:191], a[144:147], v[156:159]
s_waitcnt vmcnt(16) lgkmcnt(6)
v_mfma_f32_16x16x32_bf16 v[128:131], a[160:163], a[96:99], v[128:131]
ds_read_b64_tr_b16 a[180:181], v57 offset:32768
v_mfma_f32_16x16x32_bf16 v[160:163], a[160:163], a[100:103], v[160:163]
ds_read_b64_tr_b16 a[182:183], v57 offset:36864
v_mfma_f32_16x16x32_bf16 v[192:195], a[160:163], a[104:107], v[192:195]
buffer_load_dwordx4 a[144:147], v2, s[20:23], s101 offen offset:0 sc1
v_mfma_f32_16x16x32_bf16 v[224:227], a[160:163], a[108:111], v[224:227]
v_mfma_f32_16x16x32_bf16 v[228:231], a[164:167], a[108:111], v[228:231]
ds_read_b64_tr_b16 a[184:185], v58 offset:32768
v_mfma_f32_16x16x32_bf16 v[196:199], a[164:167], a[104:107], v[196:199]
ds_read_b64_tr_b16 a[186:187], v58 offset:36864
v_mfma_f32_16x16x32_bf16 v[164:167], a[164:167], a[100:103], v[164:167]
v_mfma_f32_16x16x32_bf16 v[132:135], a[164:167], a[96:99], v[132:135]
s_waitcnt lgkmcnt(6)
v_mfma_f32_16x16x32_bf16 v[136:139], a[168:171], a[96:99], v[136:139]
ds_read_b64_tr_b16 a[188:189], v59 offset:32768
v_mfma_f32_16x16x32_bf16 v[168:171], a[168:171], a[100:103], v[168:171]
ds_read_b64_tr_b16 a[190:191], v59 offset:36864
v_mfma_f32_16x16x32_bf16 v[200:203], a[168:171], a[104:107], v[200:203]
buffer_load_dwordx4 a[148:151], v2, s[20:23], s101 offen offset:1024 sc1
v_mfma_f32_16x16x32_bf16 v[232:235], a[168:171], a[108:111], v[232:235]
v_mfma_f32_16x16x32_bf16 v[236:239], a[172:175], a[108:111], v[236:239]
ds_read_b64_tr_b16 a[160:161], v52 offset:40960
v_mfma_f32_16x16x32_bf16 v[204:207], a[172:175], a[104:107], v[204:207]
ds_read_b64_tr_b16 a[162:163], v52 offset:45056
v_mfma_f32_16x16x32_bf16 v[172:175], a[172:175], a[100:103], v[172:175]
v_mfma_f32_16x16x32_bf16 v[140:143], a[172:175], a[96:99], v[140:143]
s_waitcnt lgkmcnt(6)
v_mfma_f32_16x16x32_bf16 v[144:147], a[176:179], a[96:99], v[144:147]
ds_read_b64_tr_b16 a[164:165], v53 offset:40960
v_mfma_f32_16x16x32_bf16 v[176:179], a[176:179], a[100:103], v[176:179]
ds_read_b64_tr_b16 a[166:167], v53 offset:45056
v_mfma_f32_16x16x32_bf16 v[208:211], a[176:179], a[104:107], v[208:211]
buffer_load_dwordx4 a[152:155], v2, s[20:23], s101 offen offset:2048 sc1
v_mfma_f32_16x16x32_bf16 v[240:243], a[176:179], a[108:111], v[240:243]
v_mfma_f32_16x16x32_bf16 v[244:247], a[180:183], a[108:111], v[244:247]
ds_read_b64_tr_b16 a[168:169], v54 offset:40960
s_add_u32 m0, s7, 18432
v_mfma_f32_16x16x32_bf16 v[212:215], a[180:183], a[104:107], v[212:215]
ds_read_b64_tr_b16 a[170:171], v54 offset:45056
s_add_u32 s44, s98, 606208
v_mfma_f32_16x16x32_bf16 v[180:183], a[180:183], a[100:103], v[180:183]
L_pg14:
s_cbranch_execz L_pg18
buffer_load_dwordx4 v6, s[28:31], s44 offen lds
v_mfma_f32_16x16x32_bf16 v[148:151], a[180:183], a[96:99], v[148:151]
s_waitcnt lgkmcnt(6)
v_mfma_f32_16x16x32_bf16 v[152:155], a[184:187], a[96:99], v[152:155]
ds_read_b64_tr_b16 a[172:173], v55 offset:40960
s_waitcnt vmcnt(15)
v_cmp_gt_i32 vcc, 1, v49
v_mfma_f32_16x16x32_bf16 v[184:187], a[184:187], a[100:103], v[184:187]
ds_read_b64_tr_b16 a[174:175], v55 offset:45056
v_mfma_f32_16x16x32_bf16 v[216:219], a[184:187], a[104:107], v[216:219]
buffer_load_dwordx4 a[156:159], v2, s[20:23], s101 offen offset:3072 sc1
v_mfma_f32_16x16x32_bf16 v[248:251], a[184:187], a[108:111], v[248:251]
s_add_u32 s101, s101, 4096
s_cbranch_vccnz L_slow19
L_back20:
v_mfma_f32_16x16x32_bf16 v[252:255], a[188:191], a[108:111], v[252:255]
ds_read_b64_tr_b16 a[176:177], v56 offset:40960
v_mfma_f32_16x16x32_bf16 v[220:223], a[188:191], a[104:107], v[220:223]
ds_read_b64_tr_b16 a[178:179], v56 offset:45056
s_add_u32 m0, s7, 19456
v_mfma_f32_16x16x32_bf16 v[188:191], a[188:191], a[100:103], v[188:191]
buffer_load_dwordx4 v7, s[28:31], s44 offen lds
v_mfma_f32_16x16x32_bf16 v[156:159], a[188:191], a[96:99], v[156:159]
s_waitcnt vmcnt(14) lgkmcnt(6)
v_mfma_f32_16x16x32_bf16 v[128:131], a[160:163], a[112:115], v[128:131]
ds_read_b64_tr_b16 a[180:181], v57 offset:40960
s_add_u32 s49, s101, 77824
v_mfma_f32_16x16x32_bf16 v[160:163], a[160:163], a[116:119], v[160:163]
ds_read_b64_tr_b16 a[182:183], v57 offset:45056
v_mfma_f32_16x16x32_bf16 v[192:195], a[160:163], a[120:123], v[192:195]
buffer_load_dwordx4 a[96:99], v2, s[20:23], s101 offen offset:0 sc1
v_mfma_f32_16x16x32_bf16 v[224:227], a[160:163], a[124:127], v[224:227]
v_mfma_f32_16x16x32_bf16 v[228:231], a[164:167], a[124:127], v[228:231]
ds_read_b64_tr_b16 a[184:185], v58 offset:40960
v_mfma_f32_16x16x32_bf16 v[196:199], a[164:167], a[120:123], v[196:199]
ds_read_b64_tr_b16 a[186:187], v58 offset:45056
v_mfma_f32_16x16x32_bf16 v[164:167], a[164:167], a[116:119], v[164:167]
v_mfma_f32_16x16x32_bf16 v[132:135], a[164:167], a[112:115], v[132:135]
s_waitcnt lgkmcnt(6)
v_mfma_f32_16x16x32_bf16 v[136:139], a[168:171], a[112:115], v[136:139]
ds_read_b64_tr_b16 a[188:189], v59 offset:40960
v_mov_b32_e64 v24, 2
v_mfma_f32_16x16x32_bf16 v[168:171], a[168:171], a[116:119], v[168:171]
ds_read_b64_tr_b16 a[190:191], v59 offset:45056
v_mfma_f32_16x16x32_bf16 v[200:203], a[168:171], a[120:123], v[200:203]
buffer_load_dwordx4 a[100:103], v2, s[20:23], s101 offen offset:1024 sc1
v_mfma_f32_16x16x32_bf16 v[232:235], a[168:171], a[124:127], v[232:235]
v_mfma_f32_16x16x32_bf16 v[236:239], a[172:175], a[124:127], v[236:239]
ds_read_b64_tr_b16 a[160:161], v52 offset:49152
v_mfma_f32_16x16x32_bf16 v[204:207], a[172:175], a[120:123], v[204:207]
ds_read_b64_tr_b16 a[162:163], v52 offset:53248
v_mfma_f32_16x16x32_bf16 v[172:175], a[172:175], a[116:119], v[172:175]
s_waitcnt vmcnt(13)
buffer_store_dword v24, v25, s[20:23], s50 offen sc1
v_mfma_f32_16x16x32_bf16 v[140:143], a[172:175], a[112:115], v[140:143]
s_waitcnt lgkmcnt(6)
v_mfma_f32_16x16x32_bf16 v[144:147], a[176:179], a[112:115], v[144:147]
ds_read_b64_tr_b16 a[164:165], v53 offset:49152
v_mfma_f32_16x16x32_bf16 v[176:179], a[176:179], a[116:119], v[176:179]
ds_read_b64_tr_b16 a[166:167], v53 offset:53248
v_mfma_f32_16x16x32_bf16 v[208:211], a[176:179], a[120:123], v[208:211]
buffer_load_dwordx4 a[104:107], v2, s[20:23], s101 offen offset:2048 sc1
v_mfma_f32_16x16x32_bf16 v[240:243], a[176:179], a[124:127], v[240:243]
v_mfma_f32_16x16x32_bf16 v[244:247], a[180:183], a[124:127], v[244:247]
ds_read_b64_tr_b16 a[168:169], v54 offset:49152
s_add_u32 m0, s7, 65536
v_mfma_f32_16x16x32_bf16 v[212:215], a[180:183], a[120:123], v[212:215]
ds_read_b64_tr_b16 a[170:171], v54 offset:53248
s_add_u32 s44, s98, 1048576
v_mfma_f32_16x16x32_bf16 v[180:183], a[180:183], a[116:119], v[180:183]
buffer_load_dwordx4 v6, s[28:31], s44 offen lds
v_mfma_f32_16x16x32_bf16 v[148:151], a[180:183], a[112:115], v[148:151]
s_waitcnt lgkmcnt(6)
v_mfma_f32_16x16x32_bf16 v[152:155], a[184:187], a[112:115], v[152:155]
ds_read_b64_tr_b16 a[172:173], v55 offset:49152
v_mfma_f32_16x16x32_bf16 v[184:187], a[184:187], a[116:119], v[184:187]
ds_read_b64_tr_b16 a[174:175], v55 offset:53248
v_mfma_f32_16x16x32_bf16 v[216:219], a[184:187], a[120:123], v[216:219]
buffer_load_dwordx4 a[108:111], v2, s[20:23], s101 offen offset:3072 sc1
v_mfma_f32_16x16x32_bf16 v[248:251], a[184:187], a[124:127], v[248:251]
s_add_u32 s101, s101, 4096
v_mfma_f32_16x16x32_bf16 v[252:255], a[188:191], a[124:127], v[252:255]
ds_read_b64_tr_b16 a[176:177], v56 offset:49152
v_mfma_f32_16x16x32_bf16 v[220:223], a[188:191], a[120:123], v[220:223]
ds_read_b64_tr_b16 a[178:179], v56 offset:53248
s_add_u32 m0, s7, 66560
v_mfma_f32_16x16x32_bf16 v[188:191], a[188:191], a[116:119], v[188:191]
buffer_load_dwordx4 v7, s[28:31], s44 offen lds
v_mfma_f32_16x16x32_bf16 v[156:159], a[188:191], a[112:115], v[156:159]
s_waitcnt vmcnt(14) lgkmcnt(6)
v_mfma_f32_16x16x32_bf16 v[128:131], a[160:163], a[128:131], v[128:131]
ds_read_b64_tr_b16 a[180:181], v57 offset:49152
v_mfma_f32_16x16x32_bf16 v[160:163], a[160:163], a[132:135], v[160:163]
ds_read_b64_tr_b16 a[182:183], v57 offset:53248
v_mfma_f32_16x16x32_bf16 v[192:195], a[160:163], a[136:139], v[192:195]
buffer_load_dwordx4 a[112:115], v2, s[20:23], s101 offen offset:0 sc1
v_mfma_f32_16x16x32_bf16 v[224:227], a[160:163], a[140:143], v[224:227]
v_mfma_f32_16x16x32_bf16 v[228:231], a[164:167], a[140:143], v[228:231]
ds_read_b64_tr_b16 a[184:185], v58 offset:49152
v_mfma_f32_16x16x32_bf16 v[196:199], a[164:167], a[136:139], v[196:199]
ds_read_b64_tr_b16 a[186:187], v58 offset:53248
v_mfma_f32_16x16x32_bf16 v[164:167], a[164:167], a[132:135], v[164:167]
v_mfma_f32_16x16x32_bf16 v[132:135], a[164:167], a[128:131], v[132:135]
s_waitcnt lgkmcnt(6)
v_mfma_f32_16x16x32_bf16 v[136:139], a[168:171], a[128:131], v[136:139]
ds_read_b64_tr_b16 a[188:189], v59 offset:49152
v_mfma_f32_16x16x32_bf16 v[168:171], a[168:171], a[132:135], v[168:171]
ds_read_b64_tr_b16 a[190:191], v59 offset:53248
v_mfma_f32_16x16x32_bf16 v[200:203], a[168:171], a[136:139], v[200:203]
buffer_load_dwordx4 a[116:119], v2, s[20:23], s101 offen offset:1024 sc1
v_mfma_f32_16x16x32_bf16 v[232:235], a[168:171], a[140:143], v[232:235]
v_mfma_f32_16x16x32_bf16 v[236:239], a[172:175], a[140:143], v[236:239]
ds_read_b64_tr_b16 a[160:161], v52 offset:57344
v_mfma_f32_16x16x32_bf16 v[204:207], a[172:175], a[136:139], v[204:207]
ds_read_b64_tr_b16 a[162:163], v52 offset:61440
v_mfma_f32_16x16x32_bf16 v[172:175], a[172:175], a[132:135], v[172:175]
v_mfma_f32_16x16x32_bf16 v[140:143], a[172:175], a[128:131], v[140:143]
s_waitcnt lgkmcnt(6)
v_mfma_f32_16x16x32_bf16 v[144:147], a[176:179], a[128:131], v[144:147]
ds_read_b64_tr_b16 a[164:165], v53 offset:57344
v_mfma_f32_16x16x32_bf16 v[176:179], a[176:179], a[132:135], v[176:179]
ds_read_b64_tr_b16 a[166:167], v53 offset:61440
v_mfma_f32_16x16x32_bf16 v[208:211], a[176:179], a[136:139], v[208:211]
buffer_load_dwordx4 a[120:123], v2, s[20:23], s101 offen offset:2048 sc1
v_mfma_f32_16x16x32_bf16 v[240:243], a[176:179], a[140:143], v[240:243]
v_mfma_f32_16x16x32_bf16 v[244:247], a[180:183], a[140:143], v[244:247]
ds_read_b64_tr_b16 a[168:169], v54 offset:57344
s_add_u32 m0, s7, 67584
v_mfma_f32_16x16x32_bf16 v[212:215], a[180:183], a[136:139], v[212:215]
ds_read_b64_tr_b16 a[170:171], v54 offset:61440
s_add_u32 s44, s98, 1064960
v_mfma_f32_16x16x32_bf16 v[180:183], a[180:183], a[132:135], v[180:183]
buffer_load_dwordx4 v6, s[28:31], s44 offen lds
v_mfma_f32_16x16x32_bf16 v[148:151], a[180:183], a[128:131], v[148:151]
s_waitcnt lgkmcnt(6)
v_mfma_f32_16x16x32_bf16 v[152:155], a[184:187], a[128:131], v[152:155]
ds_read_b64_tr_b16 a[172:173], v55 offset:57344
v_mfma_f32_16x16x32_bf16 v[184:187], a[184:187], a[132:135], v[184:187]
ds_read_b64_tr_b16 a[174:175], v55 offset:61440
v_mfma_f32_16x16x32_bf16 v[216:219], a[184:187], a[136:139], v[216:219]
buffer_load_dwordx4 a[124:127], v2, s[20:23], s101 offen offset:3072 sc1
v_mfma_f32_16x16x32_bf16 v[248:251], a[184:187], a[140:143], v[248:251]
s_add_u32 s101, s101, 4096
v_mfma_f32_16x16x32_bf16 v[252:255], a[188:191], a[140:143], v[252:255]
ds_read_b64_tr_b16 a[176:177], v56 offset:57344
v_mfma_f32_16x16x32_bf16 v[220:223], a[188:191], a[136:139], v[220:223]
ds_read_b64_tr_b16 a[178:179], v56 offset:61440
s_add_u32 m0, s7, 68608
v_mfma_f32_16x16x32_bf16 v[188:191], a[188:191], a[132:135], v[188:191]
buffer_load_dwordx4 v7, s[28:31], s44 offen lds
v_mfma_f32_16x16x32_bf16 v[156:159], a[188:191], a[128:131], v[156:159]
s_waitcnt vmcnt(14) lgkmcnt(6)
v_mfma_f32_16x16x32_bf16 v[128:131], a[160:163], a[144:147], v[128:131]
ds_read_b64_tr_b16 a[180:181], v57 offset:57344
v_mfma_f32_16x16x32_bf16 v[160:163], a[160:163], a[148:151], v[160:163]
ds_read_b64_tr_b16 a[182:183], v57 offset:61440
v_mfma_f32_16x16x32_bf16 v[192:195], a[160:163], a[152:155], v[192:195]
buffer_load_dwordx4 a[128:131], v2, s[20:23], s101 offen offset:0 sc1
v_mfma_f32_16x16x32_bf16 v[224:227], a[160:163], a[156:159], v[224:227]
v_mfma_f32_16x16x32_bf16 v[228:231], a[164:167], a[156:159], v[228:231]
ds_read_b64_tr_b16 a[184:185], v58 offset:57344
v_mfma_f32_16x16x32_bf16 v[196:199], a[164:167], a[152:155], v[196:199]
ds_read_b64_tr_b16 a[186:187], v58 offset:61440
v_mfma_f32_16x16x32_bf16 v[164:167], a[164:167], a[148:151], v[164:167]
v_mfma_f32_16x16x32_bf16 v[132:135], a[164:167], a[144:147], v[132:135]
s_waitcnt lgkmcnt(6)
v_mfma_f32_16x16x32_bf16 v[136:139], a[168:171], a[144:147], v[136:139]
ds_read_b64_tr_b16 a[188:189], v59 offset:57344
v_mfma_f32_16x16x32_bf16 v[168:171], a[168:171], a[148:151], v[168:171]
ds_read_b64_tr_b16 a[190:191], v59 offset:61440
v_mfma_f32_16x16x32_bf16 v[200:203], a[168:171], a[152:155], v[200:203]
buffer_load_dwordx4 a[132:135], v2, s[20:23], s101 offen offset:1024 sc1
v_mfma_f32_16x16x32_bf16 v[232:235], a[168:171], a[156:159], v[232:235]
s_waitcnt vmcnt(15)
s_barrier
v_mfma_f32_16x16x32_bf16 v[236:239], a[172:175], a[156:159], v[236:239]
ds_read_b64_tr_b16 a[160:161], v12 offset:0
v_mfma_f32_16x16x32_bf16 v[204:207], a[172:175], a[152:155], v[204:207]
ds_read_b64_tr_b16 a[162:163], v12 offset:4096
v_mfma_f32_16x16x32_bf16 v[172:175], a[172:175], a[148:151], v[172:175]
v_mfma_f32_16x16x32_bf16 v[140:143], a[172:175], a[144:147], v[140:143]
s_waitcnt lgkmcnt(6)
v_mfma_f32_16x16x32_bf16 v[144:147], a[176:179], a[144:147], v[144:147]
ds_read_b64_tr_b16 a[164:165], v13 offset:0
v_mfma_f32_16x16x32_bf16 v[176:179], a[176:179], a[148:151], v[176:179]
ds_read_b64_tr_b16 a[166:167], v13 offset:4096
v_mfma_f32_16x16x32_bf16 v[208:211], a[176:179], a[152:155], v[208:211]
buffer_load_dwordx4 a[136:139], v2, s[20:23], s101 offen offset:2048 sc1
v_mfma_f32_16x16x32_bf16 v[240:243], a[176:179], a[156:159], v[240:243]
v_mfma_f32_16x16x32_bf16 v[244:247], a[180:183], a[156:159], v[244:247]
ds_read_b64_tr_b16 a[168:169], v14 offset:0
s_add_u32 m0, s7, 32768
v_mfma_f32_16x16x32_bf16 v[212:215], a[180:183], a[152:155], v[212:215]
ds_read_b64_tr_b16 a[170:171], v14 offset:4096
s_add_u32 s44, s98, 1507328
v_mfma_f32_16x16x32_bf16 v[180:183], a[180:183], a[148:151], v[180:183]
buffer_load_dwordx4 v6, s[28:31], s44 offen lds
v_mfma_f32_16x16x32_bf16 v[148:151], a[180:183], a[144:147], v[148:151]
s_waitcnt lgkmcnt(6)
v_mfma_f32_16x16x32_bf16 v[152:155], a[184:187], a[144:147], v[152:155]
ds_read_b64_tr_b16 a[172:173], v15 offset:0
v_mfma_f32_16x16x32_bf16 v[184:187], a[184:187], a[148:151], v[184:187]
ds_read_b64_tr_b16 a[174:175], v15 offset:4096
v_mfma_f32_16x16x32_bf16 v[216:219], a[184:187], a[152:155], v[216:219]
buffer_load_dwordx4 a[140:143], v2, s[20:23], s101 offen offset:3072 sc1
v_mfma_f32_16x16x32_bf16 v[248:251], a[184:187], a[156:159], v[248:251]
s_add_u32 s101, s101, 4096
v_mfma_f32_16x16x32_bf16 v[252:255], a[188:191], a[156:159], v[252:255]
ds_read_b64_tr_b16 a[176:177], v16 offset:0
v_mfma_f32_16x16x32_bf16 v[220:223], a[188:191], a[152:155], v[220:223]
ds_read_b64_tr_b16 a[178:179], v16 offset:4096
s_add_u32 m0, s7, 33792
v_mfma_f32_16x16x32_bf16 v[188:191], a[188:191], a[148:151], v[188:191]
buffer_load_dwordx4 v7, s[28:31], s44 offen lds
v_mfma_f32_16x16x32_bf16 v[156:159], a[188:191], a[144:147], v[156:159]
s_waitcnt vmcnt(13) lgkmcnt(6)
v_mfma_f32_16x16x32_bf16 v[128:131], a[160:163], a[96:99], v[128:131]
ds_read_b64_tr_b16 a[180:181], v17 offset:0
v_mfma_f32_16x16x32_bf16 v[160:163], a[160:163], a[100:103], v[160:163]
ds_read_b64_tr_b16 a[182:183], v17 offset:4096
v_mfma_f32_16x16x32_bf16 v[192:195], a[160:163], a[104:107], v[192:195]
buffer_load_dwordx4 a[144:147], v2, s[20:23], s101 offen offset:0 sc1
v_mfma_f32_16x16x32_bf16 v[224:227], a[160:163], a[108:111], v[224:227]
v_mfma_f32_16x16x32_bf16 v[228:231], a[164:167], a[108:111], v[228:231]
ds_read_b64_tr_b16 a[184:185], v18 offset:0
v_mfma_f32_16x16x32_bf16 v[196:199], a[164:167], a[104:107], v[196:199]
ds_read_b64_tr_b16 a[186:187], v18 offset:4096
v_mfma_f32_16x16x32_bf16 v[164:167], a[164:167], a[100:103], v[164:167]
buffer_load_dword v49, v48, s[20:23], s51 offen sc1
v_mfma_f32_16x16x32_bf16 v[132:135], a[164:167], a[96:99], v[132:135]
s_waitcnt lgkmcnt(6)
v_mfma_f32_16x16x32_bf16 v[136:139], a[168:171], a[96:99], v[136:139]
ds_read_b64_tr_b16 a[188:189], v19 offset:0
v_mfma_f32_16x16x32_bf16 v[168:171], a[168:171], a[100:103], v[168:171]
ds_read_b64_tr_b16 a[190:191], v19 offset:4096
v_mfma_f32_16x16x32_bf16 v[200:203], a[168:171], a[104:107], v[200:203]
buffer_load_dwordx4 a[148:151], v2, s[20:23], s101 offen offset:1024 sc1
v_mfma_f32_16x16x32_bf16 v[232:235], a[168:171], a[108:111], v[232:235]
v_mfma_f32_16x16x32_bf16 v[236:239], a[172:175], a[108:111], v[236:239]
ds_read_b64_tr_b16 a[160:161], v12 offset:8192
v_mfma_f32_16x16x32_bf16 v[204:207], a[172:175], a[104:107], v[204:207]
ds_read_b64_tr_b16 a[162:163], v12 offset:12288
v_mfma_f32_16x16x32_bf16 v[172:175], a[172:175], a[100:103], v[172:175]
v_mfma_f32_16x16x32_bf16 v[140:143], a[172:175], a[96:99], v[140:143]
s_waitcnt lgkmcnt(6)
v_mfma_f32_16x16x32_bf16 v[144:147], a[176:179], a[96:99], v[144:147]
ds_read_b64_tr_b16 a[164:165], v13 offset:8192
v_mfma_f32_16x16x32_bf16 v[176:179], a[176:179], a[100:103], v[176:179]
ds_read_b64_tr_b16 a[166:167], v13 offset:12288
v_mfma_f32_16x16x32_bf16 v[208:211], a[176:179], a[104:107], v[208:211]
buffer_load_dwordx4 a[152:155], v2, s[20:23], s101 offen offset:2048 sc1
v_mfma_f32_16x16x32_bf16 v[240:243], a[176:179], a[108:111], v[240:243]
v_mfma_f32_16x16x32_bf16 v[244:247], a[180:183], a[108:111], v[244:247]
ds_read_b64_tr_b16 a[168:169], v14 offset:8192
s_add_u32 m0, s7, 34816
v_mfma_f32_16x16x32_bf16 v[212:215], a[180:183], a[104:107], v[212:215]
ds_read_b64_tr_b16 a[170:171], v14 offset:12288
s_add_u32 s44, s98, 1523712
v_mfma_f32_16x16x32_bf16 v[180:183], a[180:183], a[100:103], v[180:183]
buffer_load_dwordx4 v6, s[28:31], s44 offen lds
v_mfma_f32_16x16x32_bf16 v[148:151], a[180:183], a[96:99], v[148:151]
s_waitcnt lgkmcnt(6)
v_mfma_f32_16x16x32_bf16 v[152:155], a[184:187], a[96:99], v[152:155]
ds_read_b64_tr_b16 a[172:173], v15 offset:8192
v_mfma_f32_16x16x32_bf16 v[184:187], a[184:187], a[100:103], v[184:187]
ds_read_b64_tr_b16 a[174:175], v15 offset:12288
v_mfma_f32_16x16x32_bf16 v[216:219], a[184:187], a[104:107], v[216:219]
buffer_load_dwordx4 a[156:159], v2, s[20:23], s101 offen offset:3072 sc1
v_mfma_f32_16x16x32_bf16 v[248:251], a[184:187], a[108:111], v[248:251]
s_add_u32 s101, s101, 4096
v_mfma_f32_16x16x32_bf16 v[252:255], a[188:191], a[108:111], v[252:255]
ds_read_b64_tr_b16 a[176:177], v16 offset:8192
v_mfma_f32_16x16x32_bf16 v[220:223], a[188:191], a[104:107], v[220:223]
ds_read_b64_tr_b16 a[178:179], v16 offset:12288
s_add_u32 m0, s7, 35840
v_mfma_f32_16x16x32_bf16 v[188:191], a[188:191], a[100:103], v[188:191]
buffer_load_dwordx4 v7, s[28:31], s44 offen lds
v_mfma_f32_16x16x32_bf16 v[156:159], a[188:191], a[96:99], v[156:159]
s_waitcnt vmcnt(14) lgkmcnt(6)
v_mfma_f32_16x16x32_bf16 v[128:131], a[160:163], a[112:115], v[128:131]
ds_read_b64_tr_b16 a[180:181], v17 offset:8192
v_mfma_f32_16x16x32_bf16 v[160:163], a[160:163], a[116:119], v[160:163]
ds_read_b64_tr_b16 a[182:183], v17 offset:12288
v_mfma_f32_16x16x32_bf16 v[192:195], a[160:163], a[120:123], v[192:195]
buffer_load_dwordx4 a[96:99], v2, s[20:23], s101 offen offset:0 sc1
v_mfma_f32_16x16x32_bf16 v[224:227], a[160:163], a[124:127], v[224:227]
v_mfma_f32_16x16x32_bf16 v[228:231], a[164:167], a[124:127], v[228:231]
ds_read_b64_tr_b16 a[184:185], v18 offset:8192
v_mfma_f32_16x16x32_bf16 v[196:199], a[164:167], a[120:123], v[196:199]
ds_read_b64_tr_b16 a[186:187], v18 offset:12288
v_mfma_f32_16x16x32_bf16 v[164:167], a[164:167], a[116:119], v[164:167]
v_mfma_f32_16x16x32_bf16 v[132:135], a[164:167], a[112:115], v[132:135]
s_waitcnt lgkmcnt(6)
v_mfma_f32_16x16x32_bf16 v[136:139], a[168:171], a[112:115], v[136:139]
ds_read_b64_tr_b16 a[188:189], v19 offset:8192
v_mfma_f32_16x16x32_bf16 v[168:171], a[168:171], a[116:119], v[168:171]
ds_read_b64_tr_b16 a[190:191], v19 offset:12288
v_mfma_f32_16x16x32_bf16 v[200:203], a[168:171], a[120:123], v[200:203]
buffer_load_dwordx4 a[100:103], v2, s[20:23], s101 offen offset:1024 sc1
v_mfma_f32_16x16x32_bf16 v[232:235], a[168:171], a[124:127], v[232:235]
v_mfma_f32_16x16x32_bf16 v[236:239], a[172:175], a[124:127], v[236:239]
ds_read_b64_tr_b16 a[160:161], v12 offset:16384
v_mfma_f32_16x16x32_bf16 v[204:207], a[172:175], a[120:123], v[204:207]
ds_read_b64_tr_b16 a[162:163], v12 offset:20480
v_mfma_f32_16x16x32_bf16 v[172:175], a[172:175], a[116:119], v[172:175]
v_mfma_f32_16x16x32_bf16 v[140:143], a[172:175], a[112:115], v[140:143]
s_waitcnt lgkmcnt(6)
v_mfma_f32_16x16x32_bf16 v[144:147], a[176:179], a[112:115], v[144:147]
ds_read_b64_tr_b16 a[164:165], v13 offset:16384
v_mfma_f32_16x16x32_bf16 v[176:179], a[176:179], a[116:119], v[176:179]
ds_read_b64_tr_b16 a[166:167], v13 offset:20480
v_mfma_f32_16x16x32_bf16 v[208:211], a[176:179], a[120:123], v[208:211]
buffer_load_dwordx4 a[104:107], v2, s[20:23], s101 offen offset:2048 sc1
v_mfma_f32_16x16x32_bf16 v[240:243], a[176:179], a[124:127], v[240:243]
v_mfma_f32_16x16x32_bf16 v[244:247], a[180:183], a[124:127], v[244:247]
ds_read_b64_tr_b16 a[168:169], v14 offset:16384
s_add_u32 m0, s7, 49152
v_mfma_f32_16x16x32_bf16 v[212:215], a[180:183], a[120:123], v[212:215]
ds_read_b64_tr_b16 a[170:171], v14 offset:20480
s_add_u32 s44, s99, 196608
v_mfma_f32_16x16x32_bf16 v[180:183], a[180:183], a[116:119], v[180:183]
buffer_load_dwordx4 v6, s[28:31], s44 offen lds
v_mfma_f32_16x16x32_bf16 v[148:151], a[180:183], a[112:115], v[148:151]
s_waitcnt lgkmcnt(6)
v_mfma_f32_16x16x32_bf16 v[152:155], a[184:187], a[112:115], v[152:155]
ds_read_b64_tr_b16 a[172:173], v15 offset:16384
s_waitcnt vmcnt(9)
v_cmp_gt_i32 vcc, 2, v49
v_mfma_f32_16x16x32_bf16 v[184:187], a[184:187], a[116:119], v[184:187]
ds_read_b64_tr_b16 a[174:175], v15 offset:20480
v_mfma_f32_16x16x32_bf16 v[216:219], a[184:187], a[120:123], v[216:219]
buffer_load_dwordx4 a[108:111], v2, s[20:23], s101 offen offset:3072 sc1
v_mfma_f32_16x16x32_bf16 v[248:251], a[184:187], a[124:127], v[248:251]
s_add_u32 s101, s101, 4096
s_cbranch_vccnz L_slow22
L_back23:
v_mfma_f32_16x16x32_bf16 v[252:255], a[188:191], a[124:127], v[252:255]
ds_read_b64_tr_b16 a[176:177], v16 offset:16384
v_mfma_f32_16x16x32_bf16 v[220:223], a[188:191], a[120:123], v[220:223]
ds_read_b64_tr_b16 a[178:179], v16 offset:20480
s_add_u32 m0, s7, 50176
v_mfma_f32_16x16x32_bf16 v[188:191], a[188:191], a[116:119], v[188:191]
buffer_load_dwordx4 v7, s[28:31], s44 offen lds
v_mfma_f32_16x16x32_bf16 v[156:159], a[188:191], a[112:115], v[156:159]
s_waitcnt lgkmcnt(6)
v_mfma_f32_16x16x32_bf16 v[128:131], a[160:163], a[128:131], v[128:131]
ds_read_b64_tr_b16 a[180:181], v17 offset:16384
v_mfma_f32_16x16x32_bf16 v[160:163], a[160:163], a[132:135], v[160:163]
ds_read_b64_tr_b16 a[182:183], v17 offset:20480
v_mfma_f32_16x16x32_bf16 v[192:195], a[160:163], a[136:139], v[192:195]
buffer_load_dwordx4 a[112:115], v2, s[20:23], s101 offen offset:0 sc1
v_mfma_f32_16x16x32_bf16 v[224:227], a[160:163], a[140:143], v[224:227]
v_mfma_f32_16x16x32_bf16 v[228:231], a[164:167], a[140:143], v[228:231]
ds_read_b64_tr_b16 a[184:185], v18 offset:16384
v_mfma_f32_16x16x32_bf16 v[196:199], a[164:167], a[136:139], v[196:199]
ds_read_b64_tr_b16 a[186:187], v18 offset:20480
s_add_u32 s49, s49, 4096
v_mfma_f32_16x16x32_bf16 v[164:167], a[164:167], a[132:135], v[164:167]
buffer_load_dwordx4 a[0:3], v2, s[20:23], s49 offen offset:0 sc1
v_mfma_f32_16x16x32_bf16 v[132:135], a[164:167], a[128:131], v[132:135]
s_waitcnt lgkmcnt(6)
v_mfma_f32_16x16x32_bf16 v[136:139], a[168:171], a[128:131], v[136:139]
ds_read_b64_tr_b16 a[188:189], v19 offset:16384
v_mfma_f32_16x16x32_bf16 v[168:171], a[168:171], a[132:135], v[168:171]
ds_read_b64_tr_b16 a[190:191], v19 offset:20480
v_mfma_f32_16x16x32_bf16 v[200:203], a[168:171], a[136:139], v[200:203]
buffer_load_dwordx4 a[116:119], v2, s[20:23], s101 offen offset:1024 sc1
v_mfma_f32_16x16x32_bf16 v[232:235], a[168:171], a[140:143], v[232:235]
v_mfma_f32_16x16x32_bf16 v[236:239], a[172:175], a[140:143], v[236:239]
ds_read_b64_tr_b16 a[160:161], v12 offset:24576
v_mfma_f32_16x16x32_bf16 v[204:207], a[172:175], a[136:139], v[204:207]
ds_read_b64_tr_b16 a[162:163], v12 offset:28672
v_mfma_f32_16x16x32_bf16 v[172:175], a[172:175], a[132:135], v[172:175]
buffer_load_dwordx4 a[4:7], v2, s[20:23], s49 offen offset:1024 sc1
v_mfma_f32_16x16x32_bf16 v[140:143], a[172:175], a[128:131], v[140:143]
s_waitcnt lgkmcnt(6)
v_mfma_f32_16x16x32_bf16 v[144:147], a[176:179], a[128:131], v[144:147]
ds_read_b64_tr_b16 a[164:165], v13 offset:24576
v_mfma_f32_16x16x32_bf16 v[176:179], a[176:179], a[132:135], v[176:179]
ds_read_b64_tr_b16 a[166:167], v13 offset:28672
v_mfma_f32_16x16x32_bf16 v[208:211], a[176:179], a[136:139], v[208:211]
buffer_load_dwordx4 a[120:123], v2, s[20:23], s101 offen offset:2048 sc1
v_mfma_f32_16x16x32_bf16 v[240:243], a[176:179], a[140:143], v[240:243]
v_mfma_f32_16x16x32_bf16 v[244:247], a[180:183], a[140:143], v[244:247]
ds_read_b64_tr_b16 a[168:169], v14 offset:24576
s_add_u32 m0, s7, 51200
v_mfma_f32_16x16x32_bf16 v[212:215], a[180:183], a[136:139], v[212:215]
ds_read_b64_tr_b16 a[170:171], v14 offset:28672
s_add_u32 s44, s99, 212992
v_mfma_f32_16x16x32_bf16 v[180:183], a[180:183], a[132:135], v[180:183]
buffer_load_dwordx4 v6, s[28:31], s44 offen lds
v_mfma_f32_16x16x32_bf16 v[148:151], a[180:183], a[128:131], v[148:151]
s_waitcnt lgkmcnt(6)
v_mfma_f32_16x16x32_bf16 v[152:155], a[184:187], a[128:131], v[152:155]
ds_read_b64_tr_b16 a[172:173], v15 offset:24576
v_mfma_f32_16x16x32_bf16 v[184:187], a[184:187], a[132:135], v[184:187]
ds_read_b64_tr_b16 a[174:175], v15 offset:28672
v_mfma_f32_16x16x32_bf16 v[216:219], a[184:187], a[136:139], v[216:219]
buffer_load_dwordx4 a[124:127], v2, s[20:23], s101 offen offset:3072 sc1
v_mfma_f32_16x16x32_bf16 v[248:251], a[184:187], a[140:143], v[248:251]
s_add_u32 s101, s101, 4096
v_mfma_f32_16x16x32_bf16 v[252:255], a[188:191], a[140:143], v[252:255]
ds_read_b64_tr_b16 a[176:177], v16 offset:24576
v_mfma_f32_16x16x32_bf16 v[220:223], a[188:191], a[136:139], v[220:223]
ds_read_b64_tr_b16 a[178:179], v16 offset:28672
s_add_u32 m0, s7, 52224
v_mfma_f32_16x16x32_bf16 v[188:191], a[188:191], a[132:135], v[188:191]
buffer_load_dwordx4 v7, s[28:31], s44 offen lds
v_mfma_f32_16x16x32_bf16 v[156:159], a[188:191], a[128:131], v[156:159]
s_waitcnt vmcnt(15) lgkmcnt(6)
v_mfma_f32_16x16x32_bf16 v[128:131], a[160:163], a[144:147], v[128:131]
ds_read_b64_tr_b16 a[180:181], v17 offset:24576
v_mfma_f32_16x16x32_bf16 v[160:163], a[160:163], a[148:151], v[160:163]
ds_read_b64_tr_b16 a[182:183], v17 offset:28672
v_mfma_f32_16x16x32_bf16 v[192:195], a[160:163], a[152:155], v[192:195]
buffer_load_dwordx4 a[128:131], v2, s[20:23], s101 offen offset:0 sc1
v_mfma_f32_16x16x32_bf16 v[224:227], a[160:163], a[156:159], v[224:227]
v_mfma_f32_16x16x32_bf16 v[228:231], a[164:167], a[156:159], v[228:231]
ds_read_b64_tr_b16 a[184:185], v18 offset:24576
v_mfma_f32_16x16x32_bf16 v[196:199], a[164:167], a[152:155], v[196:199]
ds_read_b64_tr_b16 a[186:187], v18 offset:28672
v_mfma_f32_16x16x32_bf16 v[164:167], a[164:167], a[148:151], v[164:167]
v_mfma_f32_16x16x32_bf16 v[132:135], a[164:167], a[144:147], v[132:135]
s_waitcnt lgkmcnt(6)
v_mfma_f32_16x16x32_bf16 v[136:139], a[168:171], a[144:147], v[136:139]
ds_read_b64_tr_b16 a[188:189], v19 offset:24576
v_mfma_f32_16x16x32_bf16 v[168:171], a[168:171], a[148:151], v[168:171]
ds_read_b64_tr_b16 a[190:191], v19 offset:28672
v_mfma_f32_16x16x32_bf16 v[200:203], a[168:171], a[152:155], v[200:203]
buffer_load_dwordx4 a[132:135], v2, s[20:23], s101 offen offset:1024 sc1
v_mfma_f32_16x16x32_bf16 v[232:235], a[168:171], a[156:159], v[232:235]
s_waitcnt vmcnt(16)
s_barrier
v_mfma_f32_16x16x32_bf16 v[236:239], a[172:175], a[156:159], v[236:239]
ds_read_b64_tr_b16 a[160:161], v52 offset:0
v_mfma_f32_16x16x32_bf16 v[204:207], a[172:175], a[152:155], v[204:207]
ds_read_b64_tr_b16 a[162:163], v52 offset:4096
v_mfma_f32_16x16x32_bf16 v[172:175], a[172:175], a[148:151], v[172:175]
buffer_load_dwordx4 a[8:11], v2, s[20:23], s49 offen offset:2048 sc1
v_mfma_f32_16x16x32_bf16 v[140:143], a[172:175], a[144:147], v[140:143]
s_waitcnt lgkmcnt(6)
v_mfma_f32_16x16x32_bf16 v[144:147], a[176:179], a[144:147], v[144:147]
ds_read_b64_tr_b16 a[164:165], v53 offset:0
v_mfma_f32_16x16x32_bf16 v[176:179], a[176:179], a[148:151], v[176:179]
ds_read_b64_tr_b16 a[166:167], v53 offset:4096
v_mfma_f32_16x16x32_bf16 v[208:211], a[176:179], a[152:155], v[208:211]
buffer_load_dwordx4 a[136:139], v2, s[20:23], s101 offen offset:2048 sc1
v_mfma_f32_16x16x32_bf16 v[240:243], a[176:179], a[156:159], v[240:243]
v_mfma_f32_16x16x32_bf16 v[244:247], a[180:183], a[156:159], v[244:247]
ds_read_b64_tr_b16 a[168:169], v54 offset:0
s_add_u32 m0, s7, 81920
v_mfma_f32_16x16x32_bf16 v[212:215], a[180:183], a[152:155], v[212:215]
ds_read_b64_tr_b16 a[170:171], v54 offset:4096
s_add_u32 s44, s99, 1114112
v_mfma_f32_16x16x32_bf16 v[180:183], a[180:183], a[148:151], v[180:183]
buffer_load_dwordx4 v6, s[28:31], s44 offen lds
v_mfma_f32_16x16x32_bf16 v[148:151], a[180:183], a[144:147], v[148:151]
s_waitcnt lgkmcnt(6)
v_mfma_f32_16x16x32_bf16 v[152:155], a[184:187], a[144:147], v[152:155]
ds_read_b64_tr_b16 a[172:173], v55 offset:0
v_mfma_f32_16x16x32_bf16 v[184:187], a[184:187], a[148:151], v[184:187]
ds_read_b64_tr_b16 a[174:175], v55 offset:4096
v_mfma_f32_16x16x32_bf16 v[216:219], a[184:187], a[152:155], v[216:219]
buffer_load_dwordx4 a[140:143], v2, s[20:23], s101 offen offset:3072 sc1
v_mfma_f32_16x16x32_bf16 v[248:251], a[184:187], a[156:159], v[248:251]
s_add_u32 s101, s101, 4096
v_mfma_f32_16x16x32_bf16 v[252:255], a[188:191], a[156:159], v[252:255]
ds_read_b64_tr_b16 a[176:177], v56 offset:0
v_mfma_f32_16x16x32_bf16 v[220:223], a[188:191], a[152:155], v[220:223]
ds_read_b64_tr_b16 a[178:179], v56 offset:4096
s_add_u32 m0, s7, 82944
v_mfma_f32_16x16x32_bf16 v[188:191], a[188:191], a[148:151], v[188:191]
buffer_load_dwordx4 v7, s[28:31], s44 offen lds
v_mfma_f32_16x16x32_bf16 v[156:159], a[188:191], a[144:147], v[156:159]
s_waitcnt vmcnt(16) lgkmcnt(6)
v_mfma_f32_16x16x32_bf16 v[128:131], a[160:163], a[96:99], v[128:131]
ds_read_b64_tr_b16 a[180:181], v57 offset:0
v_mfma_f32_16x16x32_bf16 v[160:163], a[160:163], a[100:103], v[160:163]
ds_read_b64_tr_b16 a[182:183], v57 offset:4096
v_mfma_f32_16x16x32_bf16 v[192:195], a[160:163], a[104:107], v[192:195]
buffer_load_dwordx4 a[144:147], v2, s[20:23], s101 offen offset:0 sc1
v_mfma_f32_16x16x32_bf16 v[224:227], a[160:163], a[108:111], v[224:227]
v_mfma_f32_16x16x32_bf16 v[228:231], a[164:167], a[108:111], v[228:231]
ds_read_b64_tr_b16 a[184:185], v58 offset:0
v_mfma_f32_16x16x32_bf16 v[196:199], a[164:167], a[104:107], v[196:199]
ds_read_b64_tr_b16 a[186:187], v58 offset:4096
v_mfma_f32_16x16x32_bf16 v[164:167], a[164:167], a[100:103], v[164:167]
buffer_load_dwordx4 a[12:15], v2, s[20:23], s49 offen offset:3072 sc1
v_mfma_f32_16x16x32_bf16 v[132:135], a[164:167], a[96:99], v[132:135]
s_waitcnt lgkmcnt(6)
v_mfma_f32_16x16x32_bf16 v[136:139], a[168:171], a[96:99], v[136:139]
ds_read_b64_tr_b16 a[188:189], v59 offset:0
v_mfma_f32_16x16x32_bf16 v[168:171], a[168:171], a[100:103], v[168:171]
ds_read_b64_tr_b16 a[190:191], v59 offset:4096
v_mfma_f32_16x16x32_bf16 v[200:203], a[168:171], a[104:107], v[200:203]
buffer_load_dwordx4 a[148:151], v2, s[20:23], s101 offen offset:1024 sc1
v_mfma_f32_16x16x32_bf16 v[232:235], a[168:171], a[108:111], v[232:235]
v_mfma_f32_16x16x32_bf16 v[236:239], a[172:175], a[108:111], v[236:239]
ds_read_b64_tr_b16 a[160:161], v52 offset:8192
v_mfma_f32_16x16x32_bf16 v[204:207], a[172:175], a[104:107], v[204:207]
ds_read_b64_tr_b16 a[162:163], v52 offset:12288
v_mfma_f32_16x16x32_bf16 v[172:175], a[172:175], a[100:103], v[172:175]
v_mfma_f32_16x16x32_bf16 v[140:143], a[172:175], a[96:99], v[140:143]
s_waitcnt lgkmcnt(6)
v_mfma_f32_16x16x32_bf16 v[144:147], a[176:179], a[96:99], v[144:147]
ds_read_b64_tr_b16 a[164:165], v53 offset:8192
v_mfma_f32_16x16x32_bf16 v[176:179], a[176:179], a[100:103], v[176:179]
ds_read_b64_tr_b16 a[166:167], v53 offset:12288
v_mfma_f32_16x16x32_bf16 v[208:211], a[176:179], a[104:107], v[208:211]
buffer_load_dwordx4 a[152:155], v2, s[20:23], s101 offen offset:2048 sc1
v_mfma_f32_16x16x32_bf16 v[240:243], a[176:179], a[108:111], v[240:243]
v_mfma_f32_16x16x32_bf16 v[244:247], a[180:183], a[108:111], v[244:247]
ds_read_b64_tr_b16 a[168:169], v54 offset:8192
s_add_u32 m0, s7, 83968
v_mfma_f32_16x16x32_bf16 v[212:215], a[180:183], a[104:107], v[212:215]
ds_read_b64_tr_b16 a[170:171], v54 offset:12288
s_add_u32 s44, s99, 1130496
v_mfma_f32_16x16x32_bf16 v[180:183], a[180:183], a[100:103], v[180:183]
buffer_load_dwordx4 v6, s[28:31], s44 offen lds
v_mfma_f32_16x16x32_bf16 v[148:151], a[180:183], a[96:99], v[148:151]
s_waitcnt lgkmcnt(6)
v_mfma_f32_16x16x32_bf16 v[152:155], a[184:187], a[96:99], v[152:155]
ds_read_b64_tr_b16 a[172:173], v55 offset:8192
v_mfma_f32_16x16x32_bf16 v[184:187], a[184:187], a[100:103], v[184:187]
ds_read_b64_tr_b16 a[174:175], v55 offset:12288
v_mfma_f32_16x16x32_bf16 v[216:219], a[184:187], a[104:107], v[216:219]
buffer_load_dwordx4 a[156:159], v2, s[20:23], s101 offen offset:3072 sc1
v_mfma_f32_16x16x32_bf16 v[248:251], a[184:187], a[108:111], v[248:251]
s_add_u32 s101, s101, 4096
v_mfma_f32_16x16x32_bf16 v[252:255], a[188:191], a[108:111], v[252:255]
ds_read_b64_tr_b16 a[176:177], v56 offset:8192
v_mfma_f32_16x16x32_bf16 v[220:223], a[188:191], a[104:107], v[220:223]
ds_read_b64_tr_b16 a[178:179], v56 offset:12288
s_add_u32 m0, s7, 84992
v_mfma_f32_16x16x32_bf16 v[188:191], a[188:191], a[100:103], v[188:191]
L_pg15:
s_cbranch_execz L_ret3
buffer_load_dwordx4 v7, s[28:31], s44 offen lds
v_mfma_f32_16x16x32_bf16 v[156:159], a[188:191], a[96:99], v[156:159]
s_waitcnt vmcnt(15) lgkmcnt(6)
v_mfma_f32_16x16x32_bf16 v[128:131], a[160:163], a[112:115], v[128:131]
ds_read_b64_tr_b16 a[180:181], v57 offset:8192
v_mfma_f32_16x16x32_bf16 v[160:163], a[160:163], a[116:119], v[160:163]
ds_read_b64_tr_b16 a[182:183], v57 offset:12288
v_mfma_f32_16x16x32_bf16 v[192:195], a[160:163], a[120:123], v[192:195]
buffer_load_dwordx4 a[96:99], v2, s[20:23], s101 offen offset:0 sc1
v_mfma_f32_16x16x32_bf16 v[224:227], a[160:163], a[124:127], v[224:227]
v_mfma_f32_16x16x32_bf16 v[228:231], a[164:167], a[124:127], v[228:231]
ds_read_b64_tr_b16 a[184:185], v58 offset:8192
v_mfma_f32_16x16x32_bf16 v[196:199], a[164:167], a[120:123], v[196:199]
ds_read_b64_tr_b16 a[186:187], v58 offset:12288
s_add_u32 s49, s49, 4096
v_mfma_f32_16x16x32_bf16 v[164:167], a[164:167], a[116:119], v[164:167]
buffer_load_dwordx4 a[16:19], v2, s[20:23], s49 offen offset:0 sc1
v_mfma_f32_16x16x32_bf16 v[132:135], a[164:167], a[112:115], v[132:135]
s_waitcnt lgkmcnt(6)
v_mfma_f32_16x16x32_bf16 v[136:139], a[168:171], a[112:115], v[136:139]
ds_read_b64_tr_b16 a[188:189], v59 offset:8192
v_mfma_f32_16x16x32_bf16 v[168:171], a[168:171], a[116:119], v[168:171]
ds_read_b64_tr_b16 a[190:191], v59 offset:12288
v_mfma_f32_16x16x32_bf16 v[200:203], a[168:171], a[120:123], v[200:203]
buffer_load_dwordx4 a[100:103], v2, s[20:23], s101 offen offset:1024 sc1
v_mfma_f32_16x16x32_bf16 v[232:235], a[168:171], a[124:127], v[232:235]
v_mfma_f32_16x16x32_bf16 v[236:239], a[172:175], a[124:127], v[236:239]
ds_read_b64_tr_b16 a[160:161], v12 offset:32768
v_mfma_f32_16x16x32_bf16 v[204:207], a[172:175], a[120:123], v[204:207]
ds_read_b64_tr_b16 a[162:163], v12 offset:36864
v_mfma_f32_16x16x32_bf16 v[172:175], a[172:175], a[116:119], v[172:175]
v_mfma_f32_16x16x32_bf16 v[140:143], a[172:175], a[112:115], v[140:143]
s_waitcnt lgkmcnt(6)
v_mfma_f32_16x16x32_bf16 v[144:147], a[176:179], a[112:115], v[144:147]
ds_read_b64_tr_b16 a[164:165], v13 offset:32768
v_mfma_f32_16x16x32_bf16 v[176:179], a[176:179], a[116:119], v[176:179]
ds_read_b64_tr_b16 a[166:167], v13 offset:36864
v_mfma_f32_16x16x32_bf16 v[208:211], a[176:179], a[120:123], v[208:211]
buffer_load_dwordx4 a[104:107], v2, s[20:23], s101 offen offset:2048 sc1
v_mfma_f32_16x16x32_bf16 v[240:243], a[176:179], a[124:127], v[240:243]
v_mfma_f32_16x16x32_bf16 v[244:247], a[180:183], a[124:127], v[244:247]
ds_read_b64_tr_b16 a[168:169], v14 offset:32768
s_add_u32 m0, s7, 98304
v_mfma_f32_16x16x32_bf16 v[212:215], a[180:183], a[120:123], v[212:215]
ds_read_b64_tr_b16 a[170:171], v14 offset:36864
s_add_u32 s44, s100, 0
v_mfma_f32_16x16x32_bf16 v[180:183], a[180:183], a[116:119], v[180:183]
buffer_load_dwordx4 v8, s[32:35], s44 offen lds
v_mfma_f32_16x16x32_bf16 v[148:151], a[180:183], a[112:115], v[148:151]
s_waitcnt lgkmcnt(6)
v_mfma_f32_16x16x32_bf16 v[152:155], a[184:187], a[112:115], v[152:155]
ds_read_b64_tr_b16 a[172:173], v15 offset:32768
v_mfma_f32_16x16x32_bf16 v[184:187], a[184:187], a[116:119], v[184:187]
ds_read_b64_tr_b16 a[174:175], v15 offset:36864
v_mfma_f32_16x16x32_bf16 v[216:219], a[184:187], a[120:123], v[216:219]
buffer_load_dwordx4 a[108:111], v2, s[20:23], s101 offen offset:3072 sc1
v_mfma_f32_16x16x32_bf16 v[248:251], a[184:187], a[124:127], v[248:251]
s_add_u32 s101, s101, 4096
v_mfma_f32_16x16x32_bf16 v[252:255], a[188:191], a[124:127], v[252:255]
ds_read_b64_tr_b16 a[176:177], v16 offset:32768
v_mfma_f32_16x16x32_bf16 v[220:223], a[188:191], a[120:123], v[220:223]
ds_read_b64_tr_b16 a[178:179], v16 offset:36864
s_add_u32 m0, s7, 99328
v_mfma_f32_16x16x32_bf16 v[188:191], a[188:191], a[116:119], v[188:191]
buffer_load_dwordx4 v9, s[32:35], s44 offen lds
v_mfma_f32_16x16x32_bf16 v[156:159], a[188:191], a[112:115], v[156:159]
s_waitcnt vmcnt(15) lgkmcnt(6)
v_mfma_f32_16x16x32_bf16 v[128:131], a[160:163], a[128:131], v[128:131]
ds_read_b64_tr_b16 a[180:181], v17 offset:32768
v_mfma_f32_16x16x32_bf16 v[160:163], a[160:163], a[132:135], v[160:163]
ds_read_b64_tr_b16 a[182:183], v17 offset:36864
v_mfma_f32_16x16x32_bf16 v[192:195], a[160:163], a[136:139], v[192:195]
buffer_load_dwordx4 a[112:115], v2, s[20:23], s101 offen offset:0 sc1
v_mfma_f32_16x16x32_bf16 v[224:227], a[160:163], a[140:143], v[224:227]
v_mfma_f32_16x16x32_bf16 v[228:231], a[164:167], a[140:143], v[228:231]
ds_read_b64_tr_b16 a[184:185], v18 offset:32768
v_mfma_f32_16x16x32_bf16 v[196:199], a[164:167], a[136:139], v[196:199]
ds_read_b64_tr_b16 a[186:187], v18 offset:36864
v_mfma_f32_16x16x32_bf16 v[164:167], a[164:167], a[132:135], v[164:167]
buffer_load_dwordx4 a[20:23], v2, s[20:23], s49 offen offset:1024 sc1
v_mfma_f32_16x16x32_bf16 v[132:135], a[164:167], a[128:131], v[132:135]
s_waitcnt lgkmcnt(6)
v_mfma_f32_16x16x32_bf16 v[136:139], a[168:171], a[128:131], v[136:139]
ds_read_b64_tr_b16 a[188:189], v19 offset:32768
v_mfma_f32_16x16x32_bf16 v[168:171], a[168:171], a[132:135], v[168:171]
ds_read_b64_tr_b16 a[190:191], v19 offset:36864
v_mfma_f32_16x16x32_bf16 v[200:203], a[168:171], a[136:139], v[200:203]
buffer_load_dwordx4 a[116:119], v2, s[20:23], s101 offen offset:1024 sc1
v_mfma_f32_16x16x32_bf16 v[232:235], a[168:171], a[140:143], v[232:235]
v_mfma_f32_16x16x32_bf16 v[236:239], a[172:175], a[140:143], v[236:239]
ds_read_b64_tr_b16 a[160:161], v12 offset:40960
v_mfma_f32_16x16x32_bf16 v[204:207], a[172:175], a[136:139], v[204:207]
ds_read_b64_tr_b16 a[162:163], v12 offset:45056
v_mfma_f32_16x16x32_bf16 v[172:175], a[172:175], a[132:135], v[172:175]
buffer_load_dwordx4 a[24:27], v2, s[20:23], s49 offen offset:2048 sc1
v_mfma_f32_16x16x32_bf16 v[140:143], a[172:175], a[128:131], v[140:143]
s_waitcnt lgkmcnt(6)
v_mfma_f32_16x16x32_bf16 v[144:147], a[176:179], a[128:131], v[144:147]
ds_read_b64_tr_b16 a[164:165], v13 offset:40960
v_mfma_f32_16x16x32_bf16 v[176:179], a[176:179], a[132:135], v[176:179]
ds_read_b64_tr_b16 a[166:167], v13 offset:45056
v_mfma_f32_16x16x32_bf16 v[208:211], a[176:179], a[136:139], v[208:211]
buffer_load_dwordx4 a[120:123], v2, s[20:23], s101 offen offset:2048 sc1
v_mfma_f32_16x16x32_bf16 v[240:243], a[176:179], a[140:143], v[240:243]
v_mfma_f32_16x16x32_bf16 v[244:247], a[180:183], a[140:143], v[244:247]
ds_read_b64_tr_b16 a[168:169], v14 offset:40960
s_add_u32 m0, s7, 100352
v_mfma_f32_16x16x32_bf16 v[212:215], a[180:183], a[136:139], v[212:215]
ds_read_b64_tr_b16 a[170:171], v14 offset:45056
s_add_u32 s44, s100, 32768
v_mfma_f32_16x16x32_bf16 v[180:183], a[180:183], a[132:135], v[180:183]
buffer_load_dwordx4 v8, s[32:35], s44 offen lds
v_mfma_f32_16x16x32_bf16 v[148:151], a[180:183], a[128:131], v[148:151]
s_waitcnt lgkmcnt(6)
v_mfma_f32_16x16x32_bf16 v[152:155], a[184:187], a[128:131], v[152:155]
ds_read_b64_tr_b16 a[172:173], v15 offset:40960
v_mfma_f32_16x16x32_bf16 v[184:187], a[184:187], a[132:135], v[184:187]
ds_read_b64_tr_b16 a[174:175], v15 offset:45056
v_mfma_f32_16x16x32_bf16 v[216:219], a[184:187], a[136:139], v[216:219]
buffer_load_dwordx4 a[124:127], v2, s[20:23], s101 offen offset:3072 sc1
v_mfma_f32_16x16x32_bf16 v[248:251], a[184:187], a[140:143], v[248:251]
s_add_u32 s101, s101, 4096
v_mfma_f32_16x16x32_bf16 v[252:255], a[188:191], a[140:143], v[252:255]
ds_read_b64_tr_b16 a[176:177], v16 offset:40960
v_mfma_f32_16x16x32_bf16 v[220:223], a[188:191], a[136:139], v[220:223]
ds_read_b64_tr_b16 a[178:179], v16 offset:45056
s_add_u32 m0, s7, 101376
v_mfma_f32_16x16x32_bf16 v[188:191], a[188:191], a[132:135], v[188:191]
buffer_load_dwordx4 v9, s[32:35], s44 offen lds
v_mfma_f32_16x16x32_bf16 v[156:159], a[188:191], a[128:131], v[156:159]
s_waitcnt vmcnt(16) lgkmcnt(6)
v_mfma_f32_16x16x32_bf16 v[128:131], a[160:163], a[144:147], v[128:131]
ds_read_b64_tr_b16 a[180:181], v17 offset:40960
v_mfma_f32_16x16x32_bf16 v[160:163], a[160:163], a[148:151], v[160:163]
ds_read_b64_tr_b16 a[182:183], v17 offset:45056
v_mfma_f32_16x16x32_bf16 v[192:195], a[160:163], a[152:155], v[192:195]
buffer_load_dwordx4 a[128:131], v2, s[20:23], s101 offen offset:0 sc1
v_mfma_f32_16x16x32_bf16 v[224:227], a[160:163], a[156:159], v[224:227]
s_bitcmp1_b32 s3, 0
s_cselect_b64 s[12:13], s[76:77], s[74:75]
v_mfma_f32_16x16x32_bf16 v[228:231], a[164:167], a[156:159], v[228:231]
ds_read_b64_tr_b16 a[184:185], v18 offset:40960
v_mfma_f32_16x16x32_bf16 v[196:199], a[164:167], a[152:155], v[196:199]
ds_read_b64_tr_b16 a[186:187], v18 offset:45056
v_mfma_f32_16x16x32_bf16 v[164:167], a[164:167], a[148:151], v[164:167]
s_mov_b32 s14, 2097152
v_mfma_f32_16x16x32_bf16 v[132:135], a[164:167], a[144:147], v[132:135]
s_waitcnt lgkmcnt(6)
v_mfma_f32_16x16x32_bf16 v[136:139], a[168:171], a[144:147], v[136:139]
ds_read_b64_tr_b16 a[188:189], v19 offset:40960
s_mul_i32 s98, s52, 66048
v_mfma_f32_16x16x32_bf16 v[168:171], a[168:171], a[148:151], v[168:171]
ds_read_b64_tr_b16 a[190:191], v19 offset:45056
v_mfma_f32_16x16x32_bf16 v[200:203], a[168:171], a[152:155], v[200:203]
buffer_load_dwordx4 a[132:135], v2, s[20:23], s101 offen offset:1024 sc1
v_mfma_f32_16x16x32_bf16 v[232:235], a[168:171], a[156:159], v[232:235]
s_waitcnt vmcnt(17)
s_barrier
v_mfma_f32_16x16x32_bf16 v[236:239], a[172:175], a[156:159], v[236:239]
ds_read_b64_tr_b16 a[160:161], v12 offset:49152
v_mfma_f32_16x16x32_bf16 v[204:207], a[172:175], a[152:155], v[204:207]
ds_read_b64_tr_b16 a[162:163], v12 offset:53248
s_lshr_b32 s45, s3, 1
v_mfma_f32_16x16x32_bf16 v[172:175], a[172:175], a[148:151], v[172:175]
buffer_load_dwordx4 a[28:31], v2, s[20:23], s49 offen offset:3072 sc1
v_mfma_f32_16x16x32_bf16 v[140:143], a[172:175], a[144:147], v[140:143]
s_waitcnt lgkmcnt(6)
v_mfma_f32_16x16x32_bf16 v[144:147], a[176:179], a[144:147], v[144:147]
ds_read_b64_tr_b16 a[164:165], v13 offset:49152
v_mfma_f32_16x16x32_bf16 v[176:179], a[176:179], a[148:151], v[176:179]
ds_read_b64_tr_b16 a[166:167], v13 offset:53248
s_lshl_b32 s45, s45, 7
v_mfma_f32_16x16x32_bf16 v[208:211], a[176:179], a[152:155], v[208:211]
buffer_load_dwordx4 a[136:139], v2, s[20:23], s101 offen offset:2048 sc1
v_mfma_f32_16x16x32_bf16 v[240:243], a[176:179], a[156:159], v[240:243]
v_mfma_f32_16x16x32_bf16 v[244:247], a[180:183], a[156:159], v[244:247]
ds_read_b64_tr_b16 a[168:169], v14 offset:49152
s_add_u32 m0, s7, 114688
v_mfma_f32_16x16x32_bf16 v[212:215], a[180:183], a[152:155], v[212:215]
ds_read_b64_tr_b16 a[170:171], v14 offset:53248
s_add_u32 s44, s100, 0
v_mfma_f32_16x16x32_bf16 v[180:183], a[180:183], a[148:151], v[180:183]
buffer_load_dwordx4 v8, s[36:39], s44 offen lds
v_mfma_f32_16x16x32_bf16 v[148:151], a[180:183], a[144:147], v[148:151]
s_add_u32 s98, s98, s45
s_waitcnt lgkmcnt(6)
v_mfma_f32_16x16x32_bf16 v[152:155], a[184:187], a[144:147], v[152:155]
ds_read_b64_tr_b16 a[172:173], v15 offset:49152
v_mfma_f32_16x16x32_bf16 v[184:187], a[184:187], a[148:151], v[184:187]
ds_read_b64_tr_b16 a[174:175], v15 offset:53248
v_mfma_f32_16x16x32_bf16 v[216:219], a[184:187], a[152:155], v[216:219]
buffer_load_dwordx4 a[140:143], v2, s[20:23], s101 offen offset:3072 sc1
v_mfma_f32_16x16x32_bf16 v[248:251], a[184:187], a[156:159], v[248:251]
s_add_u32 s101, s101, 4096
s_add_u32 s98, s98, 256
v_mfma_f32_16x16x32_bf16 v[252:255], a[188:191], a[156:159], v[252:255]
ds_read_b64_tr_b16 a[176:177], v16 offset:49152
v_mfma_f32_16x16x32_bf16 v[220:223], a[188:191], a[152:155], v[220:223]
ds_read_b64_tr_b16 a[178:179], v16 offset:53248
s_add_u32 m0, s7, 115712
v_mfma_f32_16x16x32_bf16 v[188:191], a[188:191], a[148:151], v[188:191]
buffer_load_dwordx4 v9, s[36:39], s44 offen lds
v_mfma_f32_16x16x32_bf16 v[156:159], a[188:191], a[144:147], v[156:159]
s_waitcnt vmcnt(16) lgkmcnt(6)
v_mfma_f32_16x16x32_bf16 v[128:131], a[160:163], a[96:99], v[128:131]
ds_read_b64_tr_b16 a[180:181], v17 offset:49152
v_mfma_f32_16x16x32_bf16 v[160:163], a[160:163], a[100:103], v[160:163]
ds_read_b64_tr_b16 a[182:183], v17 offset:53248
v_mfma_f32_16x16x32_bf16 v[192:195], a[160:163], a[104:107], v[192:195]
buffer_load_dwordx4 a[144:147], v2, s[20:23], s101 offen offset:0 sc1
v_mfma_f32_16x16x32_bf16 v[224:227], a[160:163], a[108:111], v[224:227]
v_mfma_f32_16x16x32_bf16 v[228:231], a[164:167], a[108:111], v[228:231]
ds_read_b64_tr_b16 a[184:185], v18 offset:49152
v_mfma_f32_16x16x32_bf16 v[196:199], a[164:167], a[104:107], v[196:199]
ds_read_b64_tr_b16 a[186:187], v18 offset:53248
s_add_u32 s49, s49, 4096
v_mfma_f32_16x16x32_bf16 v[164:167], a[164:167], a[100:103], v[164:167]
buffer_load_dwordx4 a[32:35], v2, s[20:23], s49 offen offset:0 sc1
v_mfma_f32_16x16x32_bf16 v[132:135], a[164:167], a[96:99], v[132:135]
s_waitcnt lgkmcnt(6)
v_mfma_f32_16x16x32_bf16 v[136:139], a[168:171], a[96:99], v[136:139]
ds_read_b64_tr_b16 a[188:189], v19 offset:49152
v_mfma_f32_16x16x32_bf16 v[168:171], a[168:171], a[100:103], v[168:171]
ds_read_b64_tr_b16 a[190:191], v19 offset:53248
v_mfma_f32_16x16x32_bf16 v[200:203], a[168:171], a[104:107], v[200:203]
buffer_load_dwordx4 a[148:151], v2, s[20:23], s101 offen offset:1024 sc1
v_mfma_f32_16x16x32_bf16 v[232:235], a[168:171], a[108:111], v[232:235]
v_mfma_f32_16x16x32_bf16 v[236:239], a[172:175], a[108:111], v[236:239]
ds_read_b64_tr_b16 a[160:161], v12 offset:57344
v_mfma_f32_16x16x32_bf16 v[204:207], a[172:175], a[104:107], v[204:207]
ds_read_b64_tr_b16 a[162:163], v12 offset:61440
v_mfma_f32_16x16x32_bf16 v[172:175], a[172:175], a[100:103], v[172:175]
v_mfma_f32_16x16x32_bf16 v[140:143], a[172:175], a[96:99], v[140:143]
s_waitcnt lgkmcnt(6)
v_mfma_f32_16x16x32_bf16 v[144:147], a[176:179], a[96:99], v[144:147]
ds_read_b64_tr_b16 a[164:165], v13 offset:57344
v_mfma_f32_16x16x32_bf16 v[176:179], a[176:179], a[100:103], v[176:179]
ds_read_b64_tr_b16 a[166:167], v13 offset:61440
v_mfma_f32_16x16x32_bf16 v[208:211], a[176:179], a[104:107], v[208:211]
buffer_load_dwordx4 a[152:155], v2, s[20:23], s101 offen offset:2048 sc1
v_mfma_f32_16x16x32_bf16 v[240:243], a[176:179], a[108:111], v[240:243]
v_mfma_f32_16x16x32_bf16 v[244:247], a[180:183], a[108:111], v[244:247]
ds_read_b64_tr_b16 a[168:169], v14 offset:57344
s_add_u32 m0, s7, 116736
v_mfma_f32_16x16x32_bf16 v[212:215], a[180:183], a[104:107], v[212:215]
ds_read_b64_tr_b16 a[170:171], v14 offset:61440
s_add_u32 s44, s100, 32768
v_mfma_f32_16x16x32_bf16 v[180:183], a[180:183], a[100:103], v[180:183]
buffer_load_dwordx4 v8, s[36:39], s44 offen lds
v_mfma_f32_16x16x32_bf16 v[148:151], a[180:183], a[96:99], v[148:151]
s_waitcnt lgkmcnt(6)
v_mfma_f32_16x16x32_bf16 v[152:155], a[184:187], a[96:99], v[152:155]
ds_read_b64_tr_b16 a[172:173], v15 offset:57344
v_mfma_f32_16x16x32_bf16 v[184:187], a[184:187], a[100:103], v[184:187]
ds_read_b64_tr_b16 a[174:175], v15 offset:61440
v_mfma_f32_16x16x32_bf16 v[216:219], a[184:187], a[104:107], v[216:219]
buffer_load_dwordx4 a[156:159], v2, s[20:23], s101 offen offset:3072 sc1
v_mfma_f32_16x16x32_bf16 v[248:251], a[184:187], a[108:111], v[248:251]
s_add_u32 s101, s101, 4096
v_mfma_f32_16x16x32_bf16 v[252:255], a[188:191], a[108:111], v[252:255]
ds_read_b64_tr_b16 a[176:177], v16 offset:57344
v_mfma_f32_16x16x32_bf16 v[220:223], a[188:191], a[104:107], v[220:223]
ds_read_b64_tr_b16 a[178:179], v16 offset:61440
s_add_u32 m0, s7, 117760
v_mfma_f32_16x16x32_bf16 v[188:191], a[188:191], a[100:103], v[188:191]
buffer_load_dwordx4 v9, s[36:39], s44 offen lds
v_mfma_f32_16x16x32_bf16 v[156:159], a[188:191], a[96:99], v[156:159]
s_waitcnt vmcnt(15) lgkmcnt(6)
v_mfma_f32_16x16x32_bf16 v[128:131], a[160:163], a[112:115], v[128:131]
ds_read_b64_tr_b16 a[180:181], v17 offset:57344
v_mfma_f32_16x16x32_bf16 v[160:163], a[160:163], a[116:119], v[160:163]
ds_read_b64_tr_b16 a[182:183], v17 offset:61440
v_mfma_f32_16x16x32_bf16 v[192:195], a[160:163], a[120:123], v[192:195]
buffer_load_dwordx4 a[96:99], v2, s[20:23], s101 offen offset:0 sc1
v_mfma_f32_16x16x32_bf16 v[224:227], a[160:163], a[124:127], v[224:227]
v_mfma_f32_16x16x32_bf16 v[228:231], a[164:167], a[124:127], v[228:231]
ds_read_b64_tr_b16 a[184:185], v18 offset:57344
v_mfma_f32_16x16x32_bf16 v[196:199], a[164:167], a[120:123], v[196:199]
ds_read_b64_tr_b16 a[186:187], v18 offset:61440
v_mfma_f32_16x16x32_bf16 v[164:167], a[164:167], a[116:119], v[164:167]
buffer_load_dwordx4 a[36:39], v2, s[20:23], s49 offen offset:1024 sc1
v_mfma_f32_16x16x32_bf16 v[132:135], a[164:167], a[112:115], v[132:135]
s_waitcnt lgkmcnt(6)
v_mfma_f32_16x16x32_bf16 v[136:139], a[168:171], a[112:115], v[136:139]
ds_read_b64_tr_b16 a[188:189], v19 offset:57344
v_mfma_f32_16x16x32_bf16 v[168:171], a[168:171], a[116:119], v[168:171]
ds_read_b64_tr_b16 a[190:191], v19 offset:61440
v_mfma_f32_16x16x32_bf16 v[200:203], a[168:171], a[120:123], v[200:203]
buffer_load_dwordx4 a[100:103], v2, s[20:23], s101 offen offset:1024 sc1
v_mfma_f32_16x16x32_bf16 v[232:235], a[168:171], a[124:127], v[232:235]
v_mfma_f32_16x16x32_bf16 v[236:239], a[172:175], a[124:127], v[236:239]
ds_read_b64_tr_b16 a[160:161], v52 offset:16384
v_mfma_f32_16x16x32_bf16 v[204:207], a[172:175], a[120:123], v[204:207]
ds_read_b64_tr_b16 a[162:163], v52 offset:20480
v_mfma_f32_16x16x32_bf16 v[172:175], a[172:175], a[116:119], v[172:175]
v_mfma_f32_16x16x32_bf16 v[140:143], a[172:175], a[112:115], v[140:143]
s_waitcnt lgkmcnt(6)
v_mfma_f32_16x16x32_bf16 v[144:147], a[176:179], a[112:115], v[144:147]
ds_read_b64_tr_b16 a[164:165], v53 offset:16384
v_mfma_f32_16x16x32_bf16 v[176:179], a[176:179], a[116:119], v[176:179]
ds_read_b64_tr_b16 a[166:167], v53 offset:20480
v_mfma_f32_16x16x32_bf16 v[208:211], a[176:179], a[120:123], v[208:211]
buffer_load_dwordx4 a[104:107], v2, s[20:23], s101 offen offset:2048 sc1
v_mfma_f32_16x16x32_bf16 v[240:243], a[176:179], a[124:127], v[240:243]
v_mfma_f32_16x16x32_bf16 v[244:247], a[180:183], a[124:127], v[244:247]
ds_read_b64_tr_b16 a[168:169], v54 offset:16384
s_add_u32 m0, s7, 0
v_mfma_f32_16x16x32_bf16 v[212:215], a[180:183], a[120:123], v[212:215]
ds_read_b64_tr_b16 a[170:171], v54 offset:20480
s_add_u32 s44, s100, 128
v_mfma_f32_16x16x32_bf16 v[180:183], a[180:183], a[116:119], v[180:183]
buffer_load_dwordx4 v8, s[32:35], s44 offen lds
v_mfma_f32_16x16x32_bf16 v[148:151], a[180:183], a[112:115], v[148:151]
s_waitcnt lgkmcnt(6)
v_mfma_f32_16x16x32_bf16 v[152:155], a[184:187], a[112:115], v[152:155]
ds_read_b64_tr_b16 a[172:173], v55 offset:16384
v_mfma_f32_16x16x32_bf16 v[184:187], a[184:187], a[116:119], v[184:187]
ds_read_b64_tr_b16 a[174:175], v55 offset:20480
v_mfma_f32_16x16x32_bf16 v[216:219], a[184:187], a[120:123], v[216:219]
buffer_load_dwordx4 a[108:111], v2, s[20:23], s101 offen offset:3072 sc1
v_mfma_f32_16x16x32_bf16 v[248:251], a[184:187], a[124:127], v[248:251]
s_add_u32 s101, s101, 4096
v_mfma_f32_16x16x32_bf16 v[252:255], a[188:191], a[124:127], v[252:255]
ds_read_b64_tr_b16 a[176:177], v56 offset:16384
v_mfma_f32_16x16x32_bf16 v[220:223], a[188:191], a[120:123], v[220:223]
ds_read_b64_tr_b16 a[178:179], v56 offset:20480
s_add_u32 m0, s7, 1024
v_mfma_f32_16x16x32_bf16 v[188:191], a[188:191], a[116:119], v[188:191]
buffer_load_dwordx4 v9, s[32:35], s44 offen lds
v_mfma_f32_16x16x32_bf16 v[156:159], a[188:191], a[112:115], v[156:159]
s_waitcnt vmcnt(15) lgkmcnt(6)
v_mfma_f32_16x16x32_bf16 v[128:131], a[160:163], a[128:131], v[128:131]
ds_read_b64_tr_b16 a[180:181], v57 offset:16384
s_lshr_b32 s45, s2, 3
v_mfma_f32_16x16x32_bf16 v[160:163], a[160:163], a[132:135], v[160:163]
ds_read_b64_tr_b16 a[182:183], v57 offset:20480
v_mfma_f32_16x16x32_bf16 v[192:195], a[160:163], a[136:139], v[192:195]
buffer_load_dwordx4 a[112:115], v2, s[20:23], s101 offen offset:0 sc1
v_mfma_f32_16x16x32_bf16 v[224:227], a[160:163], a[140:143], v[224:227]
s_lshl_b32 s45, s45, 2
v_mfma_f32_16x16x32_bf16 v[228:231], a[164:167], a[140:143], v[228:231]
ds_read_b64_tr_b16 a[184:185], v58 offset:16384
v_mfma_f32_16x16x32_bf16 v[196:199], a[164:167], a[136:139], v[196:199]
ds_read_b64_tr_b16 a[186:187], v58 offset:20480
s_add_u32 s45, s45, s3
v_mfma_f32_16x16x32_bf16 v[164:167], a[164:167], a[132:135], v[164:167]
buffer_load_dwordx4 a[40:43], v2, s[20:23], s49 offen offset:2048 sc1
v_mfma_f32_16x16x32_bf16 v[132:135], a[164:167], a[128:131], v[132:135]
s_waitcnt lgkmcnt(6)
v_mfma_f32_16x16x32_bf16 v[136:139], a[168:171], a[128:131], v[136:139]
ds_read_b64_tr_b16 a[188:189], v59 offset:16384
v_mfma_f32_16x16x32_bf16 v[168:171], a[168:171], a[132:135], v[168:171]
ds_read_b64_tr_b16 a[190:191], v59 offset:20480
s_lshl_b32 s45, s45, 7
v_mfma_f32_16x16x32_bf16 v[200:203], a[168:171], a[136:139], v[200:203]
buffer_load_dwordx4 a[116:119], v2, s[20:23], s101 offen offset:1024 sc1
v_mfma_f32_16x16x32_bf16 v[232:235], a[168:171], a[140:143], v[232:235]
v_mfma_f32_16x16x32_bf16 v[236:239], a[172:175], a[140:143], v[236:239]
ds_read_b64_tr_b16 a[160:161], v52 offset:24576
s_add_u32 s45, s45, 65536
v_mfma_f32_16x16x32_bf16 v[204:207], a[172:175], a[136:139], v[204:207]
ds_read_b64_tr_b16 a[162:163], v52 offset:28672
v_mfma_f32_16x16x32_bf16 v[172:175], a[172:175], a[132:135], v[172:175]
buffer_load_dwordx4 a[44:47], v2, s[20:23], s49 offen offset:3072 sc1
v_mfma_f32_16x16x32_bf16 v[140:143], a[172:175], a[128:131], v[140:143]
s_min_u32 s45, s45, L_codeend-L_main-4
s_waitcnt lgkmcnt(6)
v_mfma_f32_16x16x32_bf16 v[144:147], a[176:179], a[128:131], v[144:147]
ds_read_b64_tr_b16 a[164:165], v53 offset:24576
v_mfma_f32_16x16x32_bf16 v[176:179], a[176:179], a[132:135], v[176:179]
ds_read_b64_tr_b16 a[166:167], v53 offset:28672
v_mfma_f32_16x16x32_bf16 v[208:211], a[176:179], a[136:139], v[208:211]
buffer_load_dwordx4 a[120:123], v2, s[20:23], s101 offen offset:2048 sc1
v_mfma_f32_16x16x32_bf16 v[240:243], a[176:179], a[140:143], v[240:243]
v_mov_b32_e64 v51, s45
v_mfma_f32_16x16x32_bf16 v[244:247], a[180:183], a[140:143], v[244:247]
ds_read_b64_tr_b16 a[168:169], v54 offset:24576
s_add_u32 m0, s7, 2048
v_mfma_f32_16x16x32_bf16 v[212:215], a[180:183], a[136:139], v[212:215]
ds_read_b64_tr_b16 a[170:171], v54 offset:28672
s_add_u32 s44, s100, 32896
v_mfma_f32_16x16x32_bf16 v[180:183], a[180:183], a[132:135], v[180:183]
buffer_load_dwordx4 v8, s[32:35], s44 offen lds
v_mfma_f32_16x16x32_bf16 v[148:151], a[180:183], a[128:131], v[148:151]
s_waitcnt lgkmcnt(6)
v_mfma_f32_16x16x32_bf16 v[152:155], a[184:187], a[128:131], v[152:155]
ds_read_b64_tr_b16 a[172:173], v55 offset:24576
v_mfma_f32_16x16x32_bf16 v[184:187], a[184:187], a[132:135], v[184:187]
ds_read_b64_tr_b16 a[174:175], v55 offset:28672
v_mfma_f32_16x16x32_bf16 v[216:219], a[184:187], a[136:139], v[216:219]
buffer_load_dwordx4 a[124:127], v2, s[20:23], s101 offen offset:3072 sc1
v_mfma_f32_16x16x32_bf16 v[248:251], a[184:187], a[140:143], v[248:251]
s_add_u32 s101, s101, 4096
global_load_dword v50, v51, s[82:83]
v_mfma_f32_16x16x32_bf16 v[252:255], a[188:191], a[140:143], v[252:255]
ds_read_b64_tr_b16 a[176:177], v56 offset:24576
v_mfma_f32_16x16x32_bf16 v[220:223], a[188:191], a[136:139], v[220:223]
ds_read_b64_tr_b16 a[178:179], v56 offset:28672
s_add_u32 m0, s7, 3072
v_mfma_f32_16x16x32_bf16 v[188:191], a[188:191], a[132:135], v[188:191]
buffer_load_dwordx4 v9, s[32:35], s44 offen lds
v_mfma_f32_16x16x32_bf16 v[156:159], a[188:191], a[128:131], v[156:159]
s_waitcnt vmcnt(17) lgkmcnt(6)
v_mfma_f32_16x16x32_bf16 v[128:131], a[160:163], a[144:147], v[128:131]
ds_read_b64_tr_b16 a[180:181], v57 offset:24576
v_mfma_f32_16x16x32_bf16 v[160:163], a[160:163], a[148:151], v[160:163]
ds_read_b64_tr_b16 a[182:183], v57 offset:28672
v_mfma_f32_16x16x32_bf16 v[192:195], a[160:163], a[152:155], v[192:195]
buffer_load_dwordx4 a[128:131], v2, s[20:23], s101 offen offset:0 sc1
v_mfma_f32_16x16x32_bf16 v[224:227], a[160:163], a[156:159], v[224:227]
v_mfma_f32_16x16x32_bf16 v[228:231], a[164:167], a[156:159], v[228:231]
ds_read_b64_tr_b16 a[184:185], v58 offset:24576
v_mfma_f32_16x16x32_bf16 v[196:199], a[164:167], a[152:155], v[196:199]
ds_read_b64_tr_b16 a[186:187], v58 offset:28672
v_mfma_f32_16x16x32_bf16 v[164:167], a[164:167], a[148:151], v[164:167]
v_mfma_f32_16x16x32_bf16 v[132:135], a[164:167], a[144:147], v[132:135]
s_waitcnt lgkmcnt(6)
v_mfma_f32_16x16x32_bf16 v[136:139], a[168:171], a[144:147], v[136:139]
ds_read_b64_tr_b16 a[188:189], v59 offset:24576
v_mfma_f32_16x16x32_bf16 v[168:171], a[168:171], a[148:151], v[168:171]
ds_read_b64_tr_b16 a[190:191], v59 offset:28672
v_mfma_f32_16x16x32_bf16 v[200:203], a[168:171], a[152:155], v[200:203]
buffer_load_dwordx4 a[132:135], v2, s[20:23], s101 offen offset:1024 sc1
v_mfma_f32_16x16x32_bf16 v[232:235], a[168:171], a[156:159], v[232:235]
s_waitcnt vmcnt(18)
s_barrier
v_mfma_f32_16x16x32_bf16 v[236:239], a[172:175], a[156:159], v[236:239]
ds_read_b128 a[160:163], v3 offset:32768
v_mfma_f32_16x16x32_bf16 v[204:207], a[172:175], a[152:155], v[204:207]
s_add_u32 s49, s49, 4096
v_mfma_f32_16x16x32_bf16 v[172:175], a[172:175], a[148:151], v[172:175]
buffer_load_dwordx4 a[48:51], v2, s[20:23], s49 offen offset:0 sc1
v_mfma_f32_16x16x32_bf16 v[140:143], a[172:175], a[144:147], v[140:143]
s_waitcnt lgkmcnt(5)
v_mfma_f32_16x16x32_bf16 v[144:147], a[176:179], a[144:147], v[144:147]
ds_read_b128 a[164:167], v3 offset:34816
v_mfma_f32_16x16x32_bf16 v[176:179], a[176:179], a[148:151], v[176:179]
v_mfma_f32_16x16x32_bf16 v[208:211], a[176:179], a[152:155], v[208:211]
buffer_load_dwordx4 a[136:139], v2, s[20:23], s101 offen offset:2048 sc1
v_mfma_f32_16x16x32_bf16 v[240:243], a[176:179], a[156:159], v[240:243]
v_mfma_f32_16x16x32_bf16 v[244:247], a[180:183], a[156:159], v[244:247]
ds_read_b128 a[168:171], v3 offset:36864
s_add_u32 m0, s7, 16384
v_mfma_f32_16x16x32_bf16 v[212:215], a[180:183], a[152:155], v[212:215]
s_add_u32 s44, s100, 128
v_mfma_f32_16x16x32_bf16 v[180:183], a[180:183], a[148:151], v[180:183]
buffer_load_dwordx4 v8, s[36:39], s44 offen lds
v_mfma_f32_16x16x32_bf16 v[148:151], a[180:183], a[144:147], v[148:151]
s_waitcnt lgkmcnt(3)
v_mfma_f32_16x16x32_bf16 v[152:155], a[184:187], a[144:147], v[152:155]
ds_read_b128 a[172:175], v3 offset:38912
v_mfma_f32_16x16x32_bf16 v[184:187], a[184:187], a[148:151], v[184:187]
v_mfma_f32_16x16x32_bf16 v[216:219], a[184:187], a[152:155], v[216:219]
buffer_load_dwordx4 a[140:143], v2, s[20:23], s101 offen offset:3072 sc1
v_mfma_f32_16x16x32_bf16 v[248:251], a[184:187], a[156:159], v[248:251]
s_add_u32 s101, s101, 4096
v_mfma_f32_16x16x32_bf16 v[252:255], a[188:191], a[156:159], v[252:255]
ds_read_b128 a[176:179], v3 offset:40960
v_mfma_f32_16x16x32_bf16 v[220:223], a[188:191], a[152:155], v[220:223]
s_add_u32 m0, s7, 17408
v_mfma_f32_16x16x32_bf16 v[188:191], a[188:191], a[148:151], v[188:191]
buffer_load_dwordx4 v9, s[36:39], s44 offen lds
v_mfma_f32_16x16x32_bf16 v[156:159], a[188:191], a[144:147], v[156:159]
s_waitcnt vmcnt(17) lgkmcnt(3)
v_mfma_f32_16x16x32_bf16 v[128:131], a[160:163], a[96:99], v[128:131]
ds_read_b128 a[180:183], v3 offset:43008
s_mov_b32 s24, s90
v_mfma_f32_16x16x32_bf16 v[160:163], a[160:163], a[100:103], v[160:163]
v_mfma_f32_16x16x32_bf16 v[192:195], a[160:163], a[104:107], v[192:195]
buffer_load_dwordx4 a[144:147], v2, s[20:23], s101 offen offset:0 sc1
v_mfma_f32_16x16x32_bf16 v[224:227], a[160:163], a[108:111], v[224:227]
s_mov_b32 s25, s91
v_mfma_f32_16x16x32_bf16 v[228:231], a[164:167], a[108:111], v[228:231]
ds_read_b128 a[184:187], v3 offset:45056
v_mfma_f32_16x16x32_bf16 v[196:199], a[164:167], a[104:107], v[196:199]
v_mfma_f32_16x16x32_bf16 v[164:167], a[164:167], a[100:103], v[164:167]
buffer_load_dwordx4 a[52:55], v2, s[20:23], s49 offen offset:1024 sc1
v_mfma_f32_16x16x32_bf16 v[132:135], a[164:167], a[96:99], v[132:135]
s_waitcnt lgkmcnt(3)
v_mfma_f32_16x16x32_bf16 v[136:139], a[168:171], a[96:99], v[136:139]
ds_read_b128 a[188:191], v3 offset:47104
s_mov_b32 s26, 8388608
v_mfma_f32_16x16x32_bf16 v[168:171], a[168:171], a[100:103], v[168:171]
v_mfma_f32_16x16x32_bf16 v[200:203], a[168:171], a[104:107], v[200:203]
buffer_load_dwordx4 a[148:151], v2, s[20:23], s101 offen offset:1024 sc1
v_mfma_f32_16x16x32_bf16 v[232:235], a[168:171], a[108:111], v[232:235]
s_mov_b32 s27, 0x20000
v_mfma_f32_16x16x32_bf16 v[236:239], a[172:175], a[108:111], v[236:239]
ds_read_b128 a[160:163], v4 offset:32768
v_mfma_f32_16x16x32_bf16 v[204:207], a[172:175], a[104:107], v[204:207]
v_mfma_f32_16x16x32_bf16 v[172:175], a[172:175], a[100:103], v[172:175]
s_lshl_b32 s45, s54, 6
v_mfma_f32_16x16x32_bf16 v[140:143], a[172:175], a[96:99], v[140:143]
s_waitcnt lgkmcnt(3)
v_mfma_f32_16x16x32_bf16 v[144:147], a[176:179], a[96:99], v[144:147]
ds_read_b128 a[164:167], v4 offset:34816
v_mfma_f32_16x16x32_bf16 v[176:179], a[176:179], a[100:103], v[176:179]
v_mfma_f32_16x16x32_bf16 v[208:211], a[176:179], a[104:107], v[208:211]
buffer_load_dwordx4 a[152:155], v2, s[20:23], s101 offen offset:2048 sc1
v_mfma_f32_16x16x32_bf16 v[240:243], a[176:179], a[108:111], v[240:243]
v_lshrrev_b32 v34, 3, v1
v_mfma_f32_16x16x32_bf16 v[244:247], a[180:183], a[108:111], v[244:247]
ds_read_b128 a[168:171], v4 offset:36864
s_add_u32 m0, s7, 18432
v_mfma_f32_16x16x32_bf16 v[212:215], a[180:183], a[104:107], v[212:215]
s_add_u32 s44, s100, 32896
v_mfma_f32_16x16x32_bf16 v[180:183], a[180:183], a[100:103], v[180:183]
buffer_load_dwordx4 v8, s[36:39], s44 offen lds
v_mfma_f32_16x16x32_bf16 v[148:151], a[180:183], a[96:99], v[148:151]
v_add_u32 v34, s45, v34
s_waitcnt lgkmcnt(3)
v_mfma_f32_16x16x32_bf16 v[152:155], a[184:187], a[96:99], v[152:155]
ds_read_b128 a[172:175], v4 offset:38912
v_mfma_f32_16x16x32_bf16 v[184:187], a[184:187], a[100:103], v[184:187]
v_mfma_f32_16x16x32_bf16 v[216:219], a[184:187], a[104:107], v[216:219]
buffer_load_dwordx4 a[156:159], v2, s[20:23], s101 offen offset:3072 sc1
v_mfma_f32_16x16x32_bf16 v[248:251], a[184:187], a[108:111], v[248:251]
s_add_u32 s101, s101, 4096
s_lshl_b32 s45, s53, 2
v_mfma_f32_16x16x32_bf16 v[252:255], a[188:191], a[108:111], v[252:255]
ds_read_b128 a[176:179], v4 offset:40960
v_mfma_f32_16x16x32_bf16 v[220:223], a[188:191], a[104:107], v[220:223]
s_add_u32 m0, s7, 19456
v_mfma_f32_16x16x32_bf16 v[188:191], a[188:191], a[100:103], v[188:191]
buffer_load_dwordx4 v9, s[36:39], s44 offen lds
v_mfma_f32_16x16x32_bf16 v[156:159], a[188:191], a[96:99], v[156:159]
s_waitcnt vmcnt(16) lgkmcnt(3)
v_mfma_f32_16x16x32_bf16 v[128:131], a[160:163], a[112:115], v[128:131]
ds_read_b128 a[180:183], v4 offset:43008
s_add_u32 s45, s45, s52
v_mfma_f32_16x16x32_bf16 v[160:163], a[160:163], a[116:119], v[160:163]
v_mfma_f32_16x16x32_bf16 v[192:195], a[160:163], a[120:123], v[192:195]
buffer_load_dwordx4 a[96:99], v2, s[20:23], s101 offen offset:0 sc1
v_mfma_f32_16x16x32_bf16 v[224:227], a[160:163], a[124:127], v[224:227]
s_lshl_b32 s45, s45, 6
v_mfma_f32_16x16x32_bf16 v[228:231], a[164:167], a[124:127], v[228:231]
ds_read_b128 a[184:187], v4 offset:45056
v_mfma_f32_16x16x32_bf16 v[196:199], a[164:167], a[120:123], v[196:199]
v_mfma_f32_16x16x32_bf16 v[164:167], a[164:167], a[116:119], v[164:167]
buffer_load_dwordx4 a[56:59], v2, s[20:23], s49 offen offset:2048 sc1
L_pg16:
s_cbranch_execz L_ret3
v_mfma_f32_16x16x32_bf16 v[132:135], a[164:167], a[112:115], v[132:135]
s_waitcnt lgkmcnt(3)
v_mfma_f32_16x16x32_bf16 v[136:139], a[168:171], a[112:115], v[136:139]
ds_read_b128 a[188:191], v4 offset:47104
v_and_b32_e64 v35, 7, v1
v_mfma_f32_16x16x32_bf16 v[168:171], a[168:171], a[116:119], v[168:171]
v_mfma_f32_16x16x32_bf16 v[200:203], a[168:171], a[120:123], v[200:203]
buffer_load_dwordx4 a[100:103], v2, s[20:23], s101 offen offset:1024 sc1
v_mfma_f32_16x16x32_bf16 v[232:235], a[168:171], a[124:127], v[232:235]
v_lshl_add_u32 v35, v35, 3, s45
v_mfma_f32_16x16x32_bf16 v[236:239], a[172:175], a[124:127], v[236:239]
ds_read_b128 a[160:163], v3 offset:49152
v_mfma_f32_16x16x32_bf16 v[204:207], a[172:175], a[120:123], v[204:207]
v_mfma_f32_16x16x32_bf16 v[172:175], a[172:175], a[116:119], v[172:175]
v_lshl_add_u32 v36, v34, 11, v35
v_mfma_f32_16x16x32_bf16 v[140:143], a[172:175], a[112:115], v[140:143]
s_waitcnt lgkmcnt(3)
v_mfma_f32_16x16x32_bf16 v[144:147], a[176:179], a[112:115], v[144:147]
ds_read_b128 a[164:167], v3 offset:51200
v_mfma_f32_16x16x32_bf16 v[176:179], a[176:179], a[116:119], v[176:179]
v_mfma_f32_16x16x32_bf16 v[208:211], a[176:179], a[120:123], v[208:211]
buffer_load_dwordx4 a[104:107], v2, s[20:23], s101 offen offset:2048 sc1
v_mfma_f32_16x16x32_bf16 v[240:243], a[176:179], a[124:127], v[240:243]
v_lshlrev_b32 v37, 1, v36
v_mfma_f32_16x16x32_bf16 v[244:247], a[180:183], a[124:127], v[244:247]
ds_read_b128 a[168:171], v3 offset:53248
s_add_u32 m0, s7, 65536
v_mfma_f32_16x16x32_bf16 v[212:215], a[180:183], a[120:123], v[212:215]
s_xor_b32 s44, s98, 65536
v_mfma_f32_16x16x32_bf16 v[180:183], a[180:183], a[116:119], v[180:183]
buffer_load_dwordx4 v8, s[12:15], s44 offen lds
v_mfma_f32_16x16x32_bf16 v[148:151], a[180:183], a[112:115], v[148:151]
v_lshlrev_b32 v34, 3, v34
s_waitcnt lgkmcnt(3)
v_mfma_f32_16x16x32_bf16 v[152:155], a[184:187], a[112:115], v[152:155]
ds_read_b128 a[172:175], v3 offset:55296
v_mfma_f32_16x16x32_bf16 v[184:187], a[184:187], a[116:119], v[184:187]
v_mfma_f32_16x16x32_bf16 v[216:219], a[184:187], a[120:123], v[216:219]
buffer_load_dwordx4 a[108:111], v2, s[20:23], s101 offen offset:3072 sc1
v_mfma_f32_16x16x32_bf16 v[248:251], a[184:187], a[124:127], v[248:251]
s_add_u32 s101, s101, 4096
s_mov_b32 s47, 25165824
v_mfma_f32_16x16x32_bf16 v[252:255], a[188:191], a[124:127], v[252:255]
ds_read_b128 a[176:179], v3 offset:57344
v_mfma_f32_16x16x32_bf16 v[220:223], a[188:191], a[120:123], v[220:223]
s_add_u32 m0, s7, 66560
v_mfma_f32_16x16x32_bf16 v[188:191], a[188:191], a[116:119], v[188:191]
buffer_load_dwordx4 v9, s[12:15], s44 offen lds
v_mfma_f32_16x16x32_bf16 v[156:159], a[188:191], a[112:115], v[156:159]
s_waitcnt vmcnt(15) lgkmcnt(3)
v_mfma_f32_16x16x32_bf16 v[128:131], a[160:163], a[128:131], v[128:131]
ds_read_b128 a[180:183], v3 offset:59392
v_mov_b32 v28, 0
v_mfma_f32_16x16x32_bf16 v[160:163], a[160:163], a[132:135], v[160:163]
v_mfma_f32_16x16x32_bf16 v[192:195], a[160:163], a[136:139], v[192:195]
buffer_load_dwordx4 a[112:115], v2, s[20:23], s101 offen offset:0 sc1
v_mfma_f32_16x16x32_bf16 v[224:227], a[160:163], a[140:143], v[224:227]
v_mov_b32_e64 v29, 0
v_mfma_f32_16x16x32_bf16 v[228:231], a[164:167], a[140:143], v[228:231]
ds_read_b128 a[184:187], v3 offset:61440
v_mfma_f32_16x16x32_bf16 v[196:199], a[164:167], a[136:139], v[196:199]
v_mov_b32_e64 v32, 0
v_mfma_f32_16x16x32_bf16 v[164:167], a[164:167], a[132:135], v[164:167]
buffer_load_dwordx4 a[60:63], v2, s[20:23], s49 offen offset:3072 sc1
v_mfma_f32_16x16x32_bf16 v[132:135], a[164:167], a[128:131], v[132:135]
s_waitcnt lgkmcnt(3)
v_mfma_f32_16x16x32_bf16 v[136:139], a[168:171], a[128:131], v[136:139]
ds_read_b128 a[188:191], v3 offset:63488
v_mov_b32 v33, 0
v_mfma_f32_16x16x32_bf16 v[168:171], a[168:171], a[132:135], v[168:171]
v_mfma_f32_16x16x32_bf16 v[200:203], a[168:171], a[136:139], v[200:203]
buffer_load_dwordx4 a[116:119], v2, s[20:23], s101 offen offset:1024 sc1
v_mfma_f32_16x16x32_bf16 v[232:235], a[168:171], a[140:143], v[232:235]
v_and_b32_e64 v40, 1, v1
v_mfma_f32_16x16x32_bf16 v[236:239], a[172:175], a[140:143], v[236:239]
ds_read_b128 a[160:163], v4 offset:49152
v_mfma_f32_16x16x32_bf16 v[204:207], a[172:175], a[136:139], v[204:207]
s_add_u32 s49, s49, 4096
v_lshlrev_b32_e64 v40, 4, v40
v_mfma_f32_16x16x32_bf16 v[172:175], a[172:175], a[132:135], v[172:175]
buffer_load_dwordx4 a[64:67], v2, s[20:23], s49 offen offset:0 sc1
v_mfma_f32_16x16x32_bf16 v[140:143], a[172:175], a[128:131], v[140:143]
s_waitcnt lgkmcnt(3)
v_mfma_f32_16x16x32_bf16 v[144:147], a[176:179], a[128:131], v[144:147]
ds_read_b128 a[164:167], v4 offset:51200
v_mfma_f32_16x16x32_bf16 v[176:179], a[176:179], a[132:135], v[176:179]
v_mov_b32 v41, 0x3f80
v_mfma_f32_16x16x32_bf16 v[208:211], a[176:179], a[136:139], v[208:211]
buffer_load_dwordx4 a[120:123], v2, s[20:23], s101 offen offset:2048 sc1
v_mfma_f32_16x16x32_bf16 v[240:243], a[176:179], a[140:143], v[240:243]
v_lshlrev_b32 v40, v40, v41
v_mfma_f32_16x16x32_bf16 v[244:247], a[180:183], a[140:143], v[244:247]
ds_read_b128 a[168:171], v4 offset:53248
s_add_u32 m0, s7, 67584
v_mfma_f32_16x16x32_bf16 v[212:215], a[180:183], a[136:139], v[212:215]
s_xor_b32 s44, s98, 98304
v_mfma_f32_16x16x32_bf16 v[180:183], a[180:183], a[132:135], v[180:183]
buffer_load_dwordx4 v8, s[12:15], s44 offen lds
v_mfma_f32_16x16x32_bf16 v[148:151], a[180:183], a[128:131], v[148:151]
v_bfe_u32 v41, v1, 1, 3
s_waitcnt lgkmcnt(3)
v_mfma_f32_16x16x32_bf16 v[152:155], a[184:187], a[128:131], v[152:155]
ds_read_b128 a[172:175], v4 offset:55296
v_mfma_f32_16x16x32_bf16 v[184:187], a[184:187], a[132:135], v[184:187]
v_mfma_f32_16x16x32_bf16 v[216:219], a[184:187], a[136:139], v[216:219]
buffer_load_dwordx4 a[124:127], v2, s[20:23], s101 offen offset:3072 sc1
v_mfma_f32_16x16x32_bf16 v[248:251], a[184:187], a[140:143], v[248:251]
s_add_u32 s101, s101, 4096
v_lshrrev_b32 v42, 4, v1
v_mfma_f32_16x16x32_bf16 v[252:255], a[188:191], a[140:143], v[252:255]
ds_read_b128 a[176:179], v4 offset:57344
v_mfma_f32_16x16x32_bf16 v[220:223], a[188:191], a[136:139], v[220:223]
s_add_u32 m0, s7, 68608
v_lshlrev_b32_e64 v42, 1, v42
v_mfma_f32_16x16x32_bf16 v[188:191], a[188:191], a[132:135], v[188:191]
buffer_load_dwordx4 v9, s[12:15], s44 offen lds
v_mfma_f32_16x16x32_bf16 v[156:159], a[188:191], a[128:131], v[156:159]
s_waitcnt vmcnt(16) lgkmcnt(3)
v_mfma_f32_16x16x32_bf16 v[128:131], a[160:163], a[144:147], v[128:131]
ds_read_b128 a[180:183], v4 offset:59392
v_xor_b32 v41, v41, v42
v_mfma_f32_16x16x32_bf16 v[160:163], a[160:163], a[148:151], v[160:163]
v_mfma_f32_16x16x32_bf16 v[192:195], a[160:163], a[152:155], v[192:195]
buffer_load_dwordx4 a[128:131], v2, s[20:23], s101 offen offset:0 sc1
v_mfma_f32_16x16x32_bf16 v[224:227], a[160:163], a[156:159], v[224:227]
v_cmp_eq_u32 s[56:57], 0, v41
v_mfma_f32_16x16x32_bf16 v[228:231], a[164:167], a[156:159], v[228:231]
ds_read_b128 a[184:187], v4 offset:61440
v_mfma_f32_16x16x32_bf16 v[196:199], a[164:167], a[152:155], v[196:199]
v_cmp_eq_u32 s[58:59], 1, v41
v_mfma_f32_16x16x32_bf16 v[164:167], a[164:167], a[148:151], v[164:167]
v_mfma_f32_16x16x32_bf16 v[132:135], a[164:167], a[144:147], v[132:135]
v_cndmask_b32 v30, 0, v40, s[56:57]
s_waitcnt lgkmcnt(3)
v_mfma_f32_16x16x32_bf16 v[136:139], a[168:171], a[144:147], v[136:139]
ds_read_b128 a[188:191], v4 offset:63488
v_mfma_f32_16x16x32_bf16 v[168:171], a[168:171], a[148:151], v[168:171]
v_cndmask_b32 v31, 0, v40, s[58:59]
v_mfma_f32_16x16x32_bf16 v[200:203], a[168:171], a[152:155], v[200:203]
buffer_load_dwordx4 a[132:135], v2, s[20:23], s101 offen offset:1024 sc1
v_mfma_f32_16x16x32_bf16 v[232:235], a[168:171], a[156:159], v[232:235]
s_waitcnt vmcnt(17)
s_barrier
v_mfma_f32_16x16x32_bf16 v[236:239], a[172:175], a[156:159], v[236:239]
ds_read_b128 a[160:163], v10 offset:0
v_mfma_f32_16x16x32_bf16 v[204:207], a[172:175], a[152:155], v[204:207]
s_lshl_b32 s45, s3, 13
v_mfma_f32_16x16x32_bf16 v[172:175], a[172:175], a[148:151], v[172:175]
buffer_load_dwordx4 a[68:71], v2, s[20:23], s49 offen offset:1024 sc1
v_mfma_f32_16x16x32_bf16 v[140:143], a[172:175], a[144:147], v[140:143]
s_waitcnt lgkmcnt(3)
v_mfma_f32_16x16x32_bf16 v[144:147], a[176:179], a[144:147], v[144:147]
ds_read_b128 a[164:167], v10 offset:2048
s_add_u32 s45, s45, 98304
v_mfma_f32_16x16x32_bf16 v[176:179], a[176:179], a[148:151], v[176:179]
v_mfma_f32_16x16x32_bf16 v[208:211], a[176:179], a[152:155], v[208:211]
buffer_load_dwordx4 a[136:139], v2, s[20:23], s101 offen offset:2048 sc1
v_mfma_f32_16x16x32_bf16 v[240:243], a[176:179], a[156:159], v[240:243]
v_and_b32 v41, 15, v1
v_mfma_f32_16x16x32_bf16 v[244:247], a[180:183], a[156:159], v[244:247]
ds_read_b128 a[168:171], v10 offset:4096
s_add_u32 m0, s7, 32768
v_mfma_f32_16x16x32_bf16 v[212:215], a[180:183], a[152:155], v[212:215]
s_xor_b32 s44, s98, 131072
v_mfma_f32_16x16x32_bf16 v[180:183], a[180:183], a[148:151], v[180:183]
buffer_load_dwordx4 v8, s[12:15], s44 offen lds
v_mfma_f32_16x16x32_bf16 v[148:151], a[180:183], a[144:147], v[148:151]
v_lshrrev_b32 v42, 4, v1
s_waitcnt lgkmcnt(3)
v_mfma_f32_16x16x32_bf16 v[152:155], a[184:187], a[144:147], v[152:155]
ds_read_b128 a[172:175], v10 offset:6144
v_mfma_f32_16x16x32_bf16 v[184:187], a[184:187], a[148:151], v[184:187]
v_and_b32_e64 v43, 7, v1
v_mfma_f32_16x16x32_bf16 v[216:219], a[184:187], a[152:155], v[216:219]
buffer_load_dwordx4 a[140:143], v2, s[20:23], s101 offen offset:3072 sc1
v_mfma_f32_16x16x32_bf16 v[248:251], a[184:187], a[156:159], v[248:251]
s_add_u32 s101, s101, 4096
v_mfma_f32_16x16x32_bf16 v[252:255], a[188:191], a[156:159], v[252:255]
ds_read_b128 a[176:179], v10 offset:8192
v_xor_b32_e64 v42, v42, v43
v_mfma_f32_16x16x32_bf16 v[220:223], a[188:191], a[152:155], v[220:223]
s_add_u32 m0, s7, 33792
v_mfma_f32_16x16x32_bf16 v[188:191], a[188:191], a[148:151], v[188:191]
buffer_load_dwordx4 v9, s[12:15], s44 offen lds
v_mfma_f32_16x16x32_bf16 v[156:159], a[188:191], a[144:147], v[156:159]
v_lshlrev_b32 v42, 4, v42
s_waitcnt vmcnt(16) lgkmcnt(3)
v_mfma_f32_16x16x32_bf16 v[128:131], a[160:163], a[96:99], v[128:131]
ds_read_b128 a[180:183], v10 offset:10240
v_mfma_f32_16x16x32_bf16 v[160:163], a[160:163], a[100:103], v[160:163]
v_mfma_f32_16x16x32_bf16 v[192:195], a[160:163], a[104:107], v[192:195]
buffer_load_dwordx4 a[144:147], v2, s[20:23], s101 offen offset:0 sc1
v_mfma_f32_16x16x32_bf16 v[224:227], a[160:163], a[108:111], v[224:227]
v_lshl_add_u32 v41, v41, 9, v42
v_mfma_f32_16x16x32_bf16 v[228:231], a[164:167], a[108:111], v[228:231]
ds_read_b128 a[184:187], v10 offset:12288
v_mfma_f32_16x16x32_bf16 v[196:199], a[164:167], a[104:107], v[196:199]
v_add_u32_e64 v41, s45, v41
v_mfma_f32_16x16x32_bf16 v[164:167], a[164:167], a[100:103], v[164:167]
buffer_load_dwordx4 a[72:75], v2, s[20:23], s49 offen offset:2048 sc1
v_mfma_f32_16x16x32_bf16 v[132:135], a[164:167], a[96:99], v[132:135]
s_waitcnt lgkmcnt(3)
v_mfma_f32_16x16x32_bf16 v[136:139], a[168:171], a[96:99], v[136:139]
ds_read_b128 a[188:191], v10 offset:14336
v_xor_b32 v42, 64, v41
v_mfma_f32_16x16x32_bf16 v[168:171], a[168:171], a[100:103], v[168:171]
v_mfma_f32_16x16x32_bf16 v[200:203], a[168:171], a[104:107], v[200:203]
buffer_load_dwordx4 a[148:151], v2, s[20:23], s101 offen offset:1024 sc1
v_mfma_f32_16x16x32_bf16 v[232:235], a[168:171], a[108:111], v[232:235]
v_lshrrev_b32 v43, 5, v1
v_mfma_f32_16x16x32_bf16 v[236:239], a[172:175], a[108:111], v[236:239]
ds_read_b128 a[160:163], v11 offset:0
v_mfma_f32_16x16x32_bf16 v[204:207], a[172:175], a[104:107], v[204:207]
v_xor_b32 v43, v43, v1
v_mfma_f32_16x16x32_bf16 v[172:175], a[172:175], a[100:103], v[172:175]
v_mfma_f32_16x16x32_bf16 v[140:143], a[172:175], a[96:99], v[140:143]
v_lshlrev_b32 v43, 4, v43
s_waitcnt lgkmcnt(3)
v_mfma_f32_16x16x32_bf16 v[144:147], a[176:179], a[96:99], v[144:147]
ds_read_b128 a[164:167], v11 offset:2048
v_mfma_f32_16x16x32_bf16 v[176:179], a[176:179], a[100:103], v[176:179]
v_add_u32_e64 v43, s45, v43
v_mfma_f32_16x16x32_bf16 v[208:211], a[176:179], a[104:107], v[208:211]
buffer_load_dwordx4 a[152:155], v2, s[20:23], s101 offen offset:2048 sc1
v_mfma_f32_16x16x32_bf16 v[240:243], a[176:179], a[108:111], v[240:243]
v_mfma_f32_16x16x32_bf16 v[244:247], a[180:183], a[108:111], v[244:247]
ds_read_b128 a[168:171], v11 offset:4096
s_add_u32 m0, s7, 34816
v_mfma_f32_16x16x32_bf16 v[212:215], a[180:183], a[104:107], v[212:215]
s_xor_b32 s44, s98, 163840
v_xor_b32_e64 v44, 32, v43
v_mfma_f32_16x16x32_bf16 v[180:183], a[180:183], a[100:103], v[180:183]
buffer_load_dwordx4 v8, s[12:15], s44 offen lds
v_mfma_f32_16x16x32_bf16 v[148:151], a[180:183], a[96:99], v[148:151]
s_waitcnt lgkmcnt(3)
v_mfma_f32_16x16x32_bf16 v[152:155], a[184:187], a[96:99], v[152:155]
ds_read_b128 a[172:175], v11 offset:6144
v_xor_b32 v45, 64, v43
v_mfma_f32_16x16x32_bf16 v[184:187], a[184:187], a[100:103], v[184:187]
v_mfma_f32_16x16x32_bf16 v[216:219], a[184:187], a[104:107], v[216:219]
buffer_load_dwordx4 a[156:159], v2, s[20:23], s101 offen offset:3072 sc1
v_mfma_f32_16x16x32_bf16 v[248:251], a[184:187], a[108:111], v[248:251]
s_add_u32 s101, s101, 4096
v_xor_b32 v46, 96, v43
v_mfma_f32_16x16x32_bf16 v[252:255], a[188:191], a[108:111], v[252:255]
ds_read_b128 a[176:179], v11 offset:8192
v_mfma_f32_16x16x32_bf16 v[220:223], a[188:191], a[104:107], v[220:223]
s_add_u32 m0, s7, 35840
s_mul_i32 s62, s55, 12288
v_mfma_f32_16x16x32_bf16 v[188:191], a[188:191], a[100:103], v[188:191]
buffer_load_dwordx4 v9, s[12:15], s44 offen lds
v_mfma_f32_16x16x32_bf16 v[156:159], a[188:191], a[96:99], v[156:159]
s_waitcnt vmcnt(15) lgkmcnt(3)
v_mfma_f32_16x16x32_bf16 v[128:131], a[160:163], a[112:115], v[128:131]
ds_read_b128 a[180:183], v11 offset:10240
v_mfma_f32_16x16x32_bf16 v[160:163], a[160:163], a[116:119], v[160:163]
s_add_u32 s62, s62, 33554432
v_mfma_f32_16x16x32_bf16 v[192:195], a[160:163], a[120:123], v[192:195]
buffer_load_dwordx4 a[76:79], v2, s[20:23], s49 offen offset:3072 sc1
v_mfma_f32_16x16x32_bf16 v[224:227], a[160:163], a[124:127], v[224:227]
s_lshl_b32 s63, s55, 6
v_mfma_f32_16x16x32_bf16 v[228:231], a[164:167], a[124:127], v[228:231]
ds_read_b128 a[184:187], v11 offset:12288
v_mfma_f32_16x16x32_bf16 v[196:199], a[164:167], a[120:123], v[196:199]
s_add_u32 s49, s49, 4096
v_mfma_f32_16x16x32_bf16 v[164:167], a[164:167], a[116:119], v[164:167]
buffer_load_dwordx4 a[80:83], v2, s[20:23], s49 offen offset:0 sc1
v_mfma_f32_16x16x32_bf16 v[132:135], a[164:167], a[112:115], v[132:135]
s_add_u32 s63, s63, 29360128
s_waitcnt lgkmcnt(3)
v_mfma_f32_16x16x32_bf16 v[136:139], a[168:171], a[112:115], v[136:139]
ds_read_b128 a[188:191], v11 offset:14336
v_mfma_f32_16x16x32_bf16 v[168:171], a[168:171], a[116:119], v[168:171]
v_and_b32 v40, 1, v1
v_mfma_f32_16x16x32_bf16 v[200:203], a[168:171], a[120:123], v[200:203]
buffer_load_dwordx4 a[84:87], v2, s[20:23], s49 offen offset:1024 sc1
v_mfma_f32_16x16x32_bf16 v[232:235], a[168:171], a[124:127], v[232:235]
v_mfma_f32_16x16x32_bf16 v[236:239], a[172:175], a[124:127], v[236:239]
ds_read_b128 a[160:163], v10 offset:16384
v_add_u32 v40, 1, v40
v_mfma_f32_16x16x32_bf16 v[204:207], a[172:175], a[120:123], v[204:207]
v_mfma_f32_16x16x32_bf16 v[172:175], a[172:175], a[116:119], v[172:175]
v_lshlrev_b32 v47, 9, v40
v_mfma_f32_16x16x32_bf16 v[140:143], a[172:175], a[112:115], v[140:143]
s_waitcnt lgkmcnt(3)
v_mfma_f32_16x16x32_bf16 v[144:147], a[176:179], a[112:115], v[144:147]
ds_read_b128 a[164:167], v10 offset:18432
v_xor_b32 v47, s63, v47
v_mfma_f32_16x16x32_bf16 v[176:179], a[176:179], a[116:119], v[176:179]
v_mfma_f32_16x16x32_bf16 v[208:211], a[176:179], a[120:123], v[208:211]
buffer_load_dwordx4 a[88:91], v2, s[20:23], s49 offen offset:2048 sc1
v_mfma_f32_16x16x32_bf16 v[240:243], a[176:179], a[124:127], v[240:243]
s_xor_b32 s60, s63, 1536
v_mfma_f32_16x16x32_bf16 v[244:247], a[180:183], a[124:127], v[244:247]
ds_read_b128 a[168:171], v10 offset:20480
s_add_u32 m0, s7, 49152
v_mfma_f32_16x16x32_bf16 v[212:215], a[180:183], a[120:123], v[212:215]
s_xor_b32 s44, s98, 196608
v_mfma_f32_16x16x32_bf16 v[180:183], a[180:183], a[116:119], v[180:183]
buffer_load_dwordx4 v8, s[12:15], s44 offen lds
v_mfma_f32_16x16x32_bf16 v[148:151], a[180:183], a[112:115], v[148:151]
v_mov_b32 v5, 0
s_waitcnt lgkmcnt(3)
v_mfma_f32_16x16x32_bf16 v[152:155], a[184:187], a[112:115], v[152:155]
ds_read_b128 a[172:175], v10 offset:22528
v_mfma_f32_16x16x32_bf16 v[184:187], a[184:187], a[116:119], v[184:187]
v_min_u32_e64 v49, 1, v1
v_mfma_f32_16x16x32_bf16 v[216:219], a[184:187], a[120:123], v[216:219]
buffer_load_dwordx4 a[92:95], v2, s[20:23], s49 offen offset:3072 sc1
v_mfma_f32_16x16x32_bf16 v[248:251], a[184:187], a[124:127], v[248:251]
v_mfma_f32_16x16x32_bf16 v[252:255], a[188:191], a[124:127], v[252:255]
ds_read_b128 a[176:179], v10 offset:24576
v_lshlrev_b32_e64 v49, 30, v49
v_mfma_f32_16x16x32_bf16 v[220:223], a[188:191], a[120:123], v[220:223]
s_add_u32 m0, s7, 50176
v_mfma_f32_16x16x32_bf16 v[188:191], a[188:191], a[116:119], v[188:191]
buffer_load_dwordx4 v9, s[12:15], s44 offen lds
v_mfma_f32_16x16x32_bf16 v[156:159], a[188:191], a[112:115], v[156:159]
s_waitcnt vmcnt(15) lgkmcnt(3)
v_mfma_f32_16x16x32_bf16 v[128:131], a[160:163], a[128:131], v[128:131]
ds_read_b128 a[180:183], v10 offset:26624
v_mfma_f32_16x16x32_bf16 v[160:163], a[160:163], a[132:135], v[160:163]
s_add_u32 s49, s49, 4096
v_mfma_f32_16x16x32_bf16 v[192:195], a[160:163], a[136:139], v[192:195]
buffer_load_dwordx4 a[192:195], v2, s[20:23], s49 offen offset:0 sc1
v_mfma_f32_16x16x32_bf16 v[224:227], a[160:163], a[140:143], v[224:227]
v_mfma_f32_16x16x32_bf16 v[228:231], a[164:167], a[140:143], v[228:231]
ds_read_b128 a[184:187], v10 offset:28672
v_mfma_f32_16x16x32_bf16 v[196:199], a[164:167], a[136:139], v[196:199]
v_mfma_f32_16x16x32_bf16 v[164:167], a[164:167], a[132:135], v[164:167]
v_mfma_f32_16x16x32_bf16 v[132:135], a[164:167], a[128:131], v[132:135]
s_waitcnt lgkmcnt(3)
v_mfma_f32_16x16x32_bf16 v[136:139], a[168:171], a[128:131], v[136:139]
ds_read_b128 a[188:191], v10 offset:30720
v_mfma_f32_16x16x32_bf16 v[168:171], a[168:171], a[132:135], v[168:171]
v_mfma_f32_16x16x32_bf16 v[200:203], a[168:171], a[136:139], v[200:203]
buffer_load_dwordx4 a[196:199], v2, s[20:23], s49 offen offset:1024 sc1
v_mfma_f32_16x16x32_bf16 v[232:235], a[168:171], a[140:143], v[232:235]
v_mfma_f32_16x16x32_bf16 v[236:239], a[172:175], a[140:143], v[236:239]
ds_read_b128 a[160:163], v11 offset:16384
v_mfma_f32_16x16x32_bf16 v[204:207], a[172:175], a[136:139], v[204:207]
v_mfma_f32_16x16x32_bf16 v[172:175], a[172:175], a[132:135], v[172:175]
v_mfma_f32_16x16x32_bf16 v[140:143], a[172:175], a[128:131], v[140:143]
s_waitcnt lgkmcnt(3)
v_mfma_f32_16x16x32_bf16 v[144:147], a[176:179], a[128:131], v[144:147]
ds_read_b128 a[164:167], v11 offset:18432
v_mfma_f32_16x16x32_bf16 v[176:179], a[176:179], a[132:135], v[176:179]
v_mfma_f32_16x16x32_bf16 v[208:211], a[176:179], a[136:139], v[208:211]
buffer_load_dwordx4 a[200:203], v2, s[20:23], s49 offen offset:2048 sc1
v_mfma_f32_16x16x32_bf16 v[240:243], a[176:179], a[140:143], v[240:243]
v_mfma_f32_16x16x32_bf16 v[244:247], a[180:183], a[140:143], v[244:247]
ds_read_b128 a[168:171], v11 offset:20480
s_add_u32 m0, s7, 51200
v_mfma_f32_16x16x32_bf16 v[212:215], a[180:183], a[136:139], v[212:215]
s_xor_b32 s44, s98, 229376
v_mfma_f32_16x16x32_bf16 v[180:183], a[180:183], a[132:135], v[180:183]
buffer_load_dwordx4 v8, s[12:15], s44 offen lds
v_mfma_f32_16x16x32_bf16 v[148:151], a[180:183], a[128:131], v[148:151]
s_waitcnt lgkmcnt(3)
v_mfma_f32_16x16x32_bf16 v[152:155], a[184:187], a[128:131], v[152:155]
ds_read_b128 a[172:175], v11 offset:22528
v_mfma_f32_16x16x32_bf16 v[184:187], a[184:187], a[132:135], v[184:187]
v_mfma_f32_16x16x32_bf16 v[216:219], a[184:187], a[136:139], v[216:219]
buffer_load_dwordx4 a[204:207], v2, s[20:23], s49 offen offset:3072 sc1
v_mfma_f32_16x16x32_bf16 v[248:251], a[184:187], a[140:143], v[248:251]
v_mfma_f32_16x16x32_bf16 v[252:255], a[188:191], a[140:143], v[252:255]
ds_read_b128 a[176:179], v11 offset:24576
v_mfma_f32_16x16x32_bf16 v[220:223], a[188:191], a[136:139], v[220:223]
s_add_u32 m0, s7, 52224
v_mfma_f32_16x16x32_bf16 v[188:191], a[188:191], a[132:135], v[188:191]
buffer_load_dwordx4 v9, s[12:15], s44 offen lds
v_mfma_f32_16x16x32_bf16 v[156:159], a[188:191], a[128:131], v[156:159]
s_waitcnt vmcnt(14) lgkmcnt(3)
v_mfma_f32_16x16x32_bf16 v[128:131], a[160:163], a[144:147], v[128:131]
ds_read_b128 a[180:183], v11 offset:26624
v_mfma_f32_16x16x32_bf16 v[160:163], a[160:163], a[148:151], v[160:163]
s_add_u32 s49, s49, 4096
v_mfma_f32_16x16x32_bf16 v[192:195], a[160:163], a[152:155], v[192:195]
buffer_load_dwordx4 a[208:211], v2, s[20:23], s49 offen offset:0 sc1
v_mfma_f32_16x16x32_bf16 v[224:227], a[160:163], a[156:159], v[224:227]
v_mfma_f32_16x16x32_bf16 v[228:231], a[164:167], a[156:159], v[228:231]
ds_read_b128 a[184:187], v11 offset:28672
v_mfma_f32_16x16x32_bf16 v[196:199], a[164:167], a[152:155], v[196:199]
v_mfma_f32_16x16x32_bf16 v[164:167], a[164:167], a[148:151], v[164:167]
v_mfma_f32_16x16x32_bf16 v[132:135], a[164:167], a[144:147], v[132:135]
s_waitcnt lgkmcnt(3)
v_mfma_f32_16x16x32_bf16 v[136:139], a[168:171], a[144:147], v[136:139]
ds_read_b128 a[188:191], v11 offset:30720
v_mfma_f32_16x16x32_bf16 v[168:171], a[168:171], a[148:151], v[168:171]
v_mfma_f32_16x16x32_bf16 v[200:203], a[168:171], a[152:155], v[200:203]
buffer_load_dwordx4 a[212:215], v2, s[20:23], s49 offen offset:1024 sc1
v_mfma_f32_16x16x32_bf16 v[232:235], a[168:171], a[156:159], v[232:235]
s_waitcnt vmcnt(15)
s_barrier
v_mfma_f32_16x16x32_bf16 v[236:239], a[172:175], a[156:159], v[236:239]
ds_read_b128 a[160:163], v3 offset:0
v_mfma_f32_16x16x32_bf16 v[204:207], a[172:175], a[152:155], v[204:207]
v_mfma_f32_16x16x32_bf16 v[172:175], a[172:175], a[148:151], v[172:175]
v_mfma_f32_16x16x32_bf16 v[140:143], a[172:175], a[144:147], v[140:143]
s_waitcnt lgkmcnt(3)
v_mfma_f32_16x16x32_bf16 v[144:147], a[176:179], a[144:147], v[144:147]
ds_read_b128 a[164:167], v3 offset:2048
v_mfma_f32_16x16x32_bf16 v[176:179], a[176:179], a[148:151], v[176:179]
v_mfma_f32_16x16x32_bf16 v[208:211], a[176:179], a[152:155], v[208:211]
buffer_load_dwordx4 a[216:219], v2, s[20:23], s49 offen offset:2048 sc1
v_mfma_f32_16x16x32_bf16 v[240:243], a[176:179], a[156:159], v[240:243]
v_mfma_f32_16x16x32_bf16 v[244:247], a[180:183], a[156:159], v[244:247]
ds_read_b128 a[168:171], v4 offset:0
s_add_u32 m0, s7, 81920
v_mfma_f32_16x16x32_bf16 v[212:215], a[180:183], a[152:155], v[212:215]
s_xor_b32 s44, s98, 0
v_mfma_f32_16x16x32_bf16 v[180:183], a[180:183], a[148:151], v[180:183]
buffer_load_dwordx4 v8, s[12:15], s44 offen lds
v_mfma_f32_16x16x32_bf16 v[148:151], a[180:183], a[144:147], v[148:151]
s_waitcnt lgkmcnt(3)
v_mfma_f32_16x16x32_bf16 v[152:155], a[184:187], a[144:147], v[152:155]
ds_read_b128 a[172:175], v4 offset:2048
v_mfma_f32_16x16x32_bf16 v[184:187], a[184:187], a[148:151], v[184:187]
v_mfma_f32_16x16x32_bf16 v[216:219], a[184:187], a[152:155], v[216:219]
buffer_load_dwordx4 a[220:223], v2, s[20:23], s49 offen offset:3072 sc1
v_mfma_f32_16x16x32_bf16 v[248:251], a[184:187], a[156:159], v[248:251]
v_mfma_f32_16x16x32_bf16 v[252:255], a[188:191], a[156:159], v[252:255]
ds_read_b128 a[176:179], v3 offset:4096
v_mfma_f32_16x16x32_bf16 v[220:223], a[188:191], a[152:155], v[220:223]
s_add_u32 m0, s7, 82944
v_mfma_f32_16x16x32_bf16 v[188:191], a[188:191], a[148:151], v[188:191]
buffer_load_dwordx4 v9, s[12:15], s44 offen lds
v_mfma_f32_16x16x32_bf16 v[156:159], a[188:191], a[144:147], v[156:159]
s_waitcnt lgkmcnt(3)
v_mfma_f32_16x16x32_bf16 v[136:139], a[160:163], a[0:3], v[136:139]
ds_read_b128 a[180:183], v3 offset:6144
v_mfma_f32_16x16x32_bf16 v[168:171], a[160:163], a[4:7], v[168:171]
v_mfma_f32_16x16x32_bf16 v[200:203], a[160:163], a[8:11], v[200:203]
buffer_load_dwordx2 v[112:113], v34, s[20:23], s47 offen offset:0 sc1
v_mfma_f32_16x16x32_bf16 v[232:235], a[160:163], a[12:15], v[232:235]
v_mfma_f32_16x16x32_bf16 v[236:239], a[164:167], a[12:15], v[236:239]
ds_read_b128 a[184:187], v4 offset:4096
v_mfma_f32_16x16x32_bf16 v[204:207], a[164:167], a[8:11], v[204:207]
s_mov_b32 s46, 0
v_mfma_f32_16x16x32_bf16 v[172:175], a[164:167], a[4:7], v[172:175]
buffer_load_dwordx2 v[96:97], v36, s[8:11], s46 offen
v_mfma_f32_16x16x32_bf16 v[140:143], a[164:167], a[0:3], v[140:143]
s_waitcnt lgkmcnt(3)
v_mfma_f32_16x16x32_bf16 v[136:139], a[168:171], a[16:19], v[136:139]
ds_read_b128 a[188:191], v4 offset:6144
v_mfma_f32_16x16x32_bf16 v[168:171], a[168:171], a[20:23], v[168:171]
v_mfma_f32_16x16x32_bf16 v[200:203], a[168:171], a[24:27], v[200:203]
buffer_load_dwordx2 v[114:115], v34, s[20:23], s47 offen offset:64 sc1
v_mfma_f32_16x16x32_bf16 v[232:235], a[168:171], a[28:31], v[232:235]
v_mfma_f32_16x16x32_bf16 v[236:239], a[172:175], a[28:31], v[236:239]
ds_read_b128 a[160:163], v3 offset:8192
v_mfma_f32_16x16x32_bf16 v[204:207], a[172:175], a[24:27], v[204:207]
s_mov_b32 s46, 16384
v_mfma_f32_16x16x32_bf16 v[172:175], a[172:175], a[20:23], v[172:175]
buffer_load_dwordx2 v[98:99], v36, s[8:11], s46 offen
v_mfma_f32_16x16x32_bf16 v[140:143], a[172:175], a[16:19], v[140:143]
s_waitcnt lgkmcnt(3)
v_mfma_f32_16x16x32_bf16 v[136:139], a[176:179], a[32:35], v[136:139]
ds_read_b128 a[164:167], v3 offset:10240
v_mfma_f32_16x16x32_bf16 v[168:171], a[176:179], a[36:39], v[168:171]
v_mfma_f32_16x16x32_bf16 v[200:203], a[176:179], a[40:43], v[200:203]
buffer_load_dwordx2 v[116:117], v34, s[20:23], s47 offen offset:128 sc1
v_mfma_f32_16x16x32_bf16 v[232:235], a[176:179], a[44:47], v[232:235]
v_mfma_f32_16x16x32_bf16 v[236:239], a[180:183], a[44:47], v[236:239]
ds_read_b128 a[168:171], v4 offset:8192
s_add_u32 m0, s7, 83968
v_mfma_f32_16x16x32_bf16 v[204:207], a[180:183], a[40:43], v[204:207]
s_xor_b32 s44, s98, 32768
v_mfma_f32_16x16x32_bf16 v[172:175], a[180:183], a[36:39], v[172:175]
buffer_load_dwordx4 v8, s[12:15], s44 offen lds
s_mov_b32 s46, 32768
v_mfma_f32_16x16x32_bf16 v[140:143], a[180:183], a[32:35], v[140:143]
buffer_load_dwordx2 v[100:101], v36, s[8:11], s46 offen
s_waitcnt lgkmcnt(3)
v_mfma_f32_16x16x32_bf16 v[136:139], a[184:187], a[48:51], v[136:139]
ds_read_b128 a[172:175], v4 offset:10240
v_mfma_f32_16x16x32_bf16 v[168:171], a[184:187], a[52:55], v[168:171]
v_mfma_f32_16x16x32_bf16 v[200:203], a[184:187], a[56:59], v[200:203]
buffer_load_dwordx2 v[118:119], v34, s[20:23], s47 offen offset:192 sc1
v_mfma_f32_16x16x32_bf16 v[232:235], a[184:187], a[60:63], v[232:235]
v_mfma_f32_16x16x32_bf16 v[236:239], a[188:191], a[60:63], v[236:239]
ds_read_b128 a[176:179], v3 offset:12288
v_mfma_f32_16x16x32_bf16 v[204:207], a[188:191], a[56:59], v[204:207]
s_add_u32 m0, s7, 84992
v_mfma_f32_16x16x32_bf16 v[172:175], a[188:191], a[52:55], v[172:175]
buffer_load_dwordx4 v9, s[12:15], s44 offen lds
s_mov_b32 s46, 49152
v_mfma_f32_16x16x32_bf16 v[140:143], a[188:191], a[48:51], v[140:143]
buffer_load_dwordx2 v[102:103], v36, s[8:11], s46 offen
s_waitcnt vmcnt(28) lgkmcnt(3)
v_mfma_f32_16x16x32_bf16 v[136:139], a[160:163], a[64:67], v[136:139]
ds_read_b128 a[180:183], v3 offset:14336
v_mfma_f32_16x16x32_bf16 v[168:171], a[160:163], a[68:71], v[168:171]
v_mfma_f32_16x16x32_bf16 v[200:203], a[160:163], a[72:75], v[200:203]
buffer_load_dwordx2 v[120:121], v34, s[20:23], s47 offen offset:256 sc1
v_mfma_f32_16x16x32_bf16 v[232:235], a[160:163], a[76:79], v[232:235]
v_mfma_f32_16x16x32_bf16 v[236:239], a[164:167], a[76:79], v[236:239]
ds_read_b128 a[184:187], v4 offset:12288
v_mfma_f32_16x16x32_bf16 v[204:207], a[164:167], a[72:75], v[204:207]
s_mov_b32 s46, 65536
v_mfma_f32_16x16x32_bf16 v[172:175], a[164:167], a[68:71], v[172:175]
buffer_load_dwordx2 v[104:105], v36, s[8:11], s46 offen
v_mfma_f32_16x16x32_bf16 v[140:143], a[164:167], a[64:67], v[140:143]
s_waitcnt vmcnt(25) lgkmcnt(3)
v_mfma_f32_16x16x32_bf16 v[136:139], a[168:171], a[80:83], v[136:139]
ds_read_b128 a[188:191], v4 offset:14336
v_mfma_f32_16x16x32_bf16 v[168:171], a[168:171], a[84:87], v[168:171]
v_mfma_f32_16x16x32_bf16 v[200:203], a[168:171], a[88:91], v[200:203]
buffer_load_dwordx2 v[122:123], v34, s[20:23], s47 offen offset:320 sc1
v_mfma_f32_16x16x32_bf16 v[232:235], a[168:171], a[92:95], v[232:235]
v_mfma_f32_16x16x32_bf16 v[236:239], a[172:175], a[92:95], v[236:239]
ds_read_b128 a[160:163], v10 offset:32768
v_mfma_f32_16x16x32_bf16 v[204:207], a[172:175], a[88:91], v[204:207]
s_mov_b32 s46, 81920
v_mfma_f32_16x16x32_bf16 v[172:175], a[172:175], a[84:87], v[172:175]
buffer_load_dwordx2 v[106:107], v36, s[8:11], s46 offen
v_mfma_f32_16x16x32_bf16 v[140:143], a[172:175], a[80:83], v[140:143]
s_waitcnt vmcnt(21) lgkmcnt(3)
v_mfma_f32_16x16x32_bf16 v[136:139], a[176:179], a[192:195], v[136:139]
ds_read_b128 a[164:167], v10 offset:34816
v_mfma_f32_16x16x32_bf16 v[168:171], a[176:179], a[196:199], v[168:171]
v_mfma_f32_16x16x32_bf16 v[200:203], a[176:179], a[200:203], v[200:203]
buffer_load_dwordx2 v[124:125], v34, s[20:23], s47 offen offset:384 sc1
v_mfma_f32_16x16x32_bf16 v[232:235], a[176:179], a[204:207], v[232:235]
v_mfma_f32_16x16x32_bf16 v[236:239], a[180:183], a[204:207], v[236:239]
ds_read_b128 a[168:171], v11 offset:32768
v_mfma_f32_16x16x32_bf16 v[204:207], a[180:183], a[200:203], v[204:207]
s_mov_b32 s46, 98304
v_mfma_f32_16x16x32_bf16 v[172:175], a[180:183], a[196:199], v[172:175]
buffer_load_dwordx2 v[108:109], v36, s[8:11], s46 offen
v_mfma_f32_16x16x32_bf16 v[140:143], a[180:183], a[192:195], v[140:143]
s_waitcnt vmcnt(17) lgkmcnt(3)
v_mfma_f32_16x16x32_bf16 v[136:139], a[184:187], a[208:211], v[136:139]
ds_read_b128 a[172:175], v11 offset:34816
v_mfma_f32_16x16x32_bf16 v[168:171], a[184:187], a[212:215], v[168:171]
v_mfma_f32_16x16x32_bf16 v[200:203], a[184:187], a[216:219], v[200:203]
buffer_load_dwordx2 v[126:127], v34, s[20:23], s47 offen offset:448 sc1
v_mfma_f32_16x16x32_bf16 v[232:235], a[184:187], a[220:223], v[232:235]
v_mfma_f32_16x16x32_bf16 v[236:239], a[188:191], a[220:223], v[236:239]
ds_read_b128 a[176:179], v10 offset:36864
v_mfma_f32_16x16x32_bf16 v[204:207], a[188:191], a[216:219], v[204:207]
s_mov_b32 s46, 114688
v_mfma_f32_16x16x32_bf16 v[172:175], a[188:191], a[212:215], v[172:175]
L_pg17:
s_cbranch_execz L_ret3
buffer_load_dwordx2 v[110:111], v36, s[8:11], s46 offen
v_mfma_f32_16x16x32_bf16 v[140:143], a[188:191], a[208:211], v[140:143]
s_waitcnt lgkmcnt(3)
v_mfma_f32_16x16x32_bf16 v[144:147], a[160:163], a[0:3], v[144:147]
ds_read_b128 a[180:183], v10 offset:38912
v_mfma_f32_16x16x32_bf16 v[176:179], a[160:163], a[4:7], v[176:179]
v_mfma_f32_16x16x32_bf16 v[208:211], a[160:163], a[8:11], v[208:211]
v_mfma_f32_16x16x32_bf16 v[240:243], a[160:163], a[12:15], v[240:243]
v_mfma_f32_16x16x32_bf16 v[244:247], a[164:167], a[12:15], v[244:247]
ds_read_b128 a[184:187], v11 offset:36864
v_mfma_f32_16x16x32_bf16 v[212:215], a[164:167], a[8:11], v[212:215]
v_mfma_f32_16x16x32_bf16 v[180:183], a[164:167], a[4:7], v[180:183]
v_mfma_f32_16x16x32_bf16 v[148:151], a[164:167], a[0:3], v[148:151]
s_waitcnt lgkmcnt(3)
v_mfma_f32_16x16x32_bf16 v[144:147], a[168:171], a[16:19], v[144:147]
ds_read_b128 a[188:191], v11 offset:38912
s_xor_b32 s45, s55, 8
v_mfma_f32_16x16x32_bf16 v[176:179], a[168:171], a[20:23], v[176:179]
s_mul_i32 s45, s45, 12288
s_add_u32 s45, s45, 33554432
v_mfma_f32_16x16x32_bf16 v[208:211], a[168:171], a[24:27], v[208:211]
v_cvt_pk_bf16_f32 v136, v136, v137
v_cvt_pk_bf16_f32 v137, v138, v139
v_mfma_f32_16x16x32_bf16 v[240:243], a[168:171], a[28:31], v[240:243]
v_cvt_pk_bf16_f32 v138, v140, v141
v_mfma_f32_16x16x32_bf16 v[244:247], a[172:175], a[28:31], v[244:247]
ds_read_b128 a[160:163], v10 offset:40960
v_cvt_pk_bf16_f32 v139, v142, v143
v_mfma_f32_16x16x32_bf16 v[212:215], a[172:175], a[24:27], v[212:215]
buffer_store_dwordx4 v[136:139], v2, s[20:23], s45 offen offset:0 sc1
v_mfma_f32_16x16x32_bf16 v[180:183], a[172:175], a[20:23], v[180:183]
v_cvt_pk_bf16_f32 v168, v168, v169
v_mfma_f32_16x16x32_bf16 v[148:151], a[172:175], a[16:19], v[148:151]
v_cvt_pk_bf16_f32 v169, v170, v171
s_waitcnt lgkmcnt(3)
v_mfma_f32_16x16x32_bf16 v[144:147], a[176:179], a[32:35], v[144:147]
ds_read_b128 a[164:167], v10 offset:43008
v_cvt_pk_bf16_f32 v170, v172, v173
v_mfma_f32_16x16x32_bf16 v[176:179], a[176:179], a[36:39], v[176:179]
v_cvt_pk_bf16_f32 v171, v174, v175
v_mfma_f32_16x16x32_bf16 v[208:211], a[176:179], a[40:43], v[208:211]
buffer_store_dwordx4 v[168:171], v2, s[20:23], s45 offen offset:1024 sc1
v_mfma_f32_16x16x32_bf16 v[240:243], a[176:179], a[44:47], v[240:243]
v_cvt_pk_bf16_f32 v200, v200, v201
v_cvt_pk_bf16_f32 v201, v202, v203
v_mfma_f32_16x16x32_bf16 v[244:247], a[180:183], a[44:47], v[244:247]
ds_read_b128 a[168:171], v11 offset:40960
v_cvt_pk_bf16_f32 v202, v204, v205
v_mfma_f32_16x16x32_bf16 v[212:215], a[180:183], a[40:43], v[212:215]
v_cvt_pk_bf16_f32 v203, v206, v207
v_mfma_f32_16x16x32_bf16 v[180:183], a[180:183], a[36:39], v[180:183]
buffer_store_dwordx4 v[200:203], v2, s[20:23], s45 offen offset:2048 sc1
v_mfma_f32_16x16x32_bf16 v[148:151], a[180:183], a[32:35], v[148:151]
v_cvt_pk_bf16_f32 v232, v232, v233
s_waitcnt lgkmcnt(3)
v_mfma_f32_16x16x32_bf16 v[144:147], a[184:187], a[48:51], v[144:147]
ds_read_b128 a[172:175], v11 offset:43008
v_cvt_pk_bf16_f32 v233, v234, v235
v_mfma_f32_16x16x32_bf16 v[176:179], a[184:187], a[52:55], v[176:179]
v_cvt_pk_bf16_f32 v234, v236, v237
v_mfma_f32_16x16x32_bf16 v[208:211], a[184:187], a[56:59], v[208:211]
v_cvt_pk_bf16_f32 v235, v238, v239
v_mfma_f32_16x16x32_bf16 v[240:243], a[184:187], a[60:63], v[240:243]
buffer_store_dwordx4 v[232:235], v2, s[20:23], s45 offen offset:3072 sc1
v_mfma_f32_16x16x32_bf16 v[244:247], a[188:191], a[60:63], v[244:247]
ds_read_b128 a[176:179], v10 offset:45056
v_mfma_f32_16x16x32_bf16 v[212:215], a[188:191], a[56:59], v[212:215]
v_mfma_f32_16x16x32_bf16 v[180:183], a[188:191], a[52:55], v[180:183]
v_mfma_f32_16x16x32_bf16 v[148:151], a[188:191], a[48:51], v[148:151]
s_waitcnt lgkmcnt(3)
v_mfma_f32_16x16x32_bf16 v[144:147], a[160:163], a[64:67], v[144:147]
ds_read_b128 a[180:183], v10 offset:47104
v_lshlrev_b32 v24, 16, v26
v_mfma_f32_16x16x32_bf16 v[176:179], a[160:163], a[68:71], v[176:179]
v_and_b32 v25, 0xffff0000, v26
v_lshlrev_b32 v26, 16, v27
v_mfma_f32_16x16x32_bf16 v[208:211], a[160:163], a[72:75], v[208:211]
v_and_b32 v27, 0xffff0000, v27
v_mfma_f32_16x16x32_bf16 v[240:243], a[160:163], a[76:79], v[240:243]
s_waitcnt vmcnt(21)
v_rcp_f32 v113, v113
v_mfma_f32_16x16x32_bf16 v[244:247], a[164:167], a[76:79], v[244:247]
ds_read_b128 a[184:187], v11 offset:45056
v_mfma_f32_16x16x32_bf16 v[212:215], a[164:167], a[72:75], v[212:215]
s_waitcnt vmcnt(20)
v_lshlrev_b32 v64, 16, v96
v_add_f32 v38, v64, v112
v_mfma_f32_16x16x32_bf16 v[180:183], a[164:167], a[68:71], v[180:183]
v_mul_f32 v39, v113, v24
v_mfma_f32_16x16x32_bf16 v[148:151], a[164:167], a[64:67], v[148:151]
v_fmac_f32 v64, v38, v39
s_waitcnt lgkmcnt(3)
v_mfma_f32_16x16x32_bf16 v[144:147], a[168:171], a[80:83], v[144:147]
ds_read_b128 a[188:191], v11 offset:47104
v_and_b32 v65, 0xffff0000, v96
v_mfma_f32_16x16x32_bf16 v[176:179], a[168:171], a[84:87], v[176:179]
v_add_f32 v38, v65, v112
v_mfma_f32_16x16x32_bf16 v[208:211], a[168:171], a[88:91], v[208:211]
v_mul_f32 v39, v113, v25
v_fmac_f32 v65, v38, v39
v_mfma_f32_16x16x32_bf16 v[240:243], a[168:171], a[92:95], v[240:243]
s_waitcnt vmcnt(13)
s_barrier
v_mfma_f32_16x16x32_bf16 v[244:247], a[172:175], a[92:95], v[244:247]
ds_read_b128 a[160:163], v10 offset:49152
v_lshlrev_b32_e64 v66, 16, v97
v_mfma_f32_16x16x32_bf16 v[212:215], a[172:175], a[88:91], v[212:215]
v_add_f32 v38, v66, v112
v_mfma_f32_16x16x32_bf16 v[180:183], a[172:175], a[84:87], v[180:183]
v_mul_f32 v39, v113, v26
v_fmac_f32_e64 v66, v38, v39
v_mfma_f32_16x16x32_bf16 v[148:151], a[172:175], a[80:83], v[148:151]
v_and_b32 v67, 0xffff0000, v97
s_waitcnt lgkmcnt(3)
v_mfma_f32_16x16x32_bf16 v[144:147], a[176:179], a[192:195], v[144:147]
ds_read_b128 a[164:167], v10 offset:51200
v_mfma_f32_16x16x32_bf16 v[176:179], a[176:179], a[196:199], v[176:179]
v_add_f32 v38, v67, v112
v_mul_f32 v39, v113, v27
v_mfma_f32_16x16x32_bf16 v[208:211], a[176:179], a[200:203], v[208:211]
v_fmac_f32 v67, v38, v39
v_mfma_f32_16x16x32_bf16 v[240:243], a[176:179], a[204:207], v[240:243]
v_rcp_f32_e64 v115, v115
v_mfma_f32_16x16x32_bf16 v[244:247], a[180:183], a[204:207], v[244:247]
ds_read_b128 a[168:171], v11 offset:49152
v_mfma_f32_16x16x32_bf16 v[212:215], a[180:183], a[200:203], v[212:215]
v_lshlrev_b32 v68, 16, v98
v_add_f32 v38, v68, v114
v_mfma_f32_16x16x32_bf16 v[180:183], a[180:183], a[196:199], v[180:183]
v_mul_f32_e64 v39, v115, v24
v_mfma_f32_16x16x32_bf16 v[148:151], a[180:183], a[192:195], v[148:151]
v_fmac_f32 v68, v38, v39
s_waitcnt lgkmcnt(3)
v_mfma_f32_16x16x32_bf16 v[144:147], a[184:187], a[208:211], v[144:147]
ds_read_b128 a[172:175], v11 offset:51200
v_and_b32 v69, 0xffff0000, v98
v_mfma_f32_16x16x32_bf16 v[176:179], a[184:187], a[212:215], v[176:179]
v_add_f32 v38, v69, v114
v_mfma_f32_16x16x32_bf16 v[208:211], a[184:187], a[216:219], v[208:211]
v_mul_f32 v39, v115, v25
v_fmac_f32 v69, v38, v39
v_mfma_f32_16x16x32_bf16 v[240:243], a[184:187], a[220:223], v[240:243]
v_lshlrev_b32 v70, 16, v99
v_mfma_f32_16x16x32_bf16 v[244:247], a[188:191], a[220:223], v[244:247]
ds_read_b128 a[176:179], v10 offset:53248
v_add_f32 v38, v70, v114
v_mfma_f32_16x16x32_bf16 v[212:215], a[188:191], a[216:219], v[212:215]
v_mul_f32 v39, v115, v26
v_mfma_f32_16x16x32_bf16 v[180:183], a[188:191], a[212:215], v[180:183]
v_fmac_f32_e64 v70, v38, v39
v_and_b32 v71, 0xffff0000, v99
v_mfma_f32_16x16x32_bf16 v[148:151], a[188:191], a[208:211], v[148:151]
s_waitcnt lgkmcnt(3)
v_mfma_f32_16x16x32_bf16 v[152:155], a[160:163], a[0:3], v[152:155]
ds_read_b128 a[180:183], v10 offset:55296
v_add_f32 v38, v71, v114
v_mfma_f32_16x16x32_bf16 v[184:187], a[160:163], a[4:7], v[184:187]
v_mul_f32 v39, v115, v27
v_fmac_f32 v71, v38, v39
v_mfma_f32_16x16x32_bf16 v[216:219], a[160:163], a[8:11], v[216:219]
v_rcp_f32 v117, v117
v_mfma_f32_16x16x32_bf16 v[248:251], a[160:163], a[12:15], v[248:251]
v_lshlrev_b32 v72, 16, v100
v_mfma_f32_16x16x32_bf16 v[252:255], a[164:167], a[12:15], v[252:255]
ds_read_b128 a[184:187], v11 offset:53248
v_mfma_f32_16x16x32_bf16 v[220:223], a[164:167], a[8:11], v[220:223]
v_add_f32 v38, v72, v116
v_mul_f32 v39, v117, v24
v_mfma_f32_16x16x32_bf16 v[188:191], a[164:167], a[4:7], v[188:191]
v_fmac_f32_e64 v72, v38, v39
v_mfma_f32_16x16x32_bf16 v[156:159], a[164:167], a[0:3], v[156:159]
v_and_b32 v73, 0xffff0000, v100
s_waitcnt lgkmcnt(3)
v_mfma_f32_16x16x32_bf16 v[152:155], a[168:171], a[16:19], v[152:155]
ds_read_b128 a[188:191], v11 offset:55296
s_xor_b32 s45, s55, 16
v_mfma_f32_16x16x32_bf16 v[184:187], a[168:171], a[20:23], v[184:187]
s_mul_i32 s45, s45, 12288
s_add_u32 s45, s45, 33558528
v_add_f32_e64 v38, v73, v116
v_mfma_f32_16x16x32_bf16 v[216:219], a[168:171], a[24:27], v[216:219]
v_cvt_pk_bf16_f32 v144, v144, v145
v_cvt_pk_bf16_f32 v145, v146, v147
v_mfma_f32_16x16x32_bf16 v[248:251], a[168:171], a[28:31], v[248:251]
v_cvt_pk_bf16_f32 v146, v148, v149
v_mfma_f32_16x16x32_bf16 v[252:255], a[172:175], a[28:31], v[252:255]
ds_read_b128 a[160:163], v10 offset:57344
v_cvt_pk_bf16_f32 v147, v150, v151
v_mfma_f32_16x16x32_bf16 v[220:223], a[172:175], a[24:27], v[220:223]
buffer_store_dwordx4 v[144:147], v2, s[20:23], s45 offen offset:0 sc1
v_mfma_f32_16x16x32_bf16 v[188:191], a[172:175], a[20:23], v[188:191]
v_cvt_pk_bf16_f32 v176, v176, v177
v_mul_f32 v39, v117, v25
v_mfma_f32_16x16x32_bf16 v[156:159], a[172:175], a[16:19], v[156:159]
v_cvt_pk_bf16_f32 v177, v178, v179
s_waitcnt lgkmcnt(3)
v_mfma_f32_16x16x32_bf16 v[152:155], a[176:179], a[32:35], v[152:155]
ds_read_b128 a[164:167], v10 offset:59392
v_cvt_pk_bf16_f32 v178, v180, v181
v_mfma_f32_16x16x32_bf16 v[184:187], a[176:179], a[36:39], v[184:187]
v_cvt_pk_bf16_f32 v179, v182, v183
v_fmac_f32_e64 v73, v38, v39
v_mfma_f32_16x16x32_bf16 v[216:219], a[176:179], a[40:43], v[216:219]
buffer_store_dwordx4 v[176:179], v2, s[20:23], s45 offen offset:1024 sc1
v_mfma_f32_16x16x32_bf16 v[248:251], a[176:179], a[44:47], v[248:251]
v_cvt_pk_bf16_f32 v208, v208, v209
v_cvt_pk_bf16_f32 v209, v210, v211
v_mfma_f32_16x16x32_bf16 v[252:255], a[180:183], a[44:47], v[252:255]
ds_read_b128 a[168:171], v11 offset:57344
v_cvt_pk_bf16_f32 v210, v212, v213
v_mfma_f32_16x16x32_bf16 v[220:223], a[180:183], a[40:43], v[220:223]
v_cvt_pk_bf16_f32 v211, v214, v215
v_lshlrev_b32_e64 v74, 16, v101
v_mfma_f32_16x16x32_bf16 v[188:191], a[180:183], a[36:39], v[188:191]
buffer_store_dwordx4 v[208:211], v2, s[20:23], s45 offen offset:2048 sc1
v_mfma_f32_16x16x32_bf16 v[156:159], a[180:183], a[32:35], v[156:159]
v_cvt_pk_bf16_f32 v240, v240, v241
s_waitcnt lgkmcnt(3)
v_mfma_f32_16x16x32_bf16 v[152:155], a[184:187], a[48:51], v[152:155]
ds_read_b128 a[172:175], v11 offset:59392
v_cvt_pk_bf16_f32 v241, v242, v243
v_mfma_f32_16x16x32_bf16 v[184:187], a[184:187], a[52:55], v[184:187]
v_cvt_pk_bf16_f32 v242, v244, v245
v_mfma_f32_16x16x32_bf16 v[216:219], a[184:187], a[56:59], v[216:219]
v_cvt_pk_bf16_f32 v243, v246, v247
v_add_f32 v38, v74, v116
v_mfma_f32_16x16x32_bf16 v[248:251], a[184:187], a[60:63], v[248:251]
buffer_store_dwordx4 v[240:243], v2, s[20:23], s45 offen offset:3072 sc1
v_mfma_f32_16x16x32_bf16 v[252:255], a[188:191], a[60:63], v[252:255]
ds_read_b128 a[176:179], v10 offset:61440
v_mul_f32 v39, v117, v26
v_mfma_f32_16x16x32_bf16 v[220:223], a[188:191], a[56:59], v[220:223]
v_fmac_f32 v74, v38, v39
v_mfma_f32_16x16x32_bf16 v[188:191], a[188:191], a[52:55], v[188:191]
v_and_b32 v75, 0xffff0000, v101
v_add_f32 v38, v75, v116
v_mfma_f32_16x16x32_bf16 v[156:159], a[188:191], a[48:51], v[156:159]
s_waitcnt lgkmcnt(3)
v_mfma_f32_16x16x32_bf16 v[152:155], a[160:163], a[64:67], v[152:155]
ds_read_b128 a[180:183], v10 offset:63488
v_mov_b32 v48, 1
v_mfma_f32_16x16x32_bf16 v[184:187], a[160:163], a[68:71], v[184:187]
v_mul_f32 v39, v117, v27
v_fmac_f32_e64 v75, v38, v39
v_mfma_f32_16x16x32_bf16 v[216:219], a[160:163], a[72:75], v[216:219]
s_waitcnt vmcnt(4)
buffer_store_dword v48, v49, s[20:23], s63 offen sc1
v_mfma_f32_16x16x32_bf16 v[248:251], a[160:163], a[76:79], v[248:251]
v_rcp_f32 v119, v119
v_mfma_f32_16x16x32_bf16 v[252:255], a[164:167], a[76:79], v[252:255]
ds_read_b128 a[184:187], v11 offset:61440
v_mfma_f32_16x16x32_bf16 v[220:223], a[164:167], a[72:75], v[220:223]
v_lshlrev_b32_e64 v76, 16, v102
v_mfma_f32_16x16x32_bf16 v[188:191], a[164:167], a[68:71], v[188:191]
v_add_f32 v38, v76, v118
v_mul_f32 v39, v119, v24
v_mfma_f32_16x16x32_bf16 v[156:159], a[164:167], a[64:67], v[156:159]
v_fmac_f32 v76, v38, v39
s_waitcnt lgkmcnt(3)
v_mfma_f32_16x16x32_bf16 v[152:155], a[168:171], a[80:83], v[152:155]
ds_read_b128 a[188:191], v11 offset:63488
v_mfma_f32_16x16x32_bf16 v[184:187], a[168:171], a[84:87], v[184:187]
v_and_b32 v77, 0xffff0000, v102
v_add_f32 v38, v77, v118
v_mfma_f32_16x16x32_bf16 v[216:219], a[168:171], a[88:91], v[216:219]
v_mul_f32 v39, v119, v25
v_mfma_f32_16x16x32_bf16 v[248:251], a[168:171], a[92:95], v[248:251]
v_fmac_f32 v77, v38, v39
v_lshlrev_b32 v78, 16, v103
v_mfma_f32_16x16x32_bf16 v[252:255], a[172:175], a[92:95], v[252:255]
ds_read_b128 a[160:163], v3 offset:16384
v_mfma_f32_16x16x32_bf16 v[220:223], a[172:175], a[88:91], v[220:223]
v_add_f32 v38, v78, v118
v_mul_f32 v39, v119, v26
v_mfma_f32_16x16x32_bf16 v[188:191], a[172:175], a[84:87], v[188:191]
v_fmac_f32 v78, v38, v39
v_mfma_f32_16x16x32_bf16 v[156:159], a[172:175], a[80:83], v[156:159]
v_and_b32 v79, 0xffff0000, v103
s_waitcnt lgkmcnt(3)
v_mfma_f32_16x16x32_bf16 v[152:155], a[176:179], a[192:195], v[152:155]
ds_read_b128 a[164:167], v3 offset:18432
v_add_f32 v38, v79, v118
v_mfma_f32_16x16x32_bf16 v[184:187], a[176:179], a[196:199], v[184:187]
v_mul_f32 v39, v119, v27
v_mfma_f32_16x16x32_bf16 v[216:219], a[176:179], a[200:203], v[216:219]
v_fmac_f32 v79, v38, v39
v_mfma_f32_16x16x32_bf16 v[248:251], a[176:179], a[204:207], v[248:251]
v_rcp_f32 v121, v121
v_mfma_f32_16x16x32_bf16 v[252:255], a[180:183], a[204:207], v[252:255]
ds_read_b128 a[168:171], v4 offset:16384
v_lshlrev_b32 v80, 16, v104
v_mfma_f32_16x16x32_bf16 v[220:223], a[180:183], a[200:203], v[220:223]
v_add_f32 v38, v80, v120
v_mfma_f32_16x16x32_bf16 v[188:191], a[180:183], a[196:199], v[188:191]
v_mul_f32 v39, v121, v24
v_fmac_f32_e64 v80, v38, v39
v_mfma_f32_16x16x32_bf16 v[156:159], a[180:183], a[192:195], v[156:159]
s_waitcnt lgkmcnt(3)
v_mfma_f32_16x16x32_bf16 v[152:155], a[184:187], a[208:211], v[152:155]
ds_read_b128 a[172:175], v4 offset:18432
v_and_b32 v81, 0xffff0000, v104
v_mfma_f32_16x16x32_bf16 v[184:187], a[184:187], a[212:215], v[184:187]
v_add_f32 v38, v81, v120
v_mul_f32 v39, v121, v25
v_mfma_f32_16x16x32_bf16 v[216:219], a[184:187], a[216:219], v[216:219]
v_fmac_f32 v81, v38, v39
v_mfma_f32_16x16x32_bf16 v[248:251], a[184:187], a[220:223], v[248:251]
v_lshlrev_b32 v82, 16, v105
v_add_f32_e64 v38, v82, v120
v_mfma_f32_16x16x32_bf16 v[252:255], a[188:191], a[220:223], v[252:255]
ds_read_b128 a[176:179], v3 offset:20480
v_mfma_f32_16x16x32_bf16 v[220:223], a[188:191], a[216:219], v[220:223]
v_mul_f32 v39, v121, v26
v_fmac_f32 v82, v38, v39
v_mfma_f32_16x16x32_bf16 v[188:191], a[188:191], a[212:215], v[188:191]
v_and_b32 v83, 0xffff0000, v105
v_mfma_f32_16x16x32_bf16 v[156:159], a[188:191], a[208:211], v[156:159]
v_add_f32 v38, v83, v120
s_waitcnt lgkmcnt(3)
v_mfma_f32_16x16x32_bf16 v[128:131], a[160:163], a[0:3], v[128:131]
ds_read_b128 a[180:183], v3 offset:22528
v_mul_f32 v39, v121, v27
v_mfma_f32_16x16x32_bf16 v[160:163], a[160:163], a[4:7], v[160:163]
v_fmac_f32 v83, v38, v39
v_mfma_f32_16x16x32_bf16 v[192:195], a[160:163], a[8:11], v[192:195]
v_rcp_f32 v123, v123
v_mfma_f32_16x16x32_bf16 v[224:227], a[160:163], a[12:15], v[224:227]
v_lshlrev_b32 v84, 16, v106
v_mfma_f32_16x16x32_bf16 v[228:231], a[164:167], a[12:15], v[228:231]
ds_read_b128 a[184:187], v4 offset:20480
v_add_f32 v38, v84, v122
v_mfma_f32_16x16x32_bf16 v[196:199], a[164:167], a[8:11], v[196:199]
v_mul_f32 v39, v123, v24
v_mfma_f32_16x16x32_bf16 v[164:167], a[164:167], a[4:7], v[164:167]
v_fmac_f32 v84, v38, v39
v_and_b32 v85, 0xffff0000, v106
v_mfma_f32_16x16x32_bf16 v[132:135], a[164:167], a[0:3], v[132:135]
s_waitcnt lgkmcnt(3)
v_mfma_f32_16x16x32_bf16 v[128:131], a[168:171], a[16:19], v[128:131]
ds_read_b128 a[188:191], v4 offset:22528
s_xor_b32 s45, s55, 24
v_mfma_f32_16x16x32_bf16 v[160:163], a[168:171], a[20:23], v[160:163]
s_mul_i32 s45, s45, 12288
s_add_u32 s45, s45, 33562624
v_add_f32 v38, v85, v122
v_mfma_f32_16x16x32_bf16 v[192:195], a[168:171], a[24:27], v[192:195]
v_cvt_pk_bf16_f32 v152, v152, v153
v_cvt_pk_bf16_f32 v153, v154, v155
v_mfma_f32_16x16x32_bf16 v[224:227], a[168:171], a[28:31], v[224:227]
v_cvt_pk_bf16_f32 v154, v156, v157
v_mul_f32_e64 v39, v123, v25
v_mfma_f32_16x16x32_bf16 v[228:231], a[172:175], a[28:31], v[228:231]
ds_read_b128 a[160:163], v3 offset:24576
v_cvt_pk_bf16_f32 v155, v158, v159
v_mfma_f32_16x16x32_bf16 v[196:199], a[172:175], a[24:27], v[196:199]
buffer_store_dwordx4 v[152:155], v2, s[20:23], s45 offen offset:0 sc1
v_mfma_f32_16x16x32_bf16 v[164:167], a[172:175], a[20:23], v[164:167]
v_cvt_pk_bf16_f32 v184, v184, v185
v_fmac_f32_e64 v85, v38, v39
v_mfma_f32_16x16x32_bf16 v[132:135], a[172:175], a[16:19], v[132:135]
v_cvt_pk_bf16_f32 v185, v186, v187
s_waitcnt lgkmcnt(3)
v_mfma_f32_16x16x32_bf16 v[128:131], a[176:179], a[32:35], v[128:131]
ds_read_b128 a[164:167], v3 offset:26624
v_cvt_pk_bf16_f32 v186, v188, v189
v_mfma_f32_16x16x32_bf16 v[160:163], a[176:179], a[36:39], v[160:163]
v_cvt_pk_bf16_f32 v187, v190, v191
v_mfma_f32_16x16x32_bf16 v[192:195], a[176:179], a[40:43], v[192:195]
buffer_store_dwordx4 v[184:187], v2, s[20:23], s45 offen offset:1024 sc1
v_mfma_f32_16x16x32_bf16 v[224:227], a[176:179], a[44:47], v[224:227]
v_cvt_pk_bf16_f32 v216, v216, v217
v_cvt_pk_bf16_f32 v217, v218, v219
v_mfma_f32_16x16x32_bf16 v[228:231], a[180:183], a[44:47], v[228:231]
ds_read_b128 a[168:171], v4 offset:24576
v_cvt_pk_bf16_f32 v218, v220, v221
v_mfma_f32_16x16x32_bf16 v[196:199], a[180:183], a[40:43], v[196:199]
v_cvt_pk_bf16_f32 v219, v222, v223
v_lshlrev_b32 v86, 16, v107
v_mfma_f32_16x16x32_bf16 v[164:167], a[180:183], a[36:39], v[164:167]
buffer_store_dwordx4 v[216:219], v2, s[20:23], s45 offen offset:2048 sc1
v_mfma_f32_16x16x32_bf16 v[132:135], a[180:183], a[32:35], v[132:135]
v_cvt_pk_bf16_f32 v248, v248, v249
s_waitcnt lgkmcnt(3)
v_mfma_f32_16x16x32_bf16 v[128:131], a[184:187], a[48:51], v[128:131]
ds_read_b128 a[172:175], v4 offset:26624
v_cvt_pk_bf16_f32 v249, v250, v251
v_mfma_f32_16x16x32_bf16 v[160:163], a[184:187], a[52:55], v[160:163]
v_cvt_pk_bf16_f32 v250, v252, v253
v_add_f32 v38, v86, v122
v_mfma_f32_16x16x32_bf16 v[192:195], a[184:187], a[56:59], v[192:195]
v_cvt_pk_bf16_f32 v251, v254, v255
v_mfma_f32_16x16x32_bf16 v[224:227], a[184:187], a[60:63], v[224:227]
buffer_store_dwordx4 v[248:251], v2, s[20:23], s45 offen offset:3072 sc1
v_mfma_f32_16x16x32_bf16 v[228:231], a[188:191], a[60:63], v[228:231]
ds_read_b128 a[176:179], v3 offset:28672
v_mul_f32 v39, v123, v26
v_mfma_f32_16x16x32_bf16 v[196:199], a[188:191], a[56:59], v[196:199]
v_fmac_f32 v86, v38, v39
v_and_b32 v87, 0xffff0000, v107
v_mfma_f32_16x16x32_bf16 v[164:167], a[188:191], a[52:55], v[164:167]
v_add_f32 v38, v87, v122
v_mfma_f32_16x16x32_bf16 v[132:135], a[188:191], a[48:51], v[132:135]
v_mul_f32_e64 v39, v123, v27
s_waitcnt lgkmcnt(3)
v_mfma_f32_16x16x32_bf16 v[128:131], a[160:163], a[64:67], v[128:131]
ds_read_b128 a[180:183], v3 offset:30720
v_mov_b32 v48, 2
v_mfma_f32_16x16x32_bf16 v[160:163], a[160:163], a[68:71], v[160:163]
v_fmac_f32 v87, v38, v39
v_mfma_f32_16x16x32_bf16 v[192:195], a[160:163], a[72:75], v[192:195]
s_waitcnt vmcnt(5)
buffer_store_dword v48, v49, s[20:23], s63 offen sc1
v_mfma_f32_16x16x32_bf16 v[224:227], a[160:163], a[76:79], v[224:227]
v_rcp_f32 v125, v125
v_mfma_f32_16x16x32_bf16 v[228:231], a[164:167], a[76:79], v[228:231]
ds_read_b128 a[184:187], v4 offset:28672
v_mfma_f32_16x16x32_bf16 v[196:199], a[164:167], a[72:75], v[196:199]
v_lshlrev_b32 v88, 16, v108
v_add_f32 v38, v88, v124
v_mfma_f32_16x16x32_bf16 v[164:167], a[164:167], a[68:71], v[164:167]
v_mul_f32 v39, v125, v24
v_mfma_f32_16x16x32_bf16 v[132:135], a[164:167], a[64:67], v[132:135]
v_fmac_f32_e64 v88, v38, v39
s_waitcnt lgkmcnt(3)
v_mfma_f32_16x16x32_bf16 v[128:131], a[168:171], a[80:83], v[128:131]
ds_read_b128 a[188:191], v4 offset:30720
v_and_b32 v89, 0xffff0000, v108
v_mfma_f32_16x16x32_bf16 v[160:163], a[168:171], a[84:87], v[160:163]
v_add_f32 v38, v89, v124
v_mfma_f32_16x16x32_bf16 v[192:195], a[168:171], a[88:91], v[192:195]
v_mul_f32 v39, v125, v25
v_fmac_f32 v89, v38, v39
v_mfma_f32_16x16x32_bf16 v[224:227], a[168:171], a[92:95], v[224:227]
v_lshlrev_b32 v90, 16, v109
v_mfma_f32_16x16x32_bf16 v[228:231], a[172:175], a[92:95], v[228:231]
v_add_f32 v38, v90, v124
v_mul_f32 v39, v125, v26
v_mfma_f32_16x16x32_bf16 v[196:199], a[172:175], a[88:91], v[196:199]
v_fmac_f32_e64 v90, v38, v39
v_mfma_f32_16x16x32_bf16 v[164:167], a[172:175], a[84:87], v[164:167]
v_and_b32 v91, 0xffff0000, v109
v_mfma_f32_16x16x32_bf16 v[132:135], a[172:175], a[80:83], v[132:135]
v_add_f32 v38, v91, v124
s_waitcnt lgkmcnt(2)
v_mfma_f32_16x16x32_bf16 v[128:131], a[176:179], a[192:195], v[128:131]
v_mul_f32 v39, v125, v27
v_fmac_f32 v91, v38, v39
v_mfma_f32_16x16x32_bf16 v[160:163], a[176:179], a[196:199], v[160:163]
v_rcp_f32_e64 v127, v127
v_mfma_f32_16x16x32_bf16 v[192:195], a[176:179], a[200:203], v[192:195]
v_lshlrev_b32 v92, 16, v110
v_mfma_f32_16x16x32_bf16 v[224:227], a[176:179], a[204:207], v[224:227]
v_add_f32 v38, v92, v126
v_mfma_f32_16x16x32_bf16 v[228:231], a[180:183], a[204:207], v[228:231]
v_mul_f32 v39, v127, v24
v_mfma_f32_16x16x32_bf16 v[196:199], a[180:183], a[200:203], v[196:199]
v_fmac_f32 v92, v38, v39
v_and_b32 v93, 0xffff0000, v110
v_mfma_f32_16x16x32_bf16 v[164:167], a[180:183], a[196:199], v[164:167]
v_add_f32 v38, v93, v126
v_mfma_f32_16x16x32_bf16 v[132:135], a[180:183], a[192:195], v[132:135]
v_mul_f32 v39, v127, v25
s_waitcnt lgkmcnt(0)
v_mfma_f32_16x16x32_bf16 v[128:131], a[184:187], a[208:211], v[128:131]
v_fmac_f32 v93, v38, v39
v_lshlrev_b32 v94, 16, v111
v_mfma_f32_16x16x32_bf16 v[160:163], a[184:187], a[212:215], v[160:163]
v_add_f32 v38, v94, v126
v_mfma_f32_16x16x32_bf16 v[192:195], a[184:187], a[216:219], v[192:195]
v_mul_f32_e64 v39, v127, v26
v_mfma_f32_16x16x32_bf16 v[224:227], a[184:187], a[220:223], v[224:227]
v_fmac_f32 v94, v38, v39
v_and_b32 v95, 0xffff0000, v111
v_mfma_f32_16x16x32_bf16 v[228:231], a[188:191], a[220:223], v[228:231]
v_add_f32 v38, v95, v126
v_mfma_f32_16x16x32_bf16 v[196:199], a[188:191], a[216:219], v[196:199]
v_mul_f32 v39, v127, v27
v_fmac_f32 v95, v38, v39
v_mfma_f32_16x16x32_bf16 v[164:167], a[188:191], a[212:215], v[164:167]
buffer_load_dword v50, v47, s[20:23], 0 offen sc1
v_mfma_f32_16x16x32_bf16 v[132:135], a[188:191], a[208:211], v[132:135]
v_mov_b32 v48, 3
s_waitcnt vmcnt(2)
buffer_store_dword v48, v49, s[20:23], s63 offen sc1
s_waitcnt vmcnt(1)
v_cmp_lt_i32 vcc, v50, v40
s_nop 1
s_cbranch_vccz L_ok25
s_mov_b32 s48, 200000
L_spin26:
buffer_load_dword v50, v47, s[20:23], 0 offen sc1
s_sub_u32 s48, s48, 1
s_waitcnt vmcnt(0)
s_cbranch_scc1 L_done27
v_cmp_lt_i32 vcc, v50, v40
s_nop 1
s_cbranch_vccnz L_spin26
L_done27:
L_ok25:
s_add_u32 s46, s62, 0
buffer_load_dwordx4 a[96:99], v2, s[20:23], s46 offen offset:0 sc1
buffer_load_dwordx4 a[100:103], v2, s[20:23], s46 offen offset:1024 sc1
buffer_load_dwordx4 a[104:107], v2, s[20:23], s46 offen offset:2048 sc1
buffer_load_dwordx4 a[108:111], v2, s[20:23], s46 offen offset:3072 sc1
s_add_u32 s46, s62, 4096
buffer_load_dwordx4 a[112:115], v2, s[20:23], s46 offen offset:0 sc1
buffer_load_dwordx4 a[116:119], v2, s[20:23], s46 offen offset:1024 sc1
buffer_load_dwordx4 a[120:123], v2, s[20:23], s46 offen offset:2048 sc1
buffer_load_dwordx4 a[124:127], v2, s[20:23], s46 offen offset:3072 sc1
s_mov_b32 s48, 200000
L_spin28:
buffer_load_dword v50, v5, s[20:23], s60 offen sc1
s_sub_u32 s48, s48, 1
s_waitcnt vmcnt(0)
s_cbranch_scc1 L_done29
v_cmp_gt_i32 vcc, 3, v50
s_nop 1
s_cbranch_vccnz L_spin28
L_done29:
s_add_u32 s46, s62, 8192
buffer_load_dwordx4 a[128:131], v2, s[20:23], s46 offen offset:0 sc1
buffer_load_dwordx4 a[132:135], v2, s[20:23], s46 offen offset:1024 sc1
buffer_load_dwordx4 a[136:139], v2, s[20:23], s46 offen offset:2048 sc1
buffer_load_dwordx4 a[140:143], v2, s[20:23], s46 offen offset:3072 sc1
v_mfma_f32_16x16x32_bf16 v[128:131], v[30:33], a[96:99], v[128:131]
v_mfma_f32_16x16x32_bf16 v[132:135], v[28:31], a[96:99], v[132:135]
v_mfma_f32_16x16x32_bf16 v[160:163], v[30:33], a[100:103], v[160:163]
v_mfma_f32_16x16x32_bf16 v[164:167], v[28:31], a[100:103], v[164:167]
v_mfma_f32_16x16x32_bf16 v[192:195], v[30:33], a[104:107], v[192:195]
v_mfma_f32_16x16x32_bf16 v[196:199], v[28:31], a[104:107], v[196:199]
v_mfma_f32_16x16x32_bf16 v[224:227], v[30:33], a[108:111], v[224:227]
v_mfma_f32_16x16x32_bf16 v[228:231], v[28:31], a[108:111], v[228:231]
v_mfma_f32_16x16x32_bf16 v[128:131], v[30:33], a[112:115], v[128:131]
v_mfma_f32_16x16x32_bf16 v[132:135], v[28:31], a[112:115], v[132:135]
v_mfma_f32_16x16x32_bf16 v[160:163], v[30:33], a[116:119], v[160:163]
v_mfma_f32_16x16x32_bf16 v[164:167], v[28:31], a[116:119], v[164:167]
v_mfma_f32_16x16x32_bf16 v[192:195], v[30:33], a[120:123], v[192:195]
v_mfma_f32_16x16x32_bf16 v[196:199], v[28:31], a[120:123], v[196:199]
v_mfma_f32_16x16x32_bf16 v[224:227], v[30:33], a[124:127], v[224:227]
v_mfma_f32_16x16x32_bf16 v[228:231], v[28:31], a[124:127], v[228:231]
s_waitcnt vmcnt(3)
v_mfma_f32_16x16x32_bf16 v[128:131], v[30:33], a[128:131], v[128:131]
v_mfma_f32_16x16x32_bf16 v[132:135], v[28:31], a[128:131], v[132:135]
s_waitcnt vmcnt(2)
v_mfma_f32_16x16x32_bf16 v[160:163], v[30:33], a[132:135], v[160:163]
v_mfma_f32_16x16x32_bf16 v[164:167], v[28:31], a[132:135], v[164:167]
s_waitcnt vmcnt(1)
v_mfma_f32_16x16x32_bf16 v[192:195], v[30:33], a[136:139], v[192:195]
v_mfma_f32_16x16x32_bf16 v[196:199], v[28:31], a[136:139], v[196:199]
s_waitcnt vmcnt(0)
v_mfma_f32_16x16x32_bf16 v[224:227], v[30:33], a[140:143], v[224:227]
v_mfma_f32_16x16x32_bf16 v[228:231], v[28:31], a[140:143], v[228:231]
ds_write_b128 v41, v[128:131] offset:0
ds_write_b128 v42, v[132:135] offset:0
ds_write_b128 v41, v[160:163] offset:128
ds_write_b128 v42, v[164:167] offset:128
ds_write_b128 v41, v[192:195] offset:256
ds_write_b128 v42, v[196:199] offset:256
s_nop 0
ds_write_b128 v41, v[224:227] offset:384
ds_write_b128 v42, v[228:231] offset:384
ds_read_b128 v[136:139], v43 offset:0
ds_read_b128 v[140:143], v44 offset:1024
ds_read_b128 v[168:171], v45 offset:2048
ds_read_b128 v[172:175], v46 offset:3072
ds_read_b128 v[200:203], v43 offset:4096
ds_read_b128 v[204:207], v44 offset:5120
ds_read_b128 v[232:235], v45 offset:6144
ds_read_b128 v[236:239], v46 offset:7168
s_waitcnt lgkmcnt(7)
v_pk_add_f32 v[136:137], v[136:137], v[64:65]
v_pk_add_f32 v[138:139], v[138:139], v[66:67]
s_mov_b32 s45, 0
buffer_store_dwordx4 v[136:139], v37, s[24:27], s45 offen sc1 nt
s_waitcnt lgkmcnt(6)
v_pk_add_f32 v[140:141], v[140:141], v[68:69]
v_pk_add_f32 v[142:143], v[142:143], v[70:71]
s_mov_b32 s45, 32768
buffer_store_dwordx4 v[140:143], v37, s[24:27], s45 offen sc1 nt
s_waitcnt lgkmcnt(5)
v_pk_add_f32 v[168:169], v[168:169], v[72:73]
v_pk_add_f32 v[170:171], v[170:171], v[74:75]
s_mov_b32 s45, 65536
buffer_store_dwordx4 v[168:171], v37, s[24:27], s45 offen sc1 nt
s_waitcnt lgkmcnt(4)
v_pk_add_f32 v[172:173], v[172:173], v[76:77]
v_pk_add_f32 v[174:175], v[174:175], v[78:79]
s_mov_b32 s45, 98304
buffer_store_dwordx4 v[172:175], v37, s[24:27], s45 offen sc1 nt
s_waitcnt lgkmcnt(3)
v_pk_add_f32 v[200:201], v[200:201], v[80:81]
v_pk_add_f32 v[202:203], v[202:203], v[82:83]
s_mov_b32 s45, 131072
buffer_store_dwordx4 v[200:203], v37, s[24:27], s45 offen sc1 nt
s_waitcnt lgkmcnt(2)
v_pk_add_f32 v[204:205], v[204:205], v[84:85]
v_pk_add_f32 v[206:207], v[206:207], v[86:87]
s_mov_b32 s45, 163840
buffer_store_dwordx4 v[204:207], v37, s[24:27], s45 offen sc1 nt
s_waitcnt lgkmcnt(1)
v_pk_add_f32 v[232:233], v[232:233], v[88:89]
L_pg18:
s_cbranch_execz L_ret3
v_pk_add_f32 v[234:235], v[234:235], v[90:91]
s_mov_b32 s45, 196608
buffer_store_dwordx4 v[232:235], v37, s[24:27], s45 offen sc1 nt
s_waitcnt lgkmcnt(0)
v_pk_add_f32 v[236:237], v[236:237], v[92:93]
v_pk_add_f32 v[238:239], v[238:239], v[94:95]
s_mov_b32 s45, 229376
buffer_store_dwordx4 v[236:239], v37, s[24:27], s45 offen sc1 nt
L_end:
s_endpgm
L_slow1:
s_mov_b32 s48, 200000
L_lp3:
s_waitcnt vmcnt(0)
s_nop 7
global_load_dword v57, v56, s[92:93] sc1
s_waitcnt vmcnt(0)
v_cmp_gt_u32 vcc, 128, v57
s_nop 1
s_cbranch_vccz L_back2
s_sleep 1
s_sub_u32 s48, s48, 1
s_cmp_lg_u32 s48, 0
s_cbranch_scc1 L_lp3
s_branch L_back2
L_slow4:
s_mov_b32 s48, 200000
L_lp6:
s_waitcnt vmcnt(0)
s_nop 7
buffer_load_dwordx4 v[52:55], v60, s[20:23], s60 offen sc1
buffer_load_dwordx4 v[56:59], v60, s[20:23], s60 offen offset:16 sc1
s_waitcnt vmcnt(0)
v_max_u32_e64 v61, v52, v53
v_max3_u32 v61, v61, v54, v55
v_max3_u32 v61, v61, v56, v57
v_max3_u32 v61, v61, v58, v59
v_cmp_eq_u32 vcc, -1, v61
s_nop 1
s_cbranch_vccz L_back5
s_sleep 1
s_sub_u32 s48, s48, 1
s_cmp_lg_u32 s48, 0
s_cbranch_scc1 L_lp6
s_branch L_back5
L_slow7:
s_mov_b32 s48, 200000
L_lp9:
s_waitcnt vmcnt(0)
s_nop 7
buffer_load_dword v36, v44, s[20:23], s46 offen offset:0 sc1
buffer_load_dword v37, v44, s[20:23], s46 offen offset:1024 sc1
buffer_load_dword v38, v44, s[20:23], s46 offen offset:2048 sc1
buffer_load_dword v39, v44, s[20:23], s46 offen offset:3072 sc1
buffer_load_dword v40, v44, s[20:23], s47 offen offset:0 sc1
buffer_load_dword v41, v44, s[20:23], s47 offen offset:1024 sc1
buffer_load_dword v42, v44, s[20:23], s47 offen offset:2048 sc1
buffer_load_dword v43, v44, s[20:23], s47 offen offset:3072 sc1
s_waitcnt vmcnt(0)
v_max_u32 v45, v36, v37
v_max3_u32 v45, v45, v38, v39
v_max3_u32 v45, v45, v40, v41
v_max3_u32 v45, v45, v42, v43
v_cmp_eq_u32 vcc, -1, v45
s_nop 1
s_cbranch_vccz L_back8
s_sleep 1
s_sub_u32 s48, s48, 1
s_cmp_lg_u32 s48, 0
s_cbranch_scc1 L_lp9
s_branch L_back8
L_slow10:
s_mov_b32 s48, 200000
L_lp12:
s_waitcnt vmcnt(0)
s_nop 7
buffer_load_dword v4, v12, s[20:23], s50 offen offset:0 sc1
buffer_load_dword v5, v12, s[20:23], s51 offen offset:0 sc1
buffer_load_dword v18, v12, s[20:23], s50 offen offset:64 sc1
buffer_load_dword v19, v12, s[20:23], s51 offen offset:64 sc1
s_waitcnt vmcnt(0)
v_max_u32 v13, v4, v5
v_max3_u32 v13, v13, v18, v19
v_cmp_eq_u32 vcc, -1, v13
s_nop 1
s_cbranch_vccz L_back11
s_sleep 1
s_sub_u32 s48, s48, 1
s_cmp_lg_u32 s48, 0
s_cbranch_scc1 L_lp12
s_branch L_back11
L_slow13:
s_mov_b32 s48, 200000
L_lp15:
s_waitcnt vmcnt(0)
s_nop 7
buffer_load_dword v15, v14, s[20:23], s60 offen sc1
s_waitcnt vmcnt(0)
v_cmp_ne_u32 vcc, 1, v15
s_nop 1
s_cbranch_vccz L_back14
s_sleep 1
s_sub_u32 s48, s48, 1
s_cmp_lg_u32 s48, 0
s_cbranch_scc1 L_lp15
s_branch L_back14
L_slow16:
s_mov_b32 s48, 200000
L_lp18:
s_waitcnt vmcnt(0)
s_nop 7
buffer_load_dwordx4 v[192:195], v13, s[40:43], s50 offen offset:256 sc1
buffer_load_dwordx4 v[196:199], v13, s[40:43], s50 offen offset:512 sc1
buffer_load_dwordx4 v[200:203], v13, s[40:43], s50 offen offset:768 sc1
buffer_load_dwordx4 v[204:207], v13, s[40:43], s50 offen offset:1024 sc1
buffer_load_dwordx4 v[208:211], v13, s[40:43], s50 offen offset:1280 sc1
buffer_load_dwordx4 v[212:215], v13, s[40:43], s50 offen offset:1536 sc1
buffer_load_dwordx4 v[216:219], v13, s[40:43], s50 offen offset:1792 sc1
buffer_load_dwordx4 v[220:223], v13, s[40:43], s50 offen offset:2048 sc1
s_waitcnt vmcnt(0)
v_max_u32_e64 v168, v192, v193
v_max3_u32 v168, v168, v194, v195
v_max3_u32 v168, v168, v196, v197
v_max3_u32 v168, v168, v198, v199
v_max3_u32 v168, v168, v200, v201
v_max3_u32 v168, v168, v202, v203
v_max3_u32 v168, v168, v204, v205
v_max3_u32 v168, v168, v206, v207
v_max3_u32 v168, v168, v208, v209
v_max3_u32 v168, v168, v210, v211
v_max3_u32 v168, v168, v212, v213
v_max3_u32 v168, v168, v214, v215
v_max3_u32 v168, v168, v216, v217
v_max3_u32 v168, v168, v218, v219
v_max3_u32 v168, v168, v220, v221
v_max3_u32 v168, v168, v222, v223
v_cmp_eq_u32 vcc, -1, v168
s_nop 1
s_cbranch_vccz L_back17
s_sleep 1
s_sub_u32 s48, s48, 1
s_cmp_lg_u32 s48, 0
s_cbranch_scc1 L_lp18
s_branch L_back17
L_slow19:
s_mov_b32 s48, 200000
L_lp21:
s_waitcnt vmcnt(0)
s_nop 7
buffer_load_dword v49, v48, s[20:23], s51 offen sc1
s_waitcnt vmcnt(0)
v_cmp_gt_i32 vcc, 1, v49
s_nop 1
s_cbranch_vccz L_back20
s_sleep 1
s_sub_u32 s48, s48, 1
s_cmp_lg_u32 s48, 0
s_cbranch_scc1 L_lp21
s_branch L_back20
L_slow22:
s_mov_b32 s48, 200000
L_lp24:
s_waitcnt vmcnt(0)
s_nop 7
buffer_load_dword v49, v48, s[20:23], s51 offen sc1
s_waitcnt vmcnt(0)
v_cmp_gt_i32 vcc, 2, v49
s_nop 1
s_cbranch_vccz L_back23
s_sleep 1
s_sub_u32 s48, s48, 1
s_cmp_lg_u32 s48, 0
s_cbranch_scc1 L_lp24
s_branch L_back23
L_codeend:
.section .rodata,"a"
.p2align 6
.amdhsa_kernel parallel_sum__ssm_conv_s5__geglu_ffn__prompt_kernel
  .amdhsa_next_free_vgpr 512
  .amdhsa_next_free_sgpr 102
  .amdhsa_accum_offset 256
  .amdhsa_group_segment_fixed_size 0
  .amdhsa_kernarg_size 128
  .amdhsa_user_sgpr_count 2
  .amdhsa_user_sgpr_kernarg_segment_ptr 1
  .amdhsa_system_sgpr_workgroup_id_x 1
.end_amdhsa_kernel
```
